```python
import torch

def _softmax(x, axis=-1):
    return torch.softmax(x, dim=axis)
def _gelu(x):
    return torch.nn.functional.gelu(x, approximate="tanh")
def _silu(x):
    return torch.nn.functional.silu(x)
def _sigmoid(x):
    return torch.sigmoid(x)
def _layernorm(x, axis=-1, eps=1e-5):
    m = x.mean(dim=axis, keepdim=True)
    v = x.var(dim=axis, keepdim=True, unbiased=False)
    return (x - m) / torch.sqrt(v + eps)
def _scatter_add(tgt, idx, src, axis=0):
    return tgt.clone().index_add_(axis, idx, src)
def _segment_sum(src, seg, n):
    out = torch.zeros((n,) + src.shape[1:], dtype=src.dtype)
    return out.index_add_(0, seg, src)
def _pad(x, pw):
    flat = tuple(v for pair in reversed(pw) for v in pair)
    return torch.nn.functional.pad(x, flat)

kernel_name = 'parallel_sum__spectral_fnet__geglu_ffn__prompt'

def setup_inputs():

    _w = (lambda a: (lambda t: t.to(torch.bfloat16) if t.is_floating_point() else t)(torch.as_tensor(a)))
    def _A_setup():
        B, S, D = 1, 2048, 512
        ns = torch.arange(S)[:, None] * torch.arange(S)[None, :]
        nd = torch.arange(D)[:, None] * torch.arange(D)[None, :]
        Ws_re = torch.cos(-2.0 * torch.pi * ns / S).to(float)
        Ws_im = torch.sin(-2.0 * torch.pi * ns / S).to(float)
        Wd_re = torch.cos(-2.0 * torch.pi * nd / D).to(float)
        Wd_im = torch.sin(-2.0 * torch.pi * nd / D).to(float)
        return {
            "x": _w((lambda *s: torch.randn(*s, dtype=torch.bfloat16) * 0.05)(B, S, D)),
            "dft_seq_re": _w(Ws_re),
            "dft_seq_im": _w(Ws_im),
            "dft_hid_re": _w(Wd_re),
            "dft_hid_im": _w(Wd_im),
        }
    _A_in = _A_setup()

    def _B_setup():
        B, S, D, F = 1, 2048, 512, 1792
        return {
            "x": _w((lambda *s: torch.randn(*s, dtype=torch.bfloat16) * 0.05)(B, S, D)),
            "w_gate": _w((lambda *s: torch.randn(*s, dtype=torch.bfloat16) * 0.2)(D, F)),
            "w_up": _w((lambda *s: torch.randn(*s, dtype=torch.bfloat16) * 0.2)(D, F)),
            "w_down": _w((lambda *s: torch.randn(*s, dtype=torch.bfloat16) * 0.2)(F, D)),
        }
    _B_in = _B_setup()

    return {
        "A_x": _A_in["x"],
        "A_dft_seq_re": _A_in["dft_seq_re"],
        "A_dft_seq_im": _A_in["dft_seq_im"],
        "A_dft_hid_re": _A_in["dft_hid_re"],
        "A_dft_hid_im": _A_in["dft_hid_im"],
        "B_x": _B_in["x"],
        "B_w_gate": _B_in["w_gate"],
        "B_w_up": _B_in["w_up"],
        "B_w_down": _B_in["w_down"],
    }

def reference(A_x, A_dft_seq_re, A_dft_seq_im, A_dft_hid_re, A_dft_hid_im, B_x, B_w_gate, B_w_up, B_w_down):
    def _A_ref(x, dft_seq_re, dft_seq_im, dft_hid_re, dft_hid_im):
        a = torch.einsum("bsd,ed->bse", x, dft_hid_re)
        b = torch.einsum("bsd,ed->bse", x, dft_hid_im)
        y = torch.einsum("ts,bse->bte", dft_seq_re, a) - torch.einsum("ts,bse->bte", dft_seq_im, b)
        return y

    def _B_ref(x, w_gate, w_up, w_down):
        return (_gelu(x @ w_gate) * (x @ w_up)) @ w_down

    x = A_x
    xn = _layernorm(x, axis=-1)
    return x + _A_ref(xn, A_dft_seq_re, A_dft_seq_im, A_dft_hid_re, A_dft_hid_im) + _B_ref(xn, B_w_gate, B_w_up, B_w_down)
```

```asm
; @launch grid=(256,1,1) block=(256,1,1) lds=163840
.amdgcn_target "amdgcn-amd-amdhsa--gfx950"
.text
.globl parallel_sum__spectral_fnet__geglu_ffn__prompt_kernel
.p2align 8
.type parallel_sum__spectral_fnet__geglu_ffn__prompt_kernel,@function
parallel_sum__spectral_fnet__geglu_ffn__prompt_kernel:
  s_load_dwordx16 s[16:31], s[0:1], 0
  s_load_dwordx8 s[32:39], s[0:1], 64
  s_cmp_ge_u32 s2, 0x100
  s_cbranch_scc1 Lc_end
  s_bfe_u32 s10, s2, 0x20006
  s_getpc_b64 s[88:89]
Lc_pc:
  s_bfe_u32 s8, s2, 0x30003
  s_mul_i32 s8, s8, 0xd80
  s_mov_b32 s9, Lc_body0-Lc_pc-8192
  s_cmp_eq_u32 s10, 1
  s_cselect_b32 s9, Lc_body1-Lc_pc-8192, s9
  s_cmp_eq_u32 s10, 2
  s_cselect_b32 s9, Lc_body2-Lc_pc-8192, s9
  s_cmp_eq_u32 s10, 3
  s_cselect_b32 s9, Lc_body3-Lc_pc-8192, s9
  s_add_u32 s8, s8, s9
  v_min_u32 v61, 0x5b, v0
  v_lshlrev_b32 v61, 7, v61
  v_add_u32 v62, s8, v61
  v_min_u32 v61, Lc_body0-Lc_pc, v61
  v_cmp_gt_u32 vcc, 64, v0
  v_cndmask_b32 v61, v62, v61, vcc
  v_min_u32 v61, Lc_code_end-Lc_pc-4, v61
  global_load_dword v49, v61, s[88:89]
  s_memrealtime s[14:15]
  v_lshrrev_b32 v60, 6, v0
  v_and_b32 v0, 63, v0
  v_readfirstlane_b32 s3, v60
  s_and_b32 s8, s2, 7
  s_lshr_b32 s9, s2, 3
  s_and_b32 s10, s8, 1
  s_lshl_b32 s10, s10, 3
  s_and_b32 s11, s9, 7
  s_add_u32 s4, s10, s11
  s_lshr_b32 s6, s8, 1
  s_lshr_b32 s7, s9, 3
  s_lshl_b32 s5, s6, 2
  s_add_u32 s5, s5, s7
  s_lshl_b32 s72, s3, 12
  s_lshl_b32 s73, s3, 11
  s_lshl_b32 s74, s3, 15
  s_lshl_b32 s75, s3, 13
  v_lshrrev_b32 v60, 3, v0
  v_and_b32 v61, 7, v0
  v_lshrrev_b32 v62, 4, v0
  v_xor_b32 v63, v61, v62
  v_xor_b32 v64, 4, v63
  v_lshlrev_b32 v63, 4, v63
  v_lshlrev_b32 v64, 4, v64
  v_lshlrev_b32 v65, 10, v60
  v_add_u32 v2, v65, v63
  v_add_u32 v3, v65, v64
  v_add_u32 v3, 0x1c00, v3
  v_add_u32 v4, v65, v63
  v_add_u32 v4, 0x3800, v4
  v_add_u32 v5, v65, v64
  v_add_u32 v5, 0x5400, v5
  s_lshl_b32 s76, s4, 17
  s_add_u32 s76, s76, s74
  s_and_b32 s8, s5, 7
  s_lshl_b32 s77, s8, 16
  s_lshl_b32 s9, s3, 14
  s_add_u32 s77, s77, s9
  s_mul_i32 s8, s7, 1
  s_add_u32 s8, s8, s4
  s_and_b32 s13, s8, 7
  s_lshl_b32 s12, s13, 7
  s_waitcnt lgkmcnt(0)
  s_mov_b32 s94, s12
  s_mov_b32 s40, s16
  s_and_b32 s41, s17, 0xffff
  s_mov_b32 s42, 0x200000
  s_mov_b32 s43, 0x20000
  s_add_u32 m0, s75, 0
  s_add_u32 s95, s76, s94
  buffer_load_dwordx4 v2, s[40:43], s95 offen lds
  buffer_load_dwordx4 v3, s[40:43], s95 offen offset:1024 lds
  buffer_load_dwordx4 v4, s[40:43], s95 offen offset:2048 lds
  buffer_load_dwordx4 v5, s[40:43], s95 offen offset:3072 lds
  s_cmp_ge_u32 s5, 8
  s_cselect_b32 s44, s24, s22
  s_cselect_b32 s45, s25, s23
  s_and_b32 s45, s45, 0xffff
  s_mov_b32 s46, 0x80000
  s_mov_b32 s47, 0x20000
  s_add_u32 m0, s73, 0x10000
  s_add_u32 s95, s77, s94
  buffer_load_dwordx4 v2, s[44:47], s95 offen lds
  buffer_load_dwordx4 v3, s[44:47], s95 offen offset:1024 lds
  s_add_u32 m0, s75, 0x1000
  s_add_u32 s95, s94, 0x80
  s_and_b32 s95, s95, 0x3ff
  s_add_u32 s95, s95, s76
  buffer_load_dwordx4 v2, s[40:43], s95 offen lds
  buffer_load_dwordx4 v3, s[40:43], s95 offen offset:1024 lds
  s_cmp_ge_u32 s5, 8
  s_cselect_b32 s84, 0x80000000, 0
  s_cmp_ge_u32 s3, 2
  s_cselect_b32 s48, s30, s28
  s_cselect_b32 s49, s31, s29
  s_and_b32 s49, s49, 0xffff
  s_mov_b32 s50, 0x1c0000
  s_mov_b32 s51, 0x20000
  s_cmp_ge_u32 s6, 2
  s_cselect_b32 s52, s20, s18
  s_cselect_b32 s53, s21, s19
  s_and_b32 s53, s53, 0xffff
  s_mov_b32 s54, 0x800000
  s_mov_b32 s55, 0x20000
  s_mov_b32 s56, s32
  s_and_b32 s57, s33, 0xffff
  s_mov_b32 s58, 0x1c0000
  s_mov_b32 s59, 0x20000
  s_mov_b32 s60, s38
  s_and_b32 s61, s39, 0xffff
  s_mov_b32 s62, 0x1500000
  s_mov_b32 s63, 0x20000
  s_mov_b32 s64, s34
  s_and_b32 s65, s35, 0xffff
  s_mov_b32 s66, 0x200000
  s_mov_b32 s67, 0x20000
  s_mov_b32 s68, s36
  s_and_b32 s69, s37, 0xffff
  s_mov_b32 s70, 0x100
  s_mov_b32 s71, 0x20000
  s_mov_b32 s19, s13
  s_or_b32 s8, s2, s3
  s_or_b32 s14, s14, 1
  v_or_b32 v68, s8, v0
  v_mov_b32 v66, s14
  v_mov_b32 v67, s15
  v_lshlrev_b32 v68, 8, v68
  buffer_store_dwordx2 v[66:67], v68, s[68:71], 0 offen sc1
  v_lshlrev_b32 v1, 4, v0
  v_and_b32 v67, 31, v0
  v_lshrrev_b32 v68, 5, v0
  v_bfe_u32 v69, v0, 1, 3
  v_xor_b32 v69, v69, v68
  v_lshlrev_b32 v67, 7, v67
  s_add_u32 s8, s3, 0
  s_and_b32 s8, s8, 3
  s_lshl_b32 s9, s8, 1
  s_mul_i32 s10, s8, 0xe00
  v_xor_b32 v70, s9, v69
  v_lshl_add_u32 v18, v70, 4, v67
  v_add_u32 v14, s75, v18
  v_add_u32 v18, 0x10000, v18
  s_add_u32 s8, s3, 1
  s_and_b32 s8, s8, 3
  s_lshl_b32 s9, s8, 1
  s_mul_i32 s11, s8, 0xe00
  v_xor_b32 v70, s9, v69
  v_lshl_add_u32 v19, v70, 4, v67
  v_add_u32 v15, s75, v19
  v_add_u32 v19, 0x10000, v19
  s_add_u32 s8, s3, 2
  s_and_b32 s8, s8, 3
  s_lshl_b32 s9, s8, 1
  s_mul_i32 s12, s8, 0xe00
  v_xor_b32 v70, s9, v69
  v_lshl_add_u32 v20, v70, 4, v67
  v_add_u32 v16, s75, v20
  v_add_u32 v20, 0x10000, v20
  s_add_u32 s8, s3, 3
  s_and_b32 s8, s8, 3
  s_lshl_b32 s9, s8, 1
  s_mul_i32 s13, s8, 0xe00
  v_xor_b32 v70, s9, v69
  v_lshl_add_u32 v21, v70, 4, v67
  v_add_u32 v17, s75, v21
  v_add_u32 v21, 0x10000, v21
  v_bfe_u32 v70, v0, 4, 1
  v_mul_u32_u24 v71, 0x3880, v70
  v_bfe_u32 v70, v0, 2, 2
  v_lshl_add_u32 v70, v68, 3, v70
  v_mul_u32_u24 v70, 0xe0, v70
  v_add_u32 v71, v71, v70
  v_and_b32 v70, 3, v0
  v_lshl_add_u32 v71, v70, 3, v71
  v_add_u32 v71, 0x20000, v71
  v_add_u32 v26, s10, v71
  v_add_u32 v27, s11, v71
  v_add_u32 v28, s12, v71
  v_add_u32 v29, s13, v71
  v_and_b32 v47, 31, v0
  v_lshlrev_b32 v47, 4, v47
  v_lshl_add_u32 v48, v68, 4, v47
  v_add_u32 v48, v48, v47
  s_mov_b32 s99, 0x3f803f80
  s_and_b32 s8, s3, 1
  s_mul_i32 s8, s8, 0x1c0
  v_add_u32 v70, s8, v0
  v_mul_u32_u24 v71, 0x124a, v70
  v_lshrrev_b32 v71, 16, v71
  v_mul_u32_u24 v69, 14, v71
  v_sub_u32 v69, v70, v69
  v_lshlrev_b32 v69, 4, v69
  v_mul_u32_u24 v71, 0xe00, v71
  v_add_u32 v7, v71, v69
  v_add_u32 v70, s8, v0
  v_add_u32 v70, 64, v70
  v_mul_u32_u24 v71, 0x124a, v70
  v_lshrrev_b32 v71, 16, v71
  v_mul_u32_u24 v69, 14, v71
  v_sub_u32 v69, v70, v69
  v_lshlrev_b32 v69, 4, v69
  v_mul_u32_u24 v71, 0xe00, v71
  v_add_u32 v8, v71, v69
  v_subrev_u32 v8, 0x400, v8
  v_add_u32 v70, s8, v0
  v_add_u32 v70, 0x80, v70
  v_mul_u32_u24 v71, 0x124a, v70
  v_lshrrev_b32 v71, 16, v71
  v_mul_u32_u24 v69, 14, v71
  v_sub_u32 v69, v70, v69
  v_lshlrev_b32 v69, 4, v69
  v_mul_u32_u24 v71, 0xe00, v71
  v_add_u32 v9, v71, v69
  v_subrev_u32 v9, 0x800, v9
  v_add_u32 v70, s8, v0
  v_add_u32 v70, 0xc0, v70
  v_mul_u32_u24 v71, 0x124a, v70
  v_lshrrev_b32 v71, 16, v71
  v_mul_u32_u24 v69, 14, v71
  v_sub_u32 v69, v70, v69
  v_lshlrev_b32 v69, 4, v69
  v_mul_u32_u24 v71, 0xe00, v71
  v_add_u32 v10, v71, v69
  v_subrev_u32 v10, 0xc00, v10
  v_add_u32 v70, s8, v0
  v_add_u32 v70, 0x100, v70
  v_mul_u32_u24 v71, 0x124a, v70
  v_lshrrev_b32 v71, 16, v71
  v_mul_u32_u24 v69, 14, v71
  v_sub_u32 v69, v70, v69
  v_lshlrev_b32 v69, 4, v69
  v_mul_u32_u24 v71, 0xe00, v71
  v_add_u32 v11, v71, v69
  v_add_u32 v70, s8, v0
  v_add_u32 v70, 0x140, v70
  v_mul_u32_u24 v71, 0x124a, v70
  v_lshrrev_b32 v71, 16, v71
  v_mul_u32_u24 v69, 14, v71
  v_sub_u32 v69, v70, v69
  v_lshlrev_b32 v69, 4, v69
  v_mul_u32_u24 v71, 0xe00, v71
  v_add_u32 v12, v71, v69
  v_subrev_u32 v12, 0x400, v12
  v_add_u32 v70, s8, v0
  v_add_u32 v70, 0x180, v70
  v_mul_u32_u24 v71, 0x124a, v70
  v_lshrrev_b32 v71, 16, v71
  v_mul_u32_u24 v69, 14, v71
  v_sub_u32 v69, v70, v69
  v_lshlrev_b32 v69, 4, v69
  v_mul_u32_u24 v71, 0xe00, v71
  v_add_u32 v13, v71, v69
  v_subrev_u32 v13, 0x800, v13
  s_mul_i32 s78, s5, 0xe0
  s_and_b32 s8, s3, 1
  s_mul_i32 s8, s8, 0x1c00
  s_cmp_ge_u32 s3, 2
  s_cselect_b32 s83, 0x3880, 0
  s_add_u32 s83, s83, s8
  v_lshlrev_b32 v65, 12, v60
  v_add_u32 v22, v65, v63
  v_add_u32 v23, v65, v64
  v_add_u32 v23, 0x7c00, v23
  v_add_u32 v24, v65, v63
  v_add_u32 v24, 0xf800, v24
  v_add_u32 v25, v65, v64
  v_add_u32 v25, 0x17400, v25
  v_mov_b32 v52, 0
  v_mov_b32 v53, 0
  v_mov_b32 v54, 0
  v_mov_b32 v55, 0
  v_mov_b32 v56, 0
  v_mov_b32 v57, 0
  v_mov_b32 v58, 0
  v_mov_b32 v59, 0
  s_add_u32 m0, s75, 0x1000
  s_add_u32 s95, s94, 0x80
  s_and_b32 s95, s95, 0x3ff
  s_add_u32 s95, s95, s76
  buffer_load_dwordx4 v4, s[40:43], s95 offen offset:2048 lds
  buffer_load_dwordx4 v5, s[40:43], s95 offen offset:3072 lds
  s_add_u32 m0, s73, 0x12000
  s_add_u32 s95, s94, 0x80
  s_and_b32 s95, s95, 0x3ff
  s_add_u32 s95, s95, s77
  buffer_load_dwordx4 v2, s[44:47], s95 offen lds
  buffer_load_dwordx4 v3, s[44:47], s95 offen offset:1024 lds
  s_add_u32 m0, s75, 0x8000
  s_add_u32 s95, s94, 0x100
  s_and_b32 s95, s95, 0x3ff
  s_add_u32 s95, s95, s76
  buffer_load_dwordx4 v2, s[40:43], s95 offen lds
  buffer_load_dwordx4 v3, s[40:43], s95 offen offset:1024 lds
  buffer_load_dwordx4 v4, s[40:43], s95 offen offset:2048 lds
  buffer_load_dwordx4 v5, s[40:43], s95 offen offset:3072 lds
  s_and_b32 s8, s6, 1
  s_lshr_b32 s9, s6, 1
  v_lshrrev_b32 v51, 1, v0
  v_lshlrev_b32 v51, 12, v51
  v_and_b32 v33, 1, v0
  v_lshl_add_u32 v51, v33, 7, v51
  s_lshl_b32 s85, s5, 18
  s_lshl_b32 s11, s4, 13
  s_add_u32 s85, s85, s11
  s_add_u32 s85, s85, s73
  s_lshl_b32 s10, s4, 4
  s_add_u32 s10, s10, s5
  s_lshl_b32 s10, s10, 7
  s_add_u32 s10, s10, 0x1400000
  v_min_u32 v33, 1, v0
  v_or_b32 v33, s3, v33
  v_lshlrev_b32 v33, 26, v33
  v_add_u32 v33, s10, v33
  s_lshl_b32 s20, s5, 1
  s_lshr_b32 s10, s4, 3
  s_add_u32 s20, s20, s10
  s_lshl_b32 s20, s20, 13
  s_add_u32 s20, s20, 0x1440000
  s_xor_b32 s10, s6, s3
  s_lshl_b32 s11, s4, 2
  s_add_u32 s10, s10, s11
  s_lshl_b32 s80, s10, 17
  s_lshl_b32 s11, s8, 11
  s_add_u32 s80, s80, s11
  s_mul_i32 s82, s10, 0x1c000
  s_mul_i32 s11, s6, 0x6000
  s_add_u32 s82, s82, s11
  s_add_u32 s82, s82, 0x400000
  s_mul_i32 s10, s7, 0
  s_mul_i32 s11, s4, 1
  s_add_u32 s10, s10, s11
  s_and_b32 s10, s10, 7
  s_lshl_b32 s98, s10, 8
  s_lshl_b32 s100, s10, 13
  s_mov_b32 s24, s7
  s_and_b32 s8, s6, 1
  s_lshr_b32 s9, s6, 1
  s_lshl_b32 s10, s9, 4
  s_add_u32 s10, s10, s3
  s_lshl_b32 s11, s7, 2
  s_add_u32 s10, s10, s11
  s_lshl_b32 s79, s10, 17
  s_lshl_b32 s11, s8, 16
  s_add_u32 s79, s79, s11
  v_and_b32 v36, 7, v0
  v_lshlrev_b32 v36, 4, v36
  v_bfe_u32 v37, v0, 3, 1
  v_add_u32 v36, v36, v37
  s_lshl_b32 s10, s8, 7
  s_lshl_b32 s11, s9, 3
  s_add_u32 s10, s10, s11
  s_lshl_b32 s11, s7, 1
  s_add_u32 s10, s10, s11
  v_add_u32 v36, s10, v36
  v_and_b32 v37, 7, v0
  v_lshlrev_b32 v37, 4, v37
  s_and_b32 s10, s4, 8
  s_lshl_b32 s10, s10, 4
  s_add_u32 s10, s10, s5
  v_add_u32 v37, s10, v37
  v_lshlrev_b32 v37, 7, v37
  v_add_u32 v32, 0x1410000, v37
  v_lshlrev_b32 v36, 7, v36
  v_add_u32 v30, 0x1400000, v36
  v_add_u32 v37, 0x1400000, v37
  v_and_b32 v36, 16, v0
  v_cmp_eq_u32 vcc, 0, v36
  s_nop 1
  v_cndmask_b32 v30, v37, v30, vcc
  v_and_b32 v36, 15, v0
  s_lshl_b32 s10, s4, 4
  v_add_u32 v36, s10, v36
  v_lshlrev_b32 v36, 7, v36
  v_add_u32 v31, 0x1408000, v36
  s_lshr_b32 s10, s2, 3
  s_lshl_b32 s10, s10, 2
  s_add_u32 s10, s10, s3
  s_mul_i32 s11, s10, 0xc00
  s_mul_i32 s13, s6, 0x60000
  s_add_u32 s11, s11, s13
  v_min_u32 v6, 23, v0
  v_lshlrev_b32 v6, 7, v6
  v_add_u32 v6, s11, v6
  s_mul_i32 s11, s10, 0x800
  s_add_u32 s11, s11, 0x17f000
  v_min_u32 v36, 47, v0
  v_lshlrev_b32 v36, 7, v36
  v_add_u32 v36, s11, v36
  v_cmp_gt_u32 vcc, 32, v0
  s_nop 1
  v_cndmask_b32 v6, v36, v6, vcc
  s_and_b32 s11, s3, 1
  s_lshl_b32 s11, s11, 15
  s_lshl_b32 s12, s7, 8
  s_add_u32 s16, s11, s12
  s_lshr_b32 s11, s3, 1
  s_lshl_b32 s11, s11, 7
  s_add_u32 s16, s16, s11
  s_mul_i32 s81, s6, 0x60000
  s_add_u32 s81, s81, s16
  s_add_u32 s16, s16, 0x180000
  s_mul_i32 s101, s7, 1
  s_lshl_b32 s10, s4, 2
  s_add_u32 s10, s10, s6
  s_lshl_b32 s93, s10, 15
  s_mul_i32 s17, s10, 0x1c000
  s_mul_i32 s11, s3, 0x1000
  s_add_u32 s17, s17, s11
  s_add_u32 s17, s17, 0x418000
  s_add_u32 s93, s93, s12
  s_lshl_b32 s11, s3, 6
  s_add_u32 s93, s93, s11
  s_lshl_b32 s10, s4, 2
  s_add_u32 s10, s10, s3
  s_mul_i32 s86, s10, 0x1c000
  s_mul_i32 s11, s5, 0x1c00
  s_add_u32 s86, s86, s11
  s_add_u32 s86, s86, 0x400000
  s_lshl_b32 s10, s4, 2
  s_add_u32 s10, s10, s7
  s_lshl_b32 s10, s10, 17
  s_add_u32 s10, s10, s73
  s_add_u32 s10, s10, 0xc00000
  s_lshl_b32 s11, s6, 15
  s_add_u32 s87, s10, s11
  s_lshl_b32 s11, s6, 13
  s_add_u32 s10, s10, s11
  s_xor_b32 s11, s6, 1
  s_lshl_b32 s11, s11, 15
  s_add_u32 s90, s10, s11
  s_xor_b32 s11, s6, 2
  s_lshl_b32 s11, s11, 15
  s_add_u32 s91, s10, s11
  s_xor_b32 s11, s6, 3
  s_lshl_b32 s11, s11, 15
  s_add_u32 s92, s10, s11
  s_add_u32 m0, s75, 0x9000
  s_add_u32 s95, s94, 0x180
  s_and_b32 s95, s95, 0x3ff
  s_add_u32 s95, s95, s76
  buffer_load_dwordx4 v2, s[40:43], s95 offen lds
  buffer_load_dwordx4 v3, s[40:43], s95 offen offset:1024 lds
  buffer_load_dwordx4 v4, s[40:43], s95 offen offset:2048 lds
  buffer_load_dwordx4 v5, s[40:43], s95 offen offset:3072 lds
  s_add_u32 m0, s73, 0x14000
  s_add_u32 s95, s94, 0x100
  s_and_b32 s95, s95, 0x3ff
  s_add_u32 s95, s95, s77
  buffer_load_dwordx4 v2, s[44:47], s95 offen lds
  buffer_load_dwordx4 v3, s[44:47], s95 offen offset:1024 lds
  s_add_u32 m0, s73, 0x16000
  s_add_u32 s95, s94, 0x180
  s_and_b32 s95, s95, 0x3ff
  s_add_u32 s95, s95, s77
  buffer_load_dwordx4 v2, s[44:47], s95 offen lds
  buffer_load_dwordx4 v3, s[44:47], s95 offen offset:1024 lds
  v_mov_b32 v60, 0
  v_mov_b32 v61, 0
  v_mov_b32 v62, 0
  v_mov_b32 v63, 0
  s_bfe_u32 s10, s2, 0x20006
  s_cmp_eq_u32 s10, 1
  s_cbranch_scc1 Lc_body1
  s_cmp_eq_u32 s10, 2
  s_cbranch_scc1 Lc_body2
  s_cmp_eq_u32 s10, 3
  s_cbranch_scc1 Lc_body3
  Lc_body0:
  s_waitcnt vmcnt(14)
  ds_read_b128 v[72:75], v14
  ds_read_b128 v[76:79], v15
  ds_read_b128 v[80:83], v16
  ds_read_b128 v[84:87], v17
  ds_read_b128 v[88:91], v14 offset:4096
  ds_read_b128 v[92:95], v15 offset:4096
  ds_read_b128 v[96:99], v16 offset:4096
  ds_read_b128 v[100:103], v17 offset:4096
  ds_read_b128 a[128:131], v14
  ds_read_b128 a[144:147], v14 offset:4096
  ds_read_b128 a[132:135], v15
  ds_read_b128 a[136:139], v16
  ds_read_b128 a[140:143], v17
  ds_read_b128 a[148:151], v15 offset:4096
  ds_read_b128 a[152:155], v16 offset:4096
  ds_read_b128 a[156:159], v17 offset:4096
  s_waitcnt vmcnt(12)
  s_barrier
  ds_read_b128 v[136:139], v18
  ds_read_b128 v[140:143], v18 offset:4096
  ds_read_b128 v[144:147], v18 offset:8192
  s_waitcnt lgkmcnt(3)
  s_add_u32 m0, s75, 0
  s_add_u32 s95, s94, 0x200
  s_and_b32 s95, s95, 0x3ff
  s_add_u32 s95, s95, s76
  buffer_load_dwordx4 v2, s[40:43], s95 offen lds
  buffer_load_dwordx4 v3, s[40:43], s95 offen offset:1024 lds
  buffer_load_dwordx4 v4, s[40:43], s95 offen offset:2048 lds
  buffer_load_dwordx4 v5, s[40:43], s95 offen offset:3072 lds
  s_add_u32 m0, s75, 0x1000
  s_add_u32 s95, s94, 0x280
  s_and_b32 s95, s95, 0x3ff
  v_dot2c_f32_bf16 v60, s99, v72
  v_dot2c_f32_bf16 v62, v72, v72
  v_dot2c_f32_bf16 v61, s99, v73
  v_dot2c_f32_bf16 v63, v73, v73
  v_dot2c_f32_bf16 v60, s99, v74
  v_dot2c_f32_bf16 v62, v74, v74
  v_dot2c_f32_bf16 v61, s99, v75
  v_dot2c_f32_bf16 v63, v75, v75
  v_dot2c_f32_bf16 v60, s99, v76
  v_dot2c_f32_bf16 v62, v76, v76
  v_dot2c_f32_bf16 v61, s99, v77
  v_dot2c_f32_bf16 v63, v77, v77
  v_dot2c_f32_bf16 v60, s99, v78
  v_dot2c_f32_bf16 v62, v78, v78
  v_dot2c_f32_bf16 v61, s99, v79
  v_dot2c_f32_bf16 v63, v79, v79
  v_dot2c_f32_bf16 v60, s99, v80
  v_dot2c_f32_bf16 v62, v80, v80
  v_dot2c_f32_bf16 v61, s99, v81
  v_dot2c_f32_bf16 v63, v81, v81
  v_dot2c_f32_bf16 v60, s99, v82
  v_dot2c_f32_bf16 v62, v82, v82
  v_dot2c_f32_bf16 v61, s99, v83
  v_dot2c_f32_bf16 v63, v83, v83
  v_dot2c_f32_bf16 v60, s99, v84
  v_dot2c_f32_bf16 v62, v84, v84
  v_dot2c_f32_bf16 v61, s99, v85
  v_dot2c_f32_bf16 v63, v85, v85
  v_dot2c_f32_bf16 v60, s99, v86
  v_dot2c_f32_bf16 v62, v86, v86
  v_dot2c_f32_bf16 v61, s99, v87
  v_dot2c_f32_bf16 v63, v87, v87
  v_dot2c_f32_bf16 v60, s99, v88
  v_dot2c_f32_bf16 v62, v88, v88
  v_dot2c_f32_bf16 v61, s99, v89
  v_dot2c_f32_bf16 v63, v89, v89
  v_dot2c_f32_bf16 v60, s99, v90
  v_dot2c_f32_bf16 v62, v90, v90
  v_dot2c_f32_bf16 v61, s99, v91
  v_dot2c_f32_bf16 v63, v91, v91
  v_dot2c_f32_bf16 v60, s99, v92
  v_dot2c_f32_bf16 v62, v92, v92
  v_dot2c_f32_bf16 v61, s99, v93
  v_dot2c_f32_bf16 v63, v93, v93
  v_dot2c_f32_bf16 v60, s99, v94
  v_dot2c_f32_bf16 v62, v94, v94
  v_dot2c_f32_bf16 v61, s99, v95
  v_dot2c_f32_bf16 v63, v95, v95
  v_dot2c_f32_bf16 v60, s99, v96
  v_dot2c_f32_bf16 v62, v96, v96
  v_dot2c_f32_bf16 v61, s99, v97
  v_dot2c_f32_bf16 v63, v97, v97
  v_dot2c_f32_bf16 v60, s99, v98
  v_dot2c_f32_bf16 v62, v98, v98
  v_dot2c_f32_bf16 v61, s99, v99
  v_dot2c_f32_bf16 v63, v99, v99
  v_dot2c_f32_bf16 v60, s99, v100
  v_dot2c_f32_bf16 v62, v100, v100
  v_dot2c_f32_bf16 v61, s99, v101
  v_dot2c_f32_bf16 v63, v101, v101
  v_dot2c_f32_bf16 v60, s99, v102
  v_dot2c_f32_bf16 v62, v102, v102
  v_dot2c_f32_bf16 v61, s99, v103
  v_dot2c_f32_bf16 v63, v103, v103
  s_waitcnt lgkmcnt(2)
  v_mfma_f32_32x32x16_bf16 v[184:199], a[128:131], v[136:139], 0
  ds_read_b128 v[148:151], v18 offset:12288
  s_add_u32 s95, s95, s76
  buffer_load_dwordx4 v2, s[40:43], s95 offen lds
  s_waitcnt lgkmcnt(2)
  v_mfma_f32_32x32x16_bf16 v[200:215], a[128:131], v[140:143], 0
  ds_read_b128 a[0:3], v19
  buffer_load_dwordx4 v3, s[40:43], s95 offen offset:1024 lds
  buffer_load_dwordx4 v4, s[40:43], s95 offen offset:2048 lds
  s_waitcnt lgkmcnt(2)
  v_mfma_f32_32x32x16_bf16 v[184:199], a[144:147], v[144:147], v[184:199]
  ds_read_b128 a[4:7], v19 offset:4096
  buffer_load_dwordx4 v5, s[40:43], s95 offen offset:3072 lds
  s_add_u32 m0, s73, 0x18000
  s_waitcnt lgkmcnt(2)
  v_mfma_f32_32x32x16_bf16 v[200:215], a[144:147], v[148:151], v[200:215]
  ds_read_b128 a[8:11], v20
  s_add_u32 s95, s94, 0x200
  s_and_b32 s95, s95, 0x3ff
  s_waitcnt lgkmcnt(2)
  v_mfma_f32_32x32x16_bf16 v[184:199], a[132:135], a[0:3], v[184:199]
  ds_read_b128 a[12:15], v20 offset:4096
  s_add_u32 s95, s95, s77
  buffer_load_dwordx4 v2, s[44:47], s95 offen lds
  s_waitcnt lgkmcnt(2)
  v_mfma_f32_32x32x16_bf16 v[200:215], a[132:135], a[4:7], v[200:215]
  ds_read_b128 a[16:19], v21
  buffer_load_dwordx4 v3, s[44:47], s95 offen offset:1024 lds
  s_add_u32 m0, s73, 0x1a000
  s_waitcnt lgkmcnt(2)
  v_mfma_f32_32x32x16_bf16 v[184:199], a[136:139], a[8:11], v[184:199]
  ds_read_b128 a[20:23], v21 offset:4096
  s_add_u32 s95, s94, 0x280
  s_and_b32 s95, s95, 0x3ff
  s_waitcnt lgkmcnt(2)
  v_mfma_f32_32x32x16_bf16 v[200:215], a[136:139], a[12:15], v[200:215]
  ds_read_b128 a[24:27], v19 offset:8192
  s_add_u32 s95, s95, s77
  buffer_load_dwordx4 v2, s[44:47], s95 offen lds
  s_waitcnt lgkmcnt(2)
  v_mfma_f32_32x32x16_bf16 v[184:199], a[140:143], a[16:19], v[184:199]
  ds_read_b128 a[28:31], v19 offset:12288
  buffer_load_dwordx4 v3, s[44:47], s95 offen offset:1024 lds
  s_waitcnt lgkmcnt(2)
  v_mfma_f32_32x32x16_bf16 v[200:215], a[140:143], a[20:23], v[200:215]
  ds_read_b128 a[32:35], v20 offset:8192
  s_waitcnt lgkmcnt(2)
  v_mfma_f32_32x32x16_bf16 v[184:199], a[148:151], a[24:27], v[184:199]
  ds_read_b128 a[36:39], v20 offset:12288
  s_waitcnt lgkmcnt(2)
  v_mfma_f32_32x32x16_bf16 v[200:215], a[148:151], a[28:31], v[200:215]
  ds_read_b128 a[40:43], v21 offset:8192
  s_waitcnt vmcnt(16)
  ds_read_b128 v[104:107], v14 offset:32768
  ds_read_b128 v[108:111], v15 offset:32768
  ds_read_b128 v[112:115], v16 offset:32768
  s_waitcnt lgkmcnt(5)
  v_mfma_f32_32x32x16_bf16 v[184:199], a[152:155], a[32:35], v[184:199]
  ds_read_b128 a[44:47], v21 offset:12288
  ds_read_b128 v[116:119], v17 offset:32768
  ds_read_b128 v[120:123], v14 offset:36864
  ds_read_b128 v[124:127], v15 offset:36864
  ds_read_b128 v[128:131], v16 offset:36864
  s_waitcnt lgkmcnt(9)
  v_mfma_f32_32x32x16_bf16 v[200:215], a[152:155], a[36:39], v[200:215]
  ds_read_b128 v[132:135], v17 offset:36864
  ds_read_b128 a[160:163], v14 offset:32768
  ds_read_b128 a[176:179], v14 offset:36864
  ds_read_b128 a[164:167], v15 offset:32768
  s_waitcnt lgkmcnt(12)
  v_mfma_f32_32x32x16_bf16 v[184:199], a[156:159], a[40:43], v[184:199]
  ds_read_b128 a[168:171], v16 offset:32768
  ds_read_b128 a[172:175], v17 offset:32768
  ds_read_b128 a[180:183], v15 offset:36864
  ds_read_b128 a[184:187], v16 offset:36864
  s_waitcnt lgkmcnt(12)
  v_mfma_f32_32x32x16_bf16 v[200:215], a[156:159], a[44:47], v[200:215]
  ds_read_b128 a[188:191], v17 offset:36864
  s_waitcnt vmcnt(12) lgkmcnt(0)
  s_barrier
  ds_read_b128 v[152:155], v18 offset:16384
  ds_read_b128 v[156:159], v18 offset:20480
  ds_read_b128 v[160:163], v18 offset:24576
  s_add_u32 m0, s75, 0x8000
  s_add_u32 s95, s94, 0x300
  s_and_b32 s95, s95, 0x3ff
  s_add_u32 s95, s95, s76
  buffer_load_dwordx4 v2, s[40:43], s95 offen lds
  buffer_load_dwordx4 v3, s[40:43], s95 offen offset:1024 lds
  buffer_load_dwordx4 v4, s[40:43], s95 offen offset:2048 lds
  buffer_load_dwordx4 v5, s[40:43], s95 offen offset:3072 lds
  s_add_u32 m0, s75, 0x9000
  s_add_u32 s95, s94, 0x380
  s_and_b32 s95, s95, 0x3ff
  v_dot2c_f32_bf16 v60, s99, v104
  v_dot2c_f32_bf16 v62, v104, v104
  v_dot2c_f32_bf16 v61, s99, v105
  v_dot2c_f32_bf16 v63, v105, v105
  v_dot2c_f32_bf16 v60, s99, v106
  v_dot2c_f32_bf16 v62, v106, v106
  v_dot2c_f32_bf16 v61, s99, v107
  v_dot2c_f32_bf16 v63, v107, v107
  v_dot2c_f32_bf16 v60, s99, v108
  v_dot2c_f32_bf16 v62, v108, v108
  v_dot2c_f32_bf16 v61, s99, v109
  v_dot2c_f32_bf16 v63, v109, v109
  v_dot2c_f32_bf16 v60, s99, v110
  v_dot2c_f32_bf16 v62, v110, v110
  v_dot2c_f32_bf16 v61, s99, v111
  v_dot2c_f32_bf16 v63, v111, v111
  v_dot2c_f32_bf16 v60, s99, v112
  v_dot2c_f32_bf16 v62, v112, v112
  v_dot2c_f32_bf16 v61, s99, v113
  v_dot2c_f32_bf16 v63, v113, v113
  v_dot2c_f32_bf16 v60, s99, v114
  v_dot2c_f32_bf16 v62, v114, v114
  v_dot2c_f32_bf16 v61, s99, v115
  v_dot2c_f32_bf16 v63, v115, v115
  v_dot2c_f32_bf16 v60, s99, v116
  v_dot2c_f32_bf16 v62, v116, v116
  v_dot2c_f32_bf16 v61, s99, v117
  v_dot2c_f32_bf16 v63, v117, v117
  v_dot2c_f32_bf16 v60, s99, v118
  v_dot2c_f32_bf16 v62, v118, v118
  v_dot2c_f32_bf16 v61, s99, v119
  v_dot2c_f32_bf16 v63, v119, v119
  v_dot2c_f32_bf16 v60, s99, v120
  v_dot2c_f32_bf16 v62, v120, v120
  v_dot2c_f32_bf16 v61, s99, v121
  v_dot2c_f32_bf16 v63, v121, v121
  v_dot2c_f32_bf16 v60, s99, v122
  v_dot2c_f32_bf16 v62, v122, v122
  v_dot2c_f32_bf16 v61, s99, v123
  v_dot2c_f32_bf16 v63, v123, v123
  v_dot2c_f32_bf16 v60, s99, v124
  v_dot2c_f32_bf16 v62, v124, v124
  v_dot2c_f32_bf16 v61, s99, v125
  v_dot2c_f32_bf16 v63, v125, v125
  v_dot2c_f32_bf16 v60, s99, v126
  v_dot2c_f32_bf16 v62, v126, v126
  v_dot2c_f32_bf16 v61, s99, v127
  v_dot2c_f32_bf16 v63, v127, v127
  v_dot2c_f32_bf16 v60, s99, v128
  v_dot2c_f32_bf16 v62, v128, v128
  v_dot2c_f32_bf16 v61, s99, v129
  v_dot2c_f32_bf16 v63, v129, v129
  v_dot2c_f32_bf16 v60, s99, v130
  v_dot2c_f32_bf16 v62, v130, v130
  v_dot2c_f32_bf16 v61, s99, v131
  v_dot2c_f32_bf16 v63, v131, v131
  v_dot2c_f32_bf16 v60, s99, v132
  v_dot2c_f32_bf16 v62, v132, v132
  v_dot2c_f32_bf16 v61, s99, v133
  v_dot2c_f32_bf16 v63, v133, v133
  v_dot2c_f32_bf16 v60, s99, v134
  v_dot2c_f32_bf16 v62, v134, v134
  v_dot2c_f32_bf16 v61, s99, v135
  v_dot2c_f32_bf16 v63, v135, v135
  v_dot2c_f32_bf16 v52, s99, v136
  v_dot2c_f32_bf16 v52, s99, v137
  v_dot2c_f32_bf16 v52, s99, v138
  v_dot2c_f32_bf16 v52, s99, v139
  v_dot2c_f32_bf16 v53, s99, v140
  v_dot2c_f32_bf16 v53, s99, v141
  v_dot2c_f32_bf16 v53, s99, v142
  v_dot2c_f32_bf16 v53, s99, v143
  v_dot2c_f32_bf16 v52, s99, v144
  v_dot2c_f32_bf16 v52, s99, v145
  v_dot2c_f32_bf16 v52, s99, v146
  v_dot2c_f32_bf16 v52, s99, v147
  v_dot2c_f32_bf16 v53, s99, v148
  v_dot2c_f32_bf16 v53, s99, v149
  v_dot2c_f32_bf16 v53, s99, v150
  v_dot2c_f32_bf16 v53, s99, v151
  s_waitcnt lgkmcnt(2)
  v_mfma_f32_32x32x16_bf16 v[184:199], a[160:163], v[152:155], v[184:199]
  ds_read_b128 v[164:167], v18 offset:28672
  s_add_u32 s95, s95, s76
  buffer_load_dwordx4 v2, s[40:43], s95 offen lds
  s_waitcnt lgkmcnt(2)
  v_mfma_f32_32x32x16_bf16 v[200:215], a[160:163], v[156:159], v[200:215]
  ds_read_b128 a[48:51], v19 offset:16384
  buffer_load_dwordx4 v3, s[40:43], s95 offen offset:1024 lds
  buffer_load_dwordx4 v4, s[40:43], s95 offen offset:2048 lds
  s_waitcnt lgkmcnt(2)
  v_mfma_f32_32x32x16_bf16 v[184:199], a[176:179], v[160:163], v[184:199]
  ds_read_b128 a[52:55], v19 offset:20480
  buffer_load_dwordx4 v5, s[40:43], s95 offen offset:3072 lds
  s_add_u32 m0, s73, 0x1c000
  s_waitcnt lgkmcnt(2)
  v_mfma_f32_32x32x16_bf16 v[200:215], a[176:179], v[164:167], v[200:215]
  ds_read_b128 a[56:59], v20 offset:16384
  s_add_u32 s95, s94, 0x300
  s_and_b32 s95, s95, 0x3ff
  s_waitcnt lgkmcnt(2)
  v_mfma_f32_32x32x16_bf16 v[184:199], a[164:167], a[48:51], v[184:199]
  ds_read_b128 a[60:63], v20 offset:20480
  s_add_u32 s95, s95, s77
  buffer_load_dwordx4 v2, s[44:47], s95 offen lds
  s_waitcnt lgkmcnt(2)
  v_mfma_f32_32x32x16_bf16 v[200:215], a[164:167], a[52:55], v[200:215]
  ds_read_b128 a[0:3], v21 offset:16384
  buffer_load_dwordx4 v3, s[44:47], s95 offen offset:1024 lds
  s_add_u32 m0, s73, 0x1e000
  s_waitcnt lgkmcnt(2)
  v_mfma_f32_32x32x16_bf16 v[184:199], a[168:171], a[56:59], v[184:199]
  ds_read_b128 a[4:7], v21 offset:20480
  s_add_u32 s95, s94, 0x380
  s_and_b32 s95, s95, 0x3ff
  s_waitcnt lgkmcnt(2)
  v_mfma_f32_32x32x16_bf16 v[200:215], a[168:171], a[60:63], v[200:215]
  ds_read_b128 a[8:11], v19 offset:24576
  s_add_u32 s95, s95, s77
  buffer_load_dwordx4 v2, s[44:47], s95 offen lds
  s_waitcnt lgkmcnt(2)
  v_mfma_f32_32x32x16_bf16 v[184:199], a[172:175], a[0:3], v[184:199]
  ds_read_b128 a[12:15], v19 offset:28672
  buffer_load_dwordx4 v3, s[44:47], s95 offen offset:1024 lds
  s_add_u32 m0, s83, 0x20000
  s_waitcnt lgkmcnt(2)
  v_mfma_f32_32x32x16_bf16 v[200:215], a[172:175], a[4:7], v[200:215]
  ds_read_b128 a[16:19], v20 offset:24576
  s_add_u32 s95, s19, 0
  s_and_b32 s95, s95, 7
  s_waitcnt lgkmcnt(2)
  v_mfma_f32_32x32x16_bf16 v[184:199], a[180:183], a[8:11], v[184:199]
  ds_read_b128 a[20:23], v20 offset:28672
  s_mul_i32 s95, s95, 0x38000
  s_add_u32 s95, s95, s78
  buffer_load_dwordx4 v7, s[48:51], s95 offen lds
  buffer_load_dwordx4 v8, s[48:51], s95 offen offset:1024 lds
  buffer_load_dwordx4 v9, s[48:51], s95 offen offset:2048 lds
  buffer_load_dwordx4 v10, s[48:51], s95 offen offset:3072 lds
  s_add_u32 m0, s83, 0x21000
  s_nop 0
  buffer_load_dwordx4 v11, s[48:51], s95 offen lds
  buffer_load_dwordx4 v12, s[48:51], s95 offen offset:1024 lds
  buffer_load_dwordx4 v13, s[48:51], s95 offen offset:2048 lds
  v_mov_b32 v71, 0
  buffer_load_dwordx2 v[34:35], v71, s[68:71], 0 offen sc1
  s_add_u32 s95, s98, 0
  s_and_b32 s95, s95, 0x7ff
  s_add_u32 s95, s95, s80
  buffer_load_dword v49, v51, s[52:55], s95 offen
  s_waitcnt lgkmcnt(2)
  v_mfma_f32_32x32x16_bf16 v[200:215], a[180:183], a[12:15], v[200:215]
  ds_read_b128 a[24:27], v21 offset:24576
  s_waitcnt vmcnt(25)
  ds_read_b128 v[72:75], v14
  ds_read_b128 v[76:79], v15
  ds_read_b128 v[80:83], v16
  s_waitcnt lgkmcnt(5)
  v_mfma_f32_32x32x16_bf16 v[184:199], a[184:187], a[16:19], v[184:199]
  ds_read_b128 a[28:31], v21 offset:28672
  ds_read_b128 v[84:87], v17
  ds_read_b128 v[88:91], v14 offset:4096
  ds_read_b128 v[92:95], v15 offset:4096
  ds_read_b128 v[96:99], v16 offset:4096
  s_waitcnt lgkmcnt(9)
  v_mfma_f32_32x32x16_bf16 v[200:215], a[184:187], a[20:23], v[200:215]
  ds_read_b128 v[100:103], v17 offset:4096
  ds_read_b128 a[192:195], v14
  ds_read_b128 a[208:211], v14 offset:4096
  ds_read_b128 a[196:199], v15
  s_waitcnt lgkmcnt(12)
  v_mfma_f32_32x32x16_bf16 v[184:199], a[188:191], a[24:27], v[184:199]
  ds_read_b128 a[200:203], v16
  ds_read_b128 a[204:207], v17
  ds_read_b128 a[212:215], v15 offset:4096
  ds_read_b128 a[216:219], v16 offset:4096
  s_waitcnt lgkmcnt(12)
  v_mfma_f32_32x32x16_bf16 v[200:215], a[188:191], a[28:31], v[200:215]
  ds_read_b128 a[220:223], v17 offset:4096
  s_waitcnt vmcnt(21) lgkmcnt(0)
  s_barrier
  ds_read_b128 v[136:139], v18 offset:32768
  ds_read_b128 v[140:143], v18 offset:36864
  ds_read_b128 v[144:147], v18 offset:40960
  v_dot2c_f32_bf16 v60, s99, v72
  v_dot2c_f32_bf16 v62, v72, v72
  v_dot2c_f32_bf16 v61, s99, v73
  v_dot2c_f32_bf16 v63, v73, v73
  v_dot2c_f32_bf16 v60, s99, v74
  v_dot2c_f32_bf16 v62, v74, v74
  v_dot2c_f32_bf16 v61, s99, v75
  v_dot2c_f32_bf16 v63, v75, v75
  v_dot2c_f32_bf16 v60, s99, v76
  v_dot2c_f32_bf16 v62, v76, v76
  v_dot2c_f32_bf16 v61, s99, v77
  v_dot2c_f32_bf16 v63, v77, v77
  v_dot2c_f32_bf16 v60, s99, v78
  v_dot2c_f32_bf16 v62, v78, v78
  v_dot2c_f32_bf16 v61, s99, v79
  v_dot2c_f32_bf16 v63, v79, v79
  v_dot2c_f32_bf16 v60, s99, v80
  v_dot2c_f32_bf16 v62, v80, v80
  v_dot2c_f32_bf16 v61, s99, v81
  v_dot2c_f32_bf16 v63, v81, v81
  v_dot2c_f32_bf16 v60, s99, v82
  v_dot2c_f32_bf16 v62, v82, v82
  v_dot2c_f32_bf16 v61, s99, v83
  v_dot2c_f32_bf16 v63, v83, v83
  v_dot2c_f32_bf16 v60, s99, v84
  v_dot2c_f32_bf16 v62, v84, v84
  v_dot2c_f32_bf16 v61, s99, v85
  v_dot2c_f32_bf16 v63, v85, v85
  v_dot2c_f32_bf16 v60, s99, v86
  v_dot2c_f32_bf16 v62, v86, v86
  v_dot2c_f32_bf16 v61, s99, v87
  v_dot2c_f32_bf16 v63, v87, v87
  v_dot2c_f32_bf16 v60, s99, v88
  v_dot2c_f32_bf16 v62, v88, v88
  v_dot2c_f32_bf16 v61, s99, v89
  v_dot2c_f32_bf16 v63, v89, v89
  v_dot2c_f32_bf16 v60, s99, v90
  v_dot2c_f32_bf16 v62, v90, v90
  v_dot2c_f32_bf16 v61, s99, v91
  v_dot2c_f32_bf16 v63, v91, v91
  v_dot2c_f32_bf16 v60, s99, v92
  v_dot2c_f32_bf16 v62, v92, v92
  v_dot2c_f32_bf16 v61, s99, v93
  v_dot2c_f32_bf16 v63, v93, v93
  v_dot2c_f32_bf16 v60, s99, v94
  v_dot2c_f32_bf16 v62, v94, v94
  v_dot2c_f32_bf16 v61, s99, v95
  v_dot2c_f32_bf16 v63, v95, v95
  v_dot2c_f32_bf16 v60, s99, v96
  v_dot2c_f32_bf16 v62, v96, v96
  v_dot2c_f32_bf16 v61, s99, v97
  v_dot2c_f32_bf16 v63, v97, v97
  v_dot2c_f32_bf16 v60, s99, v98
  v_dot2c_f32_bf16 v62, v98, v98
  v_dot2c_f32_bf16 v61, s99, v99
  v_dot2c_f32_bf16 v63, v99, v99
  v_dot2c_f32_bf16 v60, s99, v100
  v_dot2c_f32_bf16 v62, v100, v100
  v_dot2c_f32_bf16 v61, s99, v101
  v_dot2c_f32_bf16 v63, v101, v101
  v_dot2c_f32_bf16 v60, s99, v102
  v_dot2c_f32_bf16 v62, v102, v102
  v_dot2c_f32_bf16 v61, s99, v103
  v_dot2c_f32_bf16 v63, v103, v103
  v_dot2c_f32_bf16 v52, s99, v152
  v_dot2c_f32_bf16 v52, s99, v153
  v_dot2c_f32_bf16 v52, s99, v154
  v_dot2c_f32_bf16 v52, s99, v155
  v_dot2c_f32_bf16 v53, s99, v156
  v_dot2c_f32_bf16 v53, s99, v157
  v_dot2c_f32_bf16 v53, s99, v158
  v_dot2c_f32_bf16 v53, s99, v159
  v_dot2c_f32_bf16 v52, s99, v160
  v_dot2c_f32_bf16 v52, s99, v161
  v_dot2c_f32_bf16 v52, s99, v162
  v_dot2c_f32_bf16 v52, s99, v163
  v_dot2c_f32_bf16 v53, s99, v164
  v_dot2c_f32_bf16 v53, s99, v165
  v_dot2c_f32_bf16 v53, s99, v166
  v_dot2c_f32_bf16 v53, s99, v167
  s_waitcnt lgkmcnt(2)
  v_mfma_f32_32x32x16_bf16 v[184:199], a[192:195], v[136:139], v[184:199]
  ds_read_b128 v[148:151], v18 offset:45056
  s_waitcnt lgkmcnt(2)
  v_mfma_f32_32x32x16_bf16 v[200:215], a[192:195], v[140:143], v[200:215]
  ds_read_b128 a[32:35], v19 offset:32768
  s_waitcnt lgkmcnt(2)
  v_mfma_f32_32x32x16_bf16 v[184:199], a[208:211], v[144:147], v[184:199]
  ds_read_b128 a[36:39], v19 offset:36864
  s_waitcnt lgkmcnt(2)
  v_mfma_f32_32x32x16_bf16 v[200:215], a[208:211], v[148:151], v[200:215]
  ds_read_b128 a[40:43], v20 offset:32768
  s_waitcnt lgkmcnt(2)
  v_mfma_f32_32x32x16_bf16 v[184:199], a[196:199], a[32:35], v[184:199]
  ds_read_b128 a[44:47], v20 offset:36864
  s_waitcnt lgkmcnt(2)
  v_mfma_f32_32x32x16_bf16 v[200:215], a[196:199], a[36:39], v[200:215]
  ds_read_b128 a[48:51], v21 offset:32768
  s_waitcnt lgkmcnt(2)
  v_mfma_f32_32x32x16_bf16 v[184:199], a[200:203], a[40:43], v[184:199]
  ds_read_b128 a[52:55], v21 offset:36864
  s_waitcnt lgkmcnt(2)
  v_mfma_f32_32x32x16_bf16 v[200:215], a[200:203], a[44:47], v[200:215]
  ds_read_b128 a[56:59], v19 offset:40960
  s_waitcnt lgkmcnt(2)
  v_mfma_f32_32x32x16_bf16 v[184:199], a[204:207], a[48:51], v[184:199]
  ds_read_b128 a[60:63], v19 offset:45056
  s_waitcnt lgkmcnt(2)
  v_mfma_f32_32x32x16_bf16 v[200:215], a[204:207], a[52:55], v[200:215]
  ds_read_b128 a[0:3], v20 offset:40960
  s_waitcnt lgkmcnt(2)
  v_mfma_f32_32x32x16_bf16 v[184:199], a[212:215], a[56:59], v[184:199]
  ds_read_b128 a[4:7], v20 offset:45056
  s_waitcnt lgkmcnt(2)
  v_mfma_f32_32x32x16_bf16 v[200:215], a[212:215], a[60:63], v[200:215]
  ds_read_b128 a[8:11], v21 offset:40960
  s_waitcnt vmcnt(13)
  ds_read_b128 v[104:107], v14 offset:32768
  ds_read_b128 v[108:111], v15 offset:32768
  ds_read_b128 v[112:115], v16 offset:32768
  s_waitcnt lgkmcnt(5)
  v_mfma_f32_32x32x16_bf16 v[184:199], a[216:219], a[0:3], v[184:199]
  ds_read_b128 a[12:15], v21 offset:45056
  ds_read_b128 v[116:119], v17 offset:32768
  ds_read_b128 v[120:123], v14 offset:36864
  ds_read_b128 v[124:127], v15 offset:36864
  ds_read_b128 v[128:131], v16 offset:36864
  s_waitcnt lgkmcnt(9)
  v_mfma_f32_32x32x16_bf16 v[200:215], a[216:219], a[4:7], v[200:215]
  ds_read_b128 v[132:135], v17 offset:36864
  ds_read_b128 a[224:227], v14 offset:32768
  ds_read_b128 a[240:243], v14 offset:36864
  ds_read_b128 a[228:231], v15 offset:32768
  s_waitcnt lgkmcnt(12)
  v_mfma_f32_32x32x16_bf16 v[184:199], a[220:223], a[8:11], v[184:199]
  ds_read_b128 a[232:235], v16 offset:32768
  ds_read_b128 a[236:239], v17 offset:32768
  ds_read_b128 a[244:247], v15 offset:36864
  ds_read_b128 a[248:251], v16 offset:36864
  s_waitcnt lgkmcnt(12)
  v_mfma_f32_32x32x16_bf16 v[200:215], a[220:223], a[12:15], v[200:215]
  ds_read_b128 a[252:255], v17 offset:36864
  s_waitcnt vmcnt(9) lgkmcnt(0)
  s_barrier
  ds_read_b128 v[152:155], v18 offset:49152
  ds_read_b128 v[156:159], v18 offset:53248
  ds_read_b128 v[160:163], v18 offset:57344
  v_dot2c_f32_bf16 v60, s99, v104
  v_dot2c_f32_bf16 v62, v104, v104
  v_dot2c_f32_bf16 v61, s99, v105
  v_dot2c_f32_bf16 v63, v105, v105
  v_dot2c_f32_bf16 v60, s99, v106
  v_dot2c_f32_bf16 v62, v106, v106
  v_dot2c_f32_bf16 v61, s99, v107
  v_dot2c_f32_bf16 v63, v107, v107
  v_dot2c_f32_bf16 v60, s99, v108
  v_dot2c_f32_bf16 v62, v108, v108
  v_dot2c_f32_bf16 v61, s99, v109
  v_dot2c_f32_bf16 v63, v109, v109
  v_dot2c_f32_bf16 v60, s99, v110
  v_dot2c_f32_bf16 v62, v110, v110
  v_dot2c_f32_bf16 v61, s99, v111
  v_dot2c_f32_bf16 v63, v111, v111
  v_dot2c_f32_bf16 v60, s99, v112
  v_dot2c_f32_bf16 v62, v112, v112
  v_dot2c_f32_bf16 v61, s99, v113
  v_dot2c_f32_bf16 v63, v113, v113
  v_dot2c_f32_bf16 v60, s99, v114
  v_dot2c_f32_bf16 v62, v114, v114
  v_dot2c_f32_bf16 v61, s99, v115
  v_dot2c_f32_bf16 v63, v115, v115
  v_dot2c_f32_bf16 v60, s99, v116
  v_dot2c_f32_bf16 v62, v116, v116
  v_dot2c_f32_bf16 v61, s99, v117
  v_dot2c_f32_bf16 v63, v117, v117
  v_dot2c_f32_bf16 v60, s99, v118
  v_dot2c_f32_bf16 v62, v118, v118
  v_dot2c_f32_bf16 v61, s99, v119
  v_dot2c_f32_bf16 v63, v119, v119
  v_dot2c_f32_bf16 v60, s99, v120
  v_dot2c_f32_bf16 v62, v120, v120
  v_dot2c_f32_bf16 v61, s99, v121
  v_dot2c_f32_bf16 v63, v121, v121
  v_dot2c_f32_bf16 v60, s99, v122
  v_dot2c_f32_bf16 v62, v122, v122
  v_dot2c_f32_bf16 v61, s99, v123
  v_dot2c_f32_bf16 v63, v123, v123
  v_dot2c_f32_bf16 v60, s99, v124
  v_dot2c_f32_bf16 v62, v124, v124
  v_dot2c_f32_bf16 v61, s99, v125
  v_dot2c_f32_bf16 v63, v125, v125
  v_dot2c_f32_bf16 v60, s99, v126
  v_dot2c_f32_bf16 v62, v126, v126
  v_dot2c_f32_bf16 v61, s99, v127
  v_dot2c_f32_bf16 v63, v127, v127
  v_dot2c_f32_bf16 v60, s99, v128
  v_dot2c_f32_bf16 v62, v128, v128
  v_dot2c_f32_bf16 v61, s99, v129
  v_dot2c_f32_bf16 v63, v129, v129
  v_dot2c_f32_bf16 v60, s99, v130
  v_dot2c_f32_bf16 v62, v130, v130
  v_dot2c_f32_bf16 v61, s99, v131
  v_dot2c_f32_bf16 v63, v131, v131
  v_dot2c_f32_bf16 v60, s99, v132
  v_dot2c_f32_bf16 v62, v132, v132
  v_dot2c_f32_bf16 v61, s99, v133
  v_dot2c_f32_bf16 v63, v133, v133
  v_dot2c_f32_bf16 v60, s99, v134
  v_dot2c_f32_bf16 v62, v134, v134
  v_dot2c_f32_bf16 v61, s99, v135
  v_dot2c_f32_bf16 v63, v135, v135
  v_dot2c_f32_bf16 v52, s99, v136
  v_dot2c_f32_bf16 v52, s99, v137
  v_dot2c_f32_bf16 v52, s99, v138
  v_dot2c_f32_bf16 v52, s99, v139
  v_dot2c_f32_bf16 v53, s99, v140
  v_dot2c_f32_bf16 v53, s99, v141
  v_dot2c_f32_bf16 v53, s99, v142
  v_dot2c_f32_bf16 v53, s99, v143
  v_dot2c_f32_bf16 v52, s99, v144
  v_dot2c_f32_bf16 v52, s99, v145
  v_dot2c_f32_bf16 v52, s99, v146
  v_dot2c_f32_bf16 v52, s99, v147
  v_dot2c_f32_bf16 v53, s99, v148
  v_dot2c_f32_bf16 v53, s99, v149
  v_dot2c_f32_bf16 v53, s99, v150
  v_dot2c_f32_bf16 v53, s99, v151
  s_waitcnt lgkmcnt(2)
  v_mfma_f32_32x32x16_bf16 v[184:199], a[224:227], v[152:155], v[184:199]
  ds_read_b128 v[164:167], v18 offset:61440
  v_add_f32 v60, v60, v61
  v_add_f32 v62, v62, v63
  v_mov_b32 v61, v60
  v_mov_b32 v63, v62
  s_waitcnt lgkmcnt(2)
  v_mfma_f32_32x32x16_bf16 v[200:215], a[224:227], v[156:159], v[200:215]
  ds_read_b128 a[16:19], v19 offset:49152
  v_permlane32_swap_b32 v60, v61
  v_permlane32_swap_b32 v62, v63
  v_add_f32 v60, v60, v61
  v_add_f32 v62, v62, v63
  s_waitcnt lgkmcnt(2)
  v_mfma_f32_32x32x16_bf16 v[184:199], a[240:243], v[160:163], v[184:199]
  ds_read_b128 a[20:23], v19 offset:53248
  v_mul_f32 v60, 0x3b000000, v60
  v_mul_f32 v62, 0x3b000000, v62
  v_fma_f32 v62, -v60, v60, v62
  v_max_f32 v62, 0, v62
  s_waitcnt lgkmcnt(2)
  v_mfma_f32_32x32x16_bf16 v[200:215], a[240:243], v[164:167], v[200:215]
  ds_read_b128 a[24:27], v20 offset:49152
  v_cvt_pk_bf16_f32 v40, -v60, -v60
  v_cvt_pk_bf16_f32 v62, v62, v62
  v_lshlrev_b32 v62, 16, v62
  v_add_f32 v62, 0x3727c5ac, v62
  s_waitcnt lgkmcnt(2)
  v_mfma_f32_32x32x16_bf16 v[184:199], a[228:231], a[16:19], v[184:199]
  ds_read_b128 a[28:31], v20 offset:53248
  v_dot2c_f32_bf16 v52, s99, v152
  v_dot2c_f32_bf16 v52, s99, v153
  v_dot2c_f32_bf16 v52, s99, v154
  v_dot2c_f32_bf16 v52, s99, v155
  v_dot2c_f32_bf16 v53, s99, v156
  v_dot2c_f32_bf16 v53, s99, v157
  v_dot2c_f32_bf16 v53, s99, v158
  v_dot2c_f32_bf16 v53, s99, v159
  v_dot2c_f32_bf16 v52, s99, v160
  v_dot2c_f32_bf16 v52, s99, v161
  v_dot2c_f32_bf16 v52, s99, v162
  v_dot2c_f32_bf16 v52, s99, v163
  v_dot2c_f32_bf16 v53, s99, v164
  v_dot2c_f32_bf16 v53, s99, v165
  v_dot2c_f32_bf16 v53, s99, v166
  v_dot2c_f32_bf16 v53, s99, v167
  s_waitcnt lgkmcnt(2)
  v_mfma_f32_32x32x16_bf16 v[200:215], a[228:231], a[20:23], v[200:215]
  ds_read_b128 a[32:35], v21 offset:49152
  v_cvt_pk_bf16_f32 v62, v62, v62
  v_lshlrev_b32 v62, 16, v62
  v_sqrt_f32 v62, v62
  v_mov_b32 v41, v40
  s_waitcnt lgkmcnt(2)
  v_mfma_f32_32x32x16_bf16 v[184:199], a[232:235], a[24:27], v[184:199]
  ds_read_b128 a[36:39], v21 offset:53248
  v_mov_b32 v42, v40
  v_mov_b32 v43, v40
  v_cvt_pk_bf16_f32 v62, v62, v62
  v_lshlrev_b32 v62, 16, v62
  s_waitcnt lgkmcnt(2)
  v_mfma_f32_32x32x16_bf16 v[200:215], a[232:235], a[28:31], v[200:215]
  ds_read_b128 a[40:43], v19 offset:57344
  v_rcp_f32 v64, v62
  v_mul_f32 v46, v62, v62
  v_mul_f32 v44, 0xc0135761, v64
  v_mul_f32 v45, v64, v64
  s_waitcnt lgkmcnt(2)
  v_mfma_f32_32x32x16_bf16 v[184:199], a[236:239], a[32:35], v[184:199]
  ds_read_b128 a[44:47], v19 offset:61440
  v_mul_f32 v45, v45, v64
  v_mul_f32 v45, 0xbdd2d3e8, v45
  v_xor_b32 v64, s84, v64
  v_lshrrev_b32 v65, 2, v47
  s_waitcnt lgkmcnt(2)
  v_mfma_f32_32x32x16_bf16 v[200:215], a[236:239], a[36:39], v[200:215]
  ds_read_b128 a[48:51], v20 offset:57344
  s_lshl_b32 s15, s3, 7
  v_add_u32 v65, s15, v65
  ds_write_b32 v65, v64 offset:30848
  s_lshl_b32 s15, s3, 2
  s_waitcnt lgkmcnt(3)
  v_mfma_f32_32x32x16_bf16 v[184:199], a[244:247], a[40:43], v[184:199]
  ds_read_b128 a[52:55], v20 offset:61440
  v_add_u32 v66, s15, v48
  v_cvt_pk_bf16_f32 v67, v52, v52
  v_and_b32 v67, 0xffff0000, v67
  v_sub_f32 v67, v52, v67
  s_waitcnt lgkmcnt(3)
  v_mfma_f32_32x32x16_bf16 v[200:215], a[244:247], a[44:47], v[200:215]
  ds_read_b128 a[56:59], v21 offset:57344
  v_cvt_pk_bf16_f32 v67, v52, v67
  ds_write_b32 v66, v67 offset:28800
  v_mov_b32 v52, 0
  v_cvt_pk_bf16_f32 v68, v53, v53
  s_waitcnt lgkmcnt(4)
  v_mfma_f32_32x32x16_bf16 v[184:199], a[248:251], a[48:51], v[184:199]
  ds_read_b128 a[60:63], v21 offset:61440
  s_add_u32 m0, s83, 0
  s_add_u32 s95, s19, 1
  s_and_b32 s95, s95, 7
  s_mul_i32 s95, s95, 0x38000
  v_and_b32 v68, 0xffff0000, v68
  v_sub_f32 v68, v53, v68
  v_cvt_pk_bf16_f32 v68, v53, v68
  ds_write_b32 v66, v68 offset:29824
  s_waitcnt lgkmcnt(4)
  v_mfma_f32_32x32x16_bf16 v[200:215], a[248:251], a[52:55], v[200:215]
  s_add_u32 s95, s95, s78
  buffer_load_dwordx4 v7, s[48:51], s95 offen lds
  buffer_load_dwordx4 v8, s[48:51], s95 offen offset:1024 lds
  buffer_load_dwordx4 v9, s[48:51], s95 offen offset:2048 lds
  v_mov_b32 v53, 0
  s_waitcnt lgkmcnt(3)
  v_mfma_f32_32x32x16_bf16 v[184:199], a[252:255], a[56:59], v[184:199]
  buffer_load_dwordx4 v10, s[48:51], s95 offen offset:3072 lds
  s_add_u32 m0, s83, 0x1000
  s_nop 0
  buffer_load_dwordx4 v11, s[48:51], s95 offen lds
  buffer_load_dwordx4 v12, s[48:51], s95 offen offset:1024 lds
  s_waitcnt lgkmcnt(1)
  v_mfma_f32_32x32x16_bf16 v[200:215], a[252:255], a[60:63], v[200:215]
  buffer_load_dwordx4 v13, s[48:51], s95 offen offset:2048 lds
  s_add_u32 m0, s83, 0x8000
  s_add_u32 s95, s19, 2
  s_and_b32 s95, s95, 7
  s_mul_i32 s95, s95, 0x38000
  s_add_u32 s95, s95, s78
  buffer_load_dwordx4 v7, s[48:51], s95 offen lds
  buffer_load_dwordx4 v8, s[48:51], s95 offen offset:1024 lds
  buffer_load_dwordx4 v9, s[48:51], s95 offen offset:2048 lds
  buffer_load_dwordx4 v10, s[48:51], s95 offen offset:3072 lds
  s_add_u32 m0, s83, 0x9000
  s_nop 0
  buffer_load_dwordx4 v11, s[48:51], s95 offen lds
  buffer_load_dwordx4 v12, s[48:51], s95 offen offset:1024 lds
  buffer_load_dwordx4 v13, s[48:51], s95 offen offset:2048 lds
  s_waitcnt vmcnt(16)
  s_waitcnt lgkmcnt(0)
  s_barrier
  ds_read_b64_tr_b16 v[216:217], v26
  ds_read_b64_tr_b16 v[218:219], v26 offset:896
  ds_read_b64_tr_b16 v[220:221], v26 offset:32
  ds_read_b64_tr_b16 v[222:223], v26 offset:928
  ds_read_b64_tr_b16 v[224:225], v26 offset:64
  ds_read_b64_tr_b16 v[226:227], v26 offset:960
  ds_read_b64_tr_b16 v[228:229], v26 offset:96
  ds_read_b64_tr_b16 v[230:231], v26 offset:992
  s_waitcnt lgkmcnt(6)
  v_mfma_f32_32x32x16_bf16 v[72:87], v[216:219], a[128:131], 0
  ds_read_b64_tr_b16 v[232:233], v26 offset:128
  ds_read_b64_tr_b16 v[234:235], v26 offset:1024
  ds_read_b64_tr_b16 v[236:237], v26 offset:160
  ds_read_b64_tr_b16 v[238:239], v26 offset:1056
  s_add_u32 m0, s83, 0x10000
  v_lshrrev_b32 v68, 5, v0
  v_lshlrev_b32 v68, 4, v68
  s_waitcnt lgkmcnt(8)
  v_mfma_f32_32x32x16_bf16 v[88:103], v[220:223], a[128:131], 0
  ds_read_b128 a[0:3], v48 offset:28800
  ds_read_b64_tr_b16 v[240:241], v26 offset:192
  ds_read_b64_tr_b16 v[242:243], v26 offset:1088
  s_add_u32 s95, s19, 3
  s_lshl_b32 s15, s3, 7
  v_add_u32 v68, s15, v68
  s_waitcnt lgkmcnt(9)
  v_mfma_f32_32x32x16_bf16 v[104:119], v[224:227], a[128:131], 0
  ds_read_b128 a[4:7], v48 offset:29824
  ds_read_b64_tr_b16 a[8:9], v27
  ds_read_b64_tr_b16 a[10:11], v27 offset:896
  s_and_b32 s95, s95, 7
  ds_read_b128 v[248:251], v68 offset:30848
  ds_read_b128 v[252:255], v68 offset:30880
  s_waitcnt lgkmcnt(12)
  v_mfma_f32_32x32x16_bf16 v[120:135], v[228:231], a[128:131], 0
  ds_read_b64_tr_b16 a[12:13], v27 offset:32
  ds_read_b64_tr_b16 a[14:15], v27 offset:928
  s_mul_i32 s95, s95, 0x38000
  s_waitcnt lgkmcnt(12)
  v_mfma_f32_32x32x16_bf16 v[136:151], v[232:235], a[128:131], 0
  ds_read_b64_tr_b16 a[16:17], v27 offset:64
  ds_read_b64_tr_b16 a[18:19], v27 offset:960
  s_add_u32 s95, s95, s78
  s_waitcnt lgkmcnt(11)
  v_mfma_f32_32x32x16_bf16 v[184:199], v[40:43], a[0:3], v[184:199]
  ds_read_b64_tr_b16 a[20:21], v27 offset:96
  ds_read_b64_tr_b16 a[22:23], v27 offset:992
  buffer_load_dwordx4 v7, s[48:51], s95 offen lds
  buffer_load_dwordx4 v8, s[48:51], s95 offen offset:1024 lds
  s_waitcnt lgkmcnt(10)
  v_mfma_f32_32x32x16_bf16 v[200:215], v[40:43], a[4:7], v[200:215]
  ds_read_b64_tr_b16 a[24:25], v27 offset:128
  ds_read_b64_tr_b16 a[26:27], v27 offset:1024
  buffer_load_dwordx4 v9, s[48:51], s95 offen offset:2048 lds
  v_mfma_f32_32x32x16_bf16 v[152:167], v[236:239], a[128:131], 0
  ds_read_b64_tr_b16 a[28:29], v27 offset:160
  ds_read_b64_tr_b16 a[30:31], v27 offset:1056
  buffer_load_dwordx4 v10, s[48:51], s95 offen offset:3072 lds
  v_mfma_f32_32x32x16_bf16 v[168:183], v[240:243], a[128:131], 0
  ds_read_b64_tr_b16 a[32:33], v27 offset:192
  ds_read_b64_tr_b16 a[34:35], v27 offset:1088
  s_add_u32 m0, s83, 0x11000
  s_waitcnt lgkmcnt(6)
  v_mfma_f32_32x32x16_bf16 v[72:87], a[8:11], a[132:135], v[72:87]
  ds_read_b64_tr_b16 a[36:37], v28
  ds_read_b64_tr_b16 a[38:39], v28 offset:896
  v_dot2c_f32_bf16 v52, s99, v216
  v_dot2c_f32_bf16 v52, s99, v217
  v_dot2c_f32_bf16 v52, s99, v218
  v_dot2c_f32_bf16 v52, s99, v219
  v_dot2c_f32_bf16 v53, s99, v220
  v_dot2c_f32_bf16 v53, s99, v221
  v_dot2c_f32_bf16 v53, s99, v222
  v_dot2c_f32_bf16 v53, s99, v223
  v_dot2c_f32_bf16 v54, s99, v224
  v_dot2c_f32_bf16 v54, s99, v225
  v_dot2c_f32_bf16 v54, s99, v226
  v_dot2c_f32_bf16 v54, s99, v227
  v_dot2c_f32_bf16 v55, s99, v228
  v_dot2c_f32_bf16 v55, s99, v229
  v_dot2c_f32_bf16 v55, s99, v230
  v_dot2c_f32_bf16 v55, s99, v231
  v_dot2c_f32_bf16 v56, s99, v232
  v_dot2c_f32_bf16 v56, s99, v233
  v_dot2c_f32_bf16 v56, s99, v234
  v_dot2c_f32_bf16 v56, s99, v235
  v_dot2c_f32_bf16 v57, s99, v236
  v_dot2c_f32_bf16 v57, s99, v237
  v_dot2c_f32_bf16 v57, s99, v238
  v_dot2c_f32_bf16 v57, s99, v239
  v_dot2c_f32_bf16 v58, s99, v240
  v_dot2c_f32_bf16 v58, s99, v241
  v_dot2c_f32_bf16 v58, s99, v242
  v_dot2c_f32_bf16 v58, s99, v243
  buffer_load_dwordx4 v11, s[48:51], s95 offen lds
  v_lshrrev_b32 v69, 5, v0
  v_lshl_add_u32 v69, v69, 9, v47
  s_lshl_b32 s14, s3, 2
  v_add_u32 v69, s14, v69
  v_permlane32_swap_b32 v52, v53
  v_add_f32 v52, v52, v53
  ds_write_b32 v69, v52 offset:61568
  v_permlane32_swap_b32 v54, v55
  v_mfma_f32_32x32x16_bf16 v[88:103], a[12:15], a[132:135], v[88:103]
  ds_read_b64_tr_b16 a[40:41], v28 offset:32
  ds_read_b64_tr_b16 a[42:43], v28 offset:928
  buffer_load_dwordx4 v12, s[48:51], s95 offen offset:1024 lds
  buffer_load_dwordx4 v13, s[48:51], s95 offen offset:2048 lds
  v_add_f32 v54, v54, v55
  ds_write_b32 v69, v54 offset:62592
  v_permlane32_swap_b32 v56, v57
  v_add_f32 v56, v56, v57
  ds_write_b32 v69, v56 offset:63616
  v_mov_b32 v59, v58
  v_add_u32 v69, s14, v47
  s_nop 0
  v_permlane32_swap_b32 v58, v59
  v_mfma_f32_32x32x16_bf16 v[104:119], a[16:19], a[132:135], v[104:119]
  ds_read_b64_tr_b16 a[44:45], v28 offset:64
  ds_read_b64_tr_b16 a[46:47], v28 offset:960
  s_add_u32 m0, s83, 0x18000
  v_add_f32 v58, v58, v59
  ds_write_b32 v69, v58 offset:64640
  v_mfma_f32_32x32x16_bf16 v[120:135], a[20:23], a[132:135], v[120:135]
  ds_read_b64_tr_b16 a[48:49], v28 offset:96
  ds_read_b64_tr_b16 a[50:51], v28 offset:992
  s_add_u32 s95, s19, 4
  s_waitcnt lgkmcnt(10)
  v_mfma_f32_32x32x16_bf16 v[136:151], a[24:27], a[132:135], v[136:151]
  ds_read_b64_tr_b16 a[52:53], v28 offset:128
  ds_read_b64_tr_b16 a[54:55], v28 offset:1024
  s_and_b32 s95, s95, 7
  v_mul_f32 v184, v184, v248
  v_mul_f32 v185, v185, v249
  v_mul_f32 v186, v186, v250
  v_mul_f32 v187, v187, v251
  v_mul_f32 v188, v188, v252
  v_mul_f32 v189, v189, v253
  v_mul_f32 v190, v190, v254
  v_mul_f32 v191, v191, v255
  v_mfma_f32_32x32x16_bf16 v[152:167], a[28:31], a[132:135], v[152:167]
  ds_read_b64_tr_b16 a[56:57], v28 offset:160
  ds_read_b64_tr_b16 a[58:59], v28 offset:1056
  s_mul_i32 s95, s95, 0x38000
  v_cvt_pk_bf16_f32 v60, v184, v185
  v_cvt_pk_bf16_f32 v61, v186, v187
  v_cvt_pk_bf16_f32 v62, v188, v189
  v_cvt_pk_bf16_f32 v63, v190, v191
  s_nop 0
  v_permlane32_swap_b32 v60, v62
  v_permlane32_swap_b32 v61, v63
  s_add_u32 s15, s85, 0
  buffer_store_dwordx4 v[60:63], v1, s[60:63], s15 offen sc1
  v_mfma_f32_32x32x16_bf16 v[168:183], a[32:35], a[132:135], v[168:183]
  ds_read_b64_tr_b16 a[60:61], v28 offset:192
  ds_read_b64_tr_b16 a[62:63], v28 offset:1088
  s_add_u32 s95, s95, s78
  v_mul_f32 v200, v200, v248
  v_mul_f32 v201, v201, v249
  v_mul_f32 v202, v202, v250
  v_mul_f32 v203, v203, v251
  v_mul_f32 v204, v204, v252
  v_mul_f32 v205, v205, v253
  v_mul_f32 v206, v206, v254
  v_mul_f32 v207, v207, v255
  v_mfma_f32_32x32x16_bf16 v[72:87], a[36:39], a[136:139], v[72:87]
  ds_read_b64_tr_b16 a[0:1], v29
  ds_read_b64_tr_b16 a[2:3], v29 offset:896
  buffer_load_dwordx4 v7, s[48:51], s95 offen lds
  buffer_load_dwordx4 v8, s[48:51], s95 offen offset:1024 lds
  v_cvt_pk_bf16_f32 v64, v200, v201
  v_cvt_pk_bf16_f32 v65, v202, v203
  v_cvt_pk_bf16_f32 v66, v204, v205
  v_cvt_pk_bf16_f32 v67, v206, v207
  s_nop 0
  v_permlane32_swap_b32 v64, v66
  v_permlane32_swap_b32 v65, v67
  s_add_u32 s15, s85, 0x20000
  buffer_store_dwordx4 v[64:67], v1, s[60:63], s15 offen sc1
  s_waitcnt lgkmcnt(6)
  v_mfma_f32_32x32x16_bf16 v[88:103], a[40:43], a[136:139], v[88:103]
  ds_read_b64_tr_b16 a[4:5], v29 offset:32
  ds_read_b64_tr_b16 a[6:7], v29 offset:928
  buffer_load_dwordx4 v9, s[48:51], s95 offen offset:2048 lds
  ds_read_b128 v[248:251], v68 offset:30912
  ds_read_b128 v[252:255], v68 offset:30944
  s_waitcnt lgkmcnt(1)
  v_mul_f32 v192, v192, v248
  v_mul_f32 v193, v193, v249
  v_mul_f32 v194, v194, v250
  v_mul_f32 v195, v195, v251
  s_waitcnt lgkmcnt(0)
  v_mul_f32 v196, v196, v252
  v_mul_f32 v197, v197, v253
  v_mfma_f32_32x32x16_bf16 v[104:119], a[44:47], a[136:139], v[104:119]
  ds_read_b64_tr_b16 a[8:9], v29 offset:64
  ds_read_b64_tr_b16 a[10:11], v29 offset:960
  buffer_load_dwordx4 v10, s[48:51], s95 offen offset:3072 lds
  v_mul_f32 v198, v198, v254
  v_mul_f32 v199, v199, v255
  v_cvt_pk_bf16_f32 v60, v192, v193
  v_cvt_pk_bf16_f32 v61, v194, v195
  v_cvt_pk_bf16_f32 v62, v196, v197
  v_cvt_pk_bf16_f32 v63, v198, v199
  s_nop 0
  v_permlane32_swap_b32 v60, v62
  v_permlane32_swap_b32 v61, v63
  v_mfma_f32_32x32x16_bf16 v[120:135], a[48:51], a[136:139], v[120:135]
  ds_read_b64_tr_b16 a[12:13], v29 offset:96
  ds_read_b64_tr_b16 a[14:15], v29 offset:992
  s_add_u32 m0, s83, 0x19000
  s_add_u32 s15, s85, 0
  buffer_store_dwordx4 v[60:63], v1, s[60:63], s15 offen offset:1024 sc1
  v_mul_f32 v208, v208, v248
  v_mul_f32 v209, v209, v249
  v_mul_f32 v210, v210, v250
  v_mul_f32 v211, v211, v251
  v_mul_f32 v212, v212, v252
  v_mul_f32 v213, v213, v253
  v_mfma_f32_32x32x16_bf16 v[136:151], a[52:55], a[136:139], v[136:151]
  ds_read_b64_tr_b16 a[16:17], v29 offset:128
  ds_read_b64_tr_b16 a[18:19], v29 offset:1024
  ds_read_b64_tr_b16 a[20:21], v29 offset:160
  ds_read_b64_tr_b16 a[22:23], v29 offset:1056
  ds_read_b64_tr_b16 a[24:25], v29 offset:192
  ds_read_b64_tr_b16 a[26:27], v29 offset:1088
  buffer_load_dwordx4 v11, s[48:51], s95 offen lds
  v_mul_f32 v214, v214, v254
  v_mul_f32 v215, v215, v255
  v_cvt_pk_bf16_f32 v64, v208, v209
  v_cvt_pk_bf16_f32 v65, v210, v211
  v_cvt_pk_bf16_f32 v66, v212, v213
  v_cvt_pk_bf16_f32 v67, v214, v215
  s_nop 0
  v_permlane32_swap_b32 v64, v66
  v_permlane32_swap_b32 v65, v67
  v_mfma_f32_32x32x16_bf16 v[152:167], a[56:59], a[136:139], v[152:167]
  buffer_load_dwordx4 v12, s[48:51], s95 offen offset:1024 lds
  buffer_load_dwordx4 v13, s[48:51], s95 offen offset:2048 lds
  s_add_u32 s15, s85, 0x20000
  buffer_store_dwordx4 v[64:67], v1, s[60:63], s15 offen offset:1024 sc1
  v_mfma_f32_32x32x16_bf16 v[168:183], a[60:63], a[136:139], v[168:183]
  s_waitcnt vmcnt(25) lgkmcnt(0)
  s_barrier
  v_mfma_f32_32x32x16_bf16 v[72:87], a[0:3], a[140:143], v[72:87]
  v_subrev_u32 v26, 0x20000, v26
  ds_read_b64_tr_b16 a[28:29], v26
  ds_read_b64_tr_b16 a[30:31], v26 offset:896
  s_add_u32 m0, s83, 0x20000
  s_lshl_b32 s14, s3, 10
  v_add_u32 v69, s14, v1
  ds_read_b128 v[52:55], v69 offset:61568
  v_mfma_f32_32x32x16_bf16 v[88:103], a[4:7], a[140:143], v[88:103]
  ds_read_b64_tr_b16 a[32:33], v26 offset:32
  ds_read_b64_tr_b16 a[34:35], v26 offset:928
  s_add_u32 s95, s19, 5
  v_mfma_f32_32x32x16_bf16 v[104:119], a[8:11], a[140:143], v[104:119]
  ds_read_b64_tr_b16 a[36:37], v26 offset:64
  ds_read_b64_tr_b16 a[38:39], v26 offset:960
  s_and_b32 s95, s95, 7
  v_mfma_f32_32x32x16_bf16 v[120:135], a[12:15], a[140:143], v[120:135]
  ds_read_b64_tr_b16 a[40:41], v26 offset:96
  ds_read_b64_tr_b16 a[42:43], v26 offset:992
  s_mul_i32 s95, s95, 0x38000
  v_lshrrev_b32 v69, 2, v69
  v_cmp_gt_u32 vcc, 0x380, v69
  s_nop 1
  v_cndmask_b32 v69, v33, v69, vcc
  s_lshl_b32 s14, s19, 10
  s_add_u32 s14, s14, s20
  s_waitcnt lgkmcnt(6)
  v_add_f32 v52, v52, v53
  v_add_f32 v54, v54, v55
  v_add_f32 v52, v52, v54
  v_cvt_pk_bf16_f32 v53, v52, v52
  v_mfma_f32_32x32x16_bf16 v[136:151], a[16:19], a[140:143], v[136:151]
  ds_read_b64_tr_b16 a[44:45], v26 offset:128
  ds_read_b64_tr_b16 a[46:47], v26 offset:1024
  s_add_u32 s95, s95, s78
  v_and_b32 v53, 0xffff0000, v53
  v_sub_f32 v53, v52, v53
  v_cvt_pk_bf16_f32 v53, v52, v53
  buffer_store_dword v53, v69, s[60:63], s14 offen sc1
  v_mfma_f32_32x32x16_bf16 v[152:167], a[20:23], a[140:143], v[152:167]
  ds_read_b64_tr_b16 a[48:49], v26 offset:160
  ds_read_b64_tr_b16 a[50:51], v26 offset:1056
  buffer_load_dwordx4 v7, s[48:51], s95 offen lds
  v_mfma_f32_32x32x16_bf16 v[168:183], a[24:27], a[140:143], v[168:183]
  ds_read_b64_tr_b16 a[52:53], v26 offset:192
  ds_read_b64_tr_b16 a[54:55], v26 offset:1088
  buffer_load_dwordx4 v8, s[48:51], s95 offen offset:1024 lds
  s_waitcnt lgkmcnt(8)
  v_mfma_f32_32x32x16_bf16 v[72:87], a[28:31], a[144:147], v[72:87]
  v_subrev_u32 v27, 0x20000, v27
  ds_read_b64_tr_b16 a[56:57], v27
  ds_read_b64_tr_b16 a[58:59], v27 offset:896
  buffer_load_dwordx4 v9, s[48:51], s95 offen offset:2048 lds
  v_mfma_f32_32x32x16_bf16 v[88:103], a[32:35], a[144:147], v[88:103]
  ds_read_b64_tr_b16 a[60:61], v27 offset:32
  ds_read_b64_tr_b16 a[62:63], v27 offset:928
  buffer_load_dwordx4 v10, s[48:51], s95 offen offset:3072 lds
  v_mfma_f32_32x32x16_bf16 v[104:119], a[36:39], a[144:147], v[104:119]
  ds_read_b64_tr_b16 a[0:1], v27 offset:64
  ds_read_b64_tr_b16 a[2:3], v27 offset:960
  s_add_u32 m0, s83, 0x21000
  s_waitcnt lgkmcnt(6)
  v_mfma_f32_32x32x16_bf16 v[120:135], a[40:43], a[144:147], v[120:135]
  ds_read_b64_tr_b16 a[4:5], v27 offset:96
  ds_read_b64_tr_b16 a[6:7], v27 offset:992
  buffer_load_dwordx4 v11, s[48:51], s95 offen lds
  v_mfma_f32_32x32x16_bf16 v[136:151], a[44:47], a[144:147], v[136:151]
  ds_read_b64_tr_b16 a[8:9], v27 offset:128
  ds_read_b64_tr_b16 a[10:11], v27 offset:1024
  buffer_load_dwordx4 v12, s[48:51], s95 offen offset:1024 lds
  v_mfma_f32_32x32x16_bf16 v[152:167], a[48:51], a[144:147], v[152:167]
  ds_read_b64_tr_b16 a[12:13], v27 offset:160
  ds_read_b64_tr_b16 a[14:15], v27 offset:1056
  buffer_load_dwordx4 v13, s[48:51], s95 offen offset:2048 lds
  v_mfma_f32_32x32x16_bf16 v[168:183], a[52:55], a[144:147], v[168:183]
  ds_read_b64_tr_b16 a[16:17], v27 offset:192
  ds_read_b64_tr_b16 a[18:19], v27 offset:1088
  s_waitcnt lgkmcnt(6)
  v_mfma_f32_32x32x16_bf16 v[72:87], a[56:59], a[148:151], v[72:87]
  v_subrev_u32 v28, 0x20000, v28
  ds_read_b64_tr_b16 a[20:21], v28
  ds_read_b64_tr_b16 a[22:23], v28 offset:896
  s_waitcnt vmcnt(7)
  s_barrier
  v_cmp_ne_u32 vcc, 0, v34
  s_nop 0
  s_cmp_eq_u64 vcc, -1
  s_cbranch_scc0 L0_slow_nonce
L0_res_nonce:
  s_mov_b32 s94, 0
  buffer_store_dwordx2 v[34:35], v33, s[60:63], s94 offen sc1
  v_mfma_f32_32x32x16_bf16 v[88:103], a[60:63], a[148:151], v[88:103]
  ds_read_b64_tr_b16 a[24:25], v28 offset:32
  ds_read_b64_tr_b16 a[26:27], v28 offset:928
  v_mfma_f32_32x32x16_bf16 v[104:119], a[0:3], a[148:151], v[104:119]
  ds_read_b64_tr_b16 a[28:29], v28 offset:64
  ds_read_b64_tr_b16 a[30:31], v28 offset:960
  v_mfma_f32_32x32x16_bf16 v[120:135], a[4:7], a[148:151], v[120:135]
  ds_read_b64_tr_b16 a[32:33], v28 offset:96
  ds_read_b64_tr_b16 a[34:35], v28 offset:992
  s_waitcnt lgkmcnt(6)
  v_mfma_f32_32x32x16_bf16 v[136:151], a[8:11], a[148:151], v[136:151]
  ds_read_b64_tr_b16 a[36:37], v28 offset:128
  ds_read_b64_tr_b16 a[38:39], v28 offset:1024
  v_mfma_f32_32x32x16_bf16 v[152:167], a[12:15], a[148:151], v[152:167]
  ds_read_b64_tr_b16 a[40:41], v28 offset:160
  ds_read_b64_tr_b16 a[42:43], v28 offset:1056
  v_mfma_f32_32x32x16_bf16 v[168:183], a[16:19], a[148:151], v[168:183]
  ds_read_b64_tr_b16 a[44:45], v28 offset:192
  ds_read_b64_tr_b16 a[46:47], v28 offset:1088
  v_mfma_f32_32x32x16_bf16 v[72:87], a[20:23], a[152:155], v[72:87]
  v_subrev_u32 v29, 0x20000, v29
  ds_read_b64_tr_b16 a[48:49], v29
  ds_read_b64_tr_b16 a[50:51], v29 offset:896
  s_waitcnt lgkmcnt(6)
  v_mfma_f32_32x32x16_bf16 v[88:103], a[24:27], a[152:155], v[88:103]
  ds_read_b64_tr_b16 a[52:53], v29 offset:32
  ds_read_b64_tr_b16 a[54:55], v29 offset:928
  v_mfma_f32_32x32x16_bf16 v[104:119], a[28:31], a[152:155], v[104:119]
  ds_read_b64_tr_b16 a[56:57], v29 offset:64
  ds_read_b64_tr_b16 a[58:59], v29 offset:960
  v_mfma_f32_32x32x16_bf16 v[120:135], a[32:35], a[152:155], v[120:135]
  ds_read_b64_tr_b16 a[60:61], v29 offset:96
  ds_read_b64_tr_b16 a[62:63], v29 offset:992
  v_mfma_f32_32x32x16_bf16 v[136:151], a[36:39], a[152:155], v[136:151]
  ds_read_b64_tr_b16 a[0:1], v29 offset:128
  ds_read_b64_tr_b16 a[2:3], v29 offset:1024
  ds_read_b64_tr_b16 a[4:5], v29 offset:160
  ds_read_b64_tr_b16 a[6:7], v29 offset:1056
  ds_read_b64_tr_b16 a[8:9], v29 offset:192
  ds_read_b64_tr_b16 a[10:11], v29 offset:1088
  s_waitcnt lgkmcnt(10)
  v_mfma_f32_32x32x16_bf16 v[152:167], a[40:43], a[152:155], v[152:167]
  v_mfma_f32_32x32x16_bf16 v[168:183], a[44:47], a[152:155], v[168:183]
  s_waitcnt lgkmcnt(0)
  s_barrier
  v_mfma_f32_32x32x16_bf16 v[72:87], a[48:51], a[156:159], v[72:87]
  v_add_u32 v26, 0x8000, v26
  ds_read_b64_tr_b16 a[12:13], v26
  ds_read_b64_tr_b16 a[14:15], v26 offset:896
  v_mfma_f32_32x32x16_bf16 v[88:103], a[52:55], a[156:159], v[88:103]
  ds_read_b64_tr_b16 a[16:17], v26 offset:32
  ds_read_b64_tr_b16 a[18:19], v26 offset:928
  s_add_u32 m0, s83, 0
  v_mfma_f32_32x32x16_bf16 v[104:119], a[56:59], a[156:159], v[104:119]
  ds_read_b64_tr_b16 a[20:21], v26 offset:64
  ds_read_b64_tr_b16 a[22:23], v26 offset:960
  s_add_u32 s95, s19, 6
  v_mfma_f32_32x32x16_bf16 v[120:135], a[60:63], a[156:159], v[120:135]
  ds_read_b64_tr_b16 a[24:25], v26 offset:96
  ds_read_b64_tr_b16 a[26:27], v26 offset:992
  s_and_b32 s95, s95, 7
  v_mfma_f32_32x32x16_bf16 v[136:151], a[0:3], a[156:159], v[136:151]
  ds_read_b64_tr_b16 a[28:29], v26 offset:128
  ds_read_b64_tr_b16 a[30:31], v26 offset:1024
  v_mfma_f32_32x32x16_bf16 v[152:167], a[4:7], a[156:159], v[152:167]
  ds_read_b64_tr_b16 a[32:33], v26 offset:160
  ds_read_b64_tr_b16 a[34:35], v26 offset:1056
  s_mul_i32 s95, s95, 0x38000
  v_mfma_f32_32x32x16_bf16 v[168:183], a[8:11], a[156:159], v[168:183]
  ds_read_b64_tr_b16 a[36:37], v26 offset:192
  ds_read_b64_tr_b16 a[38:39], v26 offset:1088
  s_add_u32 s95, s95, s78
  s_waitcnt lgkmcnt(8)
  v_mfma_f32_32x32x16_bf16 v[72:87], a[12:15], a[160:163], v[72:87]
  v_add_u32 v27, 0x8000, v27
  ds_read_b64_tr_b16 a[40:41], v27
  ds_read_b64_tr_b16 a[42:43], v27 offset:896
  buffer_load_dwordx4 v7, s[48:51], s95 offen lds
  v_mfma_f32_32x32x16_bf16 v[88:103], a[16:19], a[160:163], v[88:103]
  ds_read_b64_tr_b16 a[44:45], v27 offset:32
  ds_read_b64_tr_b16 a[46:47], v27 offset:928
  v_mfma_f32_32x32x16_bf16 v[104:119], a[20:23], a[160:163], v[104:119]
  ds_read_b64_tr_b16 a[48:49], v27 offset:64
  ds_read_b64_tr_b16 a[50:51], v27 offset:960
  buffer_load_dwordx4 v8, s[48:51], s95 offen offset:1024 lds
  s_waitcnt lgkmcnt(6)
  v_mfma_f32_32x32x16_bf16 v[120:135], a[24:27], a[160:163], v[120:135]
  ds_read_b64_tr_b16 a[52:53], v27 offset:96
  ds_read_b64_tr_b16 a[54:55], v27 offset:992
  buffer_load_dwordx4 v9, s[48:51], s95 offen offset:2048 lds
  v_mfma_f32_32x32x16_bf16 v[136:151], a[28:31], a[160:163], v[136:151]
  ds_read_b64_tr_b16 a[56:57], v27 offset:128
  ds_read_b64_tr_b16 a[58:59], v27 offset:1024
  buffer_load_dwordx4 v10, s[48:51], s95 offen offset:3072 lds
  v_mfma_f32_32x32x16_bf16 v[152:167], a[32:35], a[160:163], v[152:167]
  ds_read_b64_tr_b16 a[60:61], v27 offset:160
  ds_read_b64_tr_b16 a[62:63], v27 offset:1056
  v_mfma_f32_32x32x16_bf16 v[168:183], a[36:39], a[160:163], v[168:183]
  ds_read_b64_tr_b16 a[0:1], v27 offset:192
  ds_read_b64_tr_b16 a[2:3], v27 offset:1088
  s_add_u32 m0, s83, 0x1000
  s_waitcnt lgkmcnt(6)
  v_mfma_f32_32x32x16_bf16 v[72:87], a[40:43], a[164:167], v[72:87]
  v_add_u32 v28, 0x8000, v28
  ds_read_b64_tr_b16 a[4:5], v28
  ds_read_b64_tr_b16 a[6:7], v28 offset:896
  buffer_load_dwordx4 v11, s[48:51], s95 offen lds
  v_mfma_f32_32x32x16_bf16 v[88:103], a[44:47], a[164:167], v[88:103]
  ds_read_b64_tr_b16 a[8:9], v28 offset:32
  ds_read_b64_tr_b16 a[10:11], v28 offset:928
  buffer_load_dwordx4 v12, s[48:51], s95 offen offset:1024 lds
  v_mfma_f32_32x32x16_bf16 v[104:119], a[48:51], a[164:167], v[104:119]
  ds_read_b64_tr_b16 a[12:13], v28 offset:64
  ds_read_b64_tr_b16 a[14:15], v28 offset:960
  v_mfma_f32_32x32x16_bf16 v[120:135], a[52:55], a[164:167], v[120:135]
  ds_read_b64_tr_b16 a[16:17], v28 offset:96
  ds_read_b64_tr_b16 a[18:19], v28 offset:992
  buffer_load_dwordx4 v13, s[48:51], s95 offen offset:2048 lds
  s_waitcnt lgkmcnt(6)
  v_mfma_f32_32x32x16_bf16 v[136:151], a[56:59], a[164:167], v[136:151]
  ds_read_b64_tr_b16 a[20:21], v28 offset:128
  ds_read_b64_tr_b16 a[22:23], v28 offset:1024
  v_mfma_f32_32x32x16_bf16 v[152:167], a[60:63], a[164:167], v[152:167]
  ds_read_b64_tr_b16 a[24:25], v28 offset:160
  ds_read_b64_tr_b16 a[26:27], v28 offset:1056
  v_mfma_f32_32x32x16_bf16 v[168:183], a[0:3], a[164:167], v[168:183]
  ds_read_b64_tr_b16 a[28:29], v28 offset:192
  ds_read_b64_tr_b16 a[30:31], v28 offset:1088
  v_mfma_f32_32x32x16_bf16 v[72:87], a[4:7], a[168:171], v[72:87]
  v_add_u32 v29, 0x8000, v29
  ds_read_b64_tr_b16 a[32:33], v29
  ds_read_b64_tr_b16 a[34:35], v29 offset:896
  s_waitcnt lgkmcnt(6)
  v_mfma_f32_32x32x16_bf16 v[88:103], a[8:11], a[168:171], v[88:103]
  ds_read_b64_tr_b16 a[36:37], v29 offset:32
  ds_read_b64_tr_b16 a[38:39], v29 offset:928
  v_mfma_f32_32x32x16_bf16 v[104:119], a[12:15], a[168:171], v[104:119]
  ds_read_b64_tr_b16 a[40:41], v29 offset:64
  ds_read_b64_tr_b16 a[42:43], v29 offset:960
  v_mfma_f32_32x32x16_bf16 v[120:135], a[16:19], a[168:171], v[120:135]
  ds_read_b64_tr_b16 a[44:45], v29 offset:96
  ds_read_b64_tr_b16 a[46:47], v29 offset:992
  v_mfma_f32_32x32x16_bf16 v[136:151], a[20:23], a[168:171], v[136:151]
  ds_read_b64_tr_b16 a[48:49], v29 offset:128
  ds_read_b64_tr_b16 a[50:51], v29 offset:1024
  ds_read_b64_tr_b16 a[52:53], v29 offset:160
  ds_read_b64_tr_b16 a[54:55], v29 offset:1056
  ds_read_b64_tr_b16 a[56:57], v29 offset:192
  ds_read_b64_tr_b16 a[58:59], v29 offset:1088
  s_waitcnt lgkmcnt(10)
  v_mfma_f32_32x32x16_bf16 v[152:167], a[24:27], a[168:171], v[152:167]
  v_mfma_f32_32x32x16_bf16 v[168:183], a[28:31], a[168:171], v[168:183]
  s_waitcnt lgkmcnt(0)
  s_barrier
  v_mfma_f32_32x32x16_bf16 v[72:87], a[32:35], a[172:175], v[72:87]
  v_add_u32 v26, 0x8000, v26
  ds_read_b64_tr_b16 a[60:61], v26
  ds_read_b64_tr_b16 a[62:63], v26 offset:896
  v_mfma_f32_32x32x16_bf16 v[88:103], a[36:39], a[172:175], v[88:103]
  ds_read_b64_tr_b16 a[0:1], v26 offset:32
  ds_read_b64_tr_b16 a[2:3], v26 offset:928
  s_add_u32 m0, s83, 0x8000
  v_mfma_f32_32x32x16_bf16 v[104:119], a[40:43], a[172:175], v[104:119]
  ds_read_b64_tr_b16 a[4:5], v26 offset:64
  ds_read_b64_tr_b16 a[6:7], v26 offset:960
  s_add_u32 s95, s19, 7
  v_mfma_f32_32x32x16_bf16 v[120:135], a[44:47], a[172:175], v[120:135]
  ds_read_b64_tr_b16 a[8:9], v26 offset:96
  ds_read_b64_tr_b16 a[10:11], v26 offset:992
  s_and_b32 s95, s95, 7
  v_mfma_f32_32x32x16_bf16 v[136:151], a[48:51], a[172:175], v[136:151]
  ds_read_b64_tr_b16 a[12:13], v26 offset:128
  ds_read_b64_tr_b16 a[14:15], v26 offset:1024
  s_mul_i32 s95, s95, 0x38000
  v_mfma_f32_32x32x16_bf16 v[152:167], a[52:55], a[172:175], v[152:167]
  ds_read_b64_tr_b16 a[16:17], v26 offset:160
  ds_read_b64_tr_b16 a[18:19], v26 offset:1056
  s_add_u32 s95, s95, s78
  v_mfma_f32_32x32x16_bf16 v[168:183], a[56:59], a[172:175], v[168:183]
  ds_read_b64_tr_b16 a[20:21], v26 offset:192
  ds_read_b64_tr_b16 a[22:23], v26 offset:1088
  buffer_load_dwordx4 v7, s[48:51], s95 offen lds
  s_waitcnt lgkmcnt(8)
  v_mfma_f32_32x32x16_bf16 v[72:87], a[60:63], a[176:179], v[72:87]
  v_add_u32 v27, 0x8000, v27
  ds_read_b64_tr_b16 a[24:25], v27
  ds_read_b64_tr_b16 a[26:27], v27 offset:896
  buffer_load_dwordx4 v8, s[48:51], s95 offen offset:1024 lds
  v_mfma_f32_32x32x16_bf16 v[88:103], a[0:3], a[176:179], v[88:103]
  ds_read_b64_tr_b16 a[28:29], v27 offset:32
  ds_read_b64_tr_b16 a[30:31], v27 offset:928
  buffer_load_dwordx4 v9, s[48:51], s95 offen offset:2048 lds
  v_mfma_f32_32x32x16_bf16 v[104:119], a[4:7], a[176:179], v[104:119]
  ds_read_b64_tr_b16 a[32:33], v27 offset:64
  ds_read_b64_tr_b16 a[34:35], v27 offset:960
  buffer_load_dwordx4 v10, s[48:51], s95 offen offset:3072 lds
  s_waitcnt lgkmcnt(6)
  v_mfma_f32_32x32x16_bf16 v[120:135], a[8:11], a[176:179], v[120:135]
  ds_read_b64_tr_b16 a[36:37], v27 offset:96
  ds_read_b64_tr_b16 a[38:39], v27 offset:992
  s_add_u32 m0, s83, 0x9000
  v_mfma_f32_32x32x16_bf16 v[136:151], a[12:15], a[176:179], v[136:151]
  ds_read_b64_tr_b16 a[40:41], v27 offset:128
  ds_read_b64_tr_b16 a[42:43], v27 offset:1024
  buffer_load_dwordx4 v11, s[48:51], s95 offen lds
  v_mfma_f32_32x32x16_bf16 v[152:167], a[16:19], a[176:179], v[152:167]
  ds_read_b64_tr_b16 a[44:45], v27 offset:160
  ds_read_b64_tr_b16 a[46:47], v27 offset:1056
  buffer_load_dwordx4 v12, s[48:51], s95 offen offset:1024 lds
  v_mfma_f32_32x32x16_bf16 v[168:183], a[20:23], a[176:179], v[168:183]
  ds_read_b64_tr_b16 a[48:49], v27 offset:192
  ds_read_b64_tr_b16 a[50:51], v27 offset:1088
  buffer_load_dwordx4 v13, s[48:51], s95 offen offset:2048 lds
  s_waitcnt lgkmcnt(6)
  v_mfma_f32_32x32x16_bf16 v[72:87], a[24:27], a[180:183], v[72:87]
  v_add_u32 v28, 0x8000, v28
  ds_read_b64_tr_b16 a[52:53], v28
  ds_read_b64_tr_b16 a[54:55], v28 offset:896
  v_mfma_f32_32x32x16_bf16 v[88:103], a[28:31], a[180:183], v[88:103]
  ds_read_b64_tr_b16 a[56:57], v28 offset:32
  ds_read_b64_tr_b16 a[58:59], v28 offset:928
  v_mfma_f32_32x32x16_bf16 v[104:119], a[32:35], a[180:183], v[104:119]
  ds_read_b64_tr_b16 a[60:61], v28 offset:64
  ds_read_b64_tr_b16 a[62:63], v28 offset:960
  buffer_load_dwordx2 v[36:37], v30, s[60:63], 0 offen sc1
  v_mfma_f32_32x32x16_bf16 v[120:135], a[36:39], a[180:183], v[120:135]
  ds_read_b64_tr_b16 a[0:1], v28 offset:96
  ds_read_b64_tr_b16 a[2:3], v28 offset:992
  s_waitcnt lgkmcnt(6)
  v_mfma_f32_32x32x16_bf16 v[136:151], a[40:43], a[180:183], v[136:151]
  ds_read_b64_tr_b16 a[4:5], v28 offset:128
  ds_read_b64_tr_b16 a[6:7], v28 offset:1024
  v_mfma_f32_32x32x16_bf16 v[152:167], a[44:47], a[180:183], v[152:167]
  ds_read_b64_tr_b16 a[8:9], v28 offset:160
  ds_read_b64_tr_b16 a[10:11], v28 offset:1056
  v_mfma_f32_32x32x16_bf16 v[168:183], a[48:51], a[180:183], v[168:183]
  ds_read_b64_tr_b16 a[12:13], v28 offset:192
  ds_read_b64_tr_b16 a[14:15], v28 offset:1088
  v_mfma_f32_32x32x16_bf16 v[72:87], a[52:55], a[184:187], v[72:87]
  v_add_u32 v29, 0x8000, v29
  ds_read_b64_tr_b16 a[16:17], v29
  ds_read_b64_tr_b16 a[18:19], v29 offset:896
  s_waitcnt lgkmcnt(6)
  v_mfma_f32_32x32x16_bf16 v[88:103], a[56:59], a[184:187], v[88:103]
  ds_read_b64_tr_b16 a[20:21], v29 offset:32
  ds_read_b64_tr_b16 a[22:23], v29 offset:928
  v_mfma_f32_32x32x16_bf16 v[104:119], a[60:63], a[184:187], v[104:119]
  ds_read_b64_tr_b16 a[24:25], v29 offset:64
  ds_read_b64_tr_b16 a[26:27], v29 offset:960
  v_mfma_f32_32x32x16_bf16 v[120:135], a[0:3], a[184:187], v[120:135]
  ds_read_b64_tr_b16 a[28:29], v29 offset:96
  ds_read_b64_tr_b16 a[30:31], v29 offset:992
  v_mfma_f32_32x32x16_bf16 v[136:151], a[4:7], a[184:187], v[136:151]
  ds_read_b64_tr_b16 a[32:33], v29 offset:128
  ds_read_b64_tr_b16 a[34:35], v29 offset:1024
  ds_read_b64_tr_b16 a[36:37], v29 offset:160
  ds_read_b64_tr_b16 a[38:39], v29 offset:1056
  ds_read_b64_tr_b16 a[40:41], v29 offset:192
  ds_read_b64_tr_b16 a[42:43], v29 offset:1088
  s_waitcnt lgkmcnt(10)
  v_mfma_f32_32x32x16_bf16 v[152:167], a[8:11], a[184:187], v[152:167]
  v_mfma_f32_32x32x16_bf16 v[168:183], a[12:15], a[184:187], v[168:183]
  s_waitcnt lgkmcnt(0)
  s_barrier
  v_mfma_f32_32x32x16_bf16 v[72:87], a[16:19], a[188:191], v[72:87]
  v_add_u32 v26, 0x8000, v26
  ds_read_b64_tr_b16 a[44:45], v26
  ds_read_b64_tr_b16 a[46:47], v26 offset:896
  v_mfma_f32_32x32x16_bf16 v[88:103], a[20:23], a[188:191], v[88:103]
  ds_read_b64_tr_b16 a[48:49], v26 offset:32
  ds_read_b64_tr_b16 a[50:51], v26 offset:928
  s_add_u32 s95, s98, 0
  v_mfma_f32_32x32x16_bf16 v[104:119], a[24:27], a[188:191], v[104:119]
  ds_read_b64_tr_b16 a[52:53], v26 offset:64
  ds_read_b64_tr_b16 a[54:55], v26 offset:960
  s_and_b32 s95, s95, 0x7ff
  v_mfma_f32_32x32x16_bf16 v[120:135], a[28:31], a[188:191], v[120:135]
  ds_read_b64_tr_b16 a[56:57], v26 offset:96
  ds_read_b64_tr_b16 a[58:59], v26 offset:992
  s_add_u32 s95, s95, s80
  v_mfma_f32_32x32x16_bf16 v[136:151], a[32:35], a[188:191], v[136:151]
  ds_read_b64_tr_b16 a[60:61], v26 offset:128
  ds_read_b64_tr_b16 a[62:63], v26 offset:1024
  v_mfma_f32_32x32x16_bf16 v[152:167], a[36:39], a[188:191], v[152:167]
  ds_read_b64_tr_b16 a[0:1], v26 offset:160
  ds_read_b64_tr_b16 a[2:3], v26 offset:1056
  s_add_u32 m0, s72, 0x10000
  v_mfma_f32_32x32x16_bf16 v[168:183], a[40:43], a[188:191], v[168:183]
  ds_read_b64_tr_b16 a[4:5], v26 offset:192
  ds_read_b64_tr_b16 a[6:7], v26 offset:1088
  buffer_load_dwordx4 v22, s[52:55], s95 offen lds
  s_waitcnt lgkmcnt(8)
  v_mfma_f32_32x32x16_bf16 v[72:87], a[44:47], a[192:195], v[72:87]
  v_add_u32 v27, 0x8000, v27
  ds_read_b64_tr_b16 a[8:9], v27
  ds_read_b64_tr_b16 a[10:11], v27 offset:896
  buffer_load_dwordx4 v23, s[52:55], s95 offen offset:1024 lds
  v_mfma_f32_32x32x16_bf16 v[88:103], a[48:51], a[192:195], v[88:103]
  ds_read_b64_tr_b16 a[12:13], v27 offset:32
  ds_read_b64_tr_b16 a[14:15], v27 offset:928
  v_mfma_f32_32x32x16_bf16 v[104:119], a[52:55], a[192:195], v[104:119]
  ds_read_b64_tr_b16 a[16:17], v27 offset:64
  ds_read_b64_tr_b16 a[18:19], v27 offset:960
  buffer_load_dwordx4 v24, s[52:55], s95 offen offset:2048 lds
  s_waitcnt lgkmcnt(6)
  v_mfma_f32_32x32x16_bf16 v[120:135], a[56:59], a[192:195], v[120:135]
  ds_read_b64_tr_b16 a[20:21], v27 offset:96
  ds_read_b64_tr_b16 a[22:23], v27 offset:992
  buffer_load_dwordx4 v25, s[52:55], s95 offen offset:3072 lds
  v_mfma_f32_32x32x16_bf16 v[136:151], a[60:63], a[192:195], v[136:151]
  ds_read_b64_tr_b16 a[24:25], v27 offset:128
  ds_read_b64_tr_b16 a[26:27], v27 offset:1024
  s_add_u32 m0, s72, 0x14000
  v_mfma_f32_32x32x16_bf16 v[152:167], a[0:3], a[192:195], v[152:167]
  ds_read_b64_tr_b16 a[28:29], v27 offset:160
  ds_read_b64_tr_b16 a[30:31], v27 offset:1056
  v_mfma_f32_32x32x16_bf16 v[168:183], a[4:7], a[192:195], v[168:183]
  ds_read_b64_tr_b16 a[32:33], v27 offset:192
  ds_read_b64_tr_b16 a[34:35], v27 offset:1088
  s_add_u32 s95, s95, 0x80
  s_waitcnt lgkmcnt(6)
  v_mfma_f32_32x32x16_bf16 v[72:87], a[8:11], a[196:199], v[72:87]
  v_add_u32 v28, 0x8000, v28
  ds_read_b64_tr_b16 a[36:37], v28
  ds_read_b64_tr_b16 a[38:39], v28 offset:896
  buffer_load_dwordx4 v22, s[52:55], s95 offen lds
  v_mfma_f32_32x32x16_bf16 v[88:103], a[12:15], a[196:199], v[88:103]
  ds_read_b64_tr_b16 a[40:41], v28 offset:32
  ds_read_b64_tr_b16 a[42:43], v28 offset:928
  buffer_load_dwordx4 v23, s[52:55], s95 offen offset:1024 lds
  v_mfma_f32_32x32x16_bf16 v[104:119], a[16:19], a[196:199], v[104:119]
  ds_read_b64_tr_b16 a[44:45], v28 offset:64
  ds_read_b64_tr_b16 a[46:47], v28 offset:960
  v_mfma_f32_32x32x16_bf16 v[120:135], a[20:23], a[196:199], v[120:135]
  ds_read_b64_tr_b16 a[48:49], v28 offset:96
  ds_read_b64_tr_b16 a[50:51], v28 offset:992
  buffer_load_dwordx4 v24, s[52:55], s95 offen offset:2048 lds
  s_waitcnt lgkmcnt(6)
  v_mfma_f32_32x32x16_bf16 v[136:151], a[24:27], a[196:199], v[136:151]
  ds_read_b64_tr_b16 a[52:53], v28 offset:128
  ds_read_b64_tr_b16 a[54:55], v28 offset:1024
  buffer_load_dwordx4 v25, s[52:55], s95 offen offset:3072 lds
  v_mfma_f32_32x32x16_bf16 v[152:167], a[28:31], a[196:199], v[152:167]
  ds_read_b64_tr_b16 a[56:57], v28 offset:160
  ds_read_b64_tr_b16 a[58:59], v28 offset:1056
  v_mfma_f32_32x32x16_bf16 v[168:183], a[32:35], a[196:199], v[168:183]
  ds_read_b64_tr_b16 a[60:61], v28 offset:192
  ds_read_b64_tr_b16 a[62:63], v28 offset:1088
  v_mfma_f32_32x32x16_bf16 v[72:87], a[36:39], a[200:203], v[72:87]
  v_add_u32 v29, 0x8000, v29
  ds_read_b64_tr_b16 a[0:1], v29
  ds_read_b64_tr_b16 a[2:3], v29 offset:896
  s_waitcnt lgkmcnt(6)
  v_mfma_f32_32x32x16_bf16 v[88:103], a[40:43], a[200:203], v[88:103]
  ds_read_b64_tr_b16 a[4:5], v29 offset:32
  ds_read_b64_tr_b16 a[6:7], v29 offset:928
  v_mfma_f32_32x32x16_bf16 v[104:119], a[44:47], a[200:203], v[104:119]
  ds_read_b64_tr_b16 a[8:9], v29 offset:64
  ds_read_b64_tr_b16 a[10:11], v29 offset:960
  s_waitcnt vmcnt(8)
  v_cmp_eq_u64 vcc, v[36:37], v[34:35]
  s_nop 0
  s_cmp_eq_u64 vcc, -1
  s_cbranch_scc0 L0_slow_ka
L0_res_ka:
  s_add_u32 s25, s100, 0
  s_and_b32 s25, s25, 0xffff
  s_add_u32 s25, s25, s79
  buffer_load_dwordx4 a[64:67], v1, s[60:63], s25 offen sc1
  buffer_load_dwordx4 a[68:71], v1, s[60:63], s25 offen offset:1024 sc1
  v_mfma_f32_32x32x16_bf16 v[120:135], a[48:51], a[200:203], v[120:135]
  ds_read_b64_tr_b16 a[12:13], v29 offset:96
  ds_read_b64_tr_b16 a[14:15], v29 offset:992
  buffer_load_dwordx4 a[72:75], v1, s[60:63], s25 offen offset:2048 sc1
  buffer_load_dwordx4 a[76:79], v1, s[60:63], s25 offen offset:3072 sc1
  s_add_u32 s25, s25, 0x1000
  buffer_load_dwordx4 a[80:83], v1, s[60:63], s25 offen sc1
  buffer_load_dwordx4 a[84:87], v1, s[60:63], s25 offen offset:1024 sc1
  buffer_load_dwordx4 a[88:91], v1, s[60:63], s25 offen offset:2048 sc1
  v_mfma_f32_32x32x16_bf16 v[136:151], a[52:55], a[200:203], v[136:151]
  ds_read_b64_tr_b16 a[16:17], v29 offset:128
  ds_read_b64_tr_b16 a[18:19], v29 offset:1024
  ds_read_b64_tr_b16 a[20:21], v29 offset:160
  ds_read_b64_tr_b16 a[22:23], v29 offset:1056
  ds_read_b64_tr_b16 a[24:25], v29 offset:192
  ds_read_b64_tr_b16 a[26:27], v29 offset:1088
  buffer_load_dwordx4 a[92:95], v1, s[60:63], s25 offen offset:3072 sc1
  v_mov_b32 v68, 0x7fff0000
  v_cmp_gt_u32 vcc, 0x380, v1
  s_nop 1
  v_cndmask_b32 v68, v68, v1, vcc
  s_add_u32 s14, s20, 0x1000
  buffer_load_dwordx4 v[216:219], v68, s[60:63], s20 offen sc1
  buffer_load_dwordx4 v[220:223], v68, s[60:63], s20 offen offset:1024 sc1
  s_waitcnt lgkmcnt(10)
  v_mfma_f32_32x32x16_bf16 v[152:167], a[56:59], a[200:203], v[152:167]
  buffer_load_dwordx4 v[224:227], v68, s[60:63], s20 offen offset:2048 sc1
  buffer_load_dwordx4 v[228:231], v68, s[60:63], s20 offen offset:3072 sc1
  buffer_load_dwordx4 v[232:235], v68, s[60:63], s14 offen sc1
  buffer_load_dwordx4 v[236:239], v68, s[60:63], s14 offen offset:1024 sc1
  buffer_load_dwordx4 v[240:243], v68, s[60:63], s14 offen offset:2048 sc1
  buffer_load_dwordx4 v[244:247], v68, s[60:63], s14 offen offset:3072 sc1
  v_mfma_f32_32x32x16_bf16 v[168:183], a[60:63], a[200:203], v[168:183]
  s_waitcnt lgkmcnt(0)
  s_barrier
  v_mfma_f32_32x32x16_bf16 v[72:87], a[0:3], a[204:207], v[72:87]
  v_add_u32 v26, 0x8000, v26
  ds_read_b64_tr_b16 a[28:29], v26
  ds_read_b64_tr_b16 a[30:31], v26 offset:896
  v_mfma_f32_32x32x16_bf16 v[88:103], a[4:7], a[204:207], v[88:103]
  ds_read_b64_tr_b16 a[32:33], v26 offset:32
  ds_read_b64_tr_b16 a[34:35], v26 offset:928
  s_add_u32 s95, s98, 0x100
  v_mfma_f32_32x32x16_bf16 v[104:119], a[8:11], a[204:207], v[104:119]
  ds_read_b64_tr_b16 a[36:37], v26 offset:64
  ds_read_b64_tr_b16 a[38:39], v26 offset:960
  s_and_b32 s95, s95, 0x7ff
  v_mfma_f32_32x32x16_bf16 v[120:135], a[12:15], a[204:207], v[120:135]
  ds_read_b64_tr_b16 a[40:41], v26 offset:96
  ds_read_b64_tr_b16 a[42:43], v26 offset:992
  s_add_u32 s95, s95, s80
  v_mfma_f32_32x32x16_bf16 v[136:151], a[16:19], a[204:207], v[136:151]
  ds_read_b64_tr_b16 a[44:45], v26 offset:128
  ds_read_b64_tr_b16 a[46:47], v26 offset:1024
  v_mfma_f32_32x32x16_bf16 v[152:167], a[20:23], a[204:207], v[152:167]
  ds_read_b64_tr_b16 a[48:49], v26 offset:160
  ds_read_b64_tr_b16 a[50:51], v26 offset:1056
  s_add_u32 m0, s72, 0x18000
  v_mfma_f32_32x32x16_bf16 v[168:183], a[24:27], a[204:207], v[168:183]
  ds_read_b64_tr_b16 a[52:53], v26 offset:192
  ds_read_b64_tr_b16 a[54:55], v26 offset:1088
  buffer_load_dwordx4 v22, s[52:55], s95 offen lds
  s_waitcnt lgkmcnt(8)
  v_mfma_f32_32x32x16_bf16 v[72:87], a[28:31], a[208:211], v[72:87]
  v_add_u32 v27, 0x8000, v27
  ds_read_b64_tr_b16 a[56:57], v27
  ds_read_b64_tr_b16 a[58:59], v27 offset:896
  buffer_load_dwordx4 v23, s[52:55], s95 offen offset:1024 lds
  v_mfma_f32_32x32x16_bf16 v[88:103], a[32:35], a[208:211], v[88:103]
  ds_read_b64_tr_b16 a[60:61], v27 offset:32
  ds_read_b64_tr_b16 a[62:63], v27 offset:928
  v_mfma_f32_32x32x16_bf16 v[104:119], a[36:39], a[208:211], v[104:119]
  ds_read_b64_tr_b16 a[0:1], v27 offset:64
  ds_read_b64_tr_b16 a[2:3], v27 offset:960
  buffer_load_dwordx4 v24, s[52:55], s95 offen offset:2048 lds
  s_waitcnt lgkmcnt(6)
  v_mfma_f32_32x32x16_bf16 v[120:135], a[40:43], a[208:211], v[120:135]
  ds_read_b64_tr_b16 a[4:5], v27 offset:96
  ds_read_b64_tr_b16 a[6:7], v27 offset:992
  buffer_load_dwordx4 v25, s[52:55], s95 offen offset:3072 lds
  v_mfma_f32_32x32x16_bf16 v[136:151], a[44:47], a[208:211], v[136:151]
  ds_read_b64_tr_b16 a[8:9], v27 offset:128
  ds_read_b64_tr_b16 a[10:11], v27 offset:1024
  s_add_u32 m0, s72, 0x1c000
  v_mfma_f32_32x32x16_bf16 v[152:167], a[48:51], a[208:211], v[152:167]
  ds_read_b64_tr_b16 a[12:13], v27 offset:160
  ds_read_b64_tr_b16 a[14:15], v27 offset:1056
  v_mfma_f32_32x32x16_bf16 v[168:183], a[52:55], a[208:211], v[168:183]
  ds_read_b64_tr_b16 a[16:17], v27 offset:192
  ds_read_b64_tr_b16 a[18:19], v27 offset:1088
  s_add_u32 s95, s95, 0x80
  s_waitcnt lgkmcnt(6)
  v_mfma_f32_32x32x16_bf16 v[72:87], a[56:59], a[212:215], v[72:87]
  v_add_u32 v28, 0x8000, v28
  ds_read_b64_tr_b16 a[20:21], v28
  ds_read_b64_tr_b16 a[22:23], v28 offset:896
  buffer_load_dwordx4 v22, s[52:55], s95 offen lds
  v_mfma_f32_32x32x16_bf16 v[88:103], a[60:63], a[212:215], v[88:103]
  ds_read_b64_tr_b16 a[24:25], v28 offset:32
  ds_read_b64_tr_b16 a[26:27], v28 offset:928
  buffer_load_dwordx4 v23, s[52:55], s95 offen offset:1024 lds
  v_mfma_f32_32x32x16_bf16 v[104:119], a[0:3], a[212:215], v[104:119]
  ds_read_b64_tr_b16 a[28:29], v28 offset:64
  ds_read_b64_tr_b16 a[30:31], v28 offset:960
  v_mfma_f32_32x32x16_bf16 v[120:135], a[4:7], a[212:215], v[120:135]
  ds_read_b64_tr_b16 a[32:33], v28 offset:96
  ds_read_b64_tr_b16 a[34:35], v28 offset:992
  buffer_load_dwordx4 v24, s[52:55], s95 offen offset:2048 lds
  s_waitcnt lgkmcnt(6)
  v_mfma_f32_32x32x16_bf16 v[136:151], a[8:11], a[212:215], v[136:151]
  ds_read_b64_tr_b16 a[36:37], v28 offset:128
  ds_read_b64_tr_b16 a[38:39], v28 offset:1024
  buffer_load_dwordx4 v25, s[52:55], s95 offen offset:3072 lds
  v_mfma_f32_32x32x16_bf16 v[152:167], a[12:15], a[212:215], v[152:167]
  ds_read_b64_tr_b16 a[40:41], v28 offset:160
  ds_read_b64_tr_b16 a[42:43], v28 offset:1056
  v_mfma_f32_32x32x16_bf16 v[168:183], a[16:19], a[212:215], v[168:183]
  ds_read_b64_tr_b16 a[44:45], v28 offset:192
  ds_read_b64_tr_b16 a[46:47], v28 offset:1088
  v_mfma_f32_32x32x16_bf16 v[72:87], a[20:23], a[216:219], v[72:87]
  v_add_u32 v29, 0x8000, v29
  ds_read_b64_tr_b16 a[48:49], v29
  ds_read_b64_tr_b16 a[50:51], v29 offset:896
  s_waitcnt lgkmcnt(6)
  v_mfma_f32_32x32x16_bf16 v[88:103], a[24:27], a[216:219], v[88:103]
  ds_read_b64_tr_b16 a[52:53], v29 offset:32
  ds_read_b64_tr_b16 a[54:55], v29 offset:928
  v_mfma_f32_32x32x16_bf16 v[104:119], a[28:31], a[216:219], v[104:119]
  ds_read_b64_tr_b16 a[56:57], v29 offset:64
  ds_read_b64_tr_b16 a[58:59], v29 offset:960
  v_mfma_f32_32x32x16_bf16 v[120:135], a[32:35], a[216:219], v[120:135]
  ds_read_b64_tr_b16 a[60:61], v29 offset:96
  ds_read_b64_tr_b16 a[62:63], v29 offset:992
  v_mfma_f32_32x32x16_bf16 v[136:151], a[36:39], a[216:219], v[136:151]
  ds_read_b64_tr_b16 a[0:1], v29 offset:128
  ds_read_b64_tr_b16 a[2:3], v29 offset:1024
  ds_read_b64_tr_b16 a[4:5], v29 offset:160
  ds_read_b64_tr_b16 a[6:7], v29 offset:1056
  ds_read_b64_tr_b16 a[8:9], v29 offset:192
  ds_read_b64_tr_b16 a[10:11], v29 offset:1088
  s_waitcnt lgkmcnt(10)
  v_mfma_f32_32x32x16_bf16 v[152:167], a[40:43], a[216:219], v[152:167]
  v_mfma_f32_32x32x16_bf16 v[168:183], a[44:47], a[216:219], v[168:183]
  s_waitcnt lgkmcnt(0)
  s_barrier
  v_mfma_f32_32x32x16_bf16 v[72:87], a[48:51], a[220:223], v[72:87]
  v_subrev_u32 v26, 0x20000, v26
  ds_read_b64_tr_b16 a[12:13], v26
  ds_read_b64_tr_b16 a[14:15], v26 offset:896
  s_add_u32 s95, s98, 0x200
  v_mfma_f32_32x32x16_bf16 v[88:103], a[52:55], a[220:223], v[88:103]
  ds_read_b64_tr_b16 a[16:17], v26 offset:32
  ds_read_b64_tr_b16 a[18:19], v26 offset:928
  s_and_b32 s95, s95, 0x7ff
  v_mfma_f32_32x32x16_bf16 v[104:119], a[56:59], a[220:223], v[104:119]
  ds_read_b64_tr_b16 a[20:21], v26 offset:64
  ds_read_b64_tr_b16 a[22:23], v26 offset:960
  s_add_u32 s95, s95, s80
  s_add_u32 m0, s72, 0x20000
  v_mfma_f32_32x32x16_bf16 v[120:135], a[60:63], a[220:223], v[120:135]
  ds_read_b64_tr_b16 a[24:25], v26 offset:96
  ds_read_b64_tr_b16 a[26:27], v26 offset:992
  buffer_load_dwordx4 v22, s[52:55], s95 offen lds
  v_mfma_f32_32x32x16_bf16 v[136:151], a[0:3], a[220:223], v[136:151]
  ds_read_b64_tr_b16 a[28:29], v26 offset:128
  ds_read_b64_tr_b16 a[30:31], v26 offset:1024
  buffer_load_dwordx4 v23, s[52:55], s95 offen offset:1024 lds
  buffer_load_dwordx4 v24, s[52:55], s95 offen offset:2048 lds
  v_mfma_f32_32x32x16_bf16 v[152:167], a[4:7], a[220:223], v[152:167]
  ds_read_b64_tr_b16 a[32:33], v26 offset:160
  ds_read_b64_tr_b16 a[34:35], v26 offset:1056
  buffer_load_dwordx4 v25, s[52:55], s95 offen offset:3072 lds
  v_mfma_f32_32x32x16_bf16 v[168:183], a[8:11], a[220:223], v[168:183]
  ds_read_b64_tr_b16 a[36:37], v26 offset:192
  ds_read_b64_tr_b16 a[38:39], v26 offset:1088
  s_add_u32 m0, s72, 0x24000
  s_add_u32 s95, s95, 0x80
  s_waitcnt lgkmcnt(8)
  v_mfma_f32_32x32x16_bf16 v[72:87], a[12:15], a[224:227], v[72:87]
  v_subrev_u32 v27, 0x20000, v27
  ds_read_b64_tr_b16 a[40:41], v27
  ds_read_b64_tr_b16 a[42:43], v27 offset:896
  buffer_load_dwordx4 v22, s[52:55], s95 offen lds
  v_lshlrev_b32 v69, 3, v47
  v_lshrrev_b32 v71, 5, v0
  v_mfma_f32_32x32x16_bf16 v[88:103], a[16:19], a[224:227], v[88:103]
  ds_read_b64_tr_b16 a[44:45], v27 offset:32
  ds_read_b64_tr_b16 a[46:47], v27 offset:928
  buffer_load_dwordx4 v23, s[52:55], s95 offen offset:1024 lds
  v_bfe_u32 v70, v0, 1, 3
  v_xor_b32 v70, v70, v71
  v_mfma_f32_32x32x16_bf16 v[104:119], a[20:23], a[224:227], v[104:119]
  ds_read_b64_tr_b16 a[48:49], v27 offset:64
  ds_read_b64_tr_b16 a[50:51], v27 offset:960
  buffer_load_dwordx4 v24, s[52:55], s95 offen offset:2048 lds
  buffer_load_dwordx4 v25, s[52:55], s95 offen offset:3072 lds
  v_xor_b32 v71, 0, v70
  v_lshl_add_u32 v7, v71, 4, v69
  s_waitcnt lgkmcnt(6)
  v_mfma_f32_32x32x16_bf16 v[120:135], a[24:27], a[224:227], v[120:135]
  ds_read_b64_tr_b16 a[52:53], v27 offset:96
  ds_read_b64_tr_b16 a[54:55], v27 offset:992
  s_add_u32 s25, s100, 0x2000
  v_add_u32 v11, 0x10000, v7
  v_add_u32 v15, 0x20000, v7
  v_mfma_f32_32x32x16_bf16 v[136:151], a[28:31], a[224:227], v[136:151]
  ds_read_b64_tr_b16 a[56:57], v27 offset:128
  ds_read_b64_tr_b16 a[58:59], v27 offset:1024
  s_and_b32 s25, s25, 0xffff
  s_add_u32 s25, s25, s79
  v_xor_b32 v71, 2, v70
  v_lshl_add_u32 v8, v71, 4, v69
  v_mfma_f32_32x32x16_bf16 v[152:167], a[32:35], a[224:227], v[152:167]
  ds_read_b64_tr_b16 a[60:61], v27 offset:160
  ds_read_b64_tr_b16 a[62:63], v27 offset:1056
  buffer_load_dwordx4 a[96:99], v1, s[60:63], s25 offen sc1
  v_add_u32 v12, 0x10000, v8
  v_add_u32 v16, 0x20000, v8
  v_mfma_f32_32x32x16_bf16 v[168:183], a[36:39], a[224:227], v[168:183]
  ds_read_b64_tr_b16 a[0:1], v27 offset:192
  ds_read_b64_tr_b16 a[2:3], v27 offset:1088
  buffer_load_dwordx4 a[100:103], v1, s[60:63], s25 offen offset:1024 sc1
  buffer_load_dwordx4 a[104:107], v1, s[60:63], s25 offen offset:2048 sc1
  v_xor_b32 v71, 4, v70
  v_lshl_add_u32 v9, v71, 4, v69
  s_waitcnt lgkmcnt(6)
  v_mfma_f32_32x32x16_bf16 v[72:87], a[40:43], a[228:231], v[72:87]
  v_subrev_u32 v28, 0x20000, v28
  ds_read_b64_tr_b16 a[4:5], v28
  ds_read_b64_tr_b16 a[6:7], v28 offset:896
  buffer_load_dwordx4 a[108:111], v1, s[60:63], s25 offen offset:3072 sc1
  v_add_u32 v13, 0x10000, v9
  v_add_u32 v17, 0x20000, v9
  v_mfma_f32_32x32x16_bf16 v[88:103], a[44:47], a[228:231], v[88:103]
  ds_read_b64_tr_b16 a[8:9], v28 offset:32
  ds_read_b64_tr_b16 a[10:11], v28 offset:928
  s_add_u32 s25, s25, 0x1000
  buffer_load_dwordx4 a[112:115], v1, s[60:63], s25 offen sc1
  v_xor_b32 v71, 6, v70
  v_lshl_add_u32 v10, v71, 4, v69
  v_mfma_f32_32x32x16_bf16 v[104:119], a[48:51], a[228:231], v[104:119]
  ds_read_b64_tr_b16 a[12:13], v28 offset:64
  ds_read_b64_tr_b16 a[14:15], v28 offset:960
  buffer_load_dwordx4 a[116:119], v1, s[60:63], s25 offen offset:1024 sc1
  v_add_u32 v14, 0x10000, v10
  v_add_u32 v18, 0x20000, v10
  v_mfma_f32_32x32x16_bf16 v[120:135], a[52:55], a[228:231], v[120:135]
  ds_read_b64_tr_b16 a[16:17], v28 offset:96
  ds_read_b64_tr_b16 a[18:19], v28 offset:992
  buffer_load_dwordx4 a[120:123], v1, s[60:63], s25 offen offset:2048 sc1
  s_waitcnt lgkmcnt(6)
  v_mfma_f32_32x32x16_bf16 v[136:151], a[56:59], a[228:231], v[136:151]
  ds_read_b64_tr_b16 a[20:21], v28 offset:128
  ds_read_b64_tr_b16 a[22:23], v28 offset:1024
  buffer_load_dwordx4 a[124:127], v1, s[60:63], s25 offen offset:3072 sc1
  v_mfma_f32_32x32x16_bf16 v[152:167], a[60:63], a[228:231], v[152:167]
  ds_read_b64_tr_b16 a[24:25], v28 offset:160
  ds_read_b64_tr_b16 a[26:27], v28 offset:1056
  s_add_u32 s25, s100, 0x4000
  s_and_b32 s25, s25, 0xffff
  v_mfma_f32_32x32x16_bf16 v[168:183], a[0:3], a[228:231], v[168:183]
  ds_read_b64_tr_b16 a[28:29], v28 offset:192
  ds_read_b64_tr_b16 a[30:31], v28 offset:1088
  s_add_u32 s25, s25, s79
  buffer_load_dwordx4 a[128:131], v1, s[60:63], s25 offen sc1
  v_mfma_f32_32x32x16_bf16 v[72:87], a[4:7], a[232:235], v[72:87]
  v_subrev_u32 v29, 0x20000, v29
  ds_read_b64_tr_b16 a[32:33], v29
  ds_read_b64_tr_b16 a[34:35], v29 offset:896
  buffer_load_dwordx4 a[132:135], v1, s[60:63], s25 offen offset:1024 sc1
  buffer_load_dwordx4 a[136:139], v1, s[60:63], s25 offen offset:2048 sc1
  buffer_load_dwordx4 a[140:143], v1, s[60:63], s25 offen offset:3072 sc1
  s_waitcnt lgkmcnt(6)
  v_mfma_f32_32x32x16_bf16 v[88:103], a[8:11], a[232:235], v[88:103]
  ds_read_b64_tr_b16 a[36:37], v29 offset:32
  ds_read_b64_tr_b16 a[38:39], v29 offset:928
  s_add_u32 s25, s25, 0x1000
  buffer_load_dwordx4 a[144:147], v1, s[60:63], s25 offen sc1
  v_mfma_f32_32x32x16_bf16 v[104:119], a[12:15], a[232:235], v[104:119]
  ds_read_b64_tr_b16 a[40:41], v29 offset:64
  ds_read_b64_tr_b16 a[42:43], v29 offset:960
  buffer_load_dwordx4 a[148:151], v1, s[60:63], s25 offen offset:1024 sc1
  buffer_load_dwordx4 a[152:155], v1, s[60:63], s25 offen offset:2048 sc1
  v_mfma_f32_32x32x16_bf16 v[120:135], a[16:19], a[232:235], v[120:135]
  ds_read_b64_tr_b16 a[44:45], v29 offset:96
  ds_read_b64_tr_b16 a[46:47], v29 offset:992
  buffer_load_dwordx4 a[156:159], v1, s[60:63], s25 offen offset:3072 sc1
  v_mfma_f32_32x32x16_bf16 v[136:151], a[20:23], a[232:235], v[136:151]
  ds_read_b64_tr_b16 a[48:49], v29 offset:128
  ds_read_b64_tr_b16 a[50:51], v29 offset:1024
  ds_read_b64_tr_b16 a[52:53], v29 offset:160
  ds_read_b64_tr_b16 a[54:55], v29 offset:1056
  ds_read_b64_tr_b16 a[56:57], v29 offset:192
  ds_read_b64_tr_b16 a[58:59], v29 offset:1088
  v_mov_b32 v60, 0
  v_mov_b32 v61, 0
  v_mov_b32 v62, 0
  v_mov_b32 v63, 0
  s_waitcnt vmcnt(39)
  v_dot2c_f32_bf16 v60, 0x3f803f80, v216
  v_dot2c_f32_bf16 v61, 0x3f803f80, v217
  v_dot2c_f32_bf16 v62, 0x3f803f80, v218
  v_dot2c_f32_bf16 v63, 0x3f803f80, v219
  s_waitcnt vmcnt(38)
  v_dot2c_f32_bf16 v60, 0x3f803f80, v220
  v_dot2c_f32_bf16 v61, 0x3f803f80, v221
  v_dot2c_f32_bf16 v62, 0x3f803f80, v222
  v_dot2c_f32_bf16 v63, 0x3f803f80, v223
  s_waitcnt vmcnt(37)
  v_dot2c_f32_bf16 v60, 0x3f803f80, v224
  v_dot2c_f32_bf16 v61, 0x3f803f80, v225
  v_dot2c_f32_bf16 v62, 0x3f803f80, v226
  v_dot2c_f32_bf16 v63, 0x3f803f80, v227
  s_waitcnt vmcnt(36)
  v_dot2c_f32_bf16 v60, 0x3f803f80, v228
  v_dot2c_f32_bf16 v61, 0x3f803f80, v229
  v_dot2c_f32_bf16 v62, 0x3f803f80, v230
  v_dot2c_f32_bf16 v63, 0x3f803f80, v231
  s_waitcnt vmcnt(35)
  v_dot2c_f32_bf16 v60, 0x3f803f80, v232
  v_dot2c_f32_bf16 v61, 0x3f803f80, v233
  v_dot2c_f32_bf16 v62, 0x3f803f80, v234
  v_dot2c_f32_bf16 v63, 0x3f803f80, v235
  s_waitcnt vmcnt(34)
  v_dot2c_f32_bf16 v60, 0x3f803f80, v236
  v_dot2c_f32_bf16 v61, 0x3f803f80, v237
  v_dot2c_f32_bf16 v62, 0x3f803f80, v238
  v_dot2c_f32_bf16 v63, 0x3f803f80, v239
  s_waitcnt vmcnt(33)
  v_dot2c_f32_bf16 v60, 0x3f803f80, v240
  v_dot2c_f32_bf16 v61, 0x3f803f80, v241
  v_dot2c_f32_bf16 v62, 0x3f803f80, v242
  v_dot2c_f32_bf16 v63, 0x3f803f80, v243
  s_waitcnt vmcnt(32)
  v_dot2c_f32_bf16 v60, 0x3f803f80, v244
  s_waitcnt lgkmcnt(10)
  v_mfma_f32_32x32x16_bf16 v[152:167], a[24:27], a[232:235], v[152:167]
  v_dot2c_f32_bf16 v61, 0x3f803f80, v245
  v_dot2c_f32_bf16 v62, 0x3f803f80, v246
  v_dot2c_f32_bf16 v63, 0x3f803f80, v247
  v_cvt_pk_bf16_f32 v64, v60, v60
  v_and_b32 v64, 0xffff0000, v64
  v_sub_f32 v64, v60, v64
  v_cvt_pk_bf16_f32 v64, v60, v64
  v_cvt_pk_bf16_f32 v65, v61, v61
  v_and_b32 v65, 0xffff0000, v65
  v_sub_f32 v65, v61, v65
  v_cvt_pk_bf16_f32 v65, v61, v65
  v_cvt_pk_bf16_f32 v66, v62, v62
  v_and_b32 v66, 0xffff0000, v66
  v_sub_f32 v66, v62, v66
  v_cvt_pk_bf16_f32 v66, v62, v66
  v_cvt_pk_bf16_f32 v67, v63, v63
  v_and_b32 v67, 0xffff0000, v67
  v_sub_f32 v67, v63, v67
  v_cvt_pk_bf16_f32 v67, v63, v67
  v_add_u32 v68, 0xf080, v1
  ds_write_b128 v68, v[64:67]
  v_lshrrev_b32 v68, 2, v47
  v_add_u32 v68, 0xf080, v68
  ds_read_b32 v216, v68
  ds_read_b32 v220, v68 offset:128
  ds_read_b32 v224, v68 offset:256
  ds_read_b32 v228, v68 offset:384
  ds_read_b32 v232, v68 offset:512
  ds_read_b32 v236, v68 offset:640
  ds_read_b32 v240, v68 offset:768
  v_mov_b32 v41, 0
  v_mov_b32 v42, 0
  v_mov_b32 v43, 0
  v_cmp_gt_u32 vcc, 32, v0
  s_nop 1
  v_cndmask_b32 v40, 0, v40, vcc
  v_mfma_f32_32x32x16_bf16 v[168:183], a[28:31], a[232:235], v[168:183]
  s_waitcnt lgkmcnt(8)
  s_barrier
  v_mfma_f32_32x32x16_bf16 v[72:87], a[32:35], a[236:239], v[72:87]
  v_add_u32 v26, 0x8000, v26
  ds_read_b64_tr_b16 a[60:61], v26
  ds_read_b64_tr_b16 a[62:63], v26 offset:896
  v_mfma_f32_32x32x16_bf16 v[88:103], a[36:39], a[236:239], v[88:103]
  ds_read_b64_tr_b16 a[0:1], v26 offset:32
  ds_read_b64_tr_b16 a[2:3], v26 offset:928
  s_add_u32 s25, s100, 0x6000
  v_mfma_f32_32x32x16_bf16 v[104:119], a[40:43], a[236:239], v[104:119]
  ds_read_b64_tr_b16 a[4:5], v26 offset:64
  ds_read_b64_tr_b16 a[6:7], v26 offset:960
  s_and_b32 s25, s25, 0xffff
  v_mfma_f32_32x32x16_bf16 v[120:135], a[44:47], a[236:239], v[120:135]
  ds_read_b64_tr_b16 a[8:9], v26 offset:96
  ds_read_b64_tr_b16 a[10:11], v26 offset:992
  s_add_u32 s25, s25, s79
  v_mfma_f32_32x32x16_bf16 v[136:151], a[48:51], a[236:239], v[136:151]
  ds_read_b64_tr_b16 a[12:13], v26 offset:128
  ds_read_b64_tr_b16 a[14:15], v26 offset:1024
  v_mfma_f32_32x32x16_bf16 v[152:167], a[52:55], a[236:239], v[152:167]
  ds_read_b64_tr_b16 a[16:17], v26 offset:160
  ds_read_b64_tr_b16 a[18:19], v26 offset:1056
  buffer_load_dwordx4 a[160:163], v1, s[60:63], s25 offen sc1
  v_mfma_f32_32x32x16_bf16 v[168:183], a[56:59], a[236:239], v[168:183]
  ds_read_b64_tr_b16 a[20:21], v26 offset:192
  ds_read_b64_tr_b16 a[22:23], v26 offset:1088
  buffer_load_dwordx4 a[164:167], v1, s[60:63], s25 offen offset:1024 sc1
  s_waitcnt lgkmcnt(8)
  v_mfma_f32_32x32x16_bf16 v[72:87], a[60:63], a[240:243], v[72:87]
  v_add_u32 v27, 0x8000, v27
  ds_read_b64_tr_b16 a[24:25], v27
  ds_read_b64_tr_b16 a[26:27], v27 offset:896
  buffer_load_dwordx4 a[168:171], v1, s[60:63], s25 offen offset:2048 sc1
  v_mfma_f32_32x32x16_bf16 v[88:103], a[0:3], a[240:243], v[88:103]
  ds_read_b64_tr_b16 a[28:29], v27 offset:32
  ds_read_b64_tr_b16 a[30:31], v27 offset:928
  v_mfma_f32_32x32x16_bf16 v[104:119], a[4:7], a[240:243], v[104:119]
  ds_read_b64_tr_b16 a[32:33], v27 offset:64
  ds_read_b64_tr_b16 a[34:35], v27 offset:960
  buffer_load_dwordx4 a[172:175], v1, s[60:63], s25 offen offset:3072 sc1
  s_waitcnt lgkmcnt(6)
  v_mfma_f32_32x32x16_bf16 v[120:135], a[8:11], a[240:243], v[120:135]
  ds_read_b64_tr_b16 a[36:37], v27 offset:96
  ds_read_b64_tr_b16 a[38:39], v27 offset:992
  s_add_u32 s25, s25, 0x1000
  v_mfma_f32_32x32x16_bf16 v[136:151], a[12:15], a[240:243], v[136:151]
  ds_read_b64_tr_b16 a[40:41], v27 offset:128
  ds_read_b64_tr_b16 a[42:43], v27 offset:1024
  buffer_load_dwordx4 a[176:179], v1, s[60:63], s25 offen sc1
  v_mfma_f32_32x32x16_bf16 v[152:167], a[16:19], a[240:243], v[152:167]
  ds_read_b64_tr_b16 a[44:45], v27 offset:160
  ds_read_b64_tr_b16 a[46:47], v27 offset:1056
  v_mfma_f32_32x32x16_bf16 v[168:183], a[20:23], a[240:243], v[168:183]
  ds_read_b64_tr_b16 a[48:49], v27 offset:192
  ds_read_b64_tr_b16 a[50:51], v27 offset:1088
  buffer_load_dwordx4 a[180:183], v1, s[60:63], s25 offen offset:1024 sc1
  s_waitcnt lgkmcnt(6)
  v_mfma_f32_32x32x16_bf16 v[72:87], a[24:27], a[244:247], v[72:87]
  v_add_u32 v28, 0x8000, v28
  ds_read_b64_tr_b16 a[52:53], v28
  ds_read_b64_tr_b16 a[54:55], v28 offset:896
  buffer_load_dwordx4 a[184:187], v1, s[60:63], s25 offen offset:2048 sc1
  v_mfma_f32_32x32x16_bf16 v[88:103], a[28:31], a[244:247], v[88:103]
  ds_read_b64_tr_b16 a[56:57], v28 offset:32
  ds_read_b64_tr_b16 a[58:59], v28 offset:928
  buffer_load_dwordx4 a[188:191], v1, s[60:63], s25 offen offset:3072 sc1
  v_mfma_f32_32x32x16_bf16 v[104:119], a[32:35], a[244:247], v[104:119]
  ds_read_b64_tr_b16 a[60:61], v28 offset:64
  ds_read_b64_tr_b16 a[62:63], v28 offset:960
  v_mfma_f32_32x32x16_bf16 v[120:135], a[36:39], a[244:247], v[120:135]
  ds_read_b64_tr_b16 a[0:1], v28 offset:96
  ds_read_b64_tr_b16 a[2:3], v28 offset:992
  v_lshrrev_b32 v5, 3, v0
  s_waitcnt lgkmcnt(6)
  v_mfma_f32_32x32x16_bf16 v[136:151], a[40:43], a[244:247], v[136:151]
  ds_read_b64_tr_b16 a[4:5], v28 offset:128
  ds_read_b64_tr_b16 a[6:7], v28 offset:1024
  v_lshlrev_b32 v5, 10, v5
  v_mfma_f32_32x32x16_bf16 v[152:167], a[44:47], a[244:247], v[152:167]
  ds_read_b64_tr_b16 a[8:9], v28 offset:160
  ds_read_b64_tr_b16 a[10:11], v28 offset:1056
  v_bfe_u32 v3, v0, 4, 1
  v_mfma_f32_32x32x16_bf16 v[168:183], a[48:51], a[244:247], v[168:183]
  ds_read_b64_tr_b16 a[12:13], v28 offset:192
  ds_read_b64_tr_b16 a[14:15], v28 offset:1088
  v_mfma_f32_32x32x16_bf16 v[72:87], a[52:55], a[248:251], v[72:87]
  v_add_u32 v29, 0x8000, v29
  ds_read_b64_tr_b16 a[16:17], v29
  ds_read_b64_tr_b16 a[18:19], v29 offset:896
  v_lshlrev_b32 v3, 2, v3
  s_waitcnt lgkmcnt(6)
  v_mfma_f32_32x32x16_bf16 v[88:103], a[56:59], a[248:251], v[88:103]
  ds_read_b64_tr_b16 a[20:21], v29 offset:32
  ds_read_b64_tr_b16 a[22:23], v29 offset:928
  v_and_b32 v4, 7, v0
  v_mfma_f32_32x32x16_bf16 v[104:119], a[60:63], a[248:251], v[104:119]
  ds_read_b64_tr_b16 a[24:25], v29 offset:64
  ds_read_b64_tr_b16 a[26:27], v29 offset:960
  v_xor_b32 v3, v3, v4
  v_mfma_f32_32x32x16_bf16 v[120:135], a[0:3], a[248:251], v[120:135]
  ds_read_b64_tr_b16 a[28:29], v29 offset:96
  ds_read_b64_tr_b16 a[30:31], v29 offset:992
  v_mfma_f32_32x32x16_bf16 v[136:151], a[4:7], a[248:251], v[136:151]
  ds_read_b64_tr_b16 a[32:33], v29 offset:128
  ds_read_b64_tr_b16 a[34:35], v29 offset:1024
  v_lshl_add_u32 v2, v3, 4, v5
  s_waitcnt lgkmcnt(6)
  v_mfma_f32_32x32x16_bf16 v[152:167], a[8:11], a[248:251], v[152:167]
  ds_read_b64_tr_b16 a[36:37], v29 offset:160
  ds_read_b64_tr_b16 a[38:39], v29 offset:1056
  v_add_u32 v3, 0x1c00, v2
  v_mfma_f32_32x32x16_bf16 v[168:183], a[12:15], a[248:251], v[168:183]
  ds_read_b64_tr_b16 a[40:41], v29 offset:192
  ds_read_b64_tr_b16 a[42:43], v29 offset:1088
  v_add_u32 v4, 0x3800, v2
  v_mfma_f32_32x32x16_bf16 v[72:87], a[16:19], a[252:255], v[72:87]
  v_mfma_f32_32x32x16_bf16 v[88:103], a[20:23], a[252:255], v[88:103]
  v_add_u32 v5, 0x5400, v2
  s_waitcnt lgkmcnt(2)
  v_mfma_f32_32x32x16_bf16 v[104:119], a[24:27], a[252:255], v[104:119]
  s_add_u32 s95, s98, 0x400
  v_mfma_f32_32x32x16_bf16 v[120:135], a[28:31], a[252:255], v[120:135]
  s_and_b32 s95, s95, 0x7ff
  v_mfma_f32_32x32x16_bf16 v[136:151], a[32:35], a[252:255], v[136:151]
  v_mfma_f32_32x32x16_bf16 v[152:167], a[36:39], a[252:255], v[152:167]
  s_add_u32 s95, s95, s80
  s_waitcnt lgkmcnt(0)
  v_mfma_f32_32x32x16_bf16 v[168:183], a[40:43], a[252:255], v[168:183]
  s_add_u32 m0, s72, 0
  s_barrier
  v_mfma_f32_32x32x16_bf16 v[72:87], v[216:219], v[40:43], v[72:87]
  ds_read_b128 a[44:47], v11
  buffer_load_dwordx4 v22, s[52:55], s95 offen lds
  v_mfma_f32_32x32x16_bf16 v[88:103], v[220:223], v[40:43], v[88:103]
  ds_read_b128 a[48:51], v11 offset:4096
  v_mfma_f32_32x32x16_bf16 v[104:119], v[224:227], v[40:43], v[104:119]
  ds_read_b128 a[52:55], v11 offset:8192
  buffer_load_dwordx4 v23, s[52:55], s95 offen offset:1024 lds
  v_mfma_f32_32x32x16_bf16 v[120:135], v[228:231], v[40:43], v[120:135]
  ds_read_b128 a[56:59], v11 offset:12288
  buffer_load_dwordx4 v24, s[52:55], s95 offen offset:2048 lds
  v_mfma_f32_32x32x16_bf16 v[136:151], v[232:235], v[40:43], v[136:151]
  ds_read_b128 a[60:63], v12
  buffer_load_dwordx4 v25, s[52:55], s95 offen offset:3072 lds
  v_mfma_f32_32x32x16_bf16 v[152:167], v[236:239], v[40:43], v[152:167]
  ds_read_b128 a[0:3], v12 offset:4096
  v_mfma_f32_32x32x16_bf16 v[168:183], v[240:243], v[40:43], v[168:183]
  ds_read_b128 a[4:7], v12 offset:8192
  s_add_u32 m0, s72, 0x4000
  s_waitcnt lgkmcnt(3)
  v_mfma_f32_32x32x16_bf16 v[184:199], a[64:67], a[44:47], 0
  ds_read_b128 a[8:11], v12 offset:12288
  s_add_u32 s95, s95, 0x80
  v_mfma_f32_32x32x16_bf16 v[200:215], a[64:67], a[48:51], 0
  ds_read_b128 a[12:15], v13
  buffer_load_dwordx4 v22, s[52:55], s95 offen lds
  v_mfma_f32_32x32x16_bf16 v[216:231], a[64:67], a[52:55], 0
  ds_read_b128 a[16:19], v13 offset:4096
  v_mul_f32 v64, v72, v72
  v_mul_f32 v65, v73, v73
  v_fma_f32 v64, v64, v45, v44
  v_fma_f32 v65, v65, v45, v44
  v_mfma_f32_32x32x16_bf16 v[232:247], a[64:67], a[56:59], 0
  ds_read_b128 a[20:23], v13 offset:8192
  buffer_load_dwordx4 v23, s[52:55], s95 offen offset:1024 lds
  v_mul_f32 v64, v64, v72
  v_mul_f32 v65, v65, v73
  v_exp_f32 v64, v64
  v_mul_f32 v80, v72, v80
  s_waitcnt lgkmcnt(3)
  v_mfma_f32_32x32x16_bf16 v[184:199], a[68:71], a[60:63], v[184:199]
  ds_read_b128 a[24:27], v13 offset:12288
  buffer_load_dwordx4 v24, s[52:55], s95 offen offset:2048 lds
  v_exp_f32 v65, v65
  v_mul_f32 v81, v73, v81
  v_fma_f32 v64, v64, v46, v46
  v_fma_f32 v65, v65, v46, v46
  v_mfma_f32_32x32x16_bf16 v[200:215], a[68:71], a[0:3], v[200:215]
  ds_read_b128 a[28:31], v14
  buffer_load_dwordx4 v25, s[52:55], s95 offen offset:3072 lds
  v_rcp_f32 v64, v64
  v_rcp_f32 v65, v65
  v_mul_f32 v80, v80, v64
  v_mul_f32 v81, v81, v65
  v_mfma_f32_32x32x16_bf16 v[216:231], a[68:71], a[4:7], v[216:231]
  ds_read_b128 a[32:35], v14 offset:4096
  v_cvt_pk_bf16_f32 v72, v80, v81
  v_mul_f32 v64, v74, v74
  v_mul_f32 v65, v75, v75
  v_fma_f32 v64, v64, v45, v44
  v_mfma_f32_32x32x16_bf16 v[232:247], a[68:71], a[8:11], v[232:247]
  ds_read_b128 a[36:39], v14 offset:8192
  v_fma_f32 v65, v65, v45, v44
  v_mul_f32 v64, v64, v74
  v_mul_f32 v65, v65, v75
  v_exp_f32 v64, v64
  s_waitcnt lgkmcnt(3)
  v_mfma_f32_32x32x16_bf16 v[184:199], a[72:75], a[12:15], v[184:199]
  ds_read_b128 a[40:43], v14 offset:12288
  s_add_u32 s95, s98, 0x300
  s_and_b32 s95, s95, 0x7ff
  v_mul_f32 v82, v74, v82
  v_exp_f32 v65, v65
  v_mul_f32 v83, v75, v83
  v_fma_f32 v64, v64, v46, v46
  v_mfma_f32_32x32x16_bf16 v[200:215], a[72:75], a[16:19], v[200:215]
  ds_read_b128 a[44:47], v11 offset:16384
  s_add_u32 s95, s95, s80
  s_add_u32 m0, s72, 0x8000
  v_fma_f32 v65, v65, v46, v46
  v_rcp_f32 v64, v64
  v_rcp_f32 v65, v65
  v_mul_f32 v82, v82, v64
  v_mfma_f32_32x32x16_bf16 v[216:231], a[72:75], a[20:23], v[216:231]
  ds_read_b128 a[48:51], v11 offset:20480
  buffer_load_dwordx4 v22, s[52:55], s95 offen lds
  buffer_load_dwordx4 v23, s[52:55], s95 offen offset:1024 lds
  v_mul_f32 v83, v83, v65
  v_cvt_pk_bf16_f32 v73, v82, v83
  v_mul_f32 v64, v76, v76
  v_mul_f32 v65, v77, v77
  v_mfma_f32_32x32x16_bf16 v[232:247], a[72:75], a[24:27], v[232:247]
  ds_read_b128 a[52:55], v11 offset:24576
  buffer_load_dwordx4 v24, s[52:55], s95 offen offset:2048 lds
  buffer_load_dwordx4 v25, s[52:55], s95 offen offset:3072 lds
  v_fma_f32 v64, v64, v45, v44
  v_fma_f32 v65, v65, v45, v44
  v_mul_f32 v64, v64, v76
  v_mul_f32 v65, v65, v77
  s_waitcnt lgkmcnt(3)
  v_mfma_f32_32x32x16_bf16 v[184:199], a[76:79], a[28:31], v[184:199]
  ds_read_b128 a[56:59], v11 offset:28672
  s_add_u32 m0, s72, 0xc000
  s_add_u32 s95, s95, 0x80
  v_exp_f32 v64, v64
  v_mul_f32 v84, v76, v84
  v_exp_f32 v65, v65
  v_mul_f32 v85, v77, v85
  v_mfma_f32_32x32x16_bf16 v[200:215], a[76:79], a[32:35], v[200:215]
  ds_read_b128 a[60:63], v12 offset:16384
  buffer_load_dwordx4 v22, s[52:55], s95 offen lds
  buffer_load_dwordx4 v23, s[52:55], s95 offen offset:1024 lds
  v_fma_f32 v64, v64, v46, v46
  v_fma_f32 v65, v65, v46, v46
  v_rcp_f32 v64, v64
  v_rcp_f32 v65, v65
  v_mfma_f32_32x32x16_bf16 v[216:231], a[76:79], a[36:39], v[216:231]
  ds_read_b128 a[0:3], v12 offset:20480
  buffer_load_dwordx4 v24, s[52:55], s95 offen offset:2048 lds
  buffer_load_dwordx4 v25, s[52:55], s95 offen offset:3072 lds
  v_mul_f32 v84, v84, v64
  v_mul_f32 v85, v85, v65
  v_cvt_pk_bf16_f32 v74, v84, v85
  v_mul_f32 v64, v78, v78
  v_mfma_f32_32x32x16_bf16 v[232:247], a[76:79], a[40:43], v[232:247]
  ds_read_b128 a[4:7], v12 offset:24576
  s_add_u32 s25, s100, 0x8000
  s_and_b32 s25, s25, 0xffff
  v_mul_f32 v65, v79, v79
  v_fma_f32 v64, v64, v45, v44
  v_fma_f32 v65, v65, v45, v44
  v_mul_f32 v64, v64, v78
  s_waitcnt lgkmcnt(3)
  v_mfma_f32_32x32x16_bf16 v[184:199], a[80:83], a[44:47], v[184:199]
  ds_read_b128 a[8:11], v12 offset:28672
  s_add_u32 s25, s25, s79
  buffer_load_dwordx4 a[192:195], v1, s[60:63], s25 offen sc1
  v_mul_f32 v65, v65, v79
  v_exp_f32 v64, v64
  v_mul_f32 v86, v78, v86
  v_exp_f32 v65, v65
  v_mfma_f32_32x32x16_bf16 v[200:215], a[80:83], a[48:51], v[200:215]
  ds_read_b128 a[12:15], v13 offset:16384
  buffer_load_dwordx4 a[196:199], v1, s[60:63], s25 offen offset:1024 sc1
  buffer_load_dwordx4 a[200:203], v1, s[60:63], s25 offen offset:2048 sc1
  v_mul_f32 v87, v79, v87
  v_fma_f32 v64, v64, v46, v46
  v_fma_f32 v65, v65, v46, v46
  v_rcp_f32 v64, v64
  v_mfma_f32_32x32x16_bf16 v[216:231], a[80:83], a[52:55], v[216:231]
  ds_read_b128 a[16:19], v13 offset:20480
  buffer_load_dwordx4 a[204:207], v1, s[60:63], s25 offen offset:3072 sc1
  s_add_u32 s25, s25, 0x1000
  v_rcp_f32 v65, v65
  v_mul_f32 v86, v86, v64
  v_mul_f32 v87, v87, v65
  v_cvt_pk_bf16_f32 v75, v86, v87
  v_mfma_f32_32x32x16_bf16 v[232:247], a[80:83], a[56:59], v[232:247]
  ds_read_b128 a[20:23], v13 offset:24576
  buffer_load_dwordx4 a[208:211], v1, s[60:63], s25 offen sc1
  buffer_load_dwordx4 a[212:215], v1, s[60:63], s25 offen offset:1024 sc1
  v_mul_f32 v64, v88, v88
  v_mul_f32 v65, v89, v89
  v_fma_f32 v64, v64, v45, v44
  v_fma_f32 v65, v65, v45, v44
  s_waitcnt lgkmcnt(3)
  v_mfma_f32_32x32x16_bf16 v[184:199], a[84:87], a[60:63], v[184:199]
  ds_read_b128 a[24:27], v13 offset:28672
  buffer_load_dwordx4 a[216:219], v1, s[60:63], s25 offen offset:2048 sc1
  buffer_load_dwordx4 a[220:223], v1, s[60:63], s25 offen offset:3072 sc1
  v_mul_f32 v64, v64, v88
  v_mul_f32 v65, v65, v89
  v_exp_f32 v64, v64
  v_mul_f32 v96, v88, v96
  v_mfma_f32_32x32x16_bf16 v[200:215], a[84:87], a[0:3], v[200:215]
  ds_read_b128 a[28:31], v14 offset:16384
  v_mov_b32 v248, -1
  v_mov_b32 v249, -1
  v_exp_f32 v65, v65
  v_mul_f32 v97, v89, v97
  v_fma_f32 v64, v64, v46, v46
  v_fma_f32 v65, v65, v46, v46
  v_mfma_f32_32x32x16_bf16 v[216:231], a[84:87], a[4:7], v[216:231]
  ds_read_b128 a[32:35], v14 offset:20480
  ds_read_b128 a[36:39], v14 offset:24576
  ds_read_b128 a[40:43], v14 offset:28672
  v_mov_b32 v250, -1
  v_mov_b32 v251, -1
  v_rcp_f32 v64, v64
  v_rcp_f32 v65, v65
  v_mul_f32 v96, v96, v64
  v_mul_f32 v97, v97, v65
  v_mfma_f32_32x32x16_bf16 v[232:247], a[84:87], a[8:11], v[232:247]
  buffer_store_dwordx4 v[248:251], v1, s[60:63], s90 offen sc1
  buffer_store_dwordx4 v[248:251], v1, s[60:63], s90 offen offset:1024 sc1
  v_cvt_pk_bf16_f32 v88, v96, v97
  v_mul_f32 v64, v90, v90
  v_mul_f32 v65, v91, v91
  v_fma_f32 v64, v64, v45, v44
  s_waitcnt lgkmcnt(4)
  v_mfma_f32_32x32x16_bf16 v[184:199], a[88:91], a[12:15], v[184:199]
  v_fma_f32 v65, v65, v45, v44
  v_mul_f32 v64, v64, v90
  v_mul_f32 v65, v65, v91
  v_exp_f32 v64, v64
  s_waitcnt vmcnt(58) lgkmcnt(0)
  s_barrier
  v_mfma_f32_32x32x16_bf16 v[200:215], a[88:91], a[16:19], v[200:215]
  ds_read_b128 a[44:47], v11 offset:32768
  s_add_u32 s95, s98, 0x500
  v_mul_f32 v98, v90, v98
  v_exp_f32 v65, v65
  v_mul_f32 v99, v91, v99
  v_fma_f32 v64, v64, v46, v46
  v_mfma_f32_32x32x16_bf16 v[216:231], a[88:91], a[20:23], v[216:231]
  ds_read_b128 a[48:51], v11 offset:36864
  s_and_b32 s95, s95, 0x7ff
  v_fma_f32 v65, v65, v46, v46
  v_rcp_f32 v64, v64
  v_rcp_f32 v65, v65
  v_mul_f32 v98, v98, v64
  v_mfma_f32_32x32x16_bf16 v[232:247], a[88:91], a[24:27], v[232:247]
  ds_read_b128 a[52:55], v11 offset:40960
  s_add_u32 s95, s95, s80
  v_mul_f32 v99, v99, v65
  v_cvt_pk_bf16_f32 v89, v98, v99
  v_mul_f32 v64, v92, v92
  v_mul_f32 v65, v93, v93
  v_mfma_f32_32x32x16_bf16 v[184:199], a[92:95], a[28:31], v[184:199]
  ds_read_b128 a[56:59], v11 offset:45056
  s_add_u32 m0, s72, 0x10000
  s_nop 0
  buffer_load_dwordx4 v22, s[52:55], s95 offen lds
  v_fma_f32 v64, v64, v45, v44
  v_fma_f32 v65, v65, v45, v44
  v_mul_f32 v64, v64, v92
  v_mul_f32 v65, v65, v93
  v_mfma_f32_32x32x16_bf16 v[200:215], a[92:95], a[32:35], v[200:215]
  ds_read_b128 a[60:63], v12 offset:32768
  buffer_load_dwordx4 v23, s[52:55], s95 offen offset:1024 lds
  v_exp_f32 v64, v64
  v_mul_f32 v100, v92, v100
  v_exp_f32 v65, v65
  v_mul_f32 v101, v93, v101
  v_mfma_f32_32x32x16_bf16 v[216:231], a[92:95], a[36:39], v[216:231]
  ds_read_b128 a[0:3], v12 offset:36864
  buffer_load_dwordx4 v24, s[52:55], s95 offen offset:2048 lds
  v_fma_f32 v64, v64, v46, v46
  v_fma_f32 v65, v65, v46, v46
  v_rcp_f32 v64, v64
  v_rcp_f32 v65, v65
  v_mfma_f32_32x32x16_bf16 v[232:247], a[92:95], a[40:43], v[232:247]
  ds_read_b128 a[4:7], v12 offset:40960
  buffer_load_dwordx4 v25, s[52:55], s95 offen offset:3072 lds
  v_mul_f32 v100, v100, v64
  v_mul_f32 v101, v101, v65
  v_cvt_pk_bf16_f32 v90, v100, v101
  v_mul_f32 v64, v94, v94
  s_waitcnt lgkmcnt(3)
  s_waitcnt vmcnt(53)
  v_mfma_f32_32x32x16_bf16 v[184:199], a[96:99], a[44:47], v[184:199]
  ds_read_b128 a[8:11], v12 offset:45056
  s_add_u32 m0, s72, 0x14000
  s_add_u32 s95, s95, 0x80
  v_mul_f32 v65, v95, v95
  v_fma_f32 v64, v64, v45, v44
  v_fma_f32 v65, v65, v45, v44
  v_mul_f32 v64, v64, v94
  v_mfma_f32_32x32x16_bf16 v[200:215], a[96:99], a[48:51], v[200:215]
  ds_read_b128 a[12:15], v13 offset:32768
  buffer_load_dwordx4 v22, s[52:55], s95 offen lds
  v_mul_f32 v65, v65, v95
  v_exp_f32 v64, v64
  v_mul_f32 v102, v94, v102
  v_exp_f32 v65, v65
  v_mfma_f32_32x32x16_bf16 v[216:231], a[96:99], a[52:55], v[216:231]
  ds_read_b128 a[16:19], v13 offset:36864
  buffer_load_dwordx4 v23, s[52:55], s95 offen offset:1024 lds
  v_mul_f32 v103, v95, v103
  v_fma_f32 v64, v64, v46, v46
  v_fma_f32 v65, v65, v46, v46
  v_rcp_f32 v64, v64
  v_mfma_f32_32x32x16_bf16 v[232:247], a[96:99], a[56:59], v[232:247]
  ds_read_b128 a[20:23], v13 offset:40960
  buffer_load_dwordx4 v24, s[52:55], s95 offen offset:2048 lds
  v_rcp_f32 v65, v65
  v_mul_f32 v102, v102, v64
  v_mul_f32 v103, v103, v65
  v_cvt_pk_bf16_f32 v91, v102, v103
  s_waitcnt lgkmcnt(3)
  s_waitcnt vmcnt(55)
  v_mfma_f32_32x32x16_bf16 v[184:199], a[100:103], a[60:63], v[184:199]
  ds_read_b128 a[24:27], v13 offset:45056
  buffer_load_dwordx4 v25, s[52:55], s95 offen offset:3072 lds
  s_add_u32 s25, s100, 0xa000
  v_mul_f32 v64, v104, v104
  v_mul_f32 v65, v105, v105
  v_fma_f32 v64, v64, v45, v44
  v_fma_f32 v65, v65, v45, v44
  v_mfma_f32_32x32x16_bf16 v[200:215], a[100:103], a[0:3], v[200:215]
  ds_read_b128 a[28:31], v14 offset:32768
  s_and_b32 s25, s25, 0xffff
  v_mul_f32 v64, v64, v104
  v_mul_f32 v65, v65, v105
  v_exp_f32 v64, v64
  v_mul_f32 v112, v104, v112
  v_mfma_f32_32x32x16_bf16 v[216:231], a[100:103], a[4:7], v[216:231]
  ds_read_b128 a[32:35], v14 offset:36864
  s_add_u32 s25, s25, s79
  v_exp_f32 v65, v65
  v_mul_f32 v113, v105, v113
  v_fma_f32 v64, v64, v46, v46
  v_fma_f32 v65, v65, v46, v46
  v_mfma_f32_32x32x16_bf16 v[232:247], a[100:103], a[8:11], v[232:247]
  ds_read_b128 a[36:39], v14 offset:40960
  buffer_load_dwordx4 a[224:227], v1, s[60:63], s25 offen sc1
  buffer_load_dwordx4 a[228:231], v1, s[60:63], s25 offen offset:1024 sc1
  v_rcp_f32 v64, v64
  v_rcp_f32 v65, v65
  v_mul_f32 v112, v112, v64
  v_mul_f32 v113, v113, v65
  s_waitcnt lgkmcnt(3)
  s_waitcnt vmcnt(57)
  v_mfma_f32_32x32x16_bf16 v[184:199], a[104:107], a[12:15], v[184:199]
  ds_read_b128 a[40:43], v14 offset:45056
  buffer_load_dwordx4 a[232:235], v1, s[60:63], s25 offen offset:2048 sc1
  v_cvt_pk_bf16_f32 v104, v112, v113
  v_mul_f32 v64, v106, v106
  v_mul_f32 v65, v107, v107
  v_fma_f32 v64, v64, v45, v44
  v_mfma_f32_32x32x16_bf16 v[200:215], a[104:107], a[16:19], v[200:215]
  ds_read_b128 a[44:47], v11 offset:49152
  buffer_load_dwordx4 a[236:239], v1, s[60:63], s25 offen offset:3072 sc1
  v_fma_f32 v65, v65, v45, v44
  v_mul_f32 v64, v64, v106
  v_mul_f32 v65, v65, v107
  v_exp_f32 v64, v64
  v_mfma_f32_32x32x16_bf16 v[216:231], a[104:107], a[20:23], v[216:231]
  ds_read_b128 a[48:51], v11 offset:53248
  s_add_u32 s25, s25, 0x1000
  v_mul_f32 v114, v106, v114
  v_exp_f32 v65, v65
  v_mul_f32 v115, v107, v115
  v_fma_f32 v64, v64, v46, v46
  v_mfma_f32_32x32x16_bf16 v[232:247], a[104:107], a[24:27], v[232:247]
  ds_read_b128 a[52:55], v11 offset:57344
  buffer_load_dwordx4 a[240:243], v1, s[60:63], s25 offen sc1
  buffer_load_dwordx4 a[244:247], v1, s[60:63], s25 offen offset:1024 sc1
  v_fma_f32 v65, v65, v46, v46
  v_rcp_f32 v64, v64
  v_rcp_f32 v65, v65
  v_mul_f32 v114, v114, v64
  s_waitcnt lgkmcnt(3)
  s_waitcnt vmcnt(60)
  v_mfma_f32_32x32x16_bf16 v[184:199], a[108:111], a[28:31], v[184:199]
  ds_read_b128 a[56:59], v11 offset:61440
  buffer_load_dwordx4 a[248:251], v1, s[60:63], s25 offen offset:2048 sc1
  v_mul_f32 v115, v115, v65
  v_cvt_pk_bf16_f32 v105, v114, v115
  v_mul_f32 v64, v108, v108
  v_mul_f32 v65, v109, v109
  v_mfma_f32_32x32x16_bf16 v[200:215], a[108:111], a[32:35], v[200:215]
  ds_read_b128 a[60:63], v12 offset:49152
  buffer_load_dwordx4 a[252:255], v1, s[60:63], s25 offen offset:3072 sc1
  v_fma_f32 v64, v64, v45, v44
  v_fma_f32 v65, v65, v45, v44
  v_mul_f32 v64, v64, v108
  v_mul_f32 v65, v65, v109
  v_mfma_f32_32x32x16_bf16 v[216:231], a[108:111], a[36:39], v[216:231]
  ds_read_b128 a[0:3], v12 offset:53248
  buffer_store_dwordx4 v[248:251], v1, s[60:63], s91 offen sc1
  v_exp_f32 v64, v64
  v_mul_f32 v116, v108, v116
  v_exp_f32 v65, v65
  v_mul_f32 v117, v109, v117
  v_mfma_f32_32x32x16_bf16 v[232:247], a[108:111], a[40:43], v[232:247]
  ds_read_b128 a[4:7], v12 offset:57344
  buffer_store_dwordx4 v[248:251], v1, s[60:63], s91 offen offset:1024 sc1
  v_fma_f32 v64, v64, v46, v46
  v_fma_f32 v65, v65, v46, v46
  v_rcp_f32 v64, v64
  v_rcp_f32 v65, v65
  s_waitcnt lgkmcnt(3)
  s_waitcnt vmcnt(63)
  v_mfma_f32_32x32x16_bf16 v[184:199], a[112:115], a[44:47], v[184:199]
  ds_read_b128 a[8:11], v12 offset:61440
  s_add_u32 s25, s100, 0xc000
  v_mul_f32 v116, v116, v64
  v_mul_f32 v117, v117, v65
  v_cvt_pk_bf16_f32 v106, v116, v117
  v_mul_f32 v64, v110, v110
  v_mfma_f32_32x32x16_bf16 v[200:215], a[112:115], a[48:51], v[200:215]
  ds_read_b128 a[12:15], v13 offset:49152
  s_and_b32 s25, s25, 0xffff
  s_add_u32 s25, s25, s79
  v_mul_f32 v65, v111, v111
  v_fma_f32 v64, v64, v45, v44
  v_fma_f32 v65, v65, v45, v44
  v_mul_f32 v64, v64, v110
  v_mfma_f32_32x32x16_bf16 v[216:231], a[112:115], a[52:55], v[216:231]
  ds_read_b128 a[16:19], v13 offset:53248
  buffer_load_dwordx4 a[64:67], v1, s[60:63], s25 offen sc1
  v_mul_f32 v65, v65, v111
  v_exp_f32 v64, v64
  v_mul_f32 v118, v110, v118
  v_exp_f32 v65, v65
  v_mfma_f32_32x32x16_bf16 v[232:247], a[112:115], a[56:59], v[232:247]
  ds_read_b128 a[20:23], v13 offset:57344
  buffer_load_dwordx4 a[68:71], v1, s[60:63], s25 offen offset:1024 sc1
  buffer_load_dwordx4 a[72:75], v1, s[60:63], s25 offen offset:2048 sc1
  v_mul_f32 v119, v111, v119
  v_fma_f32 v64, v64, v46, v46
  v_fma_f32 v65, v65, v46, v46
  v_rcp_f32 v64, v64
  s_waitcnt lgkmcnt(3)
  s_waitcnt vmcnt(63)
  v_mfma_f32_32x32x16_bf16 v[184:199], a[116:119], a[60:63], v[184:199]
  ds_read_b128 a[24:27], v13 offset:61440
  buffer_load_dwordx4 a[76:79], v1, s[60:63], s25 offen offset:3072 sc1
  v_rcp_f32 v65, v65
  v_mul_f32 v118, v118, v64
  v_mul_f32 v119, v119, v65
  v_cvt_pk_bf16_f32 v107, v118, v119
  v_mfma_f32_32x32x16_bf16 v[200:215], a[116:119], a[0:3], v[200:215]
  ds_read_b128 a[28:31], v14 offset:49152
  s_add_u32 s25, s25, 0x1000
  buffer_load_dwordx4 a[80:83], v1, s[60:63], s25 offen sc1
  v_mul_f32 v64, v120, v120
  v_mul_f32 v65, v121, v121
  v_fma_f32 v64, v64, v45, v44
  v_fma_f32 v65, v65, v45, v44
  v_mfma_f32_32x32x16_bf16 v[216:231], a[116:119], a[4:7], v[216:231]
  ds_read_b128 a[32:35], v14 offset:53248
  ds_read_b128 a[36:39], v14 offset:57344
  ds_read_b128 a[40:43], v14 offset:61440
  buffer_load_dwordx4 a[84:87], v1, s[60:63], s25 offen offset:1024 sc1
  v_mul_f32 v64, v64, v120
  v_mul_f32 v65, v65, v121
  v_exp_f32 v64, v64
  v_mul_f32 v128, v120, v128
  v_mfma_f32_32x32x16_bf16 v[232:247], a[116:119], a[8:11], v[232:247]
  buffer_load_dwordx4 a[88:91], v1, s[60:63], s25 offen offset:2048 sc1
  buffer_load_dwordx4 a[92:95], v1, s[60:63], s25 offen offset:3072 sc1
  v_exp_f32 v65, v65
  v_mul_f32 v129, v121, v129
  v_fma_f32 v64, v64, v46, v46
  v_fma_f32 v65, v65, v46, v46
  s_waitcnt lgkmcnt(4)
  v_mfma_f32_32x32x16_bf16 v[184:199], a[120:123], a[12:15], v[184:199]
  v_rcp_f32 v64, v64
  v_rcp_f32 v65, v65
  v_mul_f32 v128, v128, v64
  v_mul_f32 v129, v129, v65
  s_waitcnt lgkmcnt(0)
  s_barrier
  v_mfma_f32_32x32x16_bf16 v[200:215], a[120:123], a[16:19], v[200:215]
  ds_read_b128 a[44:47], v15
  s_add_u32 s95, s98, 0x600
  v_cvt_pk_bf16_f32 v120, v128, v129
  v_mul_f32 v64, v122, v122
  v_mul_f32 v65, v123, v123
  v_fma_f32 v64, v64, v45, v44
  v_mfma_f32_32x32x16_bf16 v[216:231], a[120:123], a[20:23], v[216:231]
  ds_read_b128 a[48:51], v15 offset:4096
  s_and_b32 s95, s95, 0x7ff
  v_fma_f32 v65, v65, v45, v44
  v_mul_f32 v64, v64, v122
  v_mul_f32 v65, v65, v123
  v_exp_f32 v64, v64
  v_mfma_f32_32x32x16_bf16 v[232:247], a[120:123], a[24:27], v[232:247]
  ds_read_b128 a[52:55], v15 offset:8192
  s_add_u32 s95, s95, s80
  v_mul_f32 v130, v122, v130
  v_exp_f32 v65, v65
  v_mul_f32 v131, v123, v131
  v_fma_f32 v64, v64, v46, v46
  v_mfma_f32_32x32x16_bf16 v[184:199], a[124:127], a[28:31], v[184:199]
  ds_read_b128 a[56:59], v15 offset:12288
  s_add_u32 m0, s72, 0x18000
  v_fma_f32 v65, v65, v46, v46
  v_rcp_f32 v64, v64
  v_rcp_f32 v65, v65
  v_mul_f32 v130, v130, v64
  v_mfma_f32_32x32x16_bf16 v[200:215], a[124:127], a[32:35], v[200:215]
  ds_read_b128 a[60:63], v16
  buffer_load_dwordx4 v22, s[52:55], s95 offen lds
  v_mul_f32 v131, v131, v65
  v_cvt_pk_bf16_f32 v121, v130, v131
  v_mul_f32 v64, v124, v124
  v_mul_f32 v65, v125, v125
  v_mfma_f32_32x32x16_bf16 v[216:231], a[124:127], a[36:39], v[216:231]
  ds_read_b128 a[0:3], v16 offset:4096
  buffer_load_dwordx4 v23, s[52:55], s95 offen offset:1024 lds
  v_fma_f32 v64, v64, v45, v44
  v_fma_f32 v65, v65, v45, v44
  v_mul_f32 v64, v64, v124
  v_mul_f32 v65, v65, v125
  v_mfma_f32_32x32x16_bf16 v[232:247], a[124:127], a[40:43], v[232:247]
  ds_read_b128 a[4:7], v16 offset:8192
  buffer_load_dwordx4 v24, s[52:55], s95 offen offset:2048 lds
  v_exp_f32 v64, v64
  v_mul_f32 v132, v124, v132
  v_exp_f32 v65, v65
  v_mul_f32 v133, v125, v133
  s_waitcnt lgkmcnt(3)
  s_waitcnt vmcnt(63)
  v_mfma_f32_32x32x16_bf16 v[184:199], a[128:131], a[44:47], v[184:199]
  ds_read_b128 a[8:11], v16 offset:12288
  buffer_load_dwordx4 v25, s[52:55], s95 offen offset:3072 lds
  s_add_u32 m0, s72, 0x1c000
  v_fma_f32 v64, v64, v46, v46
  v_fma_f32 v65, v65, v46, v46
  v_rcp_f32 v64, v64
  v_rcp_f32 v65, v65
  v_mfma_f32_32x32x16_bf16 v[200:215], a[128:131], a[48:51], v[200:215]
  ds_read_b128 a[12:15], v17
  s_add_u32 s95, s95, 0x80
  v_mul_f32 v132, v132, v64
  v_mul_f32 v133, v133, v65
  v_cvt_pk_bf16_f32 v122, v132, v133
  v_mul_f32 v64, v126, v126
  v_mfma_f32_32x32x16_bf16 v[216:231], a[128:131], a[52:55], v[216:231]
  ds_read_b128 a[16:19], v17 offset:4096
  buffer_load_dwordx4 v22, s[52:55], s95 offen lds
  v_mul_f32 v65, v127, v127
  v_fma_f32 v64, v64, v45, v44
  v_fma_f32 v65, v65, v45, v44
  v_mul_f32 v64, v64, v126
  v_mfma_f32_32x32x16_bf16 v[232:247], a[128:131], a[56:59], v[232:247]
  ds_read_b128 a[20:23], v17 offset:8192
  buffer_load_dwordx4 v23, s[52:55], s95 offen offset:1024 lds
  v_mul_f32 v65, v65, v127
  v_exp_f32 v64, v64
  v_mul_f32 v134, v126, v134
  v_exp_f32 v65, v65
  s_waitcnt lgkmcnt(3)
  v_mfma_f32_32x32x16_bf16 v[184:199], a[132:135], a[60:63], v[184:199]
  ds_read_b128 a[24:27], v17 offset:12288
  buffer_load_dwordx4 v24, s[52:55], s95 offen offset:2048 lds
  v_mul_f32 v135, v127, v135
  v_fma_f32 v64, v64, v46, v46
  v_fma_f32 v65, v65, v46, v46
  v_rcp_f32 v64, v64
  v_mfma_f32_32x32x16_bf16 v[200:215], a[132:135], a[0:3], v[200:215]
  ds_read_b128 a[28:31], v18
  buffer_load_dwordx4 v25, s[52:55], s95 offen offset:3072 lds
  v_rcp_f32 v65, v65
  v_mul_f32 v134, v134, v64
  v_mul_f32 v135, v135, v65
  v_cvt_pk_bf16_f32 v123, v134, v135
  v_mfma_f32_32x32x16_bf16 v[216:231], a[132:135], a[4:7], v[216:231]
  ds_read_b128 a[32:35], v18 offset:4096
  buffer_store_dwordx4 v[248:251], v1, s[60:63], s92 offen sc1
  v_mul_f32 v64, v136, v136
  v_mul_f32 v65, v137, v137
  v_fma_f32 v64, v64, v45, v44
  v_fma_f32 v65, v65, v45, v44
  v_mfma_f32_32x32x16_bf16 v[232:247], a[132:135], a[8:11], v[232:247]
  ds_read_b128 a[36:39], v18 offset:8192
  buffer_store_dwordx4 v[248:251], v1, s[60:63], s92 offen offset:1024 sc1
  v_mul_f32 v64, v64, v136
  v_mul_f32 v65, v65, v137
  v_exp_f32 v64, v64
  v_mul_f32 v144, v136, v144
  s_waitcnt lgkmcnt(3)
  v_mfma_f32_32x32x16_bf16 v[184:199], a[136:139], a[12:15], v[184:199]
  ds_read_b128 a[40:43], v18 offset:12288
  v_exp_f32 v65, v65
  v_mul_f32 v145, v137, v145
  v_fma_f32 v64, v64, v46, v46
  v_fma_f32 v65, v65, v46, v46
  v_mfma_f32_32x32x16_bf16 v[200:215], a[136:139], a[16:19], v[200:215]
  ds_read_b128 a[44:47], v15 offset:16384
  s_add_u32 s25, s100, 0xe000
  v_rcp_f32 v64, v64
  v_rcp_f32 v65, v65
  v_mul_f32 v144, v144, v64
  v_mul_f32 v145, v145, v65
  v_mfma_f32_32x32x16_bf16 v[216:231], a[136:139], a[20:23], v[216:231]
  ds_read_b128 a[48:51], v15 offset:20480
  s_and_b32 s25, s25, 0xffff
  v_cvt_pk_bf16_f32 v136, v144, v145
  v_mul_f32 v64, v138, v138
  v_mul_f32 v65, v139, v139
  v_fma_f32 v64, v64, v45, v44
  v_mfma_f32_32x32x16_bf16 v[232:247], a[136:139], a[24:27], v[232:247]
  ds_read_b128 a[52:55], v15 offset:24576
  s_add_u32 s25, s25, s79
  v_fma_f32 v65, v65, v45, v44
  v_mul_f32 v64, v64, v138
  v_mul_f32 v65, v65, v139
  v_exp_f32 v64, v64
  s_waitcnt lgkmcnt(3)
  v_mfma_f32_32x32x16_bf16 v[184:199], a[140:143], a[28:31], v[184:199]
  ds_read_b128 a[56:59], v15 offset:28672
  v_mul_f32 v146, v138, v146
  v_exp_f32 v65, v65
  v_mul_f32 v147, v139, v147
  v_fma_f32 v64, v64, v46, v46
  v_mfma_f32_32x32x16_bf16 v[200:215], a[140:143], a[32:35], v[200:215]
  ds_read_b128 a[60:63], v16 offset:16384
  buffer_load_dwordx4 a[96:99], v1, s[60:63], s25 offen sc1
  v_fma_f32 v65, v65, v46, v46
  v_rcp_f32 v64, v64
  v_rcp_f32 v65, v65
  v_mul_f32 v146, v146, v64
  v_mfma_f32_32x32x16_bf16 v[216:231], a[140:143], a[36:39], v[216:231]
  ds_read_b128 a[0:3], v16 offset:20480
  buffer_load_dwordx4 a[100:103], v1, s[60:63], s25 offen offset:1024 sc1
  v_mul_f32 v147, v147, v65
  v_cvt_pk_bf16_f32 v137, v146, v147
  v_mul_f32 v64, v140, v140
  v_mul_f32 v65, v141, v141
  v_mfma_f32_32x32x16_bf16 v[232:247], a[140:143], a[40:43], v[232:247]
  ds_read_b128 a[4:7], v16 offset:24576
  buffer_load_dwordx4 a[104:107], v1, s[60:63], s25 offen offset:2048 sc1
  v_fma_f32 v64, v64, v45, v44
  v_fma_f32 v65, v65, v45, v44
  v_mul_f32 v64, v64, v140
  v_mul_f32 v65, v65, v141
  s_waitcnt lgkmcnt(3)
  v_mfma_f32_32x32x16_bf16 v[184:199], a[144:147], a[44:47], v[184:199]
  ds_read_b128 a[8:11], v16 offset:28672
  v_exp_f32 v64, v64
  v_mul_f32 v148, v140, v148
  v_exp_f32 v65, v65
  v_mul_f32 v149, v141, v149
  v_mfma_f32_32x32x16_bf16 v[200:215], a[144:147], a[48:51], v[200:215]
  ds_read_b128 a[12:15], v17 offset:16384
  buffer_load_dwordx4 a[108:111], v1, s[60:63], s25 offen offset:3072 sc1
  v_fma_f32 v64, v64, v46, v46
  v_fma_f32 v65, v65, v46, v46
  v_rcp_f32 v64, v64
  v_rcp_f32 v65, v65
  v_mfma_f32_32x32x16_bf16 v[216:231], a[144:147], a[52:55], v[216:231]
  ds_read_b128 a[16:19], v17 offset:20480
  s_add_u32 s25, s25, 0x1000
  v_mul_f32 v148, v148, v64
  v_mul_f32 v149, v149, v65
  v_cvt_pk_bf16_f32 v138, v148, v149
  v_mul_f32 v64, v142, v142
  v_mfma_f32_32x32x16_bf16 v[232:247], a[144:147], a[56:59], v[232:247]
  ds_read_b128 a[20:23], v17 offset:24576
  buffer_load_dwordx4 a[112:115], v1, s[60:63], s25 offen sc1
  v_mul_f32 v65, v143, v143
  v_fma_f32 v64, v64, v45, v44
  v_fma_f32 v65, v65, v45, v44
  v_mul_f32 v64, v64, v142
  s_waitcnt lgkmcnt(3)
  v_mfma_f32_32x32x16_bf16 v[184:199], a[148:151], a[60:63], v[184:199]
  ds_read_b128 a[24:27], v17 offset:28672
  v_mul_f32 v65, v65, v143
  v_exp_f32 v64, v64
  v_mul_f32 v150, v142, v150
  v_exp_f32 v65, v65
  v_mfma_f32_32x32x16_bf16 v[200:215], a[148:151], a[0:3], v[200:215]
  ds_read_b128 a[28:31], v18 offset:16384
  buffer_load_dwordx4 a[116:119], v1, s[60:63], s25 offen offset:1024 sc1
  v_mul_f32 v151, v143, v151
  v_fma_f32 v64, v64, v46, v46
  v_fma_f32 v65, v65, v46, v46
  v_rcp_f32 v64, v64
  v_mfma_f32_32x32x16_bf16 v[216:231], a[148:151], a[4:7], v[216:231]
  ds_read_b128 a[32:35], v18 offset:20480
  ds_read_b128 a[36:39], v18 offset:24576
  ds_read_b128 a[40:43], v18 offset:28672
  buffer_load_dwordx4 a[120:123], v1, s[60:63], s25 offen offset:2048 sc1
  v_rcp_f32 v65, v65
  v_mul_f32 v150, v150, v64
  v_mul_f32 v151, v151, v65
  v_cvt_pk_bf16_f32 v139, v150, v151
  v_mfma_f32_32x32x16_bf16 v[232:247], a[148:151], a[8:11], v[232:247]
  buffer_load_dwordx4 a[124:127], v1, s[60:63], s25 offen offset:3072 sc1
  v_mul_f32 v64, v152, v152
  v_mul_f32 v65, v153, v153
  v_fma_f32 v64, v64, v45, v44
  v_fma_f32 v65, v65, v45, v44
  s_waitcnt lgkmcnt(4)
  v_mfma_f32_32x32x16_bf16 v[184:199], a[152:155], a[12:15], v[184:199]
  v_mul_f32 v64, v64, v152
  v_mul_f32 v65, v65, v153
  v_exp_f32 v64, v64
  v_mul_f32 v160, v152, v160
  s_waitcnt vmcnt(54) lgkmcnt(0)
  s_barrier
  v_mfma_f32_32x32x16_bf16 v[200:215], a[152:155], a[16:19], v[200:215]
  ds_read_b128 a[44:47], v7 offset:32768
  v_exp_f32 v65, v65
  v_mul_f32 v161, v153, v161
  v_fma_f32 v64, v64, v46, v46
  v_fma_f32 v65, v65, v46, v46
  v_mfma_f32_32x32x16_bf16 v[216:231], a[152:155], a[20:23], v[216:231]
  ds_read_b128 a[48:51], v7 offset:36864
  s_add_u32 s95, s98, 0x700
  v_rcp_f32 v64, v64
  v_rcp_f32 v65, v65
  v_mul_f32 v160, v160, v64
  v_mul_f32 v161, v161, v65
  v_mfma_f32_32x32x16_bf16 v[232:247], a[152:155], a[24:27], v[232:247]
  ds_read_b128 a[52:55], v7 offset:40960
  s_and_b32 s95, s95, 0x7ff
  v_cvt_pk_bf16_f32 v152, v160, v161
  v_mul_f32 v64, v154, v154
  v_mul_f32 v65, v155, v155
  v_fma_f32 v64, v64, v45, v44
  v_mfma_f32_32x32x16_bf16 v[184:199], a[156:159], a[28:31], v[184:199]
  ds_read_b128 a[56:59], v7 offset:45056
  s_add_u32 s95, s95, s80
  v_fma_f32 v65, v65, v45, v44
  v_mul_f32 v64, v64, v154
  v_mul_f32 v65, v65, v155
  v_exp_f32 v64, v64
  v_mfma_f32_32x32x16_bf16 v[200:215], a[156:159], a[32:35], v[200:215]
  ds_read_b128 a[60:63], v8 offset:32768
  v_mul_f32 v162, v154, v162
  v_exp_f32 v65, v65
  v_mul_f32 v163, v155, v163
  v_fma_f32 v64, v64, v46, v46
  v_mfma_f32_32x32x16_bf16 v[216:231], a[156:159], a[36:39], v[216:231]
  ds_read_b128 a[0:3], v8 offset:36864
  s_add_u32 m0, s72, 0x20000
  v_fma_f32 v65, v65, v46, v46
  v_rcp_f32 v64, v64
  v_rcp_f32 v65, v65
  v_mul_f32 v162, v162, v64
  v_mfma_f32_32x32x16_bf16 v[232:247], a[156:159], a[40:43], v[232:247]
  ds_read_b128 a[4:7], v8 offset:40960
  buffer_load_dwordx4 v22, s[52:55], s95 offen lds
  v_mul_f32 v163, v163, v65
  v_cvt_pk_bf16_f32 v153, v162, v163
  v_mul_f32 v64, v156, v156
  v_mul_f32 v65, v157, v157
  s_waitcnt lgkmcnt(3)
  v_mfma_f32_32x32x16_bf16 v[184:199], a[160:163], a[44:47], v[184:199]
  ds_read_b128 a[8:11], v8 offset:45056
  buffer_load_dwordx4 v23, s[52:55], s95 offen offset:1024 lds
  v_fma_f32 v64, v64, v45, v44
  v_fma_f32 v65, v65, v45, v44
  v_mul_f32 v64, v64, v156
  v_mul_f32 v65, v65, v157
  v_mfma_f32_32x32x16_bf16 v[200:215], a[160:163], a[48:51], v[200:215]
  ds_read_b128 a[12:15], v9 offset:32768
  v_exp_f32 v64, v64
  v_mul_f32 v164, v156, v164
  v_exp_f32 v65, v65
  v_mul_f32 v165, v157, v165
  v_mfma_f32_32x32x16_bf16 v[216:231], a[160:163], a[52:55], v[216:231]
  ds_read_b128 a[16:19], v9 offset:36864
  buffer_load_dwordx4 v24, s[52:55], s95 offen offset:2048 lds
  v_fma_f32 v64, v64, v46, v46
  v_fma_f32 v65, v65, v46, v46
  v_rcp_f32 v64, v64
  v_rcp_f32 v65, v65
  v_mfma_f32_32x32x16_bf16 v[232:247], a[160:163], a[56:59], v[232:247]
  ds_read_b128 a[20:23], v9 offset:40960
  buffer_load_dwordx4 v25, s[52:55], s95 offen offset:3072 lds
  v_mul_f32 v164, v164, v64
  v_mul_f32 v165, v165, v65
  v_cvt_pk_bf16_f32 v154, v164, v165
  v_mul_f32 v64, v158, v158
  s_waitcnt lgkmcnt(3)
  v_mfma_f32_32x32x16_bf16 v[184:199], a[164:167], a[60:63], v[184:199]
  ds_read_b128 a[24:27], v9 offset:45056
  s_add_u32 m0, s72, 0x24000
  v_mul_f32 v65, v159, v159
  v_fma_f32 v64, v64, v45, v44
  v_fma_f32 v65, v65, v45, v44
  v_mul_f32 v64, v64, v158
  v_mfma_f32_32x32x16_bf16 v[200:215], a[164:167], a[0:3], v[200:215]
  ds_read_b128 a[28:31], v10 offset:32768
  v_mul_f32 v65, v65, v159
  v_exp_f32 v64, v64
  v_mul_f32 v166, v158, v166
  v_exp_f32 v65, v65
  v_mfma_f32_32x32x16_bf16 v[216:231], a[164:167], a[4:7], v[216:231]
  ds_read_b128 a[32:35], v10 offset:36864
  s_add_u32 s95, s95, 0x80
  v_mul_f32 v167, v159, v167
  v_fma_f32 v64, v64, v46, v46
  v_fma_f32 v65, v65, v46, v46
  v_rcp_f32 v64, v64
  v_mfma_f32_32x32x16_bf16 v[232:247], a[164:167], a[8:11], v[232:247]
  ds_read_b128 a[36:39], v10 offset:40960
  buffer_load_dwordx4 v22, s[52:55], s95 offen lds
  v_rcp_f32 v65, v65
  v_mul_f32 v166, v166, v64
  v_mul_f32 v167, v167, v65
  v_cvt_pk_bf16_f32 v155, v166, v167
  s_waitcnt lgkmcnt(3)
  v_mfma_f32_32x32x16_bf16 v[184:199], a[168:171], a[12:15], v[184:199]
  ds_read_b128 a[40:43], v10 offset:45056
  buffer_load_dwordx4 v23, s[52:55], s95 offen offset:1024 lds
  v_mul_f32 v64, v168, v168
  v_mul_f32 v65, v169, v169
  v_fma_f32 v64, v64, v45, v44
  v_fma_f32 v65, v65, v45, v44
  v_mfma_f32_32x32x16_bf16 v[200:215], a[168:171], a[16:19], v[200:215]
  ds_read_b128 a[44:47], v7 offset:49152
  v_mul_f32 v64, v64, v168
  v_mul_f32 v65, v65, v169
  v_exp_f32 v64, v64
  v_mul_f32 v176, v168, v176
  v_mfma_f32_32x32x16_bf16 v[216:231], a[168:171], a[20:23], v[216:231]
  ds_read_b128 a[48:51], v7 offset:53248
  buffer_load_dwordx4 v24, s[52:55], s95 offen offset:2048 lds
  v_exp_f32 v65, v65
  v_mul_f32 v177, v169, v177
  v_fma_f32 v64, v64, v46, v46
  v_fma_f32 v65, v65, v46, v46
  v_mfma_f32_32x32x16_bf16 v[232:247], a[168:171], a[24:27], v[232:247]
  ds_read_b128 a[52:55], v7 offset:57344
  buffer_load_dwordx4 v25, s[52:55], s95 offen offset:3072 lds
  v_rcp_f32 v64, v64
  v_rcp_f32 v65, v65
  v_mul_f32 v176, v176, v64
  v_mul_f32 v177, v177, v65
  s_waitcnt lgkmcnt(3)
  v_mfma_f32_32x32x16_bf16 v[184:199], a[172:175], a[28:31], v[184:199]
  ds_read_b128 a[56:59], v7 offset:61440
  v_cvt_pk_bf16_f32 v168, v176, v177
  v_mul_f32 v64, v170, v170
  v_mul_f32 v65, v171, v171
  v_fma_f32 v64, v64, v45, v44
  v_mfma_f32_32x32x16_bf16 v[200:215], a[172:175], a[32:35], v[200:215]
  ds_read_b128 a[60:63], v8 offset:49152
  v_fma_f32 v65, v65, v45, v44
  v_mul_f32 v64, v64, v170
  v_mul_f32 v65, v65, v171
  v_exp_f32 v64, v64
  v_mfma_f32_32x32x16_bf16 v[216:231], a[172:175], a[36:39], v[216:231]
  ds_read_b128 a[0:3], v8 offset:53248
  v_mul_f32 v178, v170, v178
  v_exp_f32 v65, v65
  v_mul_f32 v179, v171, v179
  v_fma_f32 v64, v64, v46, v46
  v_mfma_f32_32x32x16_bf16 v[232:247], a[172:175], a[40:43], v[232:247]
  ds_read_b128 a[4:7], v8 offset:57344
  v_fma_f32 v65, v65, v46, v46
  v_rcp_f32 v64, v64
  v_rcp_f32 v65, v65
  v_mul_f32 v178, v178, v64
  s_waitcnt lgkmcnt(3)
  v_mfma_f32_32x32x16_bf16 v[184:199], a[176:179], a[44:47], v[184:199]
  ds_read_b128 a[8:11], v8 offset:61440
  v_mul_f32 v179, v179, v65
  v_cvt_pk_bf16_f32 v169, v178, v179
  v_mul_f32 v64, v172, v172
  v_mul_f32 v65, v173, v173
  v_mfma_f32_32x32x16_bf16 v[200:215], a[176:179], a[48:51], v[200:215]
  ds_read_b128 a[12:15], v9 offset:49152
  v_fma_f32 v64, v64, v45, v44
  v_fma_f32 v65, v65, v45, v44
  v_mul_f32 v64, v64, v172
  v_mul_f32 v65, v65, v173
  v_mfma_f32_32x32x16_bf16 v[216:231], a[176:179], a[52:55], v[216:231]
  ds_read_b128 a[16:19], v9 offset:53248
  v_exp_f32 v64, v64
  v_mul_f32 v180, v172, v180
  v_exp_f32 v65, v65
  v_mul_f32 v181, v173, v181
  v_mfma_f32_32x32x16_bf16 v[232:247], a[176:179], a[56:59], v[232:247]
  ds_read_b128 a[20:23], v9 offset:57344
  v_fma_f32 v64, v64, v46, v46
  v_fma_f32 v65, v65, v46, v46
  v_rcp_f32 v64, v64
  v_rcp_f32 v65, v65
  s_waitcnt lgkmcnt(3)
  v_mfma_f32_32x32x16_bf16 v[184:199], a[180:183], a[60:63], v[184:199]
  ds_read_b128 a[24:27], v9 offset:61440
  v_mul_f32 v180, v180, v64
  v_mul_f32 v181, v181, v65
  v_cvt_pk_bf16_f32 v170, v180, v181
  v_mul_f32 v64, v174, v174
  v_mfma_f32_32x32x16_bf16 v[200:215], a[180:183], a[0:3], v[200:215]
  ds_read_b128 a[28:31], v10 offset:49152
  v_mul_f32 v65, v175, v175
  v_fma_f32 v64, v64, v45, v44
  v_fma_f32 v65, v65, v45, v44
  v_mul_f32 v64, v64, v174
  v_mfma_f32_32x32x16_bf16 v[216:231], a[180:183], a[4:7], v[216:231]
  ds_read_b128 a[32:35], v10 offset:53248
  ds_read_b128 a[36:39], v10 offset:57344
  ds_read_b128 a[40:43], v10 offset:61440
  v_mul_f32 v65, v65, v175
  v_exp_f32 v64, v64
  v_mul_f32 v182, v174, v182
  v_exp_f32 v65, v65
  v_mfma_f32_32x32x16_bf16 v[232:247], a[180:183], a[8:11], v[232:247]
  v_mul_f32 v183, v175, v183
  v_fma_f32 v64, v64, v46, v46
  v_fma_f32 v65, v65, v46, v46
  v_rcp_f32 v64, v64
  s_waitcnt lgkmcnt(4)
  v_mfma_f32_32x32x16_bf16 v[184:199], a[184:187], a[12:15], v[184:199]
  v_rcp_f32 v65, v65
  v_mul_f32 v182, v182, v64
  v_mul_f32 v183, v183, v65
  v_cvt_pk_bf16_f32 v171, v182, v183
  s_waitcnt lgkmcnt(0)
  s_barrier
  v_mfma_f32_32x32x16_bf16 v[200:215], a[184:187], a[16:19], v[200:215]
  ds_read_b128 a[44:47], v7
  buffer_store_dwordx4 v[72:75], v1, s[60:63], s86 offen sc1
  buffer_store_dwordx4 v[88:91], v1, s[60:63], s86 offen offset:1024 sc1
  buffer_store_dwordx4 v[104:107], v1, s[60:63], s86 offen offset:2048 sc1
  buffer_store_dwordx4 v[120:123], v1, s[60:63], s86 offen offset:3072 sc1
  v_mfma_f32_32x32x16_bf16 v[216:231], a[184:187], a[20:23], v[216:231]
  ds_read_b128 a[48:51], v7 offset:4096
  s_add_u32 s86, s86, 0x1000
  buffer_store_dwordx4 v[136:139], v1, s[60:63], s86 offen sc1
  buffer_store_dwordx4 v[152:155], v1, s[60:63], s86 offen offset:1024 sc1
  buffer_store_dwordx4 v[168:171], v1, s[60:63], s86 offen offset:2048 sc1
  v_mfma_f32_32x32x16_bf16 v[232:247], a[184:187], a[24:27], v[232:247]
  ds_read_b128 a[52:55], v7 offset:8192
  v_mfma_f32_32x32x16_bf16 v[184:199], a[188:191], a[28:31], v[184:199]
  ds_read_b128 a[56:59], v7 offset:12288
  v_lshrrev_b32 v82, 5, v0
  v_bfe_u32 v65, v0, 2, 2
  v_mfma_f32_32x32x16_bf16 v[200:215], a[188:191], a[32:35], v[200:215]
  ds_read_b128 a[60:63], v8
  v_lshl_add_u32 v64, v82, 2, v65
  v_lshlrev_b32 v64, 7, v64
  v_mfma_f32_32x32x16_bf16 v[216:231], a[188:191], a[36:39], v[216:231]
  ds_read_b128 a[0:3], v8 offset:4096
  v_bfe_u32 v65, v0, 4, 1
  v_lshlrev_b32 v65, 1, v65
  v_mfma_f32_32x32x16_bf16 v[232:247], a[188:191], a[40:43], v[232:247]
  ds_read_b128 a[4:7], v8 offset:8192
  v_bfe_u32 v66, v0, 1, 1
  v_add_u32 v65, v65, v66
  s_waitcnt lgkmcnt(3)
  s_waitcnt vmcnt(63)
  v_mfma_f32_32x32x16_bf16 v[184:199], a[192:195], a[44:47], v[184:199]
  ds_read_b128 a[8:11], v8 offset:12288
  s_and_b32 s8, s3, 1
  s_lshl_b32 s8, s8, 2
  v_mfma_f32_32x32x16_bf16 v[200:215], a[192:195], a[48:51], v[200:215]
  ds_read_b128 a[12:15], v9
  v_add_u32 v65, s8, v65
  v_bfe_u32 v66, v0, 3, 1
  v_mfma_f32_32x32x16_bf16 v[216:231], a[192:195], a[52:55], v[216:231]
  ds_read_b128 a[16:19], v9 offset:4096
  v_lshlrev_b32 v66, 2, v66
  v_xor_b32 v65, v65, v66
  v_mfma_f32_32x32x16_bf16 v[232:247], a[192:195], a[56:59], v[232:247]
  ds_read_b128 a[20:23], v9 offset:8192
  v_lshl_add_u32 v64, v65, 4, v64
  s_lshr_b32 s9, s3, 1
  s_waitcnt lgkmcnt(3)
  v_mfma_f32_32x32x16_bf16 v[184:199], a[196:199], a[60:63], v[184:199]
  ds_read_b128 a[24:27], v9 offset:12288
  s_lshl_b32 s9, s9, 13
  v_add_u32 v64, s9, v64
  v_mfma_f32_32x32x16_bf16 v[200:215], a[196:199], a[0:3], v[200:215]
  ds_read_b128 a[28:31], v10
  v_and_b32 v66, 1, v0
  v_lshl_add_u32 v72, v66, 3, v64
  v_mfma_f32_32x32x16_bf16 v[216:231], a[196:199], a[4:7], v[216:231]
  ds_read_b128 a[32:35], v10 offset:4096
  v_add_u32 v73, 0x10000, v72
  v_add_u32 v74, 0x20000, v72
  v_mfma_f32_32x32x16_bf16 v[232:247], a[196:199], a[8:11], v[232:247]
  ds_read_b128 a[36:39], v10 offset:8192
  v_mov_b32 v75, v1
  v_add_u32 v76, 0x10000, v1
  s_waitcnt lgkmcnt(3)
  v_mfma_f32_32x32x16_bf16 v[184:199], a[200:203], a[12:15], v[184:199]
  ds_read_b128 a[40:43], v10 offset:12288
  v_add_u32 v77, 0x20000, v1
  v_lshlrev_b32 v81, 6, v47
  v_mfma_f32_32x32x16_bf16 v[200:215], a[200:203], a[16:19], v[200:215]
  ds_read_b128 a[44:47], v7 offset:16384
  v_lshl_add_u32 v81, v82, 3, v81
  buffer_load_dwordx2 v[124:125], v81, s[40:43], s93 offen
  v_mfma_f32_32x32x16_bf16 v[216:231], a[200:203], a[20:23], v[216:231]
  ds_read_b128 a[48:51], v7 offset:20480
  buffer_load_dwordx2 v[126:127], v81, s[40:43], s93 offen offset:16
  buffer_load_dwordx2 v[128:129], v81, s[40:43], s93 offen offset:32
  v_mfma_f32_32x32x16_bf16 v[232:247], a[200:203], a[24:27], v[232:247]
  ds_read_b128 a[52:55], v7 offset:24576
  buffer_load_dwordx2 v[130:131], v81, s[40:43], s93 offen offset:48
  s_waitcnt lgkmcnt(3)
  v_mfma_f32_32x32x16_bf16 v[184:199], a[204:207], a[28:31], v[184:199]
  ds_read_b128 a[56:59], v7 offset:28672
  v_mfma_f32_32x32x16_bf16 v[200:215], a[204:207], a[32:35], v[200:215]
  ds_read_b128 a[60:63], v8 offset:16384
  v_mfma_f32_32x32x16_bf16 v[216:231], a[204:207], a[36:39], v[216:231]
  ds_read_b128 a[0:3], v8 offset:20480
  v_mfma_f32_32x32x16_bf16 v[232:247], a[204:207], a[40:43], v[232:247]
  ds_read_b128 a[4:7], v8 offset:24576
  s_waitcnt lgkmcnt(3)
  v_mfma_f32_32x32x16_bf16 v[184:199], a[208:211], a[44:47], v[184:199]
  ds_read_b128 a[8:11], v8 offset:28672
  s_waitcnt vmcnt(4)
  s_barrier
  s_mov_b32 s94, 0x8000
  buffer_store_dwordx2 v[34:35], v33, s[60:63], s94 offen sc1
  v_mfma_f32_32x32x16_bf16 v[200:215], a[208:211], a[48:51], v[200:215]
  ds_read_b128 a[12:15], v9 offset:16384
  v_mfma_f32_32x32x16_bf16 v[216:231], a[208:211], a[52:55], v[216:231]
  ds_read_b128 a[16:19], v9 offset:20480
  v_mfma_f32_32x32x16_bf16 v[232:247], a[208:211], a[56:59], v[232:247]
  ds_read_b128 a[20:23], v9 offset:24576
  buffer_load_dword v49, v6, s[56:59], 0 offen
  s_waitcnt lgkmcnt(3)
  v_mfma_f32_32x32x16_bf16 v[184:199], a[212:215], a[60:63], v[184:199]
  ds_read_b128 a[24:27], v9 offset:28672
  v_mfma_f32_32x32x16_bf16 v[200:215], a[212:215], a[0:3], v[200:215]
  ds_read_b128 a[28:31], v10 offset:16384
  v_mfma_f32_32x32x16_bf16 v[216:231], a[212:215], a[4:7], v[216:231]
  ds_read_b128 a[32:35], v10 offset:20480
  ds_read_b128 a[36:39], v10 offset:24576
  ds_read_b128 a[40:43], v10 offset:28672
  v_mfma_f32_32x32x16_bf16 v[232:247], a[212:215], a[8:11], v[232:247]
  s_waitcnt lgkmcnt(4)
  v_mfma_f32_32x32x16_bf16 v[184:199], a[216:219], a[12:15], v[184:199]
  s_waitcnt lgkmcnt(0)
  s_barrier
  v_mfma_f32_32x32x16_bf16 v[200:215], a[216:219], a[16:19], v[200:215]
  ds_read_b128 a[44:47], v11
  v_mfma_f32_32x32x16_bf16 v[216:231], a[216:219], a[20:23], v[216:231]
  ds_read_b128 a[48:51], v11 offset:4096
  s_add_u32 m0, s72, 0x8000
  v_mfma_f32_32x32x16_bf16 v[232:247], a[216:219], a[24:27], v[232:247]
  ds_read_b128 a[52:55], v11 offset:8192
  s_add_u32 s95, s101, 0
  v_mfma_f32_32x32x16_bf16 v[184:199], a[220:223], a[28:31], v[184:199]
  ds_read_b128 a[56:59], v11 offset:12288
  s_sub_u32 s12, s95, 6
  v_mfma_f32_32x32x16_bf16 v[200:215], a[220:223], a[32:35], v[200:215]
  ds_read_b128 a[60:63], v12
  v_mfma_f32_32x32x16_bf16 v[216:231], a[220:223], a[36:39], v[216:231]
  ds_read_b128 a[0:3], v12 offset:4096
  s_min_u32 s95, s95, s12
  v_mfma_f32_32x32x16_bf16 v[232:247], a[220:223], a[40:43], v[232:247]
  ds_read_b128 a[4:7], v12 offset:8192
  s_mul_i32 s95, s95, 0x10000
  s_waitcnt lgkmcnt(3)
  v_mfma_f32_32x32x16_bf16 v[184:199], a[224:227], a[44:47], v[184:199]
  ds_read_b128 a[8:11], v12 offset:12288
  s_add_u32 s95, s95, s81
  v_mfma_f32_32x32x16_bf16 v[200:215], a[224:227], a[48:51], v[200:215]
  ds_read_b128 a[12:15], v13
  v_mfma_f32_32x32x16_bf16 v[216:231], a[224:227], a[52:55], v[216:231]
  ds_read_b128 a[16:19], v13 offset:4096
  buffer_load_dwordx4 v2, s[56:59], s95 offen lds
  v_mfma_f32_32x32x16_bf16 v[232:247], a[224:227], a[56:59], v[232:247]
  ds_read_b128 a[20:23], v13 offset:8192
  buffer_load_dwordx4 v3, s[56:59], s95 offen offset:1024 lds
  s_waitcnt lgkmcnt(3)
  v_mfma_f32_32x32x16_bf16 v[184:199], a[228:231], a[60:63], v[184:199]
  ds_read_b128 a[24:27], v13 offset:12288
  buffer_load_dwordx4 v4, s[56:59], s95 offen offset:2048 lds
  v_mfma_f32_32x32x16_bf16 v[200:215], a[228:231], a[0:3], v[200:215]
  ds_read_b128 a[28:31], v14
  v_mfma_f32_32x32x16_bf16 v[216:231], a[228:231], a[4:7], v[216:231]
  ds_read_b128 a[32:35], v14 offset:4096
  buffer_load_dwordx4 v5, s[56:59], s95 offen offset:3072 lds
  v_mfma_f32_32x32x16_bf16 v[232:247], a[228:231], a[8:11], v[232:247]
  ds_read_b128 a[36:39], v14 offset:8192
  s_waitcnt lgkmcnt(3)
  v_mfma_f32_32x32x16_bf16 v[184:199], a[232:235], a[12:15], v[184:199]
  ds_read_b128 a[40:43], v14 offset:12288
  v_mfma_f32_32x32x16_bf16 v[200:215], a[232:235], a[16:19], v[200:215]
  ds_read_b128 a[44:47], v11 offset:16384
  v_mfma_f32_32x32x16_bf16 v[216:231], a[232:235], a[20:23], v[216:231]
  ds_read_b128 a[48:51], v11 offset:20480
  v_mfma_f32_32x32x16_bf16 v[232:247], a[232:235], a[24:27], v[232:247]
  ds_read_b128 a[52:55], v11 offset:24576
  s_waitcnt lgkmcnt(3)
  v_mfma_f32_32x32x16_bf16 v[184:199], a[236:239], a[28:31], v[184:199]
  ds_read_b128 a[56:59], v11 offset:28672
  v_mfma_f32_32x32x16_bf16 v[200:215], a[236:239], a[32:35], v[200:215]
  ds_read_b128 a[60:63], v12 offset:16384
  s_add_u32 m0, s72, 0
  v_mfma_f32_32x32x16_bf16 v[216:231], a[236:239], a[36:39], v[216:231]
  ds_read_b128 a[0:3], v12 offset:20480
  s_add_u32 s95, s101, 1
  v_mfma_f32_32x32x16_bf16 v[232:247], a[236:239], a[40:43], v[232:247]
  ds_read_b128 a[4:7], v12 offset:24576
  s_sub_u32 s12, s95, 6
  s_waitcnt lgkmcnt(3)
  v_mfma_f32_32x32x16_bf16 v[184:199], a[240:243], a[44:47], v[184:199]
  ds_read_b128 a[8:11], v12 offset:28672
  s_min_u32 s95, s95, s12
  v_mfma_f32_32x32x16_bf16 v[200:215], a[240:243], a[48:51], v[200:215]
  ds_read_b128 a[12:15], v13 offset:16384
  s_mul_i32 s95, s95, 0x10000
  v_mfma_f32_32x32x16_bf16 v[216:231], a[240:243], a[52:55], v[216:231]
  ds_read_b128 a[16:19], v13 offset:20480
  v_mfma_f32_32x32x16_bf16 v[232:247], a[240:243], a[56:59], v[232:247]
  ds_read_b128 a[20:23], v13 offset:24576
  s_add_u32 s95, s95, s81
  s_waitcnt lgkmcnt(3)
  v_mfma_f32_32x32x16_bf16 v[184:199], a[244:247], a[60:63], v[184:199]
  ds_read_b128 a[24:27], v13 offset:28672
  buffer_load_dwordx4 v2, s[56:59], s95 offen lds
  v_mfma_f32_32x32x16_bf16 v[200:215], a[244:247], a[0:3], v[200:215]
  ds_read_b128 a[28:31], v14 offset:16384
  buffer_load_dwordx4 v3, s[56:59], s95 offen offset:1024 lds
  v_mfma_f32_32x32x16_bf16 v[216:231], a[244:247], a[4:7], v[216:231]
  ds_read_b128 a[32:35], v14 offset:20480
  ds_read_b128 a[36:39], v14 offset:24576
  ds_read_b128 a[40:43], v14 offset:28672
  buffer_load_dwordx4 v4, s[56:59], s95 offen offset:2048 lds
  v_mfma_f32_32x32x16_bf16 v[232:247], a[244:247], a[8:11], v[232:247]
  buffer_load_dwordx4 v5, s[56:59], s95 offen offset:3072 lds
  s_waitcnt lgkmcnt(4)
  v_mfma_f32_32x32x16_bf16 v[184:199], a[248:251], a[12:15], v[184:199]
  s_waitcnt lgkmcnt(0)
  s_barrier
  v_mfma_f32_32x32x16_bf16 v[200:215], a[248:251], a[16:19], v[200:215]
  ds_read_b128 a[44:47], v11 offset:36864
  v_mfma_f32_32x32x16_bf16 v[216:231], a[248:251], a[20:23], v[216:231]
  ds_read_b128 a[48:51], v11 offset:40960
  s_add_u32 m0, s72, 0x10000
  v_mfma_f32_32x32x16_bf16 v[232:247], a[248:251], a[24:27], v[232:247]
  ds_read_b128 a[52:55], v11 offset:45056
  ds_read_b128 a[224:227], v11 offset:32768
  s_add_u32 s95, s101, 2
  v_mfma_f32_32x32x16_bf16 v[184:199], a[252:255], a[28:31], v[184:199]
  ds_read_b128 a[56:59], v12 offset:36864
  s_sub_u32 s12, s95, 6
  v_mfma_f32_32x32x16_bf16 v[200:215], a[252:255], a[32:35], v[200:215]
  ds_read_b128 a[60:63], v12 offset:40960
  s_min_u32 s95, s95, s12
  v_mfma_f32_32x32x16_bf16 v[216:231], a[252:255], a[36:39], v[216:231]
  ds_read_b128 a[0:3], v12 offset:45056
  ds_read_b128 a[228:231], v12 offset:32768
  s_mul_i32 s95, s95, 0x10000
  v_mfma_f32_32x32x16_bf16 v[232:247], a[252:255], a[40:43], v[232:247]
  ds_read_b128 a[4:7], v13 offset:36864
  s_waitcnt lgkmcnt(4)
  v_mfma_f32_32x32x16_bf16 v[200:215], a[64:67], a[44:47], v[200:215]
  ds_read_b128 a[8:11], v13 offset:40960
  s_add_u32 s95, s95, s81
  v_mfma_f32_32x32x16_bf16 v[216:231], a[64:67], a[48:51], v[216:231]
  ds_read_b128 a[12:15], v13 offset:45056
  ds_read_b128 a[232:235], v13 offset:32768
  buffer_load_dwordx4 v2, s[56:59], s95 offen lds
  v_mfma_f32_32x32x16_bf16 v[232:247], a[64:67], a[52:55], v[232:247]
  ds_read_b128 a[16:19], v14 offset:36864
  buffer_load_dwordx4 v3, s[56:59], s95 offen offset:1024 lds
  v_mfma_f32_32x32x16_bf16 v[200:215], a[68:71], a[56:59], v[200:215]
  ds_read_b128 a[20:23], v14 offset:40960
  buffer_load_dwordx4 v4, s[56:59], s95 offen offset:2048 lds
  s_waitcnt lgkmcnt(4)
  v_mfma_f32_32x32x16_bf16 v[216:231], a[68:71], a[60:63], v[216:231]
  ds_read_b128 a[24:27], v14 offset:45056
  ds_read_b128 a[236:239], v14 offset:32768
  buffer_load_dwordx4 v5, s[56:59], s95 offen offset:3072 lds
  v_mfma_f32_32x32x16_bf16 v[232:247], a[68:71], a[0:3], v[232:247]
  ds_read_b128 a[28:31], v11 offset:53248
  v_mfma_f32_32x32x16_bf16 v[200:215], a[72:75], a[4:7], v[200:215]
  ds_read_b128 a[32:35], v11 offset:57344
  v_mfma_f32_32x32x16_bf16 v[216:231], a[72:75], a[8:11], v[216:231]
  ds_read_b128 a[36:39], v11 offset:61440
  ds_read_b128 a[240:243], v11 offset:49152
  buffer_load_dwordx2 v[36:37], v31, s[60:63], 0 offen sc1
  s_waitcnt lgkmcnt(4)
  v_mfma_f32_32x32x16_bf16 v[232:247], a[72:75], a[12:15], v[232:247]
  ds_read_b128 a[40:43], v12 offset:53248
  s_mov_b32 s94, 0x3f80
  s_mov_b32 s99, 0x3f800000
  v_mfma_f32_32x32x16_bf16 v[200:215], a[76:79], a[16:19], v[200:215]
  ds_read_b128 a[44:47], v12 offset:57344
  s_waitcnt vmcnt(18)
  v_dot2c_f32_bf16 v184, s94, v124
  v_dot2c_f32_bf16 v185, s99, v124
  v_mfma_f32_32x32x16_bf16 v[216:231], a[76:79], a[20:23], v[216:231]
  ds_read_b128 a[48:51], v12 offset:61440
  ds_read_b128 a[244:247], v12 offset:49152
  v_dot2c_f32_bf16 v186, s94, v125
  v_dot2c_f32_bf16 v187, s99, v125
  v_mfma_f32_32x32x16_bf16 v[232:247], a[76:79], a[24:27], v[232:247]
  ds_read_b128 a[52:55], v13 offset:53248
  s_waitcnt vmcnt(17)
  v_dot2c_f32_bf16 v188, s94, v126
  v_dot2c_f32_bf16 v189, s99, v126
  s_waitcnt lgkmcnt(4)
  v_mfma_f32_32x32x16_bf16 v[200:215], a[80:83], a[28:31], v[200:215]
  ds_read_b128 a[56:59], v13 offset:57344
  v_dot2c_f32_bf16 v190, s94, v127
  v_dot2c_f32_bf16 v191, s99, v127
  v_mfma_f32_32x32x16_bf16 v[216:231], a[80:83], a[32:35], v[216:231]
  ds_read_b128 a[60:63], v13 offset:61440
  ds_read_b128 a[248:251], v13 offset:49152
  s_waitcnt vmcnt(16)
  v_dot2c_f32_bf16 v192, s94, v128
  v_dot2c_f32_bf16 v193, s99, v128
  v_mfma_f32_32x32x16_bf16 v[232:247], a[80:83], a[36:39], v[232:247]
  ds_read_b128 a[0:3], v14 offset:53248
  ds_read_b128 a[4:7], v14 offset:57344
  ds_read_b128 a[8:11], v14 offset:61440
  ds_read_b128 a[252:255], v14 offset:49152
  v_dot2c_f32_bf16 v194, s94, v129
  v_dot2c_f32_bf16 v195, s99, v129
  v_mfma_f32_32x32x16_bf16 v[200:215], a[84:87], a[40:43], v[200:215]
  s_waitcnt vmcnt(15)
  v_dot2c_f32_bf16 v196, s94, v130
  v_dot2c_f32_bf16 v197, s99, v130
  s_waitcnt lgkmcnt(6)
  v_mfma_f32_32x32x16_bf16 v[216:231], a[84:87], a[44:47], v[216:231]
  v_dot2c_f32_bf16 v198, s94, v131
  v_dot2c_f32_bf16 v199, s99, v131
  s_waitcnt lgkmcnt(0)
  s_barrier
  v_mfma_f32_32x32x16_bf16 v[232:247], a[84:87], a[48:51], v[232:247]
  ds_read_b128 a[12:15], v15 offset:4096
  s_waitcnt vmcnt(0)
  v_cmp_eq_u64 vcc, v[36:37], v[34:35]
  s_nop 0
  s_cmp_eq_u64 vcc, -1
  s_cbranch_scc0 L0_slow_kh
L0_res_kh:
  s_add_u32 m0, s72, 0xc000
  s_add_u32 s95, s101, 0
  s_sub_u32 s12, s95, 6
  v_lshl_add_u32 v81, v82, 3, v81
  v_mfma_f32_32x32x16_bf16 v[200:215], a[88:91], a[52:55], v[200:215]
  ds_read_b128 a[16:19], v15 offset:8192
  s_min_u32 s95, s95, s12
  s_mul_i32 s95, s95, 0x1000
  s_add_u32 s95, s95, s82
  buffer_load_dwordx4 v1, s[60:63], s95 offen sc1 lds
  v_mfma_f32_32x32x16_bf16 v[216:231], a[88:91], a[56:59], v[216:231]
  ds_read_b128 a[20:23], v15 offset:12288
  ds_read_b128 a[192:195], v15
  buffer_load_dwordx4 v1, s[60:63], s95 offen offset:1024 sc1 lds
  buffer_load_dwordx4 v1, s[60:63], s95 offen offset:2048 sc1 lds
  buffer_load_dwordx4 v1, s[60:63], s95 offen offset:3072 sc1 lds
  s_add_u32 m0, s72, 0x4000
  v_mfma_f32_32x32x16_bf16 v[232:247], a[88:91], a[60:63], v[232:247]
  ds_read_b128 a[24:27], v16 offset:4096
  s_add_u32 s95, s101, 1
  s_sub_u32 s12, s95, 6
  s_min_u32 s95, s95, s12
  s_mul_i32 s95, s95, 0x1000
  v_mfma_f32_32x32x16_bf16 v[200:215], a[92:95], a[0:3], v[200:215]
  ds_read_b128 a[28:31], v16 offset:8192
  s_add_u32 s95, s95, s82
  buffer_load_dwordx4 v1, s[60:63], s95 offen sc1 lds
  buffer_load_dwordx4 v1, s[60:63], s95 offen offset:1024 sc1 lds
  buffer_load_dwordx4 v1, s[60:63], s95 offen offset:2048 sc1 lds
  v_mfma_f32_32x32x16_bf16 v[216:231], a[92:95], a[4:7], v[216:231]
  ds_read_b128 a[32:35], v16 offset:12288
  ds_read_b128 a[196:199], v16
  buffer_load_dwordx4 v1, s[60:63], s95 offen offset:3072 sc1 lds
  v_mfma_f32_32x32x16_bf16 v[232:247], a[92:95], a[8:11], v[232:247]
  ds_read_b128 a[36:39], v17 offset:4096
  s_waitcnt lgkmcnt(4)
  v_mfma_f32_32x32x16_bf16 v[200:215], a[96:99], a[12:15], v[200:215]
  ds_read_b128 a[40:43], v17 offset:8192
  v_mfma_f32_32x32x16_bf16 v[216:231], a[96:99], a[16:19], v[216:231]
  ds_read_b128 a[44:47], v17 offset:12288
  ds_read_b128 a[200:203], v17
  v_mfma_f32_32x32x16_bf16 v[232:247], a[96:99], a[20:23], v[232:247]
  ds_read_b128 a[48:51], v18 offset:4096
  v_mfma_f32_32x32x16_bf16 v[200:215], a[100:103], a[24:27], v[200:215]
  ds_read_b128 a[52:55], v18 offset:8192
  s_waitcnt lgkmcnt(4)
  v_mfma_f32_32x32x16_bf16 v[216:231], a[100:103], a[28:31], v[216:231]
  ds_read_b128 a[56:59], v18 offset:12288
  ds_read_b128 a[204:207], v18
  v_mfma_f32_32x32x16_bf16 v[232:247], a[100:103], a[32:35], v[232:247]
  ds_read_b128 a[60:63], v15 offset:20480
  v_mfma_f32_32x32x16_bf16 v[200:215], a[104:107], a[36:39], v[200:215]
  ds_read_b128 a[0:3], v15 offset:24576
  s_add_u32 m0, s72, 0x14000
  s_add_u32 s95, s101, 2
  s_sub_u32 s12, s95, 6
  v_mfma_f32_32x32x16_bf16 v[216:231], a[104:107], a[40:43], v[216:231]
  ds_read_b128 a[4:7], v15 offset:28672
  ds_read_b128 a[208:211], v15 offset:16384
  s_min_u32 s95, s95, s12
  s_mul_i32 s95, s95, 0x1000
  s_add_u32 s95, s95, s82
  s_waitcnt lgkmcnt(4)
  v_mfma_f32_32x32x16_bf16 v[232:247], a[104:107], a[44:47], v[232:247]
  ds_read_b128 a[8:11], v16 offset:20480
  buffer_load_dwordx4 v1, s[60:63], s95 offen sc1 lds
  buffer_load_dwordx4 v1, s[60:63], s95 offen offset:1024 sc1 lds
  buffer_load_dwordx4 v1, s[60:63], s95 offen offset:2048 sc1 lds
  v_mfma_f32_32x32x16_bf16 v[200:215], a[108:111], a[48:51], v[200:215]
  ds_read_b128 a[12:15], v16 offset:24576
  buffer_load_dwordx4 v1, s[60:63], s95 offen offset:3072 sc1 lds
  s_add_u32 m0, s72, 0x18000
  s_add_u32 s95, s101, 3
  v_mfma_f32_32x32x16_bf16 v[216:231], a[108:111], a[52:55], v[216:231]
  ds_read_b128 a[16:19], v16 offset:28672
  ds_read_b128 a[212:215], v16 offset:16384
  s_sub_u32 s12, s95, 6
  s_min_u32 s95, s95, s12
  s_mul_i32 s95, s95, 0x10000
  v_mfma_f32_32x32x16_bf16 v[232:247], a[108:111], a[56:59], v[232:247]
  ds_read_b128 a[20:23], v17 offset:20480
  s_add_u32 s95, s95, s81
  buffer_load_dwordx4 v2, s[56:59], s95 offen lds
  buffer_load_dwordx4 v3, s[56:59], s95 offen offset:1024 lds
  s_waitcnt lgkmcnt(4)
  v_mfma_f32_32x32x16_bf16 v[200:215], a[112:115], a[60:63], v[200:215]
  ds_read_b128 a[24:27], v17 offset:24576
  buffer_load_dwordx4 v4, s[56:59], s95 offen offset:2048 lds
  buffer_load_dwordx4 v5, s[56:59], s95 offen offset:3072 lds
  s_add_u32 m0, s72, 0x1c000
  v_mfma_f32_32x32x16_bf16 v[216:231], a[112:115], a[0:3], v[216:231]
  ds_read_b128 a[28:31], v17 offset:28672
  ds_read_b128 a[216:219], v17 offset:16384
  s_add_u32 s95, s101, 3
  s_sub_u32 s12, s95, 6
  s_min_u32 s95, s95, s12
  v_mfma_f32_32x32x16_bf16 v[232:247], a[112:115], a[4:7], v[232:247]
  ds_read_b128 a[32:35], v18 offset:20480
  ds_read_b128 a[36:39], v18 offset:24576
  ds_read_b128 a[40:43], v18 offset:28672
  ds_read_b128 a[220:223], v18 offset:16384
  s_mul_i32 s95, s95, 0x1000
  s_add_u32 s95, s95, s82
  buffer_load_dwordx4 v1, s[60:63], s95 offen sc1 lds
  v_mfma_f32_32x32x16_bf16 v[200:215], a[116:119], a[8:11], v[200:215]
  buffer_load_dwordx4 v1, s[60:63], s95 offen offset:1024 sc1 lds
  buffer_load_dwordx4 v1, s[60:63], s95 offen offset:2048 sc1 lds
  buffer_load_dwordx4 v1, s[60:63], s95 offen offset:3072 sc1 lds
  s_waitcnt lgkmcnt(6)
  v_mfma_f32_32x32x16_bf16 v[216:231], a[116:119], a[12:15], v[216:231]
  s_waitcnt vmcnt(16) lgkmcnt(0)
  s_barrier
  v_mfma_f32_32x32x16_bf16 v[232:247], a[116:119], a[16:19], v[232:247]
  ds_read_b64_tr_b16 a[44:45], v72 offset:32768
  ds_read_b64_tr_b16 a[46:47], v72 offset:33792
  ds_read_b128 a[48:51], v75 offset:49152
  s_add_u32 m0, s72, 0x20000
  v_mfma_f32_32x32x16_bf16 v[200:215], a[120:123], a[20:23], v[200:215]
  ds_read_b128 a[52:55], v75 offset:53248
  s_add_u32 s95, s101, 4
  v_mfma_f32_32x32x16_bf16 v[216:231], a[120:123], a[24:27], v[216:231]
  ds_read_b128 a[56:59], v75 offset:57344
  s_sub_u32 s12, s95, 6
  v_mfma_f32_32x32x16_bf16 v[232:247], a[120:123], a[28:31], v[232:247]
  ds_read_b128 a[60:63], v75 offset:61440
  s_min_u32 s95, s95, s12
  s_mul_i32 s95, s95, 0x10000
  v_mfma_f32_32x32x16_bf16 v[200:215], a[124:127], a[32:35], v[200:215]
  ds_read_b64_tr_b16 a[0:1], v72 offset:34816
  ds_read_b64_tr_b16 a[2:3], v72 offset:35840
  ds_read_b128 a[4:7], v75 offset:50176
  s_add_u32 s95, s95, s81
  v_mfma_f32_32x32x16_bf16 v[216:231], a[124:127], a[36:39], v[216:231]
  ds_read_b128 a[8:11], v75 offset:54272
  buffer_load_dwordx4 v2, s[56:59], s95 offen lds
  v_mfma_f32_32x32x16_bf16 v[232:247], a[124:127], a[40:43], v[232:247]
  ds_read_b128 a[12:15], v75 offset:58368
  buffer_load_dwordx4 v3, s[56:59], s95 offen offset:1024 lds
  buffer_load_dwordx4 v4, s[56:59], s95 offen offset:2048 lds
  s_waitcnt lgkmcnt(5)
  v_mfma_f32_32x32x16_bf16 v[184:199], a[44:47], a[48:51], v[184:199]
  ds_read_b128 a[16:19], v75 offset:62464
  buffer_load_dwordx4 v5, s[56:59], s95 offen offset:3072 lds
  v_mfma_f32_32x32x16_bf16 v[200:215], a[44:47], a[52:55], v[200:215]
  ds_read_b64_tr_b16 a[20:21], v72 offset:36864
  ds_read_b64_tr_b16 a[22:23], v72 offset:37888
  ds_read_b128 a[24:27], v75 offset:51200
  s_add_u32 m0, s72, 0x24000
  v_mfma_f32_32x32x16_bf16 v[216:231], a[44:47], a[56:59], v[216:231]
  ds_read_b128 a[28:31], v75 offset:55296
  s_add_u32 s95, s101, 4
  s_sub_u32 s12, s95, 6
  v_mfma_f32_32x32x16_bf16 v[232:247], a[44:47], a[60:63], v[232:247]
  ds_read_b128 a[32:35], v75 offset:59392
  s_min_u32 s95, s95, s12
  s_waitcnt lgkmcnt(5)
  v_mfma_f32_32x32x16_bf16 v[184:199], a[0:3], a[4:7], v[184:199]
  ds_read_b128 a[36:39], v75 offset:63488
  s_mul_i32 s95, s95, 0x1000
  v_mfma_f32_32x32x16_bf16 v[200:215], a[0:3], a[8:11], v[200:215]
  ds_read_b64_tr_b16 a[40:41], v72 offset:38912
  ds_read_b64_tr_b16 a[42:43], v72 offset:39936
  ds_read_b128 a[44:47], v75 offset:52224
  s_add_u32 s95, s95, s82
  buffer_load_dwordx4 v1, s[60:63], s95 offen sc1 lds
  v_mfma_f32_32x32x16_bf16 v[216:231], a[0:3], a[12:15], v[216:231]
  ds_read_b128 a[48:51], v75 offset:56320
  ds_read_b128 a[52:55], v75 offset:60416
  ds_read_b128 a[56:59], v75 offset:64512
  buffer_load_dwordx4 v1, s[60:63], s95 offen offset:1024 sc1 lds
  v_mfma_f32_32x32x16_bf16 v[232:247], a[0:3], a[16:19], v[232:247]
  buffer_load_dwordx4 v1, s[60:63], s95 offen offset:2048 sc1 lds
  s_waitcnt lgkmcnt(6)
  v_mfma_f32_32x32x16_bf16 v[184:199], a[20:23], a[24:27], v[184:199]
  buffer_load_dwordx4 v1, s[60:63], s95 offen offset:3072 sc1 lds
  s_waitcnt vmcnt(20) lgkmcnt(0)
  s_barrier
  v_mfma_f32_32x32x16_bf16 v[200:215], a[20:23], a[28:31], v[200:215]
  ds_read_b64_tr_b16 a[60:61], v72
  ds_read_b64_tr_b16 a[62:63], v72 offset:1024
  ds_read_b128 a[0:3], v75 offset:16384
  s_add_u32 m0, s72, 0x8000
  v_mfma_f32_32x32x16_bf16 v[216:231], a[20:23], a[32:35], v[216:231]
  ds_read_b128 a[4:7], v75 offset:20480
  s_add_u32 s95, s101, 5
  v_mfma_f32_32x32x16_bf16 v[232:247], a[20:23], a[36:39], v[232:247]
  ds_read_b128 a[8:11], v75 offset:24576
  s_sub_u32 s12, s95, 6
  v_mfma_f32_32x32x16_bf16 v[184:199], a[40:43], a[44:47], v[184:199]
  ds_read_b128 a[12:15], v75 offset:28672
  s_min_u32 s95, s95, s12
  s_mul_i32 s95, s95, 0x10000
  v_mfma_f32_32x32x16_bf16 v[200:215], a[40:43], a[48:51], v[200:215]
  ds_read_b64_tr_b16 a[16:17], v72 offset:2048
  ds_read_b64_tr_b16 a[18:19], v72 offset:3072
  ds_read_b128 a[20:23], v75 offset:17408
  s_add_u32 s95, s95, s81
  v_mfma_f32_32x32x16_bf16 v[216:231], a[40:43], a[52:55], v[216:231]
  ds_read_b128 a[24:27], v75 offset:21504
  buffer_load_dwordx4 v2, s[56:59], s95 offen lds
  v_mfma_f32_32x32x16_bf16 v[232:247], a[40:43], a[56:59], v[232:247]
  ds_read_b128 a[28:31], v75 offset:25600
  buffer_load_dwordx4 v3, s[56:59], s95 offen offset:1024 lds
  buffer_load_dwordx4 v4, s[56:59], s95 offen offset:2048 lds
  s_waitcnt lgkmcnt(5)
  v_mfma_f32_32x32x16_bf16 v[184:199], a[60:63], a[0:3], v[184:199]
  ds_read_b128 a[32:35], v75 offset:29696
  buffer_load_dwordx4 v5, s[56:59], s95 offen offset:3072 lds
  v_mfma_f32_32x32x16_bf16 v[200:215], a[60:63], a[4:7], v[200:215]
  ds_read_b64_tr_b16 a[36:37], v72 offset:4096
  ds_read_b64_tr_b16 a[38:39], v72 offset:5120
  ds_read_b128 a[40:43], v75 offset:18432
  s_add_u32 m0, s72, 0xc000
  v_mfma_f32_32x32x16_bf16 v[216:231], a[60:63], a[8:11], v[216:231]
  ds_read_b128 a[44:47], v75 offset:22528
  s_add_u32 s95, s101, 5
  s_sub_u32 s12, s95, 6
  v_mfma_f32_32x32x16_bf16 v[232:247], a[60:63], a[12:15], v[232:247]
  ds_read_b128 a[48:51], v75 offset:26624
  s_min_u32 s95, s95, s12
  s_waitcnt lgkmcnt(5)
  v_mfma_f32_32x32x16_bf16 v[184:199], a[16:19], a[20:23], v[184:199]
  ds_read_b128 a[52:55], v75 offset:30720
  s_mul_i32 s95, s95, 0x1000
  v_mfma_f32_32x32x16_bf16 v[200:215], a[16:19], a[24:27], v[200:215]
  ds_read_b64_tr_b16 a[56:57], v72 offset:6144
  ds_read_b64_tr_b16 a[58:59], v72 offset:7168
  ds_read_b128 a[60:63], v75 offset:19456
  s_add_u32 s95, s95, s82
  buffer_load_dwordx4 v1, s[60:63], s95 offen sc1 lds
  v_mfma_f32_32x32x16_bf16 v[216:231], a[16:19], a[28:31], v[216:231]
  ds_read_b128 a[0:3], v75 offset:23552
  ds_read_b128 a[4:7], v75 offset:27648
  ds_read_b128 a[8:11], v75 offset:31744
  buffer_load_dwordx4 v1, s[60:63], s95 offen offset:1024 sc1 lds
  v_mfma_f32_32x32x16_bf16 v[232:247], a[16:19], a[32:35], v[232:247]
  buffer_load_dwordx4 v1, s[60:63], s95 offen offset:2048 sc1 lds
  s_waitcnt lgkmcnt(6)
  v_mfma_f32_32x32x16_bf16 v[184:199], a[36:39], a[40:43], v[184:199]
  buffer_load_dwordx4 v1, s[60:63], s95 offen offset:3072 sc1 lds
  s_waitcnt vmcnt(24) lgkmcnt(0)
  s_barrier
  v_mfma_f32_32x32x16_bf16 v[200:215], a[36:39], a[44:47], v[200:215]
  ds_read_b64_tr_b16 a[160:161], v73
  ds_read_b64_tr_b16 a[162:163], v73 offset:1024
  ds_read_b128 a[12:15], v76 offset:20480
  v_mfma_f32_32x32x16_bf16 v[216:231], a[36:39], a[48:51], v[216:231]
  ds_read_b128 a[16:19], v76 offset:24576
  s_mul_i32 s12, s3, 0x1000
  v_mfma_f32_32x32x16_bf16 v[232:247], a[36:39], a[52:55], v[232:247]
  ds_read_b128 a[20:23], v76 offset:28672
  ds_read_b128 a[176:179], v76 offset:16384
  s_add_u32 m0, s12, 0
  v_mfma_f32_32x32x16_bf16 v[184:199], a[56:59], a[60:63], v[184:199]
  ds_read_b64_tr_b16 a[164:165], v73 offset:2048
  ds_read_b64_tr_b16 a[166:167], v73 offset:3072
  ds_read_b128 a[24:27], v76 offset:21504
  s_add_u32 s95, s17, 0
  v_mfma_f32_32x32x16_bf16 v[200:215], a[56:59], a[0:3], v[200:215]
  ds_read_b128 a[28:31], v76 offset:25600
  v_mfma_f32_32x32x16_bf16 v[216:231], a[56:59], a[4:7], v[216:231]
  ds_read_b128 a[32:35], v76 offset:29696
  ds_read_b128 a[180:183], v76 offset:17408
  buffer_load_dwordx4 v1, s[60:63], s95 offen sc1 lds
  v_mfma_f32_32x32x16_bf16 v[232:247], a[56:59], a[8:11], v[232:247]
  ds_read_b64_tr_b16 a[168:169], v73 offset:4096
  ds_read_b64_tr_b16 a[170:171], v73 offset:5120
  ds_read_b128 a[36:39], v76 offset:22528
  buffer_load_dwordx4 v1, s[60:63], s95 offen offset:1024 sc1 lds
  s_waitcnt lgkmcnt(6)
  v_mfma_f32_32x32x16_bf16 v[200:215], a[160:163], a[12:15], v[200:215]
  ds_read_b128 a[40:43], v76 offset:26624
  buffer_load_dwordx4 v1, s[60:63], s95 offen offset:2048 sc1 lds
  v_mfma_f32_32x32x16_bf16 v[216:231], a[160:163], a[16:19], v[216:231]
  ds_read_b128 a[44:47], v76 offset:30720
  ds_read_b128 a[184:187], v76 offset:18432
  v_mfma_f32_32x32x16_bf16 v[232:247], a[160:163], a[20:23], v[232:247]
  ds_read_b64_tr_b16 a[172:173], v73 offset:6144
  ds_read_b64_tr_b16 a[174:175], v73 offset:7168
  ds_read_b128 a[48:51], v76 offset:23552
  ds_read_b128 a[52:55], v76 offset:27648
  ds_read_b128 a[56:59], v76 offset:31744
  ds_read_b128 a[188:191], v76 offset:19456
  buffer_load_dwordx4 v1, s[60:63], s95 offen offset:3072 sc1 lds
  v_mfma_f32_32x32x16_bf16 v[200:215], a[164:167], a[24:27], v[200:215]
  s_waitcnt lgkmcnt(8)
  v_mfma_f32_32x32x16_bf16 v[216:231], a[164:167], a[28:31], v[216:231]
  s_waitcnt vmcnt(20) lgkmcnt(0)
  s_barrier
  v_mfma_f32_32x32x16_bf16 v[232:247], a[164:167], a[32:35], v[232:247]
  ds_read_b64_tr_b16 v[148:149], v73 offset:32768
  ds_read_b64_tr_b16 v[150:151], v73 offset:33792
  ds_read_b128 a[60:63], v76 offset:53248
  s_add_u32 m0, s72, 0x10000
  v_mfma_f32_32x32x16_bf16 v[200:215], a[168:171], a[36:39], v[200:215]
  ds_read_b128 a[0:3], v76 offset:57344
  s_add_u32 s95, s16, 0
  v_mfma_f32_32x32x16_bf16 v[216:231], a[168:171], a[40:43], v[216:231]
  ds_read_b128 a[4:7], v76 offset:61440
  ds_read_b128 v[164:167], v76 offset:49152
  buffer_load_dwordx4 v2, s[56:59], s95 offen lds
  v_mfma_f32_32x32x16_bf16 v[232:247], a[168:171], a[44:47], v[232:247]
  ds_read_b64_tr_b16 v[152:153], v73 offset:34816
  ds_read_b64_tr_b16 v[154:155], v73 offset:35840
  ds_read_b128 a[8:11], v76 offset:54272
  buffer_load_dwordx4 v3, s[56:59], s95 offen offset:1024 lds
  v_mfma_f32_32x32x16_bf16 v[200:215], a[172:175], a[48:51], v[200:215]
  ds_read_b128 a[12:15], v76 offset:58368
  buffer_load_dwordx4 v4, s[56:59], s95 offen offset:2048 lds
  v_mfma_f32_32x32x16_bf16 v[216:231], a[172:175], a[52:55], v[216:231]
  ds_read_b128 a[16:19], v76 offset:62464
  ds_read_b128 v[168:171], v76 offset:50176
  buffer_load_dwordx4 v5, s[56:59], s95 offen offset:3072 lds
  v_mfma_f32_32x32x16_bf16 v[232:247], a[172:175], a[56:59], v[232:247]
  ds_read_b64_tr_b16 v[156:157], v73 offset:36864
  ds_read_b64_tr_b16 v[158:159], v73 offset:37888
  ds_read_b128 a[20:23], v76 offset:55296
  s_add_u32 m0, s72, 0x14000
  s_waitcnt lgkmcnt(6)
  v_mfma_f32_32x32x16_bf16 v[200:215], v[148:151], a[60:63], v[200:215]
  ds_read_b128 a[24:27], v76 offset:59392
  s_add_u32 s95, s16, 0x10000
  v_mfma_f32_32x32x16_bf16 v[216:231], v[148:151], a[0:3], v[216:231]
  ds_read_b128 a[28:31], v76 offset:63488
  ds_read_b128 v[172:175], v76 offset:51200
  buffer_load_dwordx4 v2, s[56:59], s95 offen lds
  v_mfma_f32_32x32x16_bf16 v[232:247], v[148:151], a[4:7], v[232:247]
  ds_read_b64_tr_b16 v[160:161], v73 offset:38912
  ds_read_b64_tr_b16 v[162:163], v73 offset:39936
  ds_read_b128 a[32:35], v76 offset:56320
  ds_read_b128 a[36:39], v76 offset:60416
  ds_read_b128 a[40:43], v76 offset:64512
  ds_read_b128 v[176:179], v76 offset:52224
  buffer_load_dwordx4 v3, s[56:59], s95 offen offset:1024 lds
  v_mfma_f32_32x32x16_bf16 v[200:215], v[152:155], a[8:11], v[200:215]
  buffer_load_dwordx4 v4, s[56:59], s95 offen offset:2048 lds
  s_waitcnt lgkmcnt(8)
  v_mfma_f32_32x32x16_bf16 v[216:231], v[152:155], a[12:15], v[216:231]
  buffer_load_dwordx4 v5, s[56:59], s95 offen offset:3072 lds
  s_waitcnt vmcnt(20) lgkmcnt(0)
  s_barrier
  v_mfma_f32_32x32x16_bf16 v[232:247], v[152:155], a[16:19], v[232:247]
  ds_read_b64_tr_b16 v[84:85], v74
  ds_read_b64_tr_b16 v[86:87], v74 offset:1024
  ds_read_b128 a[44:47], v77 offset:20480
  v_mfma_f32_32x32x16_bf16 v[200:215], v[156:159], a[20:23], v[200:215]
  ds_read_b128 a[48:51], v77 offset:24576
  s_add_u32 m0, s72, 0x18000
  v_mfma_f32_32x32x16_bf16 v[216:231], v[156:159], a[24:27], v[216:231]
  ds_read_b128 a[52:55], v77 offset:28672
  ds_read_b128 v[52:55], v77 offset:16384
  s_add_u32 s95, s16, 0x20000
  v_mfma_f32_32x32x16_bf16 v[232:247], v[156:159], a[28:31], v[232:247]
  ds_read_b64_tr_b16 v[88:89], v74 offset:2048
  ds_read_b64_tr_b16 v[90:91], v74 offset:3072
  ds_read_b128 a[56:59], v77 offset:21504
  buffer_load_dwordx4 v2, s[56:59], s95 offen lds
  v_mfma_f32_32x32x16_bf16 v[200:215], v[160:163], a[32:35], v[200:215]
  ds_read_b128 a[60:63], v77 offset:25600
  v_mfma_f32_32x32x16_bf16 v[216:231], v[160:163], a[36:39], v[216:231]
  ds_read_b128 a[0:3], v77 offset:29696
  ds_read_b128 v[56:59], v77 offset:17408
  buffer_load_dwordx4 v3, s[56:59], s95 offen offset:1024 lds
  v_mfma_f32_32x32x16_bf16 v[232:247], v[160:163], a[40:43], v[232:247]
  ds_read_b64_tr_b16 v[92:93], v74 offset:4096
  ds_read_b64_tr_b16 v[94:95], v74 offset:5120
  ds_read_b128 a[4:7], v77 offset:22528
  buffer_load_dwordx4 v4, s[56:59], s95 offen offset:2048 lds
  s_waitcnt lgkmcnt(6)
  v_mfma_f32_32x32x16_bf16 v[200:215], v[84:87], a[44:47], v[200:215]
  ds_read_b128 a[8:11], v77 offset:26624
  buffer_load_dwordx4 v5, s[56:59], s95 offen offset:3072 lds
  v_mfma_f32_32x32x16_bf16 v[216:231], v[84:87], a[48:51], v[216:231]
  ds_read_b128 a[12:15], v77 offset:30720
  ds_read_b128 v[248:251], v77 offset:18432
  v_mfma_f32_32x32x16_bf16 v[232:247], v[84:87], a[52:55], v[232:247]
  ds_read_b64_tr_b16 v[96:97], v74 offset:6144
  ds_read_b64_tr_b16 v[98:99], v74 offset:7168
  ds_read_b128 a[16:19], v77 offset:23552
  ds_read_b128 a[20:23], v77 offset:27648
  ds_read_b128 a[24:27], v77 offset:31744
  ds_read_b128 v[252:255], v77 offset:19456
  s_add_u32 m0, s72, 0x1c000
  v_mfma_f32_32x32x16_bf16 v[200:215], v[88:91], a[56:59], v[200:215]
  s_add_u32 s95, s16, 0x30000
  s_waitcnt lgkmcnt(8)
  v_mfma_f32_32x32x16_bf16 v[216:231], v[88:91], a[60:63], v[216:231]
  buffer_load_dwordx4 v2, s[56:59], s95 offen lds
  s_waitcnt vmcnt(17) lgkmcnt(0)
  s_barrier
  v_mfma_f32_32x32x16_bf16 v[232:247], v[88:91], a[0:3], v[232:247]
  ds_read_b64_tr_b16 v[132:133], v72 offset:32768
  ds_read_b64_tr_b16 v[134:135], v72 offset:33792
  ds_read_b128 a[28:31], v75 offset:53248
  v_mfma_f32_32x32x16_bf16 v[200:215], v[92:95], a[4:7], v[200:215]
  ds_read_b64_tr_b16 v[136:137], v72 offset:34816
  ds_read_b64_tr_b16 v[138:139], v72 offset:35840
  ds_read_b128 a[32:35], v75 offset:54272
  buffer_load_dwordx4 v3, s[56:59], s95 offen offset:1024 lds
  v_mfma_f32_32x32x16_bf16 v[216:231], v[92:95], a[8:11], v[216:231]
  ds_read_b64_tr_b16 v[140:141], v72 offset:36864
  ds_read_b64_tr_b16 v[142:143], v72 offset:37888
  ds_read_b128 a[36:39], v75 offset:55296
  buffer_load_dwordx4 v4, s[56:59], s95 offen offset:2048 lds
  v_mfma_f32_32x32x16_bf16 v[232:247], v[92:95], a[12:15], v[232:247]
  ds_read_b64_tr_b16 v[144:145], v72 offset:38912
  ds_read_b64_tr_b16 v[146:147], v72 offset:39936
  ds_read_b128 a[40:43], v75 offset:56320
  buffer_load_dwordx4 v5, s[56:59], s95 offen offset:3072 lds
  v_mfma_f32_32x32x16_bf16 v[200:215], v[96:99], a[16:19], v[200:215]
  ds_read_b128 a[44:47], v75 offset:57344
  v_mfma_f32_32x32x16_bf16 v[216:231], v[96:99], a[20:23], v[216:231]
  ds_read_b128 a[48:51], v75 offset:58368
  v_mfma_f32_32x32x16_bf16 v[232:247], v[96:99], a[24:27], v[232:247]
  ds_read_b128 a[52:55], v75 offset:59392
  s_waitcnt lgkmcnt(3)
  v_mfma_f32_32x32x16_bf16 v[200:215], v[132:135], a[28:31], v[200:215]
  ds_read_b128 a[56:59], v75 offset:60416
  v_mfma_f32_32x32x16_bf16 v[200:215], v[136:139], a[32:35], v[200:215]
  ds_read_b128 a[60:63], v75 offset:61440
  v_mfma_f32_32x32x16_bf16 v[200:215], v[140:143], a[36:39], v[200:215]
  ds_read_b128 a[0:3], v75 offset:62464
  v_mfma_f32_32x32x16_bf16 v[200:215], v[144:147], a[40:43], v[200:215]
  ds_read_b128 a[4:7], v75 offset:63488
  s_waitcnt lgkmcnt(3)
  v_mfma_f32_32x32x16_bf16 v[216:231], v[132:135], a[44:47], v[216:231]
  ds_read_b128 a[8:11], v75 offset:64512
  v_mfma_f32_32x32x16_bf16 v[216:231], v[136:139], a[48:51], v[216:231]
  ds_read_b128 a[12:15], v75 offset:49152
  v_mfma_f32_32x32x16_bf16 v[216:231], v[140:143], a[52:55], v[216:231]
  ds_read_b128 a[16:19], v75 offset:50176
  s_xor_b32 s8, s6, 1
  s_lshl_b32 s8, s8, 13
  s_add_u32 s8, s8, s87
  s_nop 0
  v_cvt_pk_bf16_f32 v100, v200, v201
  v_cvt_pk_bf16_f32 v101, v202, v203
  v_cvt_pk_bf16_f32 v102, v204, v205
  v_cvt_pk_bf16_f32 v103, v206, v207
  buffer_store_dwordx4 v[100:103], v1, s[60:63], s8 offen sc1
  v_mfma_f32_32x32x16_bf16 v[216:231], v[144:147], a[56:59], v[216:231]
  ds_read_b128 a[20:23], v75 offset:51200
  v_cvt_pk_bf16_f32 v104, v208, v209
  v_cvt_pk_bf16_f32 v105, v210, v211
  v_cvt_pk_bf16_f32 v106, v212, v213
  v_cvt_pk_bf16_f32 v107, v214, v215
  buffer_store_dwordx4 v[104:107], v1, s[60:63], s8 offen offset:1024 sc1
  s_waitcnt lgkmcnt(3)
  v_mfma_f32_32x32x16_bf16 v[232:247], v[132:135], a[60:63], v[232:247]
  ds_read_b128 a[24:27], v75 offset:52224
  v_mfma_f32_32x32x16_bf16 v[232:247], v[136:139], a[0:3], v[232:247]
  v_mfma_f32_32x32x16_bf16 v[232:247], v[140:143], a[4:7], v[232:247]
  s_xor_b32 s8, s6, 2
  s_lshl_b32 s8, s8, 13
  s_add_u32 s8, s8, s87
  v_cvt_pk_bf16_f32 v108, v216, v217
  v_cvt_pk_bf16_f32 v109, v218, v219
  v_cvt_pk_bf16_f32 v110, v220, v221
  v_cvt_pk_bf16_f32 v111, v222, v223
  buffer_store_dwordx4 v[108:111], v1, s[60:63], s8 offen sc1
  v_mfma_f32_32x32x16_bf16 v[232:247], v[144:147], a[8:11], v[232:247]
  v_cvt_pk_bf16_f32 v112, v224, v225
  v_cvt_pk_bf16_f32 v113, v226, v227
  v_cvt_pk_bf16_f32 v114, v228, v229
  v_cvt_pk_bf16_f32 v115, v230, v231
  buffer_store_dwordx4 v[112:115], v1, s[60:63], s8 offen offset:1024 sc1
  s_waitcnt lgkmcnt(0)
  v_mfma_f32_32x32x16_bf16 v[184:199], v[132:135], a[12:15], v[184:199]
  v_mfma_f32_32x32x16_bf16 v[184:199], v[136:139], a[16:19], v[184:199]
  v_mfma_f32_32x32x16_bf16 v[184:199], v[140:143], a[20:23], v[184:199]
  s_xor_b32 s8, s6, 3
  s_lshl_b32 s8, s8, 13
  s_add_u32 s8, s8, s87
  v_cvt_pk_bf16_f32 v116, v232, v233
  v_cvt_pk_bf16_f32 v117, v234, v235
  v_cvt_pk_bf16_f32 v118, v236, v237
  v_cvt_pk_bf16_f32 v119, v238, v239
  buffer_store_dwordx4 v[116:119], v1, s[60:63], s8 offen sc1
  v_mfma_f32_32x32x16_bf16 v[184:199], v[144:147], a[24:27], v[184:199]
  v_cvt_pk_bf16_f32 v120, v240, v241
  v_cvt_pk_bf16_f32 v121, v242, v243
  v_cvt_pk_bf16_f32 v122, v244, v245
  v_cvt_pk_bf16_f32 v123, v246, v247
  buffer_store_dwordx4 v[120:123], v1, s[60:63], s8 offen offset:1024 sc1
  v_mfma_f32_32x32x16_bf16 v[184:199], a[64:67], a[224:227], v[184:199]
  v_mfma_f32_32x32x16_bf16 v[184:199], a[68:71], a[228:231], v[184:199]
  v_mfma_f32_32x32x16_bf16 v[184:199], a[72:75], a[232:235], v[184:199]
  v_mfma_f32_32x32x16_bf16 v[184:199], a[76:79], a[236:239], v[184:199]
  v_mfma_f32_32x32x16_bf16 v[184:199], a[80:83], a[240:243], v[184:199]
  v_mfma_f32_32x32x16_bf16 v[184:199], a[84:87], a[244:247], v[184:199]
  v_mfma_f32_32x32x16_bf16 v[184:199], a[88:91], a[248:251], v[184:199]
  v_mfma_f32_32x32x16_bf16 v[184:199], a[92:95], a[252:255], v[184:199]
  v_mfma_f32_32x32x16_bf16 v[184:199], a[96:99], a[192:195], v[184:199]
  v_mfma_f32_32x32x16_bf16 v[184:199], a[100:103], a[196:199], v[184:199]
  v_mfma_f32_32x32x16_bf16 v[184:199], a[104:107], a[200:203], v[184:199]
  v_mfma_f32_32x32x16_bf16 v[184:199], a[108:111], a[204:207], v[184:199]
  v_mfma_f32_32x32x16_bf16 v[184:199], a[112:115], a[208:211], v[184:199]
  v_mfma_f32_32x32x16_bf16 v[184:199], a[116:119], a[212:215], v[184:199]
  v_mfma_f32_32x32x16_bf16 v[184:199], a[120:123], a[216:219], v[184:199]
  v_mfma_f32_32x32x16_bf16 v[184:199], a[124:127], a[220:223], v[184:199]
  v_mfma_f32_32x32x16_bf16 v[184:199], a[160:163], a[176:179], v[184:199]
  v_mfma_f32_32x32x16_bf16 v[184:199], a[164:167], a[180:183], v[184:199]
  v_mfma_f32_32x32x16_bf16 v[184:199], a[168:171], a[184:187], v[184:199]
  v_mfma_f32_32x32x16_bf16 v[184:199], a[172:175], a[188:191], v[184:199]
  v_mfma_f32_32x32x16_bf16 v[184:199], v[148:151], v[164:167], v[184:199]
  v_mfma_f32_32x32x16_bf16 v[184:199], v[152:155], v[168:171], v[184:199]
  v_mfma_f32_32x32x16_bf16 v[184:199], v[156:159], v[172:175], v[184:199]
  v_mfma_f32_32x32x16_bf16 v[184:199], v[160:163], v[176:179], v[184:199]
  s_waitcnt vmcnt(14)
  s_barrier
  v_mfma_f32_32x32x16_bf16 v[184:199], v[84:87], v[52:55], v[184:199]
  ds_read_b64_tr_b16 a[28:29], v73
  ds_read_b64_tr_b16 a[30:31], v73 offset:1024
  ds_read_b128 a[32:35], v75
  v_mfma_f32_32x32x16_bf16 v[184:199], v[88:91], v[56:59], v[184:199]
  ds_read_b64_tr_b16 a[36:37], v73 offset:2048
  ds_read_b64_tr_b16 a[38:39], v73 offset:3072
  ds_read_b128 a[40:43], v75 offset:1024
  v_mfma_f32_32x32x16_bf16 v[184:199], v[92:95], v[248:251], v[184:199]
  ds_read_b64_tr_b16 a[44:45], v73 offset:4096
  ds_read_b64_tr_b16 a[46:47], v73 offset:5120
  ds_read_b128 a[48:51], v75 offset:2048
  v_mfma_f32_32x32x16_bf16 v[184:199], v[96:99], v[252:255], v[184:199]
  ds_read_b64_tr_b16 a[52:53], v73 offset:6144
  ds_read_b64_tr_b16 a[54:55], v73 offset:7168
  ds_read_b128 a[56:59], v75 offset:3072
  s_waitcnt lgkmcnt(6)
  v_mfma_f32_32x32x16_bf16 v[184:199], a[28:31], a[32:35], v[184:199]
  ds_read_b64_tr_b16 a[60:61], v73 offset:16384
  ds_read_b64_tr_b16 a[62:63], v73 offset:17408
  ds_read_b128 a[0:3], v75 offset:4096
  buffer_load_dwordx4 v[200:203], v1, s[60:63], s90 offen sc1
  buffer_load_dwordx4 v[204:207], v1, s[60:63], s90 offen offset:1024 sc1
  buffer_load_dwordx4 v[208:211], v1, s[60:63], s91 offen sc1
  buffer_load_dwordx4 v[212:215], v1, s[60:63], s91 offen offset:1024 sc1
  buffer_load_dwordx4 v[216:219], v1, s[60:63], s92 offen sc1
  buffer_load_dwordx4 v[220:223], v1, s[60:63], s92 offen offset:1024 sc1
  v_mfma_f32_32x32x16_bf16 v[184:199], a[36:39], a[40:43], v[184:199]
  ds_read_b64_tr_b16 a[4:5], v73 offset:18432
  ds_read_b64_tr_b16 a[6:7], v73 offset:19456
  ds_read_b128 a[8:11], v75 offset:5120
  ds_read_b64_tr_b16 a[12:13], v73 offset:20480
  ds_read_b64_tr_b16 a[14:15], v73 offset:21504
  ds_read_b128 a[16:19], v75 offset:6144
  ds_read_b64_tr_b16 a[20:21], v73 offset:22528
  ds_read_b64_tr_b16 a[22:23], v73 offset:23552
  ds_read_b128 a[24:27], v75 offset:7168
  s_waitcnt lgkmcnt(12)
  v_mfma_f32_32x32x16_bf16 v[184:199], a[44:47], a[48:51], v[184:199]
  v_mfma_f32_32x32x16_bf16 v[184:199], a[52:55], a[56:59], v[184:199]
  s_waitcnt vmcnt(12) lgkmcnt(0)
  s_barrier
  v_mfma_f32_32x32x16_bf16 v[184:199], a[60:63], a[0:3], v[184:199]
  ds_read_b64_tr_b16 a[28:29], v73 offset:32768
  ds_read_b64_tr_b16 a[30:31], v73 offset:33792
  ds_read_b128 a[32:35], v75 offset:8192
  v_mfma_f32_32x32x16_bf16 v[184:199], a[4:7], a[8:11], v[184:199]
  ds_read_b64_tr_b16 a[36:37], v73 offset:34816
  ds_read_b64_tr_b16 a[38:39], v73 offset:35840
  ds_read_b128 a[40:43], v75 offset:9216
  v_mfma_f32_32x32x16_bf16 v[184:199], a[12:15], a[16:19], v[184:199]
  ds_read_b64_tr_b16 a[44:45], v73 offset:36864
  ds_read_b64_tr_b16 a[46:47], v73 offset:37888
  ds_read_b128 a[48:51], v75 offset:10240
  v_mfma_f32_32x32x16_bf16 v[184:199], a[20:23], a[24:27], v[184:199]
  ds_read_b64_tr_b16 a[52:53], v73 offset:38912
  ds_read_b64_tr_b16 a[54:55], v73 offset:39936
  ds_read_b128 a[56:59], v75 offset:11264
  s_waitcnt lgkmcnt(6)
  v_mfma_f32_32x32x16_bf16 v[184:199], a[28:31], a[32:35], v[184:199]
  ds_read_b64_tr_b16 a[60:61], v73 offset:49152
  ds_read_b64_tr_b16 a[62:63], v73 offset:50176
  ds_read_b128 a[0:3], v75 offset:12288
  v_mfma_f32_32x32x16_bf16 v[184:199], a[36:39], a[40:43], v[184:199]
  ds_read_b64_tr_b16 a[4:5], v73 offset:51200
  ds_read_b64_tr_b16 a[6:7], v73 offset:52224
  ds_read_b128 a[8:11], v75 offset:13312
  s_waitcnt lgkmcnt(6)
  v_mfma_f32_32x32x16_bf16 v[184:199], a[44:47], a[48:51], v[184:199]
  ds_read_b64_tr_b16 a[12:13], v73 offset:53248
  ds_read_b64_tr_b16 a[14:15], v73 offset:54272
  ds_read_b128 a[16:19], v75 offset:14336
  v_mfma_f32_32x32x16_bf16 v[184:199], a[52:55], a[56:59], v[184:199]
  ds_read_b64_tr_b16 a[20:21], v73 offset:55296
  ds_read_b64_tr_b16 a[22:23], v73 offset:56320
  ds_read_b128 a[24:27], v75 offset:15360
  s_waitcnt lgkmcnt(6)
  v_mfma_f32_32x32x16_bf16 v[184:199], a[60:63], a[0:3], v[184:199]
  v_mfma_f32_32x32x16_bf16 v[184:199], a[4:7], a[8:11], v[184:199]
  s_waitcnt lgkmcnt(0)
  v_mfma_f32_32x32x16_bf16 v[184:199], a[12:15], a[16:19], v[184:199]
  v_mfma_f32_32x32x16_bf16 v[184:199], a[20:23], a[24:27], v[184:199]
  s_waitcnt vmcnt(5)
  v_max3_u32 v64, v200, v201, v202
  s_waitcnt vmcnt(4)
  v_max3_u32 v65, v203, v204, v205
  v_max3_u32 v64, v64, v206, v207
  s_waitcnt vmcnt(3)
  v_max3_u32 v65, v65, v208, v209
  v_max3_u32 v64, v64, v210, v211
  s_waitcnt vmcnt(2)
  v_max3_u32 v65, v65, v212, v213
  v_max3_u32 v64, v64, v214, v215
  s_waitcnt vmcnt(1)
  v_max3_u32 v65, v65, v216, v217
  v_max3_u32 v64, v64, v218, v219
  s_waitcnt vmcnt(0)
  v_max3_u32 v65, v65, v220, v221
  v_max3_u32 v64, v64, v222, v223
  v_max_u32 v64, v64, v65
  v_cmp_eq_u32 vcc, -1, v64
  s_nop 0
  s_cbranch_vccnz L0_slow_p
L0_res_p:
  v_dot2c_f32_bf16 v184, s94, v200
  v_dot2c_f32_bf16 v185, s99, v200
  v_dot2c_f32_bf16 v186, s94, v201
  v_dot2c_f32_bf16 v187, s99, v201
  v_dot2c_f32_bf16 v188, s94, v202
  v_dot2c_f32_bf16 v189, s99, v202
  v_dot2c_f32_bf16 v190, s94, v203
  v_dot2c_f32_bf16 v191, s99, v203
  v_dot2c_f32_bf16 v192, s94, v204
  v_dot2c_f32_bf16 v193, s99, v204
  v_dot2c_f32_bf16 v194, s94, v205
  v_dot2c_f32_bf16 v195, s99, v205
  v_dot2c_f32_bf16 v196, s94, v206
  v_dot2c_f32_bf16 v197, s99, v206
  v_dot2c_f32_bf16 v198, s94, v207
  v_dot2c_f32_bf16 v199, s99, v207
  v_dot2c_f32_bf16 v184, s94, v208
  v_dot2c_f32_bf16 v185, s99, v208
  v_dot2c_f32_bf16 v186, s94, v209
  v_dot2c_f32_bf16 v187, s99, v209
  v_dot2c_f32_bf16 v188, s94, v210
  v_dot2c_f32_bf16 v189, s99, v210
  v_dot2c_f32_bf16 v190, s94, v211
  v_dot2c_f32_bf16 v191, s99, v211
  v_dot2c_f32_bf16 v192, s94, v212
  v_dot2c_f32_bf16 v193, s99, v212
  v_dot2c_f32_bf16 v194, s94, v213
  v_dot2c_f32_bf16 v195, s99, v213
  v_dot2c_f32_bf16 v196, s94, v214
  v_dot2c_f32_bf16 v197, s99, v214
  v_dot2c_f32_bf16 v198, s94, v215
  v_dot2c_f32_bf16 v199, s99, v215
  v_dot2c_f32_bf16 v184, s94, v216
  v_dot2c_f32_bf16 v185, s99, v216
  v_dot2c_f32_bf16 v186, s94, v217
  v_dot2c_f32_bf16 v187, s99, v217
  v_dot2c_f32_bf16 v188, s94, v218
  v_dot2c_f32_bf16 v189, s99, v218
  v_dot2c_f32_bf16 v190, s94, v219
  v_dot2c_f32_bf16 v191, s99, v219
  v_dot2c_f32_bf16 v192, s94, v220
  v_dot2c_f32_bf16 v193, s99, v220
  v_dot2c_f32_bf16 v194, s94, v221
  v_dot2c_f32_bf16 v195, s99, v221
  v_dot2c_f32_bf16 v196, s94, v222
  v_dot2c_f32_bf16 v197, s99, v222
  v_dot2c_f32_bf16 v198, s94, v223
  v_dot2c_f32_bf16 v199, s99, v223
  v_cvt_pk_bf16_f32 v100, v184, v185
  v_cvt_pk_bf16_f32 v101, v186, v187
  v_cvt_pk_bf16_f32 v102, v188, v189
  v_cvt_pk_bf16_f32 v103, v190, v191
  s_nop 0
  v_permlane32_swap_b32 v100, v102
  v_permlane32_swap_b32 v101, v103
  buffer_store_dwordx4 v[100:103], v81, s[64:67], s93 offen
  v_cvt_pk_bf16_f32 v104, v192, v193
  v_cvt_pk_bf16_f32 v105, v194, v195
  v_cvt_pk_bf16_f32 v106, v196, v197
  v_cvt_pk_bf16_f32 v107, v198, v199
  s_nop 0
  v_permlane32_swap_b32 v104, v106
  v_permlane32_swap_b32 v105, v107
  buffer_store_dwordx4 v[104:107], v81, s[64:67], s93 offen offset:32
Lc_end:
  s_endpgm
L0_slow_ka:
  s_mov_b32 s18, 20000
L0_slowl_ka:
  s_sleep 1
  buffer_load_dwordx2 v[36:37], v30, s[60:63], 0 offen sc1
  s_waitcnt vmcnt(0)
  v_cmp_eq_u64 vcc, v[36:37], v[34:35]
  s_nop 1
  s_cmp_eq_u64 vcc, -1
  s_cbranch_scc1 L0_res_ka
  s_sub_u32 s18, s18, 1
  s_cmp_lg_u32 s18, 0
  s_cbranch_scc1 L0_slowl_ka
  s_branch L0_res_ka
L0_slow_kh:
  s_mov_b32 s18, 20000
L0_slowl_kh:
  s_sleep 1
  buffer_load_dwordx2 v[36:37], v31, s[60:63], 0 offen sc1
  s_waitcnt vmcnt(0)
  v_cmp_eq_u64 vcc, v[36:37], v[34:35]
  s_nop 1
  s_cmp_eq_u64 vcc, -1
  s_cbranch_scc1 L0_res_kh
  s_sub_u32 s18, s18, 1
  s_cmp_lg_u32 s18, 0
  s_cbranch_scc1 L0_slowl_kh
  s_branch L0_res_kh
L0_slow_nonce:
  s_mov_b32 s18, 20000
L0_slowl_nonce:
  s_sleep 1
  v_mov_b32 v71, 0
  buffer_load_dwordx2 v[34:35], v71, s[68:71], 0 offen sc1
  s_waitcnt vmcnt(0)
  v_cmp_ne_u32 vcc, 0, v34
  s_nop 1
  s_cmp_eq_u64 vcc, -1
  s_cbranch_scc1 L0_res_nonce
  s_sub_u32 s18, s18, 1
  s_cmp_lg_u32 s18, 0
  s_cbranch_scc1 L0_slowl_nonce
  s_branch L0_res_nonce
L0_slow_p:
  s_mov_b32 s18, 20000
L0_slowl_p:
  buffer_load_dwordx4 v[200:203], v1, s[60:63], s90 offen sc1
  buffer_load_dwordx4 v[204:207], v1, s[60:63], s90 offen offset:1024 sc1
  buffer_load_dwordx4 v[208:211], v1, s[60:63], s91 offen sc1
  buffer_load_dwordx4 v[212:215], v1, s[60:63], s91 offen offset:1024 sc1
  buffer_load_dwordx4 v[216:219], v1, s[60:63], s92 offen sc1
  buffer_load_dwordx4 v[220:223], v1, s[60:63], s92 offen offset:1024 sc1
  s_waitcnt vmcnt(0)
  v_max3_u32 v64, v200, v201, v202
  v_max3_u32 v65, v203, v204, v205
  v_max3_u32 v64, v64, v206, v207
  v_max3_u32 v65, v65, v208, v209
  v_max3_u32 v64, v64, v210, v211
  v_max3_u32 v65, v65, v212, v213
  v_max3_u32 v64, v64, v214, v215
  v_max3_u32 v65, v65, v216, v217
  v_max3_u32 v64, v64, v218, v219
  v_max3_u32 v65, v65, v220, v221
  v_max3_u32 v64, v64, v222, v223
  v_max_u32 v64, v64, v65
  v_cmp_eq_u32 vcc, -1, v64
  s_nop 1
  s_cbranch_vccz L0_res_p
  s_sub_u32 s18, s18, 1
  s_cmp_lg_u32 s18, 0
  s_cbranch_scc1 L0_slowl_p
  s_branch L0_res_p
Lc_body1:
  s_waitcnt vmcnt(14)
  ds_read_b128 v[72:75], v14
  ds_read_b128 v[76:79], v15
  ds_read_b128 v[80:83], v16
  ds_read_b128 v[84:87], v17
  ds_read_b128 v[88:91], v14 offset:4096
  ds_read_b128 v[92:95], v15 offset:4096
  ds_read_b128 v[96:99], v16 offset:4096
  ds_read_b128 v[100:103], v17 offset:4096
  ds_read_b128 a[128:131], v14
  ds_read_b128 a[144:147], v14 offset:4096
  ds_read_b128 a[132:135], v15
  ds_read_b128 a[136:139], v16
  ds_read_b128 a[140:143], v17
  ds_read_b128 a[148:151], v15 offset:4096
  ds_read_b128 a[152:155], v16 offset:4096
  ds_read_b128 a[156:159], v17 offset:4096
  s_waitcnt vmcnt(12)
  s_barrier
  ds_read_b128 v[136:139], v18
  ds_read_b128 v[140:143], v18 offset:4096
  ds_read_b128 v[144:147], v18 offset:8192
  s_waitcnt lgkmcnt(3)
  s_add_u32 m0, s75, 0
  s_add_u32 s95, s94, 0x200
  s_and_b32 s95, s95, 0x3ff
  s_add_u32 s95, s95, s76
  buffer_load_dwordx4 v2, s[40:43], s95 offen lds
  buffer_load_dwordx4 v3, s[40:43], s95 offen offset:1024 lds
  buffer_load_dwordx4 v4, s[40:43], s95 offen offset:2048 lds
  buffer_load_dwordx4 v5, s[40:43], s95 offen offset:3072 lds
  s_add_u32 m0, s75, 0x1000
  s_add_u32 s95, s94, 0x280
  s_and_b32 s95, s95, 0x3ff
  v_dot2c_f32_bf16 v60, s99, v72
  v_dot2c_f32_bf16 v62, v72, v72
  v_dot2c_f32_bf16 v61, s99, v73
  v_dot2c_f32_bf16 v63, v73, v73
  v_dot2c_f32_bf16 v60, s99, v74
  v_dot2c_f32_bf16 v62, v74, v74
  v_dot2c_f32_bf16 v61, s99, v75
  v_dot2c_f32_bf16 v63, v75, v75
  v_dot2c_f32_bf16 v60, s99, v76
  v_dot2c_f32_bf16 v62, v76, v76
  v_dot2c_f32_bf16 v61, s99, v77
  v_dot2c_f32_bf16 v63, v77, v77
  v_dot2c_f32_bf16 v60, s99, v78
  v_dot2c_f32_bf16 v62, v78, v78
  v_dot2c_f32_bf16 v61, s99, v79
  v_dot2c_f32_bf16 v63, v79, v79
  v_dot2c_f32_bf16 v60, s99, v80
  v_dot2c_f32_bf16 v62, v80, v80
  v_dot2c_f32_bf16 v61, s99, v81
  v_dot2c_f32_bf16 v63, v81, v81
  v_dot2c_f32_bf16 v60, s99, v82
  v_dot2c_f32_bf16 v62, v82, v82
  v_dot2c_f32_bf16 v61, s99, v83
  v_dot2c_f32_bf16 v63, v83, v83
  v_dot2c_f32_bf16 v60, s99, v84
  v_dot2c_f32_bf16 v62, v84, v84
  v_dot2c_f32_bf16 v61, s99, v85
  v_dot2c_f32_bf16 v63, v85, v85
  v_dot2c_f32_bf16 v60, s99, v86
  v_dot2c_f32_bf16 v62, v86, v86
  v_dot2c_f32_bf16 v61, s99, v87
  v_dot2c_f32_bf16 v63, v87, v87
  v_dot2c_f32_bf16 v60, s99, v88
  v_dot2c_f32_bf16 v62, v88, v88
  v_dot2c_f32_bf16 v61, s99, v89
  v_dot2c_f32_bf16 v63, v89, v89
  v_dot2c_f32_bf16 v60, s99, v90
  v_dot2c_f32_bf16 v62, v90, v90
  v_dot2c_f32_bf16 v61, s99, v91
  v_dot2c_f32_bf16 v63, v91, v91
  v_dot2c_f32_bf16 v60, s99, v92
  v_dot2c_f32_bf16 v62, v92, v92
  v_dot2c_f32_bf16 v61, s99, v93
  v_dot2c_f32_bf16 v63, v93, v93
  v_dot2c_f32_bf16 v60, s99, v94
  v_dot2c_f32_bf16 v62, v94, v94
  v_dot2c_f32_bf16 v61, s99, v95
  v_dot2c_f32_bf16 v63, v95, v95
  v_dot2c_f32_bf16 v60, s99, v96
  v_dot2c_f32_bf16 v62, v96, v96
  v_dot2c_f32_bf16 v61, s99, v97
  v_dot2c_f32_bf16 v63, v97, v97
  v_dot2c_f32_bf16 v60, s99, v98
  v_dot2c_f32_bf16 v62, v98, v98
  v_dot2c_f32_bf16 v61, s99, v99
  v_dot2c_f32_bf16 v63, v99, v99
  v_dot2c_f32_bf16 v60, s99, v100
  v_dot2c_f32_bf16 v62, v100, v100
  v_dot2c_f32_bf16 v61, s99, v101
  v_dot2c_f32_bf16 v63, v101, v101
  v_dot2c_f32_bf16 v60, s99, v102
  v_dot2c_f32_bf16 v62, v102, v102
  v_dot2c_f32_bf16 v61, s99, v103
  v_dot2c_f32_bf16 v63, v103, v103
  s_waitcnt lgkmcnt(2)
  v_mfma_f32_32x32x16_bf16 v[184:199], a[128:131], v[136:139], 0
  ds_read_b128 v[148:151], v18 offset:12288
  s_add_u32 s95, s95, s76
  buffer_load_dwordx4 v2, s[40:43], s95 offen lds
  s_waitcnt lgkmcnt(2)
  v_mfma_f32_32x32x16_bf16 v[200:215], a[128:131], v[140:143], 0
  ds_read_b128 a[0:3], v19
  buffer_load_dwordx4 v3, s[40:43], s95 offen offset:1024 lds
  buffer_load_dwordx4 v4, s[40:43], s95 offen offset:2048 lds
  s_waitcnt lgkmcnt(2)
  v_mfma_f32_32x32x16_bf16 v[184:199], a[144:147], v[144:147], v[184:199]
  ds_read_b128 a[4:7], v19 offset:4096
  buffer_load_dwordx4 v5, s[40:43], s95 offen offset:3072 lds
  s_add_u32 m0, s73, 0x18000
  s_waitcnt lgkmcnt(2)
  v_mfma_f32_32x32x16_bf16 v[200:215], a[144:147], v[148:151], v[200:215]
  ds_read_b128 a[8:11], v20
  s_add_u32 s95, s94, 0x200
  s_and_b32 s95, s95, 0x3ff
  s_waitcnt lgkmcnt(2)
  v_mfma_f32_32x32x16_bf16 v[184:199], a[132:135], a[0:3], v[184:199]
  ds_read_b128 a[12:15], v20 offset:4096
  s_add_u32 s95, s95, s77
  buffer_load_dwordx4 v2, s[44:47], s95 offen lds
  s_waitcnt lgkmcnt(2)
  v_mfma_f32_32x32x16_bf16 v[200:215], a[132:135], a[4:7], v[200:215]
  ds_read_b128 a[16:19], v21
  buffer_load_dwordx4 v3, s[44:47], s95 offen offset:1024 lds
  s_add_u32 m0, s73, 0x1a000
  s_waitcnt lgkmcnt(2)
  v_mfma_f32_32x32x16_bf16 v[184:199], a[136:139], a[8:11], v[184:199]
  ds_read_b128 a[20:23], v21 offset:4096
  s_add_u32 s95, s94, 0x280
  s_and_b32 s95, s95, 0x3ff
  s_waitcnt lgkmcnt(2)
  v_mfma_f32_32x32x16_bf16 v[200:215], a[136:139], a[12:15], v[200:215]
  ds_read_b128 a[24:27], v19 offset:8192
  s_add_u32 s95, s95, s77
  buffer_load_dwordx4 v2, s[44:47], s95 offen lds
  s_waitcnt lgkmcnt(2)
  v_mfma_f32_32x32x16_bf16 v[184:199], a[140:143], a[16:19], v[184:199]
  ds_read_b128 a[28:31], v19 offset:12288
  buffer_load_dwordx4 v3, s[44:47], s95 offen offset:1024 lds
  s_waitcnt lgkmcnt(2)
  v_mfma_f32_32x32x16_bf16 v[200:215], a[140:143], a[20:23], v[200:215]
  ds_read_b128 a[32:35], v20 offset:8192
  s_waitcnt lgkmcnt(2)
  v_mfma_f32_32x32x16_bf16 v[184:199], a[148:151], a[24:27], v[184:199]
  ds_read_b128 a[36:39], v20 offset:12288
  s_waitcnt lgkmcnt(2)
  v_mfma_f32_32x32x16_bf16 v[200:215], a[148:151], a[28:31], v[200:215]
  ds_read_b128 a[40:43], v21 offset:8192
  s_waitcnt vmcnt(16)
  ds_read_b128 v[104:107], v14 offset:32768
  ds_read_b128 v[108:111], v15 offset:32768
  ds_read_b128 v[112:115], v16 offset:32768
  s_waitcnt lgkmcnt(5)
  v_mfma_f32_32x32x16_bf16 v[184:199], a[152:155], a[32:35], v[184:199]
  ds_read_b128 a[44:47], v21 offset:12288
  ds_read_b128 v[116:119], v17 offset:32768
  ds_read_b128 v[120:123], v14 offset:36864
  ds_read_b128 v[124:127], v15 offset:36864
  ds_read_b128 v[128:131], v16 offset:36864
  s_waitcnt lgkmcnt(9)
  v_mfma_f32_32x32x16_bf16 v[200:215], a[152:155], a[36:39], v[200:215]
  ds_read_b128 v[132:135], v17 offset:36864
  ds_read_b128 a[160:163], v14 offset:32768
  ds_read_b128 a[176:179], v14 offset:36864
  ds_read_b128 a[164:167], v15 offset:32768
  s_waitcnt lgkmcnt(12)
  v_mfma_f32_32x32x16_bf16 v[184:199], a[156:159], a[40:43], v[184:199]
  ds_read_b128 a[168:171], v16 offset:32768
  ds_read_b128 a[172:175], v17 offset:32768
  ds_read_b128 a[180:183], v15 offset:36864
  ds_read_b128 a[184:187], v16 offset:36864
  s_waitcnt lgkmcnt(12)
  v_mfma_f32_32x32x16_bf16 v[200:215], a[156:159], a[44:47], v[200:215]
  ds_read_b128 a[188:191], v17 offset:36864
  s_waitcnt vmcnt(12) lgkmcnt(0)
  s_barrier
  ds_read_b128 v[152:155], v18 offset:16384
  ds_read_b128 v[156:159], v18 offset:20480
  ds_read_b128 v[160:163], v18 offset:24576
  s_add_u32 m0, s75, 0x8000
  s_add_u32 s95, s94, 0x300
  s_and_b32 s95, s95, 0x3ff
  s_add_u32 s95, s95, s76
  buffer_load_dwordx4 v2, s[40:43], s95 offen lds
  buffer_load_dwordx4 v3, s[40:43], s95 offen offset:1024 lds
  buffer_load_dwordx4 v4, s[40:43], s95 offen offset:2048 lds
  buffer_load_dwordx4 v5, s[40:43], s95 offen offset:3072 lds
  s_add_u32 m0, s75, 0x9000
  s_add_u32 s95, s94, 0x380
  s_and_b32 s95, s95, 0x3ff
  v_dot2c_f32_bf16 v60, s99, v104
  v_dot2c_f32_bf16 v62, v104, v104
  v_dot2c_f32_bf16 v61, s99, v105
  v_dot2c_f32_bf16 v63, v105, v105
  v_dot2c_f32_bf16 v60, s99, v106
  v_dot2c_f32_bf16 v62, v106, v106
  v_dot2c_f32_bf16 v61, s99, v107
  v_dot2c_f32_bf16 v63, v107, v107
  v_dot2c_f32_bf16 v60, s99, v108
  v_dot2c_f32_bf16 v62, v108, v108
  v_dot2c_f32_bf16 v61, s99, v109
  v_dot2c_f32_bf16 v63, v109, v109
  v_dot2c_f32_bf16 v60, s99, v110
  v_dot2c_f32_bf16 v62, v110, v110
  v_dot2c_f32_bf16 v61, s99, v111
  v_dot2c_f32_bf16 v63, v111, v111
  v_dot2c_f32_bf16 v60, s99, v112
  v_dot2c_f32_bf16 v62, v112, v112
  v_dot2c_f32_bf16 v61, s99, v113
  v_dot2c_f32_bf16 v63, v113, v113
  v_dot2c_f32_bf16 v60, s99, v114
  v_dot2c_f32_bf16 v62, v114, v114
  v_dot2c_f32_bf16 v61, s99, v115
  v_dot2c_f32_bf16 v63, v115, v115
  v_dot2c_f32_bf16 v60, s99, v116
  v_dot2c_f32_bf16 v62, v116, v116
  v_dot2c_f32_bf16 v61, s99, v117
  v_dot2c_f32_bf16 v63, v117, v117
  v_dot2c_f32_bf16 v60, s99, v118
  v_dot2c_f32_bf16 v62, v118, v118
  v_dot2c_f32_bf16 v61, s99, v119
  v_dot2c_f32_bf16 v63, v119, v119
  v_dot2c_f32_bf16 v60, s99, v120
  v_dot2c_f32_bf16 v62, v120, v120
  v_dot2c_f32_bf16 v61, s99, v121
  v_dot2c_f32_bf16 v63, v121, v121
  v_dot2c_f32_bf16 v60, s99, v122
  v_dot2c_f32_bf16 v62, v122, v122
  v_dot2c_f32_bf16 v61, s99, v123
  v_dot2c_f32_bf16 v63, v123, v123
  v_dot2c_f32_bf16 v60, s99, v124
  v_dot2c_f32_bf16 v62, v124, v124
  v_dot2c_f32_bf16 v61, s99, v125
  v_dot2c_f32_bf16 v63, v125, v125
  v_dot2c_f32_bf16 v60, s99, v126
  v_dot2c_f32_bf16 v62, v126, v126
  v_dot2c_f32_bf16 v61, s99, v127
  v_dot2c_f32_bf16 v63, v127, v127
  v_dot2c_f32_bf16 v60, s99, v128
  v_dot2c_f32_bf16 v62, v128, v128
  v_dot2c_f32_bf16 v61, s99, v129
  v_dot2c_f32_bf16 v63, v129, v129
  v_dot2c_f32_bf16 v60, s99, v130
  v_dot2c_f32_bf16 v62, v130, v130
  v_dot2c_f32_bf16 v61, s99, v131
  v_dot2c_f32_bf16 v63, v131, v131
  v_dot2c_f32_bf16 v60, s99, v132
  v_dot2c_f32_bf16 v62, v132, v132
  v_dot2c_f32_bf16 v61, s99, v133
  v_dot2c_f32_bf16 v63, v133, v133
  v_dot2c_f32_bf16 v60, s99, v134
  v_dot2c_f32_bf16 v62, v134, v134
  v_dot2c_f32_bf16 v61, s99, v135
  v_dot2c_f32_bf16 v63, v135, v135
  v_dot2c_f32_bf16 v52, s99, v136
  v_dot2c_f32_bf16 v52, s99, v137
  v_dot2c_f32_bf16 v52, s99, v138
  v_dot2c_f32_bf16 v52, s99, v139
  v_dot2c_f32_bf16 v53, s99, v140
  v_dot2c_f32_bf16 v53, s99, v141
  v_dot2c_f32_bf16 v53, s99, v142
  v_dot2c_f32_bf16 v53, s99, v143
  v_dot2c_f32_bf16 v52, s99, v144
  v_dot2c_f32_bf16 v52, s99, v145
  v_dot2c_f32_bf16 v52, s99, v146
  v_dot2c_f32_bf16 v52, s99, v147
  v_dot2c_f32_bf16 v53, s99, v148
  v_dot2c_f32_bf16 v53, s99, v149
  v_dot2c_f32_bf16 v53, s99, v150
  v_dot2c_f32_bf16 v53, s99, v151
  s_waitcnt lgkmcnt(2)
  v_mfma_f32_32x32x16_bf16 v[184:199], a[160:163], v[152:155], v[184:199]
  ds_read_b128 v[164:167], v18 offset:28672
  s_add_u32 s95, s95, s76
  buffer_load_dwordx4 v2, s[40:43], s95 offen lds
  s_waitcnt lgkmcnt(2)
  v_mfma_f32_32x32x16_bf16 v[200:215], a[160:163], v[156:159], v[200:215]
  ds_read_b128 a[48:51], v19 offset:16384
  buffer_load_dwordx4 v3, s[40:43], s95 offen offset:1024 lds
  buffer_load_dwordx4 v4, s[40:43], s95 offen offset:2048 lds
  s_waitcnt lgkmcnt(2)
  v_mfma_f32_32x32x16_bf16 v[184:199], a[176:179], v[160:163], v[184:199]
  ds_read_b128 a[52:55], v19 offset:20480
  buffer_load_dwordx4 v5, s[40:43], s95 offen offset:3072 lds
  s_add_u32 m0, s73, 0x1c000
  s_waitcnt lgkmcnt(2)
  v_mfma_f32_32x32x16_bf16 v[200:215], a[176:179], v[164:167], v[200:215]
  ds_read_b128 a[56:59], v20 offset:16384
  s_add_u32 s95, s94, 0x300
  s_and_b32 s95, s95, 0x3ff
  s_waitcnt lgkmcnt(2)
  v_mfma_f32_32x32x16_bf16 v[184:199], a[164:167], a[48:51], v[184:199]
  ds_read_b128 a[60:63], v20 offset:20480
  s_add_u32 s95, s95, s77
  buffer_load_dwordx4 v2, s[44:47], s95 offen lds
  s_waitcnt lgkmcnt(2)
  v_mfma_f32_32x32x16_bf16 v[200:215], a[164:167], a[52:55], v[200:215]
  ds_read_b128 a[0:3], v21 offset:16384
  buffer_load_dwordx4 v3, s[44:47], s95 offen offset:1024 lds
  s_add_u32 m0, s73, 0x1e000
  s_waitcnt lgkmcnt(2)
  v_mfma_f32_32x32x16_bf16 v[184:199], a[168:171], a[56:59], v[184:199]
  ds_read_b128 a[4:7], v21 offset:20480
  s_add_u32 s95, s94, 0x380
  s_and_b32 s95, s95, 0x3ff
  s_waitcnt lgkmcnt(2)
  v_mfma_f32_32x32x16_bf16 v[200:215], a[168:171], a[60:63], v[200:215]
  ds_read_b128 a[8:11], v19 offset:24576
  s_add_u32 s95, s95, s77
  buffer_load_dwordx4 v2, s[44:47], s95 offen lds
  s_waitcnt lgkmcnt(2)
  v_mfma_f32_32x32x16_bf16 v[184:199], a[172:175], a[0:3], v[184:199]
  ds_read_b128 a[12:15], v19 offset:28672
  buffer_load_dwordx4 v3, s[44:47], s95 offen offset:1024 lds
  s_add_u32 m0, s83, 0x20000
  s_waitcnt lgkmcnt(2)
  v_mfma_f32_32x32x16_bf16 v[200:215], a[172:175], a[4:7], v[200:215]
  ds_read_b128 a[16:19], v20 offset:24576
  s_add_u32 s95, s19, 0
  s_and_b32 s95, s95, 7
  s_waitcnt lgkmcnt(2)
  v_mfma_f32_32x32x16_bf16 v[184:199], a[180:183], a[8:11], v[184:199]
  ds_read_b128 a[20:23], v20 offset:28672
  s_mul_i32 s95, s95, 0x38000
  s_add_u32 s95, s95, s78
  buffer_load_dwordx4 v7, s[48:51], s95 offen lds
  buffer_load_dwordx4 v8, s[48:51], s95 offen offset:1024 lds
  buffer_load_dwordx4 v9, s[48:51], s95 offen offset:2048 lds
  buffer_load_dwordx4 v10, s[48:51], s95 offen offset:3072 lds
  s_add_u32 m0, s83, 0x21000
  s_nop 0
  buffer_load_dwordx4 v11, s[48:51], s95 offen lds
  buffer_load_dwordx4 v12, s[48:51], s95 offen offset:1024 lds
  buffer_load_dwordx4 v13, s[48:51], s95 offen offset:2048 lds
  v_mov_b32 v71, 0
  buffer_load_dwordx2 v[34:35], v71, s[68:71], 0 offen sc1
  s_waitcnt lgkmcnt(2)
  v_mfma_f32_32x32x16_bf16 v[200:215], a[180:183], a[12:15], v[200:215]
  ds_read_b128 a[24:27], v21 offset:24576
  s_waitcnt vmcnt(24)
  ds_read_b128 v[72:75], v14
  ds_read_b128 v[76:79], v15
  ds_read_b128 v[80:83], v16
  s_waitcnt lgkmcnt(5)
  v_mfma_f32_32x32x16_bf16 v[184:199], a[184:187], a[16:19], v[184:199]
  ds_read_b128 a[28:31], v21 offset:28672
  ds_read_b128 v[84:87], v17
  ds_read_b128 v[88:91], v14 offset:4096
  ds_read_b128 v[92:95], v15 offset:4096
  ds_read_b128 v[96:99], v16 offset:4096
  s_waitcnt lgkmcnt(9)
  v_mfma_f32_32x32x16_bf16 v[200:215], a[184:187], a[20:23], v[200:215]
  ds_read_b128 v[100:103], v17 offset:4096
  ds_read_b128 a[192:195], v14
  ds_read_b128 a[208:211], v14 offset:4096
  ds_read_b128 a[196:199], v15
  s_waitcnt lgkmcnt(12)
  v_mfma_f32_32x32x16_bf16 v[184:199], a[188:191], a[24:27], v[184:199]
  ds_read_b128 a[200:203], v16
  ds_read_b128 a[204:207], v17
  ds_read_b128 a[212:215], v15 offset:4096
  ds_read_b128 a[216:219], v16 offset:4096
  s_waitcnt lgkmcnt(12)
  v_mfma_f32_32x32x16_bf16 v[200:215], a[188:191], a[28:31], v[200:215]
  ds_read_b128 a[220:223], v17 offset:4096
  s_waitcnt vmcnt(20) lgkmcnt(0)
  s_barrier
  ds_read_b128 v[136:139], v18 offset:32768
  ds_read_b128 v[140:143], v18 offset:36864
  ds_read_b128 v[144:147], v18 offset:40960
  v_dot2c_f32_bf16 v60, s99, v72
  v_dot2c_f32_bf16 v62, v72, v72
  v_dot2c_f32_bf16 v61, s99, v73
  v_dot2c_f32_bf16 v63, v73, v73
  v_dot2c_f32_bf16 v60, s99, v74
  v_dot2c_f32_bf16 v62, v74, v74
  v_dot2c_f32_bf16 v61, s99, v75
  v_dot2c_f32_bf16 v63, v75, v75
  v_dot2c_f32_bf16 v60, s99, v76
  v_dot2c_f32_bf16 v62, v76, v76
  v_dot2c_f32_bf16 v61, s99, v77
  v_dot2c_f32_bf16 v63, v77, v77
  v_dot2c_f32_bf16 v60, s99, v78
  v_dot2c_f32_bf16 v62, v78, v78
  v_dot2c_f32_bf16 v61, s99, v79
  v_dot2c_f32_bf16 v63, v79, v79
  v_dot2c_f32_bf16 v60, s99, v80
  v_dot2c_f32_bf16 v62, v80, v80
  v_dot2c_f32_bf16 v61, s99, v81
  v_dot2c_f32_bf16 v63, v81, v81
  v_dot2c_f32_bf16 v60, s99, v82
  v_dot2c_f32_bf16 v62, v82, v82
  v_dot2c_f32_bf16 v61, s99, v83
  v_dot2c_f32_bf16 v63, v83, v83
  v_dot2c_f32_bf16 v60, s99, v84
  v_dot2c_f32_bf16 v62, v84, v84
  v_dot2c_f32_bf16 v61, s99, v85
  v_dot2c_f32_bf16 v63, v85, v85
  v_dot2c_f32_bf16 v60, s99, v86
  v_dot2c_f32_bf16 v62, v86, v86
  v_dot2c_f32_bf16 v61, s99, v87
  v_dot2c_f32_bf16 v63, v87, v87
  v_dot2c_f32_bf16 v60, s99, v88
  v_dot2c_f32_bf16 v62, v88, v88
  v_dot2c_f32_bf16 v61, s99, v89
  v_dot2c_f32_bf16 v63, v89, v89
  v_dot2c_f32_bf16 v60, s99, v90
  v_dot2c_f32_bf16 v62, v90, v90
  v_dot2c_f32_bf16 v61, s99, v91
  v_dot2c_f32_bf16 v63, v91, v91
  v_dot2c_f32_bf16 v60, s99, v92
  v_dot2c_f32_bf16 v62, v92, v92
  v_dot2c_f32_bf16 v61, s99, v93
  v_dot2c_f32_bf16 v63, v93, v93
  v_dot2c_f32_bf16 v60, s99, v94
  v_dot2c_f32_bf16 v62, v94, v94
  v_dot2c_f32_bf16 v61, s99, v95
  v_dot2c_f32_bf16 v63, v95, v95
  v_dot2c_f32_bf16 v60, s99, v96
  v_dot2c_f32_bf16 v62, v96, v96
  v_dot2c_f32_bf16 v61, s99, v97
  v_dot2c_f32_bf16 v63, v97, v97
  v_dot2c_f32_bf16 v60, s99, v98
  v_dot2c_f32_bf16 v62, v98, v98
  v_dot2c_f32_bf16 v61, s99, v99
  v_dot2c_f32_bf16 v63, v99, v99
  v_dot2c_f32_bf16 v60, s99, v100
  v_dot2c_f32_bf16 v62, v100, v100
  v_dot2c_f32_bf16 v61, s99, v101
  v_dot2c_f32_bf16 v63, v101, v101
  v_dot2c_f32_bf16 v60, s99, v102
  v_dot2c_f32_bf16 v62, v102, v102
  v_dot2c_f32_bf16 v61, s99, v103
  v_dot2c_f32_bf16 v63, v103, v103
  v_dot2c_f32_bf16 v52, s99, v152
  v_dot2c_f32_bf16 v52, s99, v153
  v_dot2c_f32_bf16 v52, s99, v154
  v_dot2c_f32_bf16 v52, s99, v155
  v_dot2c_f32_bf16 v53, s99, v156
  v_dot2c_f32_bf16 v53, s99, v157
  v_dot2c_f32_bf16 v53, s99, v158
  v_dot2c_f32_bf16 v53, s99, v159
  v_dot2c_f32_bf16 v52, s99, v160
  v_dot2c_f32_bf16 v52, s99, v161
  v_dot2c_f32_bf16 v52, s99, v162
  v_dot2c_f32_bf16 v52, s99, v163
  v_dot2c_f32_bf16 v53, s99, v164
  v_dot2c_f32_bf16 v53, s99, v165
  v_dot2c_f32_bf16 v53, s99, v166
  v_dot2c_f32_bf16 v53, s99, v167
  s_waitcnt lgkmcnt(2)
  v_mfma_f32_32x32x16_bf16 v[184:199], a[192:195], v[136:139], v[184:199]
  ds_read_b128 v[148:151], v18 offset:45056
  s_waitcnt lgkmcnt(2)
  v_mfma_f32_32x32x16_bf16 v[200:215], a[192:195], v[140:143], v[200:215]
  ds_read_b128 a[32:35], v19 offset:32768
  s_waitcnt lgkmcnt(2)
  v_mfma_f32_32x32x16_bf16 v[184:199], a[208:211], v[144:147], v[184:199]
  ds_read_b128 a[36:39], v19 offset:36864
  s_waitcnt lgkmcnt(2)
  v_mfma_f32_32x32x16_bf16 v[200:215], a[208:211], v[148:151], v[200:215]
  ds_read_b128 a[40:43], v20 offset:32768
  s_waitcnt lgkmcnt(2)
  v_mfma_f32_32x32x16_bf16 v[184:199], a[196:199], a[32:35], v[184:199]
  ds_read_b128 a[44:47], v20 offset:36864
  s_waitcnt lgkmcnt(2)
  v_mfma_f32_32x32x16_bf16 v[200:215], a[196:199], a[36:39], v[200:215]
  ds_read_b128 a[48:51], v21 offset:32768
  s_waitcnt lgkmcnt(2)
  v_mfma_f32_32x32x16_bf16 v[184:199], a[200:203], a[40:43], v[184:199]
  ds_read_b128 a[52:55], v21 offset:36864
  s_waitcnt lgkmcnt(2)
  v_mfma_f32_32x32x16_bf16 v[200:215], a[200:203], a[44:47], v[200:215]
  ds_read_b128 a[56:59], v19 offset:40960
  s_waitcnt lgkmcnt(2)
  v_mfma_f32_32x32x16_bf16 v[184:199], a[204:207], a[48:51], v[184:199]
  ds_read_b128 a[60:63], v19 offset:45056
  s_waitcnt lgkmcnt(2)
  v_mfma_f32_32x32x16_bf16 v[200:215], a[204:207], a[52:55], v[200:215]
  ds_read_b128 a[0:3], v20 offset:40960
  s_waitcnt lgkmcnt(2)
  v_mfma_f32_32x32x16_bf16 v[184:199], a[212:215], a[56:59], v[184:199]
  ds_read_b128 a[4:7], v20 offset:45056
  s_waitcnt lgkmcnt(2)
  v_mfma_f32_32x32x16_bf16 v[200:215], a[212:215], a[60:63], v[200:215]
  ds_read_b128 a[8:11], v21 offset:40960
  s_waitcnt vmcnt(12)
  ds_read_b128 v[104:107], v14 offset:32768
  ds_read_b128 v[108:111], v15 offset:32768
  ds_read_b128 v[112:115], v16 offset:32768
  s_waitcnt lgkmcnt(5)
  v_mfma_f32_32x32x16_bf16 v[184:199], a[216:219], a[0:3], v[184:199]
  ds_read_b128 a[12:15], v21 offset:45056
  ds_read_b128 v[116:119], v17 offset:32768
  ds_read_b128 v[120:123], v14 offset:36864
  ds_read_b128 v[124:127], v15 offset:36864
  ds_read_b128 v[128:131], v16 offset:36864
  s_waitcnt lgkmcnt(9)
  v_mfma_f32_32x32x16_bf16 v[200:215], a[216:219], a[4:7], v[200:215]
  ds_read_b128 v[132:135], v17 offset:36864
  ds_read_b128 a[224:227], v14 offset:32768
  ds_read_b128 a[240:243], v14 offset:36864
  ds_read_b128 a[228:231], v15 offset:32768
  s_waitcnt lgkmcnt(12)
  v_mfma_f32_32x32x16_bf16 v[184:199], a[220:223], a[8:11], v[184:199]
  ds_read_b128 a[232:235], v16 offset:32768
  ds_read_b128 a[236:239], v17 offset:32768
  ds_read_b128 a[244:247], v15 offset:36864
  ds_read_b128 a[248:251], v16 offset:36864
  s_waitcnt lgkmcnt(12)
  v_mfma_f32_32x32x16_bf16 v[200:215], a[220:223], a[12:15], v[200:215]
  ds_read_b128 a[252:255], v17 offset:36864
  s_waitcnt vmcnt(8) lgkmcnt(0)
  s_barrier
  ds_read_b128 v[152:155], v18 offset:49152
  ds_read_b128 v[156:159], v18 offset:53248
  ds_read_b128 v[160:163], v18 offset:57344
  v_dot2c_f32_bf16 v60, s99, v104
  v_dot2c_f32_bf16 v62, v104, v104
  v_dot2c_f32_bf16 v61, s99, v105
  v_dot2c_f32_bf16 v63, v105, v105
  v_dot2c_f32_bf16 v60, s99, v106
  v_dot2c_f32_bf16 v62, v106, v106
  v_dot2c_f32_bf16 v61, s99, v107
  v_dot2c_f32_bf16 v63, v107, v107
  v_dot2c_f32_bf16 v60, s99, v108
  v_dot2c_f32_bf16 v62, v108, v108
  v_dot2c_f32_bf16 v61, s99, v109
  v_dot2c_f32_bf16 v63, v109, v109
  v_dot2c_f32_bf16 v60, s99, v110
  v_dot2c_f32_bf16 v62, v110, v110
  v_dot2c_f32_bf16 v61, s99, v111
  v_dot2c_f32_bf16 v63, v111, v111
  v_dot2c_f32_bf16 v60, s99, v112
  v_dot2c_f32_bf16 v62, v112, v112
  v_dot2c_f32_bf16 v61, s99, v113
  v_dot2c_f32_bf16 v63, v113, v113
  v_dot2c_f32_bf16 v60, s99, v114
  v_dot2c_f32_bf16 v62, v114, v114
  v_dot2c_f32_bf16 v61, s99, v115
  v_dot2c_f32_bf16 v63, v115, v115
  v_dot2c_f32_bf16 v60, s99, v116
  v_dot2c_f32_bf16 v62, v116, v116
  v_dot2c_f32_bf16 v61, s99, v117
  v_dot2c_f32_bf16 v63, v117, v117
  v_dot2c_f32_bf16 v60, s99, v118
  v_dot2c_f32_bf16 v62, v118, v118
  v_dot2c_f32_bf16 v61, s99, v119
  v_dot2c_f32_bf16 v63, v119, v119
  v_dot2c_f32_bf16 v60, s99, v120
  v_dot2c_f32_bf16 v62, v120, v120
  v_dot2c_f32_bf16 v61, s99, v121
  v_dot2c_f32_bf16 v63, v121, v121
  v_dot2c_f32_bf16 v60, s99, v122
  v_dot2c_f32_bf16 v62, v122, v122
  v_dot2c_f32_bf16 v61, s99, v123
  v_dot2c_f32_bf16 v63, v123, v123
  v_dot2c_f32_bf16 v60, s99, v124
  v_dot2c_f32_bf16 v62, v124, v124
  v_dot2c_f32_bf16 v61, s99, v125
  v_dot2c_f32_bf16 v63, v125, v125
  v_dot2c_f32_bf16 v60, s99, v126
  v_dot2c_f32_bf16 v62, v126, v126
  v_dot2c_f32_bf16 v61, s99, v127
  v_dot2c_f32_bf16 v63, v127, v127
  v_dot2c_f32_bf16 v60, s99, v128
  v_dot2c_f32_bf16 v62, v128, v128
  v_dot2c_f32_bf16 v61, s99, v129
  v_dot2c_f32_bf16 v63, v129, v129
  v_dot2c_f32_bf16 v60, s99, v130
  v_dot2c_f32_bf16 v62, v130, v130
  v_dot2c_f32_bf16 v61, s99, v131
  v_dot2c_f32_bf16 v63, v131, v131
  v_dot2c_f32_bf16 v60, s99, v132
  v_dot2c_f32_bf16 v62, v132, v132
  v_dot2c_f32_bf16 v61, s99, v133
  v_dot2c_f32_bf16 v63, v133, v133
  v_dot2c_f32_bf16 v60, s99, v134
  v_dot2c_f32_bf16 v62, v134, v134
  v_dot2c_f32_bf16 v61, s99, v135
  v_dot2c_f32_bf16 v63, v135, v135
  v_dot2c_f32_bf16 v52, s99, v136
  v_dot2c_f32_bf16 v52, s99, v137
  v_dot2c_f32_bf16 v52, s99, v138
  v_dot2c_f32_bf16 v52, s99, v139
  v_dot2c_f32_bf16 v53, s99, v140
  v_dot2c_f32_bf16 v53, s99, v141
  v_dot2c_f32_bf16 v53, s99, v142
  v_dot2c_f32_bf16 v53, s99, v143
  v_dot2c_f32_bf16 v52, s99, v144
  v_dot2c_f32_bf16 v52, s99, v145
  v_dot2c_f32_bf16 v52, s99, v146
  v_dot2c_f32_bf16 v52, s99, v147
  v_dot2c_f32_bf16 v53, s99, v148
  v_dot2c_f32_bf16 v53, s99, v149
  v_dot2c_f32_bf16 v53, s99, v150
  v_dot2c_f32_bf16 v53, s99, v151
  s_waitcnt lgkmcnt(2)
  v_mfma_f32_32x32x16_bf16 v[184:199], a[224:227], v[152:155], v[184:199]
  ds_read_b128 v[164:167], v18 offset:61440
  v_add_f32 v60, v60, v61
  v_add_f32 v62, v62, v63
  v_mov_b32 v61, v60
  v_mov_b32 v63, v62
  s_waitcnt lgkmcnt(2)
  v_mfma_f32_32x32x16_bf16 v[200:215], a[224:227], v[156:159], v[200:215]
  ds_read_b128 a[16:19], v19 offset:49152
  v_permlane32_swap_b32 v60, v61
  v_permlane32_swap_b32 v62, v63
  v_add_f32 v60, v60, v61
  v_add_f32 v62, v62, v63
  s_waitcnt lgkmcnt(2)
  v_mfma_f32_32x32x16_bf16 v[184:199], a[240:243], v[160:163], v[184:199]
  ds_read_b128 a[20:23], v19 offset:53248
  v_mul_f32 v60, 0x3b000000, v60
  v_mul_f32 v62, 0x3b000000, v62
  v_fma_f32 v62, -v60, v60, v62
  v_max_f32 v62, 0, v62
  s_waitcnt lgkmcnt(2)
  v_mfma_f32_32x32x16_bf16 v[200:215], a[240:243], v[164:167], v[200:215]
  ds_read_b128 a[24:27], v20 offset:49152
  v_cvt_pk_bf16_f32 v40, -v60, -v60
  v_cvt_pk_bf16_f32 v62, v62, v62
  v_lshlrev_b32 v62, 16, v62
  v_add_f32 v62, 0x3727c5ac, v62
  s_waitcnt lgkmcnt(2)
  v_mfma_f32_32x32x16_bf16 v[184:199], a[228:231], a[16:19], v[184:199]
  ds_read_b128 a[28:31], v20 offset:53248
  v_dot2c_f32_bf16 v52, s99, v152
  v_dot2c_f32_bf16 v52, s99, v153
  v_dot2c_f32_bf16 v52, s99, v154
  v_dot2c_f32_bf16 v52, s99, v155
  v_dot2c_f32_bf16 v53, s99, v156
  v_dot2c_f32_bf16 v53, s99, v157
  v_dot2c_f32_bf16 v53, s99, v158
  v_dot2c_f32_bf16 v53, s99, v159
  v_dot2c_f32_bf16 v52, s99, v160
  v_dot2c_f32_bf16 v52, s99, v161
  v_dot2c_f32_bf16 v52, s99, v162
  v_dot2c_f32_bf16 v52, s99, v163
  v_dot2c_f32_bf16 v53, s99, v164
  v_dot2c_f32_bf16 v53, s99, v165
  v_dot2c_f32_bf16 v53, s99, v166
  v_dot2c_f32_bf16 v53, s99, v167
  s_waitcnt lgkmcnt(2)
  v_mfma_f32_32x32x16_bf16 v[200:215], a[228:231], a[20:23], v[200:215]
  ds_read_b128 a[32:35], v21 offset:49152
  v_cvt_pk_bf16_f32 v62, v62, v62
  v_lshlrev_b32 v62, 16, v62
  v_sqrt_f32 v62, v62
  v_mov_b32 v41, v40
  s_waitcnt lgkmcnt(2)
  v_mfma_f32_32x32x16_bf16 v[184:199], a[232:235], a[24:27], v[184:199]
  ds_read_b128 a[36:39], v21 offset:53248
  v_mov_b32 v42, v40
  v_mov_b32 v43, v40
  v_cvt_pk_bf16_f32 v62, v62, v62
  v_lshlrev_b32 v62, 16, v62
  s_waitcnt lgkmcnt(2)
  v_mfma_f32_32x32x16_bf16 v[200:215], a[232:235], a[28:31], v[200:215]
  ds_read_b128 a[40:43], v19 offset:57344
  v_rcp_f32 v64, v62
  v_mul_f32 v46, v62, v62
  v_mul_f32 v44, 0xc0135761, v64
  v_mul_f32 v45, v64, v64
  s_waitcnt lgkmcnt(2)
  v_mfma_f32_32x32x16_bf16 v[184:199], a[236:239], a[32:35], v[184:199]
  ds_read_b128 a[44:47], v19 offset:61440
  v_mul_f32 v45, v45, v64
  v_mul_f32 v45, 0xbdd2d3e8, v45
  v_xor_b32 v64, s84, v64
  v_lshrrev_b32 v65, 2, v47
  s_waitcnt lgkmcnt(2)
  v_mfma_f32_32x32x16_bf16 v[200:215], a[236:239], a[36:39], v[200:215]
  ds_read_b128 a[48:51], v20 offset:57344
  s_lshl_b32 s15, s3, 7
  v_add_u32 v65, s15, v65
  ds_write_b32 v65, v64 offset:30848
  s_lshl_b32 s15, s3, 2
  s_waitcnt lgkmcnt(3)
  v_mfma_f32_32x32x16_bf16 v[184:199], a[244:247], a[40:43], v[184:199]
  ds_read_b128 a[52:55], v20 offset:61440
  v_add_u32 v66, s15, v48
  v_cvt_pk_bf16_f32 v67, v52, v52
  v_and_b32 v67, 0xffff0000, v67
  v_sub_f32 v67, v52, v67
  s_waitcnt lgkmcnt(3)
  v_mfma_f32_32x32x16_bf16 v[200:215], a[244:247], a[44:47], v[200:215]
  ds_read_b128 a[56:59], v21 offset:57344
  v_cvt_pk_bf16_f32 v67, v52, v67
  ds_write_b32 v66, v67 offset:28800
  v_mov_b32 v52, 0
  v_cvt_pk_bf16_f32 v68, v53, v53
  s_waitcnt lgkmcnt(4)
  v_mfma_f32_32x32x16_bf16 v[184:199], a[248:251], a[48:51], v[184:199]
  ds_read_b128 a[60:63], v21 offset:61440
  s_add_u32 m0, s83, 0
  s_add_u32 s95, s19, 1
  s_and_b32 s95, s95, 7
  s_mul_i32 s95, s95, 0x38000
  v_and_b32 v68, 0xffff0000, v68
  v_sub_f32 v68, v53, v68
  v_cvt_pk_bf16_f32 v68, v53, v68
  ds_write_b32 v66, v68 offset:29824
  s_waitcnt lgkmcnt(4)
  v_mfma_f32_32x32x16_bf16 v[200:215], a[248:251], a[52:55], v[200:215]
  s_add_u32 s95, s95, s78
  buffer_load_dwordx4 v7, s[48:51], s95 offen lds
  buffer_load_dwordx4 v8, s[48:51], s95 offen offset:1024 lds
  buffer_load_dwordx4 v9, s[48:51], s95 offen offset:2048 lds
  v_mov_b32 v53, 0
  s_waitcnt lgkmcnt(3)
  v_mfma_f32_32x32x16_bf16 v[184:199], a[252:255], a[56:59], v[184:199]
  buffer_load_dwordx4 v10, s[48:51], s95 offen offset:3072 lds
  s_add_u32 m0, s83, 0x1000
  s_nop 0
  buffer_load_dwordx4 v11, s[48:51], s95 offen lds
  buffer_load_dwordx4 v12, s[48:51], s95 offen offset:1024 lds
  s_waitcnt lgkmcnt(1)
  v_mfma_f32_32x32x16_bf16 v[200:215], a[252:255], a[60:63], v[200:215]
  buffer_load_dwordx4 v13, s[48:51], s95 offen offset:2048 lds
  s_add_u32 m0, s83, 0x8000
  s_add_u32 s95, s19, 2
  s_and_b32 s95, s95, 7
  s_mul_i32 s95, s95, 0x38000
  s_add_u32 s95, s95, s78
  buffer_load_dwordx4 v7, s[48:51], s95 offen lds
  buffer_load_dwordx4 v8, s[48:51], s95 offen offset:1024 lds
  buffer_load_dwordx4 v9, s[48:51], s95 offen offset:2048 lds
  buffer_load_dwordx4 v10, s[48:51], s95 offen offset:3072 lds
  s_add_u32 m0, s83, 0x9000
  s_nop 0
  buffer_load_dwordx4 v11, s[48:51], s95 offen lds
  buffer_load_dwordx4 v12, s[48:51], s95 offen offset:1024 lds
  buffer_load_dwordx4 v13, s[48:51], s95 offen offset:2048 lds
  s_waitcnt vmcnt(15)
  s_waitcnt lgkmcnt(0)
  s_barrier
  ds_read_b64_tr_b16 v[216:217], v26
  ds_read_b64_tr_b16 v[218:219], v26 offset:896
  ds_read_b64_tr_b16 v[220:221], v26 offset:32
  ds_read_b64_tr_b16 v[222:223], v26 offset:928
  ds_read_b64_tr_b16 v[224:225], v26 offset:64
  ds_read_b64_tr_b16 v[226:227], v26 offset:960
  ds_read_b64_tr_b16 v[228:229], v26 offset:96
  ds_read_b64_tr_b16 v[230:231], v26 offset:992
  s_waitcnt lgkmcnt(6)
  v_mfma_f32_32x32x16_bf16 v[72:87], v[216:219], a[128:131], 0
  ds_read_b64_tr_b16 v[232:233], v26 offset:128
  ds_read_b64_tr_b16 v[234:235], v26 offset:1024
  ds_read_b64_tr_b16 v[236:237], v26 offset:160
  ds_read_b64_tr_b16 v[238:239], v26 offset:1056
  s_add_u32 m0, s83, 0x10000
  v_lshrrev_b32 v68, 5, v0
  v_lshlrev_b32 v68, 4, v68
  s_waitcnt lgkmcnt(8)
  v_mfma_f32_32x32x16_bf16 v[88:103], v[220:223], a[128:131], 0
  ds_read_b128 a[0:3], v48 offset:28800
  ds_read_b64_tr_b16 v[240:241], v26 offset:192
  ds_read_b64_tr_b16 v[242:243], v26 offset:1088
  s_add_u32 s95, s19, 3
  s_lshl_b32 s15, s3, 7
  v_add_u32 v68, s15, v68
  s_waitcnt lgkmcnt(9)
  v_mfma_f32_32x32x16_bf16 v[104:119], v[224:227], a[128:131], 0
  ds_read_b128 a[4:7], v48 offset:29824
  ds_read_b64_tr_b16 a[8:9], v27
  ds_read_b64_tr_b16 a[10:11], v27 offset:896
  s_and_b32 s95, s95, 7
  ds_read_b128 v[248:251], v68 offset:30848
  ds_read_b128 v[252:255], v68 offset:30880
  s_waitcnt lgkmcnt(12)
  v_mfma_f32_32x32x16_bf16 v[120:135], v[228:231], a[128:131], 0
  ds_read_b64_tr_b16 a[12:13], v27 offset:32
  ds_read_b64_tr_b16 a[14:15], v27 offset:928
  s_mul_i32 s95, s95, 0x38000
  s_waitcnt lgkmcnt(12)
  v_mfma_f32_32x32x16_bf16 v[136:151], v[232:235], a[128:131], 0
  ds_read_b64_tr_b16 a[16:17], v27 offset:64
  ds_read_b64_tr_b16 a[18:19], v27 offset:960
  s_add_u32 s95, s95, s78
  s_waitcnt lgkmcnt(11)
  v_mfma_f32_32x32x16_bf16 v[184:199], v[40:43], a[0:3], v[184:199]
  ds_read_b64_tr_b16 a[20:21], v27 offset:96
  ds_read_b64_tr_b16 a[22:23], v27 offset:992
  buffer_load_dwordx4 v7, s[48:51], s95 offen lds
  buffer_load_dwordx4 v8, s[48:51], s95 offen offset:1024 lds
  s_waitcnt lgkmcnt(10)
  v_mfma_f32_32x32x16_bf16 v[200:215], v[40:43], a[4:7], v[200:215]
  ds_read_b64_tr_b16 a[24:25], v27 offset:128
  ds_read_b64_tr_b16 a[26:27], v27 offset:1024
  buffer_load_dwordx4 v9, s[48:51], s95 offen offset:2048 lds
  v_mfma_f32_32x32x16_bf16 v[152:167], v[236:239], a[128:131], 0
  ds_read_b64_tr_b16 a[28:29], v27 offset:160
  ds_read_b64_tr_b16 a[30:31], v27 offset:1056
  buffer_load_dwordx4 v10, s[48:51], s95 offen offset:3072 lds
  v_mfma_f32_32x32x16_bf16 v[168:183], v[240:243], a[128:131], 0
  ds_read_b64_tr_b16 a[32:33], v27 offset:192
  ds_read_b64_tr_b16 a[34:35], v27 offset:1088
  s_add_u32 m0, s83, 0x11000
  s_waitcnt lgkmcnt(6)
  v_mfma_f32_32x32x16_bf16 v[72:87], a[8:11], a[132:135], v[72:87]
  ds_read_b64_tr_b16 a[36:37], v28
  ds_read_b64_tr_b16 a[38:39], v28 offset:896
  v_dot2c_f32_bf16 v52, s99, v216
  v_dot2c_f32_bf16 v52, s99, v217
  v_dot2c_f32_bf16 v52, s99, v218
  v_dot2c_f32_bf16 v52, s99, v219
  v_dot2c_f32_bf16 v53, s99, v220
  v_dot2c_f32_bf16 v53, s99, v221
  v_dot2c_f32_bf16 v53, s99, v222
  v_dot2c_f32_bf16 v53, s99, v223
  v_dot2c_f32_bf16 v54, s99, v224
  v_dot2c_f32_bf16 v54, s99, v225
  v_dot2c_f32_bf16 v54, s99, v226
  v_dot2c_f32_bf16 v54, s99, v227
  v_dot2c_f32_bf16 v55, s99, v228
  v_dot2c_f32_bf16 v55, s99, v229
  v_dot2c_f32_bf16 v55, s99, v230
  v_dot2c_f32_bf16 v55, s99, v231
  v_dot2c_f32_bf16 v56, s99, v232
  v_dot2c_f32_bf16 v56, s99, v233
  v_dot2c_f32_bf16 v56, s99, v234
  v_dot2c_f32_bf16 v56, s99, v235
  v_dot2c_f32_bf16 v57, s99, v236
  v_dot2c_f32_bf16 v57, s99, v237
  v_dot2c_f32_bf16 v57, s99, v238
  v_dot2c_f32_bf16 v57, s99, v239
  v_dot2c_f32_bf16 v58, s99, v240
  v_dot2c_f32_bf16 v58, s99, v241
  v_dot2c_f32_bf16 v58, s99, v242
  v_dot2c_f32_bf16 v58, s99, v243
  buffer_load_dwordx4 v11, s[48:51], s95 offen lds
  v_lshrrev_b32 v69, 5, v0
  v_lshl_add_u32 v69, v69, 9, v47
  s_lshl_b32 s14, s3, 2
  v_add_u32 v69, s14, v69
  v_permlane32_swap_b32 v52, v53
  v_add_f32 v52, v52, v53
  ds_write_b32 v69, v52 offset:61568
  v_permlane32_swap_b32 v54, v55
  v_mfma_f32_32x32x16_bf16 v[88:103], a[12:15], a[132:135], v[88:103]
  ds_read_b64_tr_b16 a[40:41], v28 offset:32
  ds_read_b64_tr_b16 a[42:43], v28 offset:928
  buffer_load_dwordx4 v12, s[48:51], s95 offen offset:1024 lds
  buffer_load_dwordx4 v13, s[48:51], s95 offen offset:2048 lds
  v_add_f32 v54, v54, v55
  ds_write_b32 v69, v54 offset:62592
  v_permlane32_swap_b32 v56, v57
  v_add_f32 v56, v56, v57
  ds_write_b32 v69, v56 offset:63616
  v_mov_b32 v59, v58
  v_add_u32 v69, s14, v47
  s_nop 0
  v_permlane32_swap_b32 v58, v59
  v_mfma_f32_32x32x16_bf16 v[104:119], a[16:19], a[132:135], v[104:119]
  ds_read_b64_tr_b16 a[44:45], v28 offset:64
  ds_read_b64_tr_b16 a[46:47], v28 offset:960
  s_add_u32 m0, s83, 0x18000
  v_add_f32 v58, v58, v59
  ds_write_b32 v69, v58 offset:64640
  v_mfma_f32_32x32x16_bf16 v[120:135], a[20:23], a[132:135], v[120:135]
  ds_read_b64_tr_b16 a[48:49], v28 offset:96
  ds_read_b64_tr_b16 a[50:51], v28 offset:992
  s_add_u32 s95, s19, 4
  s_waitcnt lgkmcnt(10)
  v_mfma_f32_32x32x16_bf16 v[136:151], a[24:27], a[132:135], v[136:151]
  ds_read_b64_tr_b16 a[52:53], v28 offset:128
  ds_read_b64_tr_b16 a[54:55], v28 offset:1024
  s_and_b32 s95, s95, 7
  v_mul_f32 v184, v184, v248
  v_mul_f32 v185, v185, v249
  v_mul_f32 v186, v186, v250
  v_mul_f32 v187, v187, v251
  v_mul_f32 v188, v188, v252
  v_mul_f32 v189, v189, v253
  v_mul_f32 v190, v190, v254
  v_mul_f32 v191, v191, v255
  v_mfma_f32_32x32x16_bf16 v[152:167], a[28:31], a[132:135], v[152:167]
  ds_read_b64_tr_b16 a[56:57], v28 offset:160
  ds_read_b64_tr_b16 a[58:59], v28 offset:1056
  s_mul_i32 s95, s95, 0x38000
  v_cvt_pk_bf16_f32 v60, v184, v185
  v_cvt_pk_bf16_f32 v61, v186, v187
  v_cvt_pk_bf16_f32 v62, v188, v189
  v_cvt_pk_bf16_f32 v63, v190, v191
  s_nop 0
  v_permlane32_swap_b32 v60, v62
  v_permlane32_swap_b32 v61, v63
  s_add_u32 s15, s85, 0
  buffer_store_dwordx4 v[60:63], v1, s[60:63], s15 offen sc1
  v_mfma_f32_32x32x16_bf16 v[168:183], a[32:35], a[132:135], v[168:183]
  ds_read_b64_tr_b16 a[60:61], v28 offset:192
  ds_read_b64_tr_b16 a[62:63], v28 offset:1088
  s_add_u32 s95, s95, s78
  v_mul_f32 v200, v200, v248
  v_mul_f32 v201, v201, v249
  v_mul_f32 v202, v202, v250
  v_mul_f32 v203, v203, v251
  v_mul_f32 v204, v204, v252
  v_mul_f32 v205, v205, v253
  v_mul_f32 v206, v206, v254
  v_mul_f32 v207, v207, v255
  v_mfma_f32_32x32x16_bf16 v[72:87], a[36:39], a[136:139], v[72:87]
  ds_read_b64_tr_b16 a[0:1], v29
  ds_read_b64_tr_b16 a[2:3], v29 offset:896
  buffer_load_dwordx4 v7, s[48:51], s95 offen lds
  buffer_load_dwordx4 v8, s[48:51], s95 offen offset:1024 lds
  v_cvt_pk_bf16_f32 v64, v200, v201
  v_cvt_pk_bf16_f32 v65, v202, v203
  v_cvt_pk_bf16_f32 v66, v204, v205
  v_cvt_pk_bf16_f32 v67, v206, v207
  s_nop 0
  v_permlane32_swap_b32 v64, v66
  v_permlane32_swap_b32 v65, v67
  s_add_u32 s15, s85, 0x20000
  buffer_store_dwordx4 v[64:67], v1, s[60:63], s15 offen sc1
  s_waitcnt lgkmcnt(6)
  v_mfma_f32_32x32x16_bf16 v[88:103], a[40:43], a[136:139], v[88:103]
  ds_read_b64_tr_b16 a[4:5], v29 offset:32
  ds_read_b64_tr_b16 a[6:7], v29 offset:928
  buffer_load_dwordx4 v9, s[48:51], s95 offen offset:2048 lds
  ds_read_b128 v[248:251], v68 offset:30912
  ds_read_b128 v[252:255], v68 offset:30944
  s_waitcnt lgkmcnt(1)
  v_mul_f32 v192, v192, v248
  v_mul_f32 v193, v193, v249
  v_mul_f32 v194, v194, v250
  v_mul_f32 v195, v195, v251
  s_waitcnt lgkmcnt(0)
  v_mul_f32 v196, v196, v252
  v_mul_f32 v197, v197, v253
  v_mfma_f32_32x32x16_bf16 v[104:119], a[44:47], a[136:139], v[104:119]
  ds_read_b64_tr_b16 a[8:9], v29 offset:64
  ds_read_b64_tr_b16 a[10:11], v29 offset:960
  buffer_load_dwordx4 v10, s[48:51], s95 offen offset:3072 lds
  v_mul_f32 v198, v198, v254
  v_mul_f32 v199, v199, v255
  v_cvt_pk_bf16_f32 v60, v192, v193
  v_cvt_pk_bf16_f32 v61, v194, v195
  v_cvt_pk_bf16_f32 v62, v196, v197
  v_cvt_pk_bf16_f32 v63, v198, v199
  s_nop 0
  v_permlane32_swap_b32 v60, v62
  v_permlane32_swap_b32 v61, v63
  v_mfma_f32_32x32x16_bf16 v[120:135], a[48:51], a[136:139], v[120:135]
  ds_read_b64_tr_b16 a[12:13], v29 offset:96
  ds_read_b64_tr_b16 a[14:15], v29 offset:992
  s_add_u32 m0, s83, 0x19000
  s_add_u32 s15, s85, 0
  buffer_store_dwordx4 v[60:63], v1, s[60:63], s15 offen offset:1024 sc1
  v_mul_f32 v208, v208, v248
  v_mul_f32 v209, v209, v249
  v_mul_f32 v210, v210, v250
  v_mul_f32 v211, v211, v251
  v_mul_f32 v212, v212, v252
  v_mul_f32 v213, v213, v253
  v_mfma_f32_32x32x16_bf16 v[136:151], a[52:55], a[136:139], v[136:151]
  ds_read_b64_tr_b16 a[16:17], v29 offset:128
  ds_read_b64_tr_b16 a[18:19], v29 offset:1024
  ds_read_b64_tr_b16 a[20:21], v29 offset:160
  ds_read_b64_tr_b16 a[22:23], v29 offset:1056
  ds_read_b64_tr_b16 a[24:25], v29 offset:192
  ds_read_b64_tr_b16 a[26:27], v29 offset:1088
  buffer_load_dwordx4 v11, s[48:51], s95 offen lds
  v_mul_f32 v214, v214, v254
  v_mul_f32 v215, v215, v255
  v_cvt_pk_bf16_f32 v64, v208, v209
  v_cvt_pk_bf16_f32 v65, v210, v211
  v_cvt_pk_bf16_f32 v66, v212, v213
  v_cvt_pk_bf16_f32 v67, v214, v215
  s_nop 0
  v_permlane32_swap_b32 v64, v66
  v_permlane32_swap_b32 v65, v67
  v_mfma_f32_32x32x16_bf16 v[152:167], a[56:59], a[136:139], v[152:167]
  buffer_load_dwordx4 v12, s[48:51], s95 offen offset:1024 lds
  buffer_load_dwordx4 v13, s[48:51], s95 offen offset:2048 lds
  s_add_u32 s15, s85, 0x20000
  buffer_store_dwordx4 v[64:67], v1, s[60:63], s15 offen offset:1024 sc1
  v_mfma_f32_32x32x16_bf16 v[168:183], a[60:63], a[136:139], v[168:183]
  s_waitcnt vmcnt(25) lgkmcnt(0)
  s_barrier
  v_mfma_f32_32x32x16_bf16 v[72:87], a[0:3], a[140:143], v[72:87]
  v_subrev_u32 v26, 0x20000, v26
  ds_read_b64_tr_b16 a[28:29], v26
  ds_read_b64_tr_b16 a[30:31], v26 offset:896
  s_add_u32 m0, s83, 0x20000
  s_lshl_b32 s14, s3, 10
  v_add_u32 v69, s14, v1
  ds_read_b128 v[52:55], v69 offset:61568
  v_mfma_f32_32x32x16_bf16 v[88:103], a[4:7], a[140:143], v[88:103]
  ds_read_b64_tr_b16 a[32:33], v26 offset:32
  ds_read_b64_tr_b16 a[34:35], v26 offset:928
  s_add_u32 s95, s19, 5
  v_mfma_f32_32x32x16_bf16 v[104:119], a[8:11], a[140:143], v[104:119]
  ds_read_b64_tr_b16 a[36:37], v26 offset:64
  ds_read_b64_tr_b16 a[38:39], v26 offset:960
  s_and_b32 s95, s95, 7
  v_mfma_f32_32x32x16_bf16 v[120:135], a[12:15], a[140:143], v[120:135]
  ds_read_b64_tr_b16 a[40:41], v26 offset:96
  ds_read_b64_tr_b16 a[42:43], v26 offset:992
  s_mul_i32 s95, s95, 0x38000
  v_lshrrev_b32 v69, 2, v69
  v_cmp_gt_u32 vcc, 0x380, v69
  s_nop 1
  v_cndmask_b32 v69, v33, v69, vcc
  s_lshl_b32 s14, s19, 10
  s_add_u32 s14, s14, s20
  s_waitcnt lgkmcnt(6)
  v_add_f32 v52, v52, v53
  v_add_f32 v54, v54, v55
  v_add_f32 v52, v52, v54
  v_cvt_pk_bf16_f32 v53, v52, v52
  v_mfma_f32_32x32x16_bf16 v[136:151], a[16:19], a[140:143], v[136:151]
  ds_read_b64_tr_b16 a[44:45], v26 offset:128
  ds_read_b64_tr_b16 a[46:47], v26 offset:1024
  s_add_u32 s95, s95, s78
  v_and_b32 v53, 0xffff0000, v53
  v_sub_f32 v53, v52, v53
  v_cvt_pk_bf16_f32 v53, v52, v53
  buffer_store_dword v53, v69, s[60:63], s14 offen sc1
  v_mfma_f32_32x32x16_bf16 v[152:167], a[20:23], a[140:143], v[152:167]
  ds_read_b64_tr_b16 a[48:49], v26 offset:160
  ds_read_b64_tr_b16 a[50:51], v26 offset:1056
  buffer_load_dwordx4 v7, s[48:51], s95 offen lds
  v_mfma_f32_32x32x16_bf16 v[168:183], a[24:27], a[140:143], v[168:183]
  ds_read_b64_tr_b16 a[52:53], v26 offset:192
  ds_read_b64_tr_b16 a[54:55], v26 offset:1088
  buffer_load_dwordx4 v8, s[48:51], s95 offen offset:1024 lds
  s_waitcnt lgkmcnt(8)
  v_mfma_f32_32x32x16_bf16 v[72:87], a[28:31], a[144:147], v[72:87]
  v_subrev_u32 v27, 0x20000, v27
  ds_read_b64_tr_b16 a[56:57], v27
  ds_read_b64_tr_b16 a[58:59], v27 offset:896
  buffer_load_dwordx4 v9, s[48:51], s95 offen offset:2048 lds
  v_mfma_f32_32x32x16_bf16 v[88:103], a[32:35], a[144:147], v[88:103]
  ds_read_b64_tr_b16 a[60:61], v27 offset:32
  ds_read_b64_tr_b16 a[62:63], v27 offset:928
  buffer_load_dwordx4 v10, s[48:51], s95 offen offset:3072 lds
  v_mfma_f32_32x32x16_bf16 v[104:119], a[36:39], a[144:147], v[104:119]
  ds_read_b64_tr_b16 a[0:1], v27 offset:64
  ds_read_b64_tr_b16 a[2:3], v27 offset:960
  s_add_u32 m0, s83, 0x21000
  s_waitcnt lgkmcnt(6)
  v_mfma_f32_32x32x16_bf16 v[120:135], a[40:43], a[144:147], v[120:135]
  ds_read_b64_tr_b16 a[4:5], v27 offset:96
  ds_read_b64_tr_b16 a[6:7], v27 offset:992
  buffer_load_dwordx4 v11, s[48:51], s95 offen lds
  v_mfma_f32_32x32x16_bf16 v[136:151], a[44:47], a[144:147], v[136:151]
  ds_read_b64_tr_b16 a[8:9], v27 offset:128
  ds_read_b64_tr_b16 a[10:11], v27 offset:1024
  buffer_load_dwordx4 v12, s[48:51], s95 offen offset:1024 lds
  v_mfma_f32_32x32x16_bf16 v[152:167], a[48:51], a[144:147], v[152:167]
  ds_read_b64_tr_b16 a[12:13], v27 offset:160
  ds_read_b64_tr_b16 a[14:15], v27 offset:1056
  buffer_load_dwordx4 v13, s[48:51], s95 offen offset:2048 lds
  v_mfma_f32_32x32x16_bf16 v[168:183], a[52:55], a[144:147], v[168:183]
  ds_read_b64_tr_b16 a[16:17], v27 offset:192
  ds_read_b64_tr_b16 a[18:19], v27 offset:1088
  s_waitcnt lgkmcnt(6)
  v_mfma_f32_32x32x16_bf16 v[72:87], a[56:59], a[148:151], v[72:87]
  v_subrev_u32 v28, 0x20000, v28
  ds_read_b64_tr_b16 a[20:21], v28
  ds_read_b64_tr_b16 a[22:23], v28 offset:896
  s_waitcnt vmcnt(7)
  s_barrier
  v_cmp_ne_u32 vcc, 0, v34
  s_nop 0
  s_cmp_eq_u64 vcc, -1
  s_cbranch_scc0 L1_slow_nonce
L1_res_nonce:
  s_mov_b32 s94, 0
  buffer_store_dwordx2 v[34:35], v33, s[60:63], s94 offen sc1
  v_mfma_f32_32x32x16_bf16 v[88:103], a[60:63], a[148:151], v[88:103]
  ds_read_b64_tr_b16 a[24:25], v28 offset:32
  ds_read_b64_tr_b16 a[26:27], v28 offset:928
  s_add_u32 s95, s98, 0x100
  v_mfma_f32_32x32x16_bf16 v[104:119], a[0:3], a[148:151], v[104:119]
  ds_read_b64_tr_b16 a[28:29], v28 offset:64
  ds_read_b64_tr_b16 a[30:31], v28 offset:960
  s_and_b32 s95, s95, 0x7ff
  v_mfma_f32_32x32x16_bf16 v[120:135], a[4:7], a[148:151], v[120:135]
  ds_read_b64_tr_b16 a[32:33], v28 offset:96
  ds_read_b64_tr_b16 a[34:35], v28 offset:992
  s_waitcnt lgkmcnt(6)
  v_mfma_f32_32x32x16_bf16 v[136:151], a[8:11], a[148:151], v[136:151]
  ds_read_b64_tr_b16 a[36:37], v28 offset:128
  ds_read_b64_tr_b16 a[38:39], v28 offset:1024
  s_add_u32 s95, s95, s80
  v_mfma_f32_32x32x16_bf16 v[152:167], a[12:15], a[148:151], v[152:167]
  ds_read_b64_tr_b16 a[40:41], v28 offset:160
  ds_read_b64_tr_b16 a[42:43], v28 offset:1056
  buffer_load_dword v49, v51, s[52:55], s95 offen
  v_mfma_f32_32x32x16_bf16 v[168:183], a[16:19], a[148:151], v[168:183]
  ds_read_b64_tr_b16 a[44:45], v28 offset:192
  ds_read_b64_tr_b16 a[46:47], v28 offset:1088
  v_mfma_f32_32x32x16_bf16 v[72:87], a[20:23], a[152:155], v[72:87]
  v_subrev_u32 v29, 0x20000, v29
  ds_read_b64_tr_b16 a[48:49], v29
  ds_read_b64_tr_b16 a[50:51], v29 offset:896
  s_waitcnt lgkmcnt(6)
  v_mfma_f32_32x32x16_bf16 v[88:103], a[24:27], a[152:155], v[88:103]
  ds_read_b64_tr_b16 a[52:53], v29 offset:32
  ds_read_b64_tr_b16 a[54:55], v29 offset:928
  v_mfma_f32_32x32x16_bf16 v[104:119], a[28:31], a[152:155], v[104:119]
  ds_read_b64_tr_b16 a[56:57], v29 offset:64
  ds_read_b64_tr_b16 a[58:59], v29 offset:960
  v_mfma_f32_32x32x16_bf16 v[120:135], a[32:35], a[152:155], v[120:135]
  ds_read_b64_tr_b16 a[60:61], v29 offset:96
  ds_read_b64_tr_b16 a[62:63], v29 offset:992
  v_mfma_f32_32x32x16_bf16 v[136:151], a[36:39], a[152:155], v[136:151]
  ds_read_b64_tr_b16 a[0:1], v29 offset:128
  ds_read_b64_tr_b16 a[2:3], v29 offset:1024
  ds_read_b64_tr_b16 a[4:5], v29 offset:160
  ds_read_b64_tr_b16 a[6:7], v29 offset:1056
  ds_read_b64_tr_b16 a[8:9], v29 offset:192
  ds_read_b64_tr_b16 a[10:11], v29 offset:1088
  s_waitcnt lgkmcnt(10)
  v_mfma_f32_32x32x16_bf16 v[152:167], a[40:43], a[152:155], v[152:167]
  v_mfma_f32_32x32x16_bf16 v[168:183], a[44:47], a[152:155], v[168:183]
  s_waitcnt lgkmcnt(0)
  s_barrier
  v_mfma_f32_32x32x16_bf16 v[72:87], a[48:51], a[156:159], v[72:87]
  v_add_u32 v26, 0x8000, v26
  ds_read_b64_tr_b16 a[12:13], v26
  ds_read_b64_tr_b16 a[14:15], v26 offset:896
  v_mfma_f32_32x32x16_bf16 v[88:103], a[52:55], a[156:159], v[88:103]
  ds_read_b64_tr_b16 a[16:17], v26 offset:32
  ds_read_b64_tr_b16 a[18:19], v26 offset:928
  v_mfma_f32_32x32x16_bf16 v[104:119], a[56:59], a[156:159], v[104:119]
  ds_read_b64_tr_b16 a[20:21], v26 offset:64
  ds_read_b64_tr_b16 a[22:23], v26 offset:960
  v_mfma_f32_32x32x16_bf16 v[120:135], a[60:63], a[156:159], v[120:135]
  ds_read_b64_tr_b16 a[24:25], v26 offset:96
  ds_read_b64_tr_b16 a[26:27], v26 offset:992
  v_mfma_f32_32x32x16_bf16 v[136:151], a[0:3], a[156:159], v[136:151]
  ds_read_b64_tr_b16 a[28:29], v26 offset:128
  ds_read_b64_tr_b16 a[30:31], v26 offset:1024
  v_mfma_f32_32x32x16_bf16 v[152:167], a[4:7], a[156:159], v[152:167]
  ds_read_b64_tr_b16 a[32:33], v26 offset:160
  ds_read_b64_tr_b16 a[34:35], v26 offset:1056
  v_mfma_f32_32x32x16_bf16 v[168:183], a[8:11], a[156:159], v[168:183]
  ds_read_b64_tr_b16 a[36:37], v26 offset:192
  ds_read_b64_tr_b16 a[38:39], v26 offset:1088
  s_waitcnt lgkmcnt(8)
  v_mfma_f32_32x32x16_bf16 v[72:87], a[12:15], a[160:163], v[72:87]
  v_add_u32 v27, 0x8000, v27
  ds_read_b64_tr_b16 a[40:41], v27
  ds_read_b64_tr_b16 a[42:43], v27 offset:896
  v_mfma_f32_32x32x16_bf16 v[88:103], a[16:19], a[160:163], v[88:103]
  ds_read_b64_tr_b16 a[44:45], v27 offset:32
  ds_read_b64_tr_b16 a[46:47], v27 offset:928
  v_mfma_f32_32x32x16_bf16 v[104:119], a[20:23], a[160:163], v[104:119]
  ds_read_b64_tr_b16 a[48:49], v27 offset:64
  ds_read_b64_tr_b16 a[50:51], v27 offset:960
  s_waitcnt lgkmcnt(6)
  v_mfma_f32_32x32x16_bf16 v[120:135], a[24:27], a[160:163], v[120:135]
  ds_read_b64_tr_b16 a[52:53], v27 offset:96
  ds_read_b64_tr_b16 a[54:55], v27 offset:992
  v_mfma_f32_32x32x16_bf16 v[136:151], a[28:31], a[160:163], v[136:151]
  ds_read_b64_tr_b16 a[56:57], v27 offset:128
  ds_read_b64_tr_b16 a[58:59], v27 offset:1024
  v_mfma_f32_32x32x16_bf16 v[152:167], a[32:35], a[160:163], v[152:167]
  ds_read_b64_tr_b16 a[60:61], v27 offset:160
  ds_read_b64_tr_b16 a[62:63], v27 offset:1056
  v_mfma_f32_32x32x16_bf16 v[168:183], a[36:39], a[160:163], v[168:183]
  ds_read_b64_tr_b16 a[0:1], v27 offset:192
  ds_read_b64_tr_b16 a[2:3], v27 offset:1088
  s_waitcnt lgkmcnt(6)
  v_mfma_f32_32x32x16_bf16 v[72:87], a[40:43], a[164:167], v[72:87]
  v_add_u32 v28, 0x8000, v28
  ds_read_b64_tr_b16 a[4:5], v28
  ds_read_b64_tr_b16 a[6:7], v28 offset:896
  v_mfma_f32_32x32x16_bf16 v[88:103], a[44:47], a[164:167], v[88:103]
  ds_read_b64_tr_b16 a[8:9], v28 offset:32
  ds_read_b64_tr_b16 a[10:11], v28 offset:928
  v_mfma_f32_32x32x16_bf16 v[104:119], a[48:51], a[164:167], v[104:119]
  ds_read_b64_tr_b16 a[12:13], v28 offset:64
  ds_read_b64_tr_b16 a[14:15], v28 offset:960
  v_mfma_f32_32x32x16_bf16 v[120:135], a[52:55], a[164:167], v[120:135]
  ds_read_b64_tr_b16 a[16:17], v28 offset:96
  ds_read_b64_tr_b16 a[18:19], v28 offset:992
  s_waitcnt lgkmcnt(6)
  v_mfma_f32_32x32x16_bf16 v[136:151], a[56:59], a[164:167], v[136:151]
  ds_read_b64_tr_b16 a[20:21], v28 offset:128
  ds_read_b64_tr_b16 a[22:23], v28 offset:1024
  v_mfma_f32_32x32x16_bf16 v[152:167], a[60:63], a[164:167], v[152:167]
  ds_read_b64_tr_b16 a[24:25], v28 offset:160
  ds_read_b64_tr_b16 a[26:27], v28 offset:1056
  v_mfma_f32_32x32x16_bf16 v[168:183], a[0:3], a[164:167], v[168:183]
  ds_read_b64_tr_b16 a[28:29], v28 offset:192
  ds_read_b64_tr_b16 a[30:31], v28 offset:1088
  v_mfma_f32_32x32x16_bf16 v[72:87], a[4:7], a[168:171], v[72:87]
  v_add_u32 v29, 0x8000, v29
  ds_read_b64_tr_b16 a[32:33], v29
  ds_read_b64_tr_b16 a[34:35], v29 offset:896
  s_waitcnt lgkmcnt(6)
  v_mfma_f32_32x32x16_bf16 v[88:103], a[8:11], a[168:171], v[88:103]
  ds_read_b64_tr_b16 a[36:37], v29 offset:32
  ds_read_b64_tr_b16 a[38:39], v29 offset:928
  v_mfma_f32_32x32x16_bf16 v[104:119], a[12:15], a[168:171], v[104:119]
  ds_read_b64_tr_b16 a[40:41], v29 offset:64
  ds_read_b64_tr_b16 a[42:43], v29 offset:960
  v_mfma_f32_32x32x16_bf16 v[120:135], a[16:19], a[168:171], v[120:135]
  ds_read_b64_tr_b16 a[44:45], v29 offset:96
  ds_read_b64_tr_b16 a[46:47], v29 offset:992
  v_mfma_f32_32x32x16_bf16 v[136:151], a[20:23], a[168:171], v[136:151]
  ds_read_b64_tr_b16 a[48:49], v29 offset:128
  ds_read_b64_tr_b16 a[50:51], v29 offset:1024
  ds_read_b64_tr_b16 a[52:53], v29 offset:160
  ds_read_b64_tr_b16 a[54:55], v29 offset:1056
  ds_read_b64_tr_b16 a[56:57], v29 offset:192
  ds_read_b64_tr_b16 a[58:59], v29 offset:1088
  s_waitcnt lgkmcnt(10)
  v_mfma_f32_32x32x16_bf16 v[152:167], a[24:27], a[168:171], v[152:167]
  v_mfma_f32_32x32x16_bf16 v[168:183], a[28:31], a[168:171], v[168:183]
  s_waitcnt lgkmcnt(0)
  s_barrier
  v_mfma_f32_32x32x16_bf16 v[72:87], a[32:35], a[172:175], v[72:87]
  v_add_u32 v26, 0x8000, v26
  ds_read_b64_tr_b16 a[60:61], v26
  ds_read_b64_tr_b16 a[62:63], v26 offset:896
  s_add_u32 m0, s83, 0
  v_mfma_f32_32x32x16_bf16 v[88:103], a[36:39], a[172:175], v[88:103]
  ds_read_b64_tr_b16 a[0:1], v26 offset:32
  ds_read_b64_tr_b16 a[2:3], v26 offset:928
  s_add_u32 s95, s19, 6
  s_and_b32 s95, s95, 7
  v_mfma_f32_32x32x16_bf16 v[104:119], a[40:43], a[172:175], v[104:119]
  ds_read_b64_tr_b16 a[4:5], v26 offset:64
  ds_read_b64_tr_b16 a[6:7], v26 offset:960
  s_mul_i32 s95, s95, 0x38000
  s_add_u32 s95, s95, s78
  v_mfma_f32_32x32x16_bf16 v[120:135], a[44:47], a[172:175], v[120:135]
  ds_read_b64_tr_b16 a[8:9], v26 offset:96
  ds_read_b64_tr_b16 a[10:11], v26 offset:992
  buffer_load_dwordx4 v7, s[48:51], s95 offen lds
  buffer_load_dwordx4 v8, s[48:51], s95 offen offset:1024 lds
  v_mfma_f32_32x32x16_bf16 v[136:151], a[48:51], a[172:175], v[136:151]
  ds_read_b64_tr_b16 a[12:13], v26 offset:128
  ds_read_b64_tr_b16 a[14:15], v26 offset:1024
  buffer_load_dwordx4 v9, s[48:51], s95 offen offset:2048 lds
  buffer_load_dwordx4 v10, s[48:51], s95 offen offset:3072 lds
  v_mfma_f32_32x32x16_bf16 v[152:167], a[52:55], a[172:175], v[152:167]
  ds_read_b64_tr_b16 a[16:17], v26 offset:160
  ds_read_b64_tr_b16 a[18:19], v26 offset:1056
  s_add_u32 m0, s83, 0x1000
  s_nop 0
  buffer_load_dwordx4 v11, s[48:51], s95 offen lds
  v_mfma_f32_32x32x16_bf16 v[168:183], a[56:59], a[172:175], v[168:183]
  ds_read_b64_tr_b16 a[20:21], v26 offset:192
  ds_read_b64_tr_b16 a[22:23], v26 offset:1088
  buffer_load_dwordx4 v12, s[48:51], s95 offen offset:1024 lds
  buffer_load_dwordx4 v13, s[48:51], s95 offen offset:2048 lds
  s_waitcnt lgkmcnt(8)
  v_mfma_f32_32x32x16_bf16 v[72:87], a[60:63], a[176:179], v[72:87]
  v_add_u32 v27, 0x8000, v27
  ds_read_b64_tr_b16 a[24:25], v27
  ds_read_b64_tr_b16 a[26:27], v27 offset:896
  s_add_u32 m0, s83, 0x8000
  v_mfma_f32_32x32x16_bf16 v[88:103], a[0:3], a[176:179], v[88:103]
  ds_read_b64_tr_b16 a[28:29], v27 offset:32
  ds_read_b64_tr_b16 a[30:31], v27 offset:928
  s_add_u32 s95, s19, 7
  s_and_b32 s95, s95, 7
  v_mfma_f32_32x32x16_bf16 v[104:119], a[4:7], a[176:179], v[104:119]
  ds_read_b64_tr_b16 a[32:33], v27 offset:64
  ds_read_b64_tr_b16 a[34:35], v27 offset:960
  s_mul_i32 s95, s95, 0x38000
  s_add_u32 s95, s95, s78
  s_waitcnt lgkmcnt(6)
  v_mfma_f32_32x32x16_bf16 v[120:135], a[8:11], a[176:179], v[120:135]
  ds_read_b64_tr_b16 a[36:37], v27 offset:96
  ds_read_b64_tr_b16 a[38:39], v27 offset:992
  buffer_load_dwordx4 v7, s[48:51], s95 offen lds
  buffer_load_dwordx4 v8, s[48:51], s95 offen offset:1024 lds
  v_mfma_f32_32x32x16_bf16 v[136:151], a[12:15], a[176:179], v[136:151]
  ds_read_b64_tr_b16 a[40:41], v27 offset:128
  ds_read_b64_tr_b16 a[42:43], v27 offset:1024
  buffer_load_dwordx4 v9, s[48:51], s95 offen offset:2048 lds
  buffer_load_dwordx4 v10, s[48:51], s95 offen offset:3072 lds
  v_mfma_f32_32x32x16_bf16 v[152:167], a[16:19], a[176:179], v[152:167]
  ds_read_b64_tr_b16 a[44:45], v27 offset:160
  ds_read_b64_tr_b16 a[46:47], v27 offset:1056
  s_add_u32 m0, s83, 0x9000
  s_nop 0
  buffer_load_dwordx4 v11, s[48:51], s95 offen lds
  v_mfma_f32_32x32x16_bf16 v[168:183], a[20:23], a[176:179], v[168:183]
  ds_read_b64_tr_b16 a[48:49], v27 offset:192
  ds_read_b64_tr_b16 a[50:51], v27 offset:1088
  buffer_load_dwordx4 v12, s[48:51], s95 offen offset:1024 lds
  buffer_load_dwordx4 v13, s[48:51], s95 offen offset:2048 lds
  s_waitcnt lgkmcnt(6)
  v_mfma_f32_32x32x16_bf16 v[72:87], a[24:27], a[180:183], v[72:87]
  v_add_u32 v28, 0x8000, v28
  ds_read_b64_tr_b16 a[52:53], v28
  ds_read_b64_tr_b16 a[54:55], v28 offset:896
  v_mfma_f32_32x32x16_bf16 v[88:103], a[28:31], a[180:183], v[88:103]
  ds_read_b64_tr_b16 a[56:57], v28 offset:32
  ds_read_b64_tr_b16 a[58:59], v28 offset:928
  v_mfma_f32_32x32x16_bf16 v[104:119], a[32:35], a[180:183], v[104:119]
  ds_read_b64_tr_b16 a[60:61], v28 offset:64
  ds_read_b64_tr_b16 a[62:63], v28 offset:960
  buffer_load_dwordx2 v[36:37], v30, s[60:63], 0 offen sc1
  v_mfma_f32_32x32x16_bf16 v[120:135], a[36:39], a[180:183], v[120:135]
  ds_read_b64_tr_b16 a[0:1], v28 offset:96
  ds_read_b64_tr_b16 a[2:3], v28 offset:992
  s_waitcnt lgkmcnt(6)
  v_mfma_f32_32x32x16_bf16 v[136:151], a[40:43], a[180:183], v[136:151]
  ds_read_b64_tr_b16 a[4:5], v28 offset:128
  ds_read_b64_tr_b16 a[6:7], v28 offset:1024
  v_mfma_f32_32x32x16_bf16 v[152:167], a[44:47], a[180:183], v[152:167]
  ds_read_b64_tr_b16 a[8:9], v28 offset:160
  ds_read_b64_tr_b16 a[10:11], v28 offset:1056
  v_mfma_f32_32x32x16_bf16 v[168:183], a[48:51], a[180:183], v[168:183]
  ds_read_b64_tr_b16 a[12:13], v28 offset:192
  ds_read_b64_tr_b16 a[14:15], v28 offset:1088
  v_mfma_f32_32x32x16_bf16 v[72:87], a[52:55], a[184:187], v[72:87]
  v_add_u32 v29, 0x8000, v29
  ds_read_b64_tr_b16 a[16:17], v29
  ds_read_b64_tr_b16 a[18:19], v29 offset:896
  s_waitcnt lgkmcnt(6)
  v_mfma_f32_32x32x16_bf16 v[88:103], a[56:59], a[184:187], v[88:103]
  ds_read_b64_tr_b16 a[20:21], v29 offset:32
  ds_read_b64_tr_b16 a[22:23], v29 offset:928
  v_mfma_f32_32x32x16_bf16 v[104:119], a[60:63], a[184:187], v[104:119]
  ds_read_b64_tr_b16 a[24:25], v29 offset:64
  ds_read_b64_tr_b16 a[26:27], v29 offset:960
  v_mfma_f32_32x32x16_bf16 v[120:135], a[0:3], a[184:187], v[120:135]
  ds_read_b64_tr_b16 a[28:29], v29 offset:96
  ds_read_b64_tr_b16 a[30:31], v29 offset:992
  v_mfma_f32_32x32x16_bf16 v[136:151], a[4:7], a[184:187], v[136:151]
  ds_read_b64_tr_b16 a[32:33], v29 offset:128
  ds_read_b64_tr_b16 a[34:35], v29 offset:1024
  ds_read_b64_tr_b16 a[36:37], v29 offset:160
  ds_read_b64_tr_b16 a[38:39], v29 offset:1056
  ds_read_b64_tr_b16 a[40:41], v29 offset:192
  ds_read_b64_tr_b16 a[42:43], v29 offset:1088
  s_waitcnt lgkmcnt(10)
  v_mfma_f32_32x32x16_bf16 v[152:167], a[8:11], a[184:187], v[152:167]
  v_mfma_f32_32x32x16_bf16 v[168:183], a[12:15], a[184:187], v[168:183]
  s_waitcnt lgkmcnt(0)
  s_barrier
  v_mfma_f32_32x32x16_bf16 v[72:87], a[16:19], a[188:191], v[72:87]
  v_add_u32 v26, 0x8000, v26
  ds_read_b64_tr_b16 a[44:45], v26
  ds_read_b64_tr_b16 a[46:47], v26 offset:896
  v_mfma_f32_32x32x16_bf16 v[88:103], a[20:23], a[188:191], v[88:103]
  ds_read_b64_tr_b16 a[48:49], v26 offset:32
  ds_read_b64_tr_b16 a[50:51], v26 offset:928
  s_add_u32 s95, s98, 0x500
  v_mfma_f32_32x32x16_bf16 v[104:119], a[24:27], a[188:191], v[104:119]
  ds_read_b64_tr_b16 a[52:53], v26 offset:64
  ds_read_b64_tr_b16 a[54:55], v26 offset:960
  s_and_b32 s95, s95, 0x7ff
  v_mfma_f32_32x32x16_bf16 v[120:135], a[28:31], a[188:191], v[120:135]
  ds_read_b64_tr_b16 a[56:57], v26 offset:96
  ds_read_b64_tr_b16 a[58:59], v26 offset:992
  s_add_u32 s95, s95, s80
  v_mfma_f32_32x32x16_bf16 v[136:151], a[32:35], a[188:191], v[136:151]
  ds_read_b64_tr_b16 a[60:61], v26 offset:128
  ds_read_b64_tr_b16 a[62:63], v26 offset:1024
  v_mfma_f32_32x32x16_bf16 v[152:167], a[36:39], a[188:191], v[152:167]
  ds_read_b64_tr_b16 a[0:1], v26 offset:160
  ds_read_b64_tr_b16 a[2:3], v26 offset:1056
  s_add_u32 m0, s72, 0x10000
  v_mfma_f32_32x32x16_bf16 v[168:183], a[40:43], a[188:191], v[168:183]
  ds_read_b64_tr_b16 a[4:5], v26 offset:192
  ds_read_b64_tr_b16 a[6:7], v26 offset:1088
  buffer_load_dwordx4 v22, s[52:55], s95 offen lds
  s_waitcnt lgkmcnt(8)
  v_mfma_f32_32x32x16_bf16 v[72:87], a[44:47], a[192:195], v[72:87]
  v_add_u32 v27, 0x8000, v27
  ds_read_b64_tr_b16 a[8:9], v27
  ds_read_b64_tr_b16 a[10:11], v27 offset:896
  buffer_load_dwordx4 v23, s[52:55], s95 offen offset:1024 lds
  v_mfma_f32_32x32x16_bf16 v[88:103], a[48:51], a[192:195], v[88:103]
  ds_read_b64_tr_b16 a[12:13], v27 offset:32
  ds_read_b64_tr_b16 a[14:15], v27 offset:928
  v_mfma_f32_32x32x16_bf16 v[104:119], a[52:55], a[192:195], v[104:119]
  ds_read_b64_tr_b16 a[16:17], v27 offset:64
  ds_read_b64_tr_b16 a[18:19], v27 offset:960
  buffer_load_dwordx4 v24, s[52:55], s95 offen offset:2048 lds
  s_waitcnt lgkmcnt(6)
  v_mfma_f32_32x32x16_bf16 v[120:135], a[56:59], a[192:195], v[120:135]
  ds_read_b64_tr_b16 a[20:21], v27 offset:96
  ds_read_b64_tr_b16 a[22:23], v27 offset:992
  buffer_load_dwordx4 v25, s[52:55], s95 offen offset:3072 lds
  v_mfma_f32_32x32x16_bf16 v[136:151], a[60:63], a[192:195], v[136:151]
  ds_read_b64_tr_b16 a[24:25], v27 offset:128
  ds_read_b64_tr_b16 a[26:27], v27 offset:1024
  s_add_u32 m0, s72, 0x14000
  v_mfma_f32_32x32x16_bf16 v[152:167], a[0:3], a[192:195], v[152:167]
  ds_read_b64_tr_b16 a[28:29], v27 offset:160
  ds_read_b64_tr_b16 a[30:31], v27 offset:1056
  v_mfma_f32_32x32x16_bf16 v[168:183], a[4:7], a[192:195], v[168:183]
  ds_read_b64_tr_b16 a[32:33], v27 offset:192
  ds_read_b64_tr_b16 a[34:35], v27 offset:1088
  s_add_u32 s95, s95, 0x80
  s_waitcnt lgkmcnt(6)
  v_mfma_f32_32x32x16_bf16 v[72:87], a[8:11], a[196:199], v[72:87]
  v_add_u32 v28, 0x8000, v28
  ds_read_b64_tr_b16 a[36:37], v28
  ds_read_b64_tr_b16 a[38:39], v28 offset:896
  buffer_load_dwordx4 v22, s[52:55], s95 offen lds
  v_mfma_f32_32x32x16_bf16 v[88:103], a[12:15], a[196:199], v[88:103]
  ds_read_b64_tr_b16 a[40:41], v28 offset:32
  ds_read_b64_tr_b16 a[42:43], v28 offset:928
  buffer_load_dwordx4 v23, s[52:55], s95 offen offset:1024 lds
  v_mfma_f32_32x32x16_bf16 v[104:119], a[16:19], a[196:199], v[104:119]
  ds_read_b64_tr_b16 a[44:45], v28 offset:64
  ds_read_b64_tr_b16 a[46:47], v28 offset:960
  v_mfma_f32_32x32x16_bf16 v[120:135], a[20:23], a[196:199], v[120:135]
  ds_read_b64_tr_b16 a[48:49], v28 offset:96
  ds_read_b64_tr_b16 a[50:51], v28 offset:992
  buffer_load_dwordx4 v24, s[52:55], s95 offen offset:2048 lds
  s_waitcnt lgkmcnt(6)
  v_mfma_f32_32x32x16_bf16 v[136:151], a[24:27], a[196:199], v[136:151]
  ds_read_b64_tr_b16 a[52:53], v28 offset:128
  ds_read_b64_tr_b16 a[54:55], v28 offset:1024
  buffer_load_dwordx4 v25, s[52:55], s95 offen offset:3072 lds
  v_mfma_f32_32x32x16_bf16 v[152:167], a[28:31], a[196:199], v[152:167]
  ds_read_b64_tr_b16 a[56:57], v28 offset:160
  ds_read_b64_tr_b16 a[58:59], v28 offset:1056
  v_mfma_f32_32x32x16_bf16 v[168:183], a[32:35], a[196:199], v[168:183]
  ds_read_b64_tr_b16 a[60:61], v28 offset:192
  ds_read_b64_tr_b16 a[62:63], v28 offset:1088
  v_mfma_f32_32x32x16_bf16 v[72:87], a[36:39], a[200:203], v[72:87]
  v_add_u32 v29, 0x8000, v29
  ds_read_b64_tr_b16 a[0:1], v29
  ds_read_b64_tr_b16 a[2:3], v29 offset:896
  s_waitcnt lgkmcnt(6)
  v_mfma_f32_32x32x16_bf16 v[88:103], a[40:43], a[200:203], v[88:103]
  ds_read_b64_tr_b16 a[4:5], v29 offset:32
  ds_read_b64_tr_b16 a[6:7], v29 offset:928
  v_mfma_f32_32x32x16_bf16 v[104:119], a[44:47], a[200:203], v[104:119]
  ds_read_b64_tr_b16 a[8:9], v29 offset:64
  ds_read_b64_tr_b16 a[10:11], v29 offset:960
  v_mfma_f32_32x32x16_bf16 v[120:135], a[48:51], a[200:203], v[120:135]
  ds_read_b64_tr_b16 a[12:13], v29 offset:96
  ds_read_b64_tr_b16 a[14:15], v29 offset:992
  v_mfma_f32_32x32x16_bf16 v[136:151], a[52:55], a[200:203], v[136:151]
  ds_read_b64_tr_b16 a[16:17], v29 offset:128
  ds_read_b64_tr_b16 a[18:19], v29 offset:1024
  ds_read_b64_tr_b16 a[20:21], v29 offset:160
  ds_read_b64_tr_b16 a[22:23], v29 offset:1056
  ds_read_b64_tr_b16 a[24:25], v29 offset:192
  ds_read_b64_tr_b16 a[26:27], v29 offset:1088
  s_waitcnt lgkmcnt(10)
  v_mfma_f32_32x32x16_bf16 v[152:167], a[56:59], a[200:203], v[152:167]
  v_mfma_f32_32x32x16_bf16 v[168:183], a[60:63], a[200:203], v[168:183]
  s_waitcnt vmcnt(25) lgkmcnt(0)
  s_barrier
  v_mfma_f32_32x32x16_bf16 v[72:87], a[0:3], a[204:207], v[72:87]
  v_add_u32 v26, 0x8000, v26
  ds_read_b64_tr_b16 a[28:29], v26
  ds_read_b64_tr_b16 a[30:31], v26 offset:896
  s_waitcnt vmcnt(8)
  v_cmp_eq_u64 vcc, v[36:37], v[34:35]
  s_nop 0
  s_cmp_eq_u64 vcc, -1
  s_cbranch_scc0 L1_slow_ka
L1_res_ka:
  v_mfma_f32_32x32x16_bf16 v[88:103], a[4:7], a[204:207], v[88:103]
  ds_read_b64_tr_b16 a[32:33], v26 offset:32
  ds_read_b64_tr_b16 a[34:35], v26 offset:928
  s_add_u32 s25, s100, 0
  v_mfma_f32_32x32x16_bf16 v[104:119], a[8:11], a[204:207], v[104:119]
  ds_read_b64_tr_b16 a[36:37], v26 offset:64
  ds_read_b64_tr_b16 a[38:39], v26 offset:960
  s_and_b32 s25, s25, 0xffff
  v_mfma_f32_32x32x16_bf16 v[120:135], a[12:15], a[204:207], v[120:135]
  ds_read_b64_tr_b16 a[40:41], v26 offset:96
  ds_read_b64_tr_b16 a[42:43], v26 offset:992
  s_add_u32 s25, s25, s79
  v_mfma_f32_32x32x16_bf16 v[136:151], a[16:19], a[204:207], v[136:151]
  ds_read_b64_tr_b16 a[44:45], v26 offset:128
  ds_read_b64_tr_b16 a[46:47], v26 offset:1024
  buffer_load_dwordx4 a[64:67], v1, s[60:63], s25 offen sc1
  v_mfma_f32_32x32x16_bf16 v[152:167], a[20:23], a[204:207], v[152:167]
  ds_read_b64_tr_b16 a[48:49], v26 offset:160
  ds_read_b64_tr_b16 a[50:51], v26 offset:1056
  v_mfma_f32_32x32x16_bf16 v[168:183], a[24:27], a[204:207], v[168:183]
  ds_read_b64_tr_b16 a[52:53], v26 offset:192
  ds_read_b64_tr_b16 a[54:55], v26 offset:1088
  buffer_load_dwordx4 a[68:71], v1, s[60:63], s25 offen offset:1024 sc1
  s_waitcnt lgkmcnt(8)
  v_mfma_f32_32x32x16_bf16 v[72:87], a[28:31], a[208:211], v[72:87]
  v_add_u32 v27, 0x8000, v27
  ds_read_b64_tr_b16 a[56:57], v27
  ds_read_b64_tr_b16 a[58:59], v27 offset:896
  buffer_load_dwordx4 a[72:75], v1, s[60:63], s25 offen offset:2048 sc1
  v_mfma_f32_32x32x16_bf16 v[88:103], a[32:35], a[208:211], v[88:103]
  ds_read_b64_tr_b16 a[60:61], v27 offset:32
  ds_read_b64_tr_b16 a[62:63], v27 offset:928
  buffer_load_dwordx4 a[76:79], v1, s[60:63], s25 offen offset:3072 sc1
  v_mfma_f32_32x32x16_bf16 v[104:119], a[36:39], a[208:211], v[104:119]
  ds_read_b64_tr_b16 a[0:1], v27 offset:64
  ds_read_b64_tr_b16 a[2:3], v27 offset:960
  s_add_u32 s25, s25, 0x1000
  s_waitcnt lgkmcnt(6)
  v_mfma_f32_32x32x16_bf16 v[120:135], a[40:43], a[208:211], v[120:135]
  ds_read_b64_tr_b16 a[4:5], v27 offset:96
  ds_read_b64_tr_b16 a[6:7], v27 offset:992
  buffer_load_dwordx4 a[80:83], v1, s[60:63], s25 offen sc1
  v_mfma_f32_32x32x16_bf16 v[136:151], a[44:47], a[208:211], v[136:151]
  ds_read_b64_tr_b16 a[8:9], v27 offset:128
  ds_read_b64_tr_b16 a[10:11], v27 offset:1024
  buffer_load_dwordx4 a[84:87], v1, s[60:63], s25 offen offset:1024 sc1
  v_mfma_f32_32x32x16_bf16 v[152:167], a[48:51], a[208:211], v[152:167]
  ds_read_b64_tr_b16 a[12:13], v27 offset:160
  ds_read_b64_tr_b16 a[14:15], v27 offset:1056
  v_mfma_f32_32x32x16_bf16 v[168:183], a[52:55], a[208:211], v[168:183]
  ds_read_b64_tr_b16 a[16:17], v27 offset:192
  ds_read_b64_tr_b16 a[18:19], v27 offset:1088
  buffer_load_dwordx4 a[88:91], v1, s[60:63], s25 offen offset:2048 sc1
  s_waitcnt lgkmcnt(6)
  v_mfma_f32_32x32x16_bf16 v[72:87], a[56:59], a[212:215], v[72:87]
  v_add_u32 v28, 0x8000, v28
  ds_read_b64_tr_b16 a[20:21], v28
  ds_read_b64_tr_b16 a[22:23], v28 offset:896
  buffer_load_dwordx4 a[92:95], v1, s[60:63], s25 offen offset:3072 sc1
  v_mfma_f32_32x32x16_bf16 v[88:103], a[60:63], a[212:215], v[88:103]
  ds_read_b64_tr_b16 a[24:25], v28 offset:32
  ds_read_b64_tr_b16 a[26:27], v28 offset:928
  v_mov_b32 v68, 0x7fff0000
  v_mfma_f32_32x32x16_bf16 v[104:119], a[0:3], a[212:215], v[104:119]
  ds_read_b64_tr_b16 a[28:29], v28 offset:64
  ds_read_b64_tr_b16 a[30:31], v28 offset:960
  v_cmp_gt_u32 vcc, 0x380, v1
  s_nop 1
  v_cndmask_b32 v68, v68, v1, vcc
  v_mfma_f32_32x32x16_bf16 v[120:135], a[4:7], a[212:215], v[120:135]
  ds_read_b64_tr_b16 a[32:33], v28 offset:96
  ds_read_b64_tr_b16 a[34:35], v28 offset:992
  s_add_u32 s14, s20, 0x1000
  s_waitcnt lgkmcnt(6)
  v_mfma_f32_32x32x16_bf16 v[136:151], a[8:11], a[212:215], v[136:151]
  ds_read_b64_tr_b16 a[36:37], v28 offset:128
  ds_read_b64_tr_b16 a[38:39], v28 offset:1024
  buffer_load_dwordx4 v[216:219], v68, s[60:63], s20 offen sc1
  v_mfma_f32_32x32x16_bf16 v[152:167], a[12:15], a[212:215], v[152:167]
  ds_read_b64_tr_b16 a[40:41], v28 offset:160
  ds_read_b64_tr_b16 a[42:43], v28 offset:1056
  v_mfma_f32_32x32x16_bf16 v[168:183], a[16:19], a[212:215], v[168:183]
  ds_read_b64_tr_b16 a[44:45], v28 offset:192
  ds_read_b64_tr_b16 a[46:47], v28 offset:1088
  buffer_load_dwordx4 v[220:223], v68, s[60:63], s20 offen offset:1024 sc1
  v_mfma_f32_32x32x16_bf16 v[72:87], a[20:23], a[216:219], v[72:87]
  v_add_u32 v29, 0x8000, v29
  ds_read_b64_tr_b16 a[48:49], v29
  ds_read_b64_tr_b16 a[50:51], v29 offset:896
  buffer_load_dwordx4 v[224:227], v68, s[60:63], s20 offen offset:2048 sc1
  s_waitcnt lgkmcnt(6)
  v_mfma_f32_32x32x16_bf16 v[88:103], a[24:27], a[216:219], v[88:103]
  ds_read_b64_tr_b16 a[52:53], v29 offset:32
  ds_read_b64_tr_b16 a[54:55], v29 offset:928
  buffer_load_dwordx4 v[228:231], v68, s[60:63], s20 offen offset:3072 sc1
  v_mfma_f32_32x32x16_bf16 v[104:119], a[28:31], a[216:219], v[104:119]
  ds_read_b64_tr_b16 a[56:57], v29 offset:64
  ds_read_b64_tr_b16 a[58:59], v29 offset:960
  buffer_load_dwordx4 v[232:235], v68, s[60:63], s14 offen sc1
  v_mfma_f32_32x32x16_bf16 v[120:135], a[32:35], a[216:219], v[120:135]
  ds_read_b64_tr_b16 a[60:61], v29 offset:96
  ds_read_b64_tr_b16 a[62:63], v29 offset:992
  buffer_load_dwordx4 v[236:239], v68, s[60:63], s14 offen offset:1024 sc1
  v_mfma_f32_32x32x16_bf16 v[136:151], a[36:39], a[216:219], v[136:151]
  ds_read_b64_tr_b16 a[0:1], v29 offset:128
  ds_read_b64_tr_b16 a[2:3], v29 offset:1024
  ds_read_b64_tr_b16 a[4:5], v29 offset:160
  ds_read_b64_tr_b16 a[6:7], v29 offset:1056
  ds_read_b64_tr_b16 a[8:9], v29 offset:192
  ds_read_b64_tr_b16 a[10:11], v29 offset:1088
  buffer_load_dwordx4 v[240:243], v68, s[60:63], s14 offen offset:2048 sc1
  s_waitcnt lgkmcnt(10)
  v_mfma_f32_32x32x16_bf16 v[152:167], a[40:43], a[216:219], v[152:167]
  v_mfma_f32_32x32x16_bf16 v[168:183], a[44:47], a[216:219], v[168:183]
  buffer_load_dwordx4 v[244:247], v68, s[60:63], s14 offen offset:3072 sc1
  s_waitcnt lgkmcnt(0)
  s_barrier
  v_mfma_f32_32x32x16_bf16 v[72:87], a[48:51], a[220:223], v[72:87]
  v_subrev_u32 v26, 0x20000, v26
  ds_read_b64_tr_b16 a[12:13], v26
  ds_read_b64_tr_b16 a[14:15], v26 offset:896
  s_add_u32 s95, s98, 0
  s_and_b32 s95, s95, 0x7ff
  v_mfma_f32_32x32x16_bf16 v[88:103], a[52:55], a[220:223], v[88:103]
  ds_read_b64_tr_b16 a[16:17], v26 offset:32
  ds_read_b64_tr_b16 a[18:19], v26 offset:928
  s_add_u32 s95, s95, s80
  s_add_u32 m0, s72, 0x18000
  v_mfma_f32_32x32x16_bf16 v[104:119], a[56:59], a[220:223], v[104:119]
  ds_read_b64_tr_b16 a[20:21], v26 offset:64
  ds_read_b64_tr_b16 a[22:23], v26 offset:960
  buffer_load_dwordx4 v22, s[52:55], s95 offen lds
  buffer_load_dwordx4 v23, s[52:55], s95 offen offset:1024 lds
  v_mfma_f32_32x32x16_bf16 v[120:135], a[60:63], a[220:223], v[120:135]
  ds_read_b64_tr_b16 a[24:25], v26 offset:96
  ds_read_b64_tr_b16 a[26:27], v26 offset:992
  buffer_load_dwordx4 v24, s[52:55], s95 offen offset:2048 lds
  buffer_load_dwordx4 v25, s[52:55], s95 offen offset:3072 lds
  v_mfma_f32_32x32x16_bf16 v[136:151], a[0:3], a[220:223], v[136:151]
  ds_read_b64_tr_b16 a[28:29], v26 offset:128
  ds_read_b64_tr_b16 a[30:31], v26 offset:1024
  s_add_u32 m0, s72, 0x1c000
  s_add_u32 s95, s95, 0x80
  v_mfma_f32_32x32x16_bf16 v[152:167], a[4:7], a[220:223], v[152:167]
  ds_read_b64_tr_b16 a[32:33], v26 offset:160
  ds_read_b64_tr_b16 a[34:35], v26 offset:1056
  buffer_load_dwordx4 v22, s[52:55], s95 offen lds
  buffer_load_dwordx4 v23, s[52:55], s95 offen offset:1024 lds
  v_mfma_f32_32x32x16_bf16 v[168:183], a[8:11], a[220:223], v[168:183]
  ds_read_b64_tr_b16 a[36:37], v26 offset:192
  ds_read_b64_tr_b16 a[38:39], v26 offset:1088
  buffer_load_dwordx4 v24, s[52:55], s95 offen offset:2048 lds
  buffer_load_dwordx4 v25, s[52:55], s95 offen offset:3072 lds
  s_waitcnt lgkmcnt(8)
  v_mfma_f32_32x32x16_bf16 v[72:87], a[12:15], a[224:227], v[72:87]
  v_subrev_u32 v27, 0x20000, v27
  ds_read_b64_tr_b16 a[40:41], v27
  ds_read_b64_tr_b16 a[42:43], v27 offset:896
  s_add_u32 s95, s98, 0x100
  s_and_b32 s95, s95, 0x7ff
  v_lshlrev_b32 v69, 3, v47
  v_lshrrev_b32 v71, 5, v0
  v_mfma_f32_32x32x16_bf16 v[88:103], a[16:19], a[224:227], v[88:103]
  ds_read_b64_tr_b16 a[44:45], v27 offset:32
  ds_read_b64_tr_b16 a[46:47], v27 offset:928
  s_add_u32 s95, s95, s80
  s_add_u32 m0, s72, 0x20000
  v_bfe_u32 v70, v0, 1, 3
  v_xor_b32 v70, v70, v71
  v_mfma_f32_32x32x16_bf16 v[104:119], a[20:23], a[224:227], v[104:119]
  ds_read_b64_tr_b16 a[48:49], v27 offset:64
  ds_read_b64_tr_b16 a[50:51], v27 offset:960
  buffer_load_dwordx4 v22, s[52:55], s95 offen lds
  buffer_load_dwordx4 v23, s[52:55], s95 offen offset:1024 lds
  v_xor_b32 v71, 0, v70
  v_lshl_add_u32 v7, v71, 4, v69
  s_waitcnt lgkmcnt(6)
  v_mfma_f32_32x32x16_bf16 v[120:135], a[24:27], a[224:227], v[120:135]
  ds_read_b64_tr_b16 a[52:53], v27 offset:96
  ds_read_b64_tr_b16 a[54:55], v27 offset:992
  buffer_load_dwordx4 v24, s[52:55], s95 offen offset:2048 lds
  buffer_load_dwordx4 v25, s[52:55], s95 offen offset:3072 lds
  v_add_u32 v11, 0x10000, v7
  v_add_u32 v15, 0x20000, v7
  v_mfma_f32_32x32x16_bf16 v[136:151], a[28:31], a[224:227], v[136:151]
  ds_read_b64_tr_b16 a[56:57], v27 offset:128
  ds_read_b64_tr_b16 a[58:59], v27 offset:1024
  s_add_u32 m0, s72, 0x24000
  s_add_u32 s95, s95, 0x80
  v_xor_b32 v71, 2, v70
  v_lshl_add_u32 v8, v71, 4, v69
  v_mfma_f32_32x32x16_bf16 v[152:167], a[32:35], a[224:227], v[152:167]
  ds_read_b64_tr_b16 a[60:61], v27 offset:160
  ds_read_b64_tr_b16 a[62:63], v27 offset:1056
  buffer_load_dwordx4 v22, s[52:55], s95 offen lds
  buffer_load_dwordx4 v23, s[52:55], s95 offen offset:1024 lds
  v_add_u32 v12, 0x10000, v8
  v_add_u32 v16, 0x20000, v8
  v_mfma_f32_32x32x16_bf16 v[168:183], a[36:39], a[224:227], v[168:183]
  ds_read_b64_tr_b16 a[0:1], v27 offset:192
  ds_read_b64_tr_b16 a[2:3], v27 offset:1088
  buffer_load_dwordx4 v24, s[52:55], s95 offen offset:2048 lds
  buffer_load_dwordx4 v25, s[52:55], s95 offen offset:3072 lds
  v_xor_b32 v71, 4, v70
  v_lshl_add_u32 v9, v71, 4, v69
  s_waitcnt lgkmcnt(6)
  v_mfma_f32_32x32x16_bf16 v[72:87], a[40:43], a[228:231], v[72:87]
  v_subrev_u32 v28, 0x20000, v28
  ds_read_b64_tr_b16 a[4:5], v28
  ds_read_b64_tr_b16 a[6:7], v28 offset:896
  s_add_u32 s25, s100, 0x2000
  s_and_b32 s25, s25, 0xffff
  v_add_u32 v13, 0x10000, v9
  v_add_u32 v17, 0x20000, v9
  v_mfma_f32_32x32x16_bf16 v[88:103], a[44:47], a[228:231], v[88:103]
  ds_read_b64_tr_b16 a[8:9], v28 offset:32
  ds_read_b64_tr_b16 a[10:11], v28 offset:928
  s_add_u32 s25, s25, s79
  buffer_load_dwordx4 a[96:99], v1, s[60:63], s25 offen sc1
  v_xor_b32 v71, 6, v70
  v_lshl_add_u32 v10, v71, 4, v69
  v_mfma_f32_32x32x16_bf16 v[104:119], a[48:51], a[228:231], v[104:119]
  ds_read_b64_tr_b16 a[12:13], v28 offset:64
  ds_read_b64_tr_b16 a[14:15], v28 offset:960
  buffer_load_dwordx4 a[100:103], v1, s[60:63], s25 offen offset:1024 sc1
  buffer_load_dwordx4 a[104:107], v1, s[60:63], s25 offen offset:2048 sc1
  v_add_u32 v14, 0x10000, v10
  v_add_u32 v18, 0x20000, v10
  v_mfma_f32_32x32x16_bf16 v[120:135], a[52:55], a[228:231], v[120:135]
  ds_read_b64_tr_b16 a[16:17], v28 offset:96
  ds_read_b64_tr_b16 a[18:19], v28 offset:992
  buffer_load_dwordx4 a[108:111], v1, s[60:63], s25 offen offset:3072 sc1
  s_add_u32 s25, s25, 0x1000
  s_waitcnt lgkmcnt(6)
  v_mfma_f32_32x32x16_bf16 v[136:151], a[56:59], a[228:231], v[136:151]
  ds_read_b64_tr_b16 a[20:21], v28 offset:128
  ds_read_b64_tr_b16 a[22:23], v28 offset:1024
  buffer_load_dwordx4 a[112:115], v1, s[60:63], s25 offen sc1
  buffer_load_dwordx4 a[116:119], v1, s[60:63], s25 offen offset:1024 sc1
  v_mfma_f32_32x32x16_bf16 v[152:167], a[60:63], a[228:231], v[152:167]
  ds_read_b64_tr_b16 a[24:25], v28 offset:160
  ds_read_b64_tr_b16 a[26:27], v28 offset:1056
  buffer_load_dwordx4 a[120:123], v1, s[60:63], s25 offen offset:2048 sc1
  buffer_load_dwordx4 a[124:127], v1, s[60:63], s25 offen offset:3072 sc1
  v_mfma_f32_32x32x16_bf16 v[168:183], a[0:3], a[228:231], v[168:183]
  ds_read_b64_tr_b16 a[28:29], v28 offset:192
  ds_read_b64_tr_b16 a[30:31], v28 offset:1088
  v_mfma_f32_32x32x16_bf16 v[72:87], a[4:7], a[232:235], v[72:87]
  v_subrev_u32 v29, 0x20000, v29
  ds_read_b64_tr_b16 a[32:33], v29
  ds_read_b64_tr_b16 a[34:35], v29 offset:896
  s_add_u32 s25, s100, 0x4000
  s_and_b32 s25, s25, 0xffff
  s_waitcnt lgkmcnt(6)
  v_mfma_f32_32x32x16_bf16 v[88:103], a[8:11], a[232:235], v[88:103]
  ds_read_b64_tr_b16 a[36:37], v29 offset:32
  ds_read_b64_tr_b16 a[38:39], v29 offset:928
  s_add_u32 s25, s25, s79
  buffer_load_dwordx4 a[128:131], v1, s[60:63], s25 offen sc1
  v_mfma_f32_32x32x16_bf16 v[104:119], a[12:15], a[232:235], v[104:119]
  ds_read_b64_tr_b16 a[40:41], v29 offset:64
  ds_read_b64_tr_b16 a[42:43], v29 offset:960
  buffer_load_dwordx4 a[132:135], v1, s[60:63], s25 offen offset:1024 sc1
  buffer_load_dwordx4 a[136:139], v1, s[60:63], s25 offen offset:2048 sc1
  buffer_load_dwordx4 a[140:143], v1, s[60:63], s25 offen offset:3072 sc1
  v_mfma_f32_32x32x16_bf16 v[120:135], a[16:19], a[232:235], v[120:135]
  ds_read_b64_tr_b16 a[44:45], v29 offset:96
  ds_read_b64_tr_b16 a[46:47], v29 offset:992
  s_add_u32 s25, s25, 0x1000
  buffer_load_dwordx4 a[144:147], v1, s[60:63], s25 offen sc1
  v_mfma_f32_32x32x16_bf16 v[136:151], a[20:23], a[232:235], v[136:151]
  ds_read_b64_tr_b16 a[48:49], v29 offset:128
  ds_read_b64_tr_b16 a[50:51], v29 offset:1024
  ds_read_b64_tr_b16 a[52:53], v29 offset:160
  ds_read_b64_tr_b16 a[54:55], v29 offset:1056
  ds_read_b64_tr_b16 a[56:57], v29 offset:192
  ds_read_b64_tr_b16 a[58:59], v29 offset:1088
  buffer_load_dwordx4 a[148:151], v1, s[60:63], s25 offen offset:1024 sc1
  buffer_load_dwordx4 a[152:155], v1, s[60:63], s25 offen offset:2048 sc1
  s_waitcnt lgkmcnt(10)
  v_mfma_f32_32x32x16_bf16 v[152:167], a[24:27], a[232:235], v[152:167]
  buffer_load_dwordx4 a[156:159], v1, s[60:63], s25 offen offset:3072 sc1
  v_mfma_f32_32x32x16_bf16 v[168:183], a[28:31], a[232:235], v[168:183]
  v_mov_b32 v60, 0
  v_mov_b32 v61, 0
  v_mov_b32 v62, 0
  v_mov_b32 v63, 0
  s_waitcnt vmcnt(39)
  v_dot2c_f32_bf16 v60, 0x3f803f80, v216
  v_dot2c_f32_bf16 v61, 0x3f803f80, v217
  v_dot2c_f32_bf16 v62, 0x3f803f80, v218
  v_dot2c_f32_bf16 v63, 0x3f803f80, v219
  s_waitcnt vmcnt(38)
  v_dot2c_f32_bf16 v60, 0x3f803f80, v220
  v_dot2c_f32_bf16 v61, 0x3f803f80, v221
  v_dot2c_f32_bf16 v62, 0x3f803f80, v222
  v_dot2c_f32_bf16 v63, 0x3f803f80, v223
  s_waitcnt vmcnt(37)
  v_dot2c_f32_bf16 v60, 0x3f803f80, v224
  v_dot2c_f32_bf16 v61, 0x3f803f80, v225
  v_dot2c_f32_bf16 v62, 0x3f803f80, v226
  v_dot2c_f32_bf16 v63, 0x3f803f80, v227
  s_waitcnt vmcnt(36)
  v_dot2c_f32_bf16 v60, 0x3f803f80, v228
  v_dot2c_f32_bf16 v61, 0x3f803f80, v229
  v_dot2c_f32_bf16 v62, 0x3f803f80, v230
  v_dot2c_f32_bf16 v63, 0x3f803f80, v231
  s_waitcnt vmcnt(35)
  v_dot2c_f32_bf16 v60, 0x3f803f80, v232
  v_dot2c_f32_bf16 v61, 0x3f803f80, v233
  v_dot2c_f32_bf16 v62, 0x3f803f80, v234
  v_dot2c_f32_bf16 v63, 0x3f803f80, v235
  s_waitcnt vmcnt(34)
  v_dot2c_f32_bf16 v60, 0x3f803f80, v236
  v_dot2c_f32_bf16 v61, 0x3f803f80, v237
  v_dot2c_f32_bf16 v62, 0x3f803f80, v238
  v_dot2c_f32_bf16 v63, 0x3f803f80, v239
  s_waitcnt vmcnt(33)
  v_dot2c_f32_bf16 v60, 0x3f803f80, v240
  v_dot2c_f32_bf16 v61, 0x3f803f80, v241
  v_dot2c_f32_bf16 v62, 0x3f803f80, v242
  v_dot2c_f32_bf16 v63, 0x3f803f80, v243
  s_waitcnt vmcnt(32)
  v_dot2c_f32_bf16 v60, 0x3f803f80, v244
  v_dot2c_f32_bf16 v61, 0x3f803f80, v245
  v_dot2c_f32_bf16 v62, 0x3f803f80, v246
  v_dot2c_f32_bf16 v63, 0x3f803f80, v247
  v_cvt_pk_bf16_f32 v64, v60, v60
  v_and_b32 v64, 0xffff0000, v64
  v_sub_f32 v64, v60, v64
  v_cvt_pk_bf16_f32 v64, v60, v64
  v_cvt_pk_bf16_f32 v65, v61, v61
  v_and_b32 v65, 0xffff0000, v65
  v_sub_f32 v65, v61, v65
  v_cvt_pk_bf16_f32 v65, v61, v65
  v_cvt_pk_bf16_f32 v66, v62, v62
  v_and_b32 v66, 0xffff0000, v66
  v_sub_f32 v66, v62, v66
  v_cvt_pk_bf16_f32 v66, v62, v66
  v_cvt_pk_bf16_f32 v67, v63, v63
  v_and_b32 v67, 0xffff0000, v67
  v_sub_f32 v67, v63, v67
  v_cvt_pk_bf16_f32 v67, v63, v67
  v_add_u32 v68, 0xf080, v1
  ds_write_b128 v68, v[64:67]
  v_lshrrev_b32 v68, 2, v47
  v_add_u32 v68, 0xf080, v68
  ds_read_b32 v216, v68
  ds_read_b32 v220, v68 offset:128
  ds_read_b32 v224, v68 offset:256
  ds_read_b32 v228, v68 offset:384
  ds_read_b32 v232, v68 offset:512
  ds_read_b32 v236, v68 offset:640
  ds_read_b32 v240, v68 offset:768
  v_mov_b32 v41, 0
  v_mov_b32 v42, 0
  v_mov_b32 v43, 0
  v_cmp_gt_u32 vcc, 32, v0
  s_nop 1
  v_cndmask_b32 v40, 0, v40, vcc
  s_waitcnt lgkmcnt(8)
  s_barrier
  v_mfma_f32_32x32x16_bf16 v[72:87], a[32:35], a[236:239], v[72:87]
  v_add_u32 v26, 0x8000, v26
  ds_read_b64_tr_b16 a[60:61], v26
  ds_read_b64_tr_b16 a[62:63], v26 offset:896
  s_add_u32 s95, s98, 0x200
  v_mfma_f32_32x32x16_bf16 v[88:103], a[36:39], a[236:239], v[88:103]
  ds_read_b64_tr_b16 a[0:1], v26 offset:32
  ds_read_b64_tr_b16 a[2:3], v26 offset:928
  s_and_b32 s95, s95, 0x7ff
  v_mfma_f32_32x32x16_bf16 v[104:119], a[40:43], a[236:239], v[104:119]
  ds_read_b64_tr_b16 a[4:5], v26 offset:64
  ds_read_b64_tr_b16 a[6:7], v26 offset:960
  s_add_u32 s95, s95, s80
  v_mfma_f32_32x32x16_bf16 v[120:135], a[44:47], a[236:239], v[120:135]
  ds_read_b64_tr_b16 a[8:9], v26 offset:96
  ds_read_b64_tr_b16 a[10:11], v26 offset:992
  s_add_u32 m0, s72, 0
  v_mfma_f32_32x32x16_bf16 v[136:151], a[48:51], a[236:239], v[136:151]
  ds_read_b64_tr_b16 a[12:13], v26 offset:128
  ds_read_b64_tr_b16 a[14:15], v26 offset:1024
  buffer_load_dwordx4 v22, s[52:55], s95 offen lds
  v_mfma_f32_32x32x16_bf16 v[152:167], a[52:55], a[236:239], v[152:167]
  ds_read_b64_tr_b16 a[16:17], v26 offset:160
  ds_read_b64_tr_b16 a[18:19], v26 offset:1056
  buffer_load_dwordx4 v23, s[52:55], s95 offen offset:1024 lds
  v_mfma_f32_32x32x16_bf16 v[168:183], a[56:59], a[236:239], v[168:183]
  ds_read_b64_tr_b16 a[20:21], v26 offset:192
  ds_read_b64_tr_b16 a[22:23], v26 offset:1088
  buffer_load_dwordx4 v24, s[52:55], s95 offen offset:2048 lds
  s_waitcnt lgkmcnt(8)
  v_mfma_f32_32x32x16_bf16 v[72:87], a[60:63], a[240:243], v[72:87]
  v_add_u32 v27, 0x8000, v27
  ds_read_b64_tr_b16 a[24:25], v27
  ds_read_b64_tr_b16 a[26:27], v27 offset:896
  buffer_load_dwordx4 v25, s[52:55], s95 offen offset:3072 lds
  v_mfma_f32_32x32x16_bf16 v[88:103], a[0:3], a[240:243], v[88:103]
  ds_read_b64_tr_b16 a[28:29], v27 offset:32
  ds_read_b64_tr_b16 a[30:31], v27 offset:928
  s_add_u32 m0, s72, 0x4000
  v_mfma_f32_32x32x16_bf16 v[104:119], a[4:7], a[240:243], v[104:119]
  ds_read_b64_tr_b16 a[32:33], v27 offset:64
  ds_read_b64_tr_b16 a[34:35], v27 offset:960
  s_add_u32 s95, s95, 0x80
  s_waitcnt lgkmcnt(6)
  v_mfma_f32_32x32x16_bf16 v[120:135], a[8:11], a[240:243], v[120:135]
  ds_read_b64_tr_b16 a[36:37], v27 offset:96
  ds_read_b64_tr_b16 a[38:39], v27 offset:992
  buffer_load_dwordx4 v22, s[52:55], s95 offen lds
  v_mfma_f32_32x32x16_bf16 v[136:151], a[12:15], a[240:243], v[136:151]
  ds_read_b64_tr_b16 a[40:41], v27 offset:128
  ds_read_b64_tr_b16 a[42:43], v27 offset:1024
  buffer_load_dwordx4 v23, s[52:55], s95 offen offset:1024 lds
  v_mfma_f32_32x32x16_bf16 v[152:167], a[16:19], a[240:243], v[152:167]
  ds_read_b64_tr_b16 a[44:45], v27 offset:160
  ds_read_b64_tr_b16 a[46:47], v27 offset:1056
  buffer_load_dwordx4 v24, s[52:55], s95 offen offset:2048 lds
  v_mfma_f32_32x32x16_bf16 v[168:183], a[20:23], a[240:243], v[168:183]
  ds_read_b64_tr_b16 a[48:49], v27 offset:192
  ds_read_b64_tr_b16 a[50:51], v27 offset:1088
  buffer_load_dwordx4 v25, s[52:55], s95 offen offset:3072 lds
  s_waitcnt lgkmcnt(6)
  v_mfma_f32_32x32x16_bf16 v[72:87], a[24:27], a[244:247], v[72:87]
  v_add_u32 v28, 0x8000, v28
  ds_read_b64_tr_b16 a[52:53], v28
  ds_read_b64_tr_b16 a[54:55], v28 offset:896
  s_add_u32 s25, s100, 0x6000
  v_mfma_f32_32x32x16_bf16 v[88:103], a[28:31], a[244:247], v[88:103]
  ds_read_b64_tr_b16 a[56:57], v28 offset:32
  ds_read_b64_tr_b16 a[58:59], v28 offset:928
  s_and_b32 s25, s25, 0xffff
  v_mfma_f32_32x32x16_bf16 v[104:119], a[32:35], a[244:247], v[104:119]
  ds_read_b64_tr_b16 a[60:61], v28 offset:64
  ds_read_b64_tr_b16 a[62:63], v28 offset:960
  s_add_u32 s25, s25, s79
  buffer_load_dwordx4 a[160:163], v1, s[60:63], s25 offen sc1
  v_mfma_f32_32x32x16_bf16 v[120:135], a[36:39], a[244:247], v[120:135]
  ds_read_b64_tr_b16 a[0:1], v28 offset:96
  ds_read_b64_tr_b16 a[2:3], v28 offset:992
  buffer_load_dwordx4 a[164:167], v1, s[60:63], s25 offen offset:1024 sc1
  s_waitcnt lgkmcnt(6)
  v_mfma_f32_32x32x16_bf16 v[136:151], a[40:43], a[244:247], v[136:151]
  ds_read_b64_tr_b16 a[4:5], v28 offset:128
  ds_read_b64_tr_b16 a[6:7], v28 offset:1024
  buffer_load_dwordx4 a[168:171], v1, s[60:63], s25 offen offset:2048 sc1
  v_mfma_f32_32x32x16_bf16 v[152:167], a[44:47], a[244:247], v[152:167]
  ds_read_b64_tr_b16 a[8:9], v28 offset:160
  ds_read_b64_tr_b16 a[10:11], v28 offset:1056
  buffer_load_dwordx4 a[172:175], v1, s[60:63], s25 offen offset:3072 sc1
  v_mfma_f32_32x32x16_bf16 v[168:183], a[48:51], a[244:247], v[168:183]
  ds_read_b64_tr_b16 a[12:13], v28 offset:192
  ds_read_b64_tr_b16 a[14:15], v28 offset:1088
  s_add_u32 s25, s25, 0x1000
  v_mfma_f32_32x32x16_bf16 v[72:87], a[52:55], a[248:251], v[72:87]
  v_add_u32 v29, 0x8000, v29
  ds_read_b64_tr_b16 a[16:17], v29
  ds_read_b64_tr_b16 a[18:19], v29 offset:896
  buffer_load_dwordx4 a[176:179], v1, s[60:63], s25 offen sc1
  s_waitcnt lgkmcnt(6)
  v_mfma_f32_32x32x16_bf16 v[88:103], a[56:59], a[248:251], v[88:103]
  ds_read_b64_tr_b16 a[20:21], v29 offset:32
  ds_read_b64_tr_b16 a[22:23], v29 offset:928
  buffer_load_dwordx4 a[180:183], v1, s[60:63], s25 offen offset:1024 sc1
  v_mfma_f32_32x32x16_bf16 v[104:119], a[60:63], a[248:251], v[104:119]
  ds_read_b64_tr_b16 a[24:25], v29 offset:64
  ds_read_b64_tr_b16 a[26:27], v29 offset:960
  buffer_load_dwordx4 a[184:187], v1, s[60:63], s25 offen offset:2048 sc1
  v_mfma_f32_32x32x16_bf16 v[120:135], a[0:3], a[248:251], v[120:135]
  ds_read_b64_tr_b16 a[28:29], v29 offset:96
  ds_read_b64_tr_b16 a[30:31], v29 offset:992
  buffer_load_dwordx4 a[188:191], v1, s[60:63], s25 offen offset:3072 sc1
  v_mfma_f32_32x32x16_bf16 v[136:151], a[4:7], a[248:251], v[136:151]
  ds_read_b64_tr_b16 a[32:33], v29 offset:128
  ds_read_b64_tr_b16 a[34:35], v29 offset:1024
  v_lshrrev_b32 v5, 3, v0
  s_waitcnt lgkmcnt(6)
  v_mfma_f32_32x32x16_bf16 v[152:167], a[8:11], a[248:251], v[152:167]
  ds_read_b64_tr_b16 a[36:37], v29 offset:160
  ds_read_b64_tr_b16 a[38:39], v29 offset:1056
  v_lshlrev_b32 v5, 10, v5
  v_mfma_f32_32x32x16_bf16 v[168:183], a[12:15], a[248:251], v[168:183]
  ds_read_b64_tr_b16 a[40:41], v29 offset:192
  ds_read_b64_tr_b16 a[42:43], v29 offset:1088
  v_bfe_u32 v3, v0, 4, 1
  v_mfma_f32_32x32x16_bf16 v[72:87], a[16:19], a[252:255], v[72:87]
  v_lshlrev_b32 v3, 2, v3
  v_mfma_f32_32x32x16_bf16 v[88:103], a[20:23], a[252:255], v[88:103]
  v_and_b32 v4, 7, v0
  s_waitcnt lgkmcnt(2)
  v_mfma_f32_32x32x16_bf16 v[104:119], a[24:27], a[252:255], v[104:119]
  v_xor_b32 v3, v3, v4
  v_mfma_f32_32x32x16_bf16 v[120:135], a[28:31], a[252:255], v[120:135]
  v_lshl_add_u32 v2, v3, 4, v5
  v_mfma_f32_32x32x16_bf16 v[136:151], a[32:35], a[252:255], v[136:151]
  v_add_u32 v3, 0x1c00, v2
  v_mfma_f32_32x32x16_bf16 v[152:167], a[36:39], a[252:255], v[152:167]
  v_add_u32 v4, 0x3800, v2
  v_add_u32 v5, 0x5400, v2
  s_waitcnt lgkmcnt(0)
  v_mfma_f32_32x32x16_bf16 v[168:183], a[40:43], a[252:255], v[168:183]
  s_waitcnt vmcnt(40)
  s_barrier
  v_mfma_f32_32x32x16_bf16 v[72:87], v[216:219], v[40:43], v[72:87]
  ds_read_b128 a[44:47], v11 offset:32768
  s_add_u32 s95, s98, 0x300
  v_mfma_f32_32x32x16_bf16 v[88:103], v[220:223], v[40:43], v[88:103]
  ds_read_b128 a[48:51], v11 offset:36864
  s_and_b32 s95, s95, 0x7ff
  v_mfma_f32_32x32x16_bf16 v[104:119], v[224:227], v[40:43], v[104:119]
  ds_read_b128 a[52:55], v11 offset:40960
  s_add_u32 s95, s95, s80
  v_mfma_f32_32x32x16_bf16 v[120:135], v[228:231], v[40:43], v[120:135]
  ds_read_b128 a[56:59], v11 offset:45056
  s_add_u32 m0, s72, 0x8000
  v_mfma_f32_32x32x16_bf16 v[136:151], v[232:235], v[40:43], v[136:151]
  ds_read_b128 a[60:63], v12 offset:32768
  buffer_load_dwordx4 v22, s[52:55], s95 offen lds
  v_mfma_f32_32x32x16_bf16 v[152:167], v[236:239], v[40:43], v[152:167]
  ds_read_b128 a[0:3], v12 offset:36864
  buffer_load_dwordx4 v23, s[52:55], s95 offen offset:1024 lds
  v_mfma_f32_32x32x16_bf16 v[168:183], v[240:243], v[40:43], v[168:183]
  ds_read_b128 a[4:7], v12 offset:40960
  buffer_load_dwordx4 v24, s[52:55], s95 offen offset:2048 lds
  s_waitcnt lgkmcnt(3)
  v_mfma_f32_32x32x16_bf16 v[184:199], a[64:67], a[44:47], 0
  ds_read_b128 a[8:11], v12 offset:45056
  buffer_load_dwordx4 v25, s[52:55], s95 offen offset:3072 lds
  v_mfma_f32_32x32x16_bf16 v[200:215], a[64:67], a[48:51], 0
  ds_read_b128 a[12:15], v13 offset:32768
  s_add_u32 m0, s72, 0xc000
  v_mfma_f32_32x32x16_bf16 v[216:231], a[64:67], a[52:55], 0
  ds_read_b128 a[16:19], v13 offset:36864
  s_add_u32 s95, s95, 0x80
  v_mul_f32 v64, v72, v72
  v_mul_f32 v65, v73, v73
  v_fma_f32 v64, v64, v45, v44
  v_fma_f32 v65, v65, v45, v44
  v_mfma_f32_32x32x16_bf16 v[232:247], a[64:67], a[56:59], 0
  ds_read_b128 a[20:23], v13 offset:40960
  buffer_load_dwordx4 v22, s[52:55], s95 offen lds
  v_mul_f32 v64, v64, v72
  v_mul_f32 v65, v65, v73
  v_exp_f32 v64, v64
  v_mul_f32 v80, v72, v80
  s_waitcnt lgkmcnt(3)
  v_mfma_f32_32x32x16_bf16 v[184:199], a[68:71], a[60:63], v[184:199]
  ds_read_b128 a[24:27], v13 offset:45056
  buffer_load_dwordx4 v23, s[52:55], s95 offen offset:1024 lds
  v_exp_f32 v65, v65
  v_mul_f32 v81, v73, v81
  v_fma_f32 v64, v64, v46, v46
  v_fma_f32 v65, v65, v46, v46
  v_mfma_f32_32x32x16_bf16 v[200:215], a[68:71], a[0:3], v[200:215]
  ds_read_b128 a[28:31], v14 offset:32768
  buffer_load_dwordx4 v24, s[52:55], s95 offen offset:2048 lds
  v_rcp_f32 v64, v64
  v_rcp_f32 v65, v65
  v_mul_f32 v80, v80, v64
  v_mul_f32 v81, v81, v65
  v_mfma_f32_32x32x16_bf16 v[216:231], a[68:71], a[4:7], v[216:231]
  ds_read_b128 a[32:35], v14 offset:36864
  buffer_load_dwordx4 v25, s[52:55], s95 offen offset:3072 lds
  v_cvt_pk_bf16_f32 v72, v80, v81
  v_mul_f32 v64, v74, v74
  v_mul_f32 v65, v75, v75
  v_fma_f32 v64, v64, v45, v44
  v_mfma_f32_32x32x16_bf16 v[232:247], a[68:71], a[8:11], v[232:247]
  ds_read_b128 a[36:39], v14 offset:40960
  s_add_u32 s25, s100, 0xa000
  v_fma_f32 v65, v65, v45, v44
  v_mul_f32 v64, v64, v74
  v_mul_f32 v65, v65, v75
  v_exp_f32 v64, v64
  s_waitcnt lgkmcnt(3)
  v_mfma_f32_32x32x16_bf16 v[184:199], a[72:75], a[12:15], v[184:199]
  ds_read_b128 a[40:43], v14 offset:45056
  s_and_b32 s25, s25, 0xffff
  v_mul_f32 v82, v74, v82
  v_exp_f32 v65, v65
  v_mul_f32 v83, v75, v83
  v_fma_f32 v64, v64, v46, v46
  v_mfma_f32_32x32x16_bf16 v[200:215], a[72:75], a[16:19], v[200:215]
  ds_read_b128 a[44:47], v11 offset:49152
  s_add_u32 s25, s25, s79
  v_fma_f32 v65, v65, v46, v46
  v_rcp_f32 v64, v64
  v_rcp_f32 v65, v65
  v_mul_f32 v82, v82, v64
  v_mfma_f32_32x32x16_bf16 v[216:231], a[72:75], a[20:23], v[216:231]
  ds_read_b128 a[48:51], v11 offset:53248
  buffer_load_dwordx4 a[192:195], v1, s[60:63], s25 offen sc1
  v_mul_f32 v83, v83, v65
  v_cvt_pk_bf16_f32 v73, v82, v83
  v_mul_f32 v64, v76, v76
  v_mul_f32 v65, v77, v77
  v_mfma_f32_32x32x16_bf16 v[232:247], a[72:75], a[24:27], v[232:247]
  ds_read_b128 a[52:55], v11 offset:57344
  buffer_load_dwordx4 a[196:199], v1, s[60:63], s25 offen offset:1024 sc1
  v_fma_f32 v64, v64, v45, v44
  v_fma_f32 v65, v65, v45, v44
  v_mul_f32 v64, v64, v76
  v_mul_f32 v65, v65, v77
  s_waitcnt lgkmcnt(3)
  v_mfma_f32_32x32x16_bf16 v[184:199], a[76:79], a[28:31], v[184:199]
  ds_read_b128 a[56:59], v11 offset:61440
  buffer_load_dwordx4 a[200:203], v1, s[60:63], s25 offen offset:2048 sc1
  v_exp_f32 v64, v64
  v_mul_f32 v84, v76, v84
  v_exp_f32 v65, v65
  v_mul_f32 v85, v77, v85
  v_mfma_f32_32x32x16_bf16 v[200:215], a[76:79], a[32:35], v[200:215]
  ds_read_b128 a[60:63], v12 offset:49152
  buffer_load_dwordx4 a[204:207], v1, s[60:63], s25 offen offset:3072 sc1
  v_fma_f32 v64, v64, v46, v46
  v_fma_f32 v65, v65, v46, v46
  v_rcp_f32 v64, v64
  v_rcp_f32 v65, v65
  v_mfma_f32_32x32x16_bf16 v[216:231], a[76:79], a[36:39], v[216:231]
  ds_read_b128 a[0:3], v12 offset:53248
  s_add_u32 s25, s25, 0x1000
  v_mul_f32 v84, v84, v64
  v_mul_f32 v85, v85, v65
  v_cvt_pk_bf16_f32 v74, v84, v85
  v_mul_f32 v64, v78, v78
  v_mfma_f32_32x32x16_bf16 v[232:247], a[76:79], a[40:43], v[232:247]
  ds_read_b128 a[4:7], v12 offset:57344
  buffer_load_dwordx4 a[208:211], v1, s[60:63], s25 offen sc1
  v_mul_f32 v65, v79, v79
  v_fma_f32 v64, v64, v45, v44
  v_fma_f32 v65, v65, v45, v44
  v_mul_f32 v64, v64, v78
  s_waitcnt lgkmcnt(3)
  v_mfma_f32_32x32x16_bf16 v[184:199], a[80:83], a[44:47], v[184:199]
  ds_read_b128 a[8:11], v12 offset:61440
  buffer_load_dwordx4 a[212:215], v1, s[60:63], s25 offen offset:1024 sc1
  v_mul_f32 v65, v65, v79
  v_exp_f32 v64, v64
  v_mul_f32 v86, v78, v86
  v_exp_f32 v65, v65
  v_mfma_f32_32x32x16_bf16 v[200:215], a[80:83], a[48:51], v[200:215]
  ds_read_b128 a[12:15], v13 offset:49152
  buffer_load_dwordx4 a[216:219], v1, s[60:63], s25 offen offset:2048 sc1
  v_mul_f32 v87, v79, v87
  v_fma_f32 v64, v64, v46, v46
  v_fma_f32 v65, v65, v46, v46
  v_rcp_f32 v64, v64
  v_mfma_f32_32x32x16_bf16 v[216:231], a[80:83], a[52:55], v[216:231]
  ds_read_b128 a[16:19], v13 offset:53248
  buffer_load_dwordx4 a[220:223], v1, s[60:63], s25 offen offset:3072 sc1
  v_rcp_f32 v65, v65
  v_mul_f32 v86, v86, v64
  v_mul_f32 v87, v87, v65
  v_cvt_pk_bf16_f32 v75, v86, v87
  v_mfma_f32_32x32x16_bf16 v[232:247], a[80:83], a[56:59], v[232:247]
  ds_read_b128 a[20:23], v13 offset:57344
  v_mov_b32 v248, -1
  v_mul_f32 v64, v88, v88
  v_mul_f32 v65, v89, v89
  v_fma_f32 v64, v64, v45, v44
  v_fma_f32 v65, v65, v45, v44
  s_waitcnt lgkmcnt(3)
  v_mfma_f32_32x32x16_bf16 v[184:199], a[84:87], a[60:63], v[184:199]
  ds_read_b128 a[24:27], v13 offset:61440
  v_mov_b32 v249, -1
  v_mul_f32 v64, v64, v88
  v_mul_f32 v65, v65, v89
  v_exp_f32 v64, v64
  v_mul_f32 v96, v88, v96
  v_mfma_f32_32x32x16_bf16 v[200:215], a[84:87], a[0:3], v[200:215]
  ds_read_b128 a[28:31], v14 offset:49152
  v_mov_b32 v250, -1
  v_exp_f32 v65, v65
  v_mul_f32 v97, v89, v97
  v_fma_f32 v64, v64, v46, v46
  v_fma_f32 v65, v65, v46, v46
  v_mfma_f32_32x32x16_bf16 v[216:231], a[84:87], a[4:7], v[216:231]
  ds_read_b128 a[32:35], v14 offset:53248
  ds_read_b128 a[36:39], v14 offset:57344
  ds_read_b128 a[40:43], v14 offset:61440
  v_mov_b32 v251, -1
  v_rcp_f32 v64, v64
  v_rcp_f32 v65, v65
  v_mul_f32 v96, v96, v64
  v_mul_f32 v97, v97, v65
  v_mfma_f32_32x32x16_bf16 v[232:247], a[84:87], a[8:11], v[232:247]
  buffer_store_dwordx4 v[248:251], v1, s[60:63], s90 offen sc1
  v_cvt_pk_bf16_f32 v88, v96, v97
  v_mul_f32 v64, v90, v90
  v_mul_f32 v65, v91, v91
  v_fma_f32 v64, v64, v45, v44
  s_waitcnt lgkmcnt(4)
  v_mfma_f32_32x32x16_bf16 v[184:199], a[88:91], a[12:15], v[184:199]
  buffer_store_dwordx4 v[248:251], v1, s[60:63], s90 offen offset:1024 sc1
  v_fma_f32 v65, v65, v45, v44
  v_mul_f32 v64, v64, v90
  v_mul_f32 v65, v65, v91
  v_exp_f32 v64, v64
  s_waitcnt vmcnt(50) lgkmcnt(0)
  s_barrier
  v_mfma_f32_32x32x16_bf16 v[200:215], a[88:91], a[16:19], v[200:215]
  ds_read_b128 a[44:47], v15
  s_add_u32 s95, s98, 0x600
  v_mul_f32 v98, v90, v98
  v_exp_f32 v65, v65
  v_mul_f32 v99, v91, v99
  v_fma_f32 v64, v64, v46, v46
  v_mfma_f32_32x32x16_bf16 v[216:231], a[88:91], a[20:23], v[216:231]
  ds_read_b128 a[48:51], v15 offset:4096
  s_and_b32 s95, s95, 0x7ff
  v_fma_f32 v65, v65, v46, v46
  v_rcp_f32 v64, v64
  v_rcp_f32 v65, v65
  v_mul_f32 v98, v98, v64
  v_mfma_f32_32x32x16_bf16 v[232:247], a[88:91], a[24:27], v[232:247]
  ds_read_b128 a[52:55], v15 offset:8192
  s_add_u32 s95, s95, s80
  v_mul_f32 v99, v99, v65
  v_cvt_pk_bf16_f32 v89, v98, v99
  v_mul_f32 v64, v92, v92
  v_mul_f32 v65, v93, v93
  v_mfma_f32_32x32x16_bf16 v[184:199], a[92:95], a[28:31], v[184:199]
  ds_read_b128 a[56:59], v15 offset:12288
  s_add_u32 m0, s72, 0x18000
  s_nop 0
  buffer_load_dwordx4 v22, s[52:55], s95 offen lds
  v_fma_f32 v64, v64, v45, v44
  v_fma_f32 v65, v65, v45, v44
  v_mul_f32 v64, v64, v92
  v_mul_f32 v65, v65, v93
  v_mfma_f32_32x32x16_bf16 v[200:215], a[92:95], a[32:35], v[200:215]
  ds_read_b128 a[60:63], v16
  buffer_load_dwordx4 v23, s[52:55], s95 offen offset:1024 lds
  v_exp_f32 v64, v64
  v_mul_f32 v100, v92, v100
  v_exp_f32 v65, v65
  v_mul_f32 v101, v93, v101
  v_mfma_f32_32x32x16_bf16 v[216:231], a[92:95], a[36:39], v[216:231]
  ds_read_b128 a[0:3], v16 offset:4096
  buffer_load_dwordx4 v24, s[52:55], s95 offen offset:2048 lds
  v_fma_f32 v64, v64, v46, v46
  v_fma_f32 v65, v65, v46, v46
  v_rcp_f32 v64, v64
  v_rcp_f32 v65, v65
  v_mfma_f32_32x32x16_bf16 v[232:247], a[92:95], a[40:43], v[232:247]
  ds_read_b128 a[4:7], v16 offset:8192
  buffer_load_dwordx4 v25, s[52:55], s95 offen offset:3072 lds
  v_mul_f32 v100, v100, v64
  v_mul_f32 v101, v101, v65
  v_cvt_pk_bf16_f32 v90, v100, v101
  v_mul_f32 v64, v94, v94
  s_waitcnt lgkmcnt(3)
  s_waitcnt vmcnt(53)
  v_mfma_f32_32x32x16_bf16 v[184:199], a[96:99], a[44:47], v[184:199]
  ds_read_b128 a[8:11], v16 offset:12288
  s_add_u32 m0, s72, 0x1c000
  s_add_u32 s95, s95, 0x80
  v_mul_f32 v65, v95, v95
  v_fma_f32 v64, v64, v45, v44
  v_fma_f32 v65, v65, v45, v44
  v_mul_f32 v64, v64, v94
  v_mfma_f32_32x32x16_bf16 v[200:215], a[96:99], a[48:51], v[200:215]
  ds_read_b128 a[12:15], v17
  buffer_load_dwordx4 v22, s[52:55], s95 offen lds
  v_mul_f32 v65, v65, v95
  v_exp_f32 v64, v64
  v_mul_f32 v102, v94, v102
  v_exp_f32 v65, v65
  v_mfma_f32_32x32x16_bf16 v[216:231], a[96:99], a[52:55], v[216:231]
  ds_read_b128 a[16:19], v17 offset:4096
  buffer_load_dwordx4 v23, s[52:55], s95 offen offset:1024 lds
  v_mul_f32 v103, v95, v103
  v_fma_f32 v64, v64, v46, v46
  v_fma_f32 v65, v65, v46, v46
  v_rcp_f32 v64, v64
  v_mfma_f32_32x32x16_bf16 v[232:247], a[96:99], a[56:59], v[232:247]
  ds_read_b128 a[20:23], v17 offset:8192
  buffer_load_dwordx4 v24, s[52:55], s95 offen offset:2048 lds
  v_rcp_f32 v65, v65
  v_mul_f32 v102, v102, v64
  v_mul_f32 v103, v103, v65
  v_cvt_pk_bf16_f32 v91, v102, v103
  s_waitcnt lgkmcnt(3)
  s_waitcnt vmcnt(55)
  v_mfma_f32_32x32x16_bf16 v[184:199], a[100:103], a[60:63], v[184:199]
  ds_read_b128 a[24:27], v17 offset:12288
  buffer_load_dwordx4 v25, s[52:55], s95 offen offset:3072 lds
  s_add_u32 s25, s100, 0xc000
  v_mul_f32 v64, v104, v104
  v_mul_f32 v65, v105, v105
  v_fma_f32 v64, v64, v45, v44
  v_fma_f32 v65, v65, v45, v44
  v_mfma_f32_32x32x16_bf16 v[200:215], a[100:103], a[0:3], v[200:215]
  ds_read_b128 a[28:31], v18
  s_and_b32 s25, s25, 0xffff
  v_mul_f32 v64, v64, v104
  v_mul_f32 v65, v65, v105
  v_exp_f32 v64, v64
  v_mul_f32 v112, v104, v112
  v_mfma_f32_32x32x16_bf16 v[216:231], a[100:103], a[4:7], v[216:231]
  ds_read_b128 a[32:35], v18 offset:4096
  s_add_u32 s25, s25, s79
  v_exp_f32 v65, v65
  v_mul_f32 v113, v105, v113
  v_fma_f32 v64, v64, v46, v46
  v_fma_f32 v65, v65, v46, v46
  v_mfma_f32_32x32x16_bf16 v[232:247], a[100:103], a[8:11], v[232:247]
  ds_read_b128 a[36:39], v18 offset:8192
  buffer_load_dwordx4 a[224:227], v1, s[60:63], s25 offen sc1
  buffer_load_dwordx4 a[228:231], v1, s[60:63], s25 offen offset:1024 sc1
  v_rcp_f32 v64, v64
  v_rcp_f32 v65, v65
  v_mul_f32 v112, v112, v64
  v_mul_f32 v113, v113, v65
  s_waitcnt lgkmcnt(3)
  s_waitcnt vmcnt(57)
  v_mfma_f32_32x32x16_bf16 v[184:199], a[104:107], a[12:15], v[184:199]
  ds_read_b128 a[40:43], v18 offset:12288
  buffer_load_dwordx4 a[232:235], v1, s[60:63], s25 offen offset:2048 sc1
  v_cvt_pk_bf16_f32 v104, v112, v113
  v_mul_f32 v64, v106, v106
  v_mul_f32 v65, v107, v107
  v_fma_f32 v64, v64, v45, v44
  v_mfma_f32_32x32x16_bf16 v[200:215], a[104:107], a[16:19], v[200:215]
  ds_read_b128 a[44:47], v15 offset:16384
  buffer_load_dwordx4 a[236:239], v1, s[60:63], s25 offen offset:3072 sc1
  v_fma_f32 v65, v65, v45, v44
  v_mul_f32 v64, v64, v106
  v_mul_f32 v65, v65, v107
  v_exp_f32 v64, v64
  v_mfma_f32_32x32x16_bf16 v[216:231], a[104:107], a[20:23], v[216:231]
  ds_read_b128 a[48:51], v15 offset:20480
  s_add_u32 s25, s25, 0x1000
  v_mul_f32 v114, v106, v114
  v_exp_f32 v65, v65
  v_mul_f32 v115, v107, v115
  v_fma_f32 v64, v64, v46, v46
  v_mfma_f32_32x32x16_bf16 v[232:247], a[104:107], a[24:27], v[232:247]
  ds_read_b128 a[52:55], v15 offset:24576
  buffer_load_dwordx4 a[240:243], v1, s[60:63], s25 offen sc1
  buffer_load_dwordx4 a[244:247], v1, s[60:63], s25 offen offset:1024 sc1
  v_fma_f32 v65, v65, v46, v46
  v_rcp_f32 v64, v64
  v_rcp_f32 v65, v65
  v_mul_f32 v114, v114, v64
  s_waitcnt lgkmcnt(3)
  s_waitcnt vmcnt(60)
  v_mfma_f32_32x32x16_bf16 v[184:199], a[108:111], a[28:31], v[184:199]
  ds_read_b128 a[56:59], v15 offset:28672
  buffer_load_dwordx4 a[248:251], v1, s[60:63], s25 offen offset:2048 sc1
  v_mul_f32 v115, v115, v65
  v_cvt_pk_bf16_f32 v105, v114, v115
  v_mul_f32 v64, v108, v108
  v_mul_f32 v65, v109, v109
  v_mfma_f32_32x32x16_bf16 v[200:215], a[108:111], a[32:35], v[200:215]
  ds_read_b128 a[60:63], v16 offset:16384
  buffer_load_dwordx4 a[252:255], v1, s[60:63], s25 offen offset:3072 sc1
  v_fma_f32 v64, v64, v45, v44
  v_fma_f32 v65, v65, v45, v44
  v_mul_f32 v64, v64, v108
  v_mul_f32 v65, v65, v109
  v_mfma_f32_32x32x16_bf16 v[216:231], a[108:111], a[36:39], v[216:231]
  ds_read_b128 a[0:3], v16 offset:20480
  buffer_store_dwordx4 v[248:251], v1, s[60:63], s91 offen sc1
  v_exp_f32 v64, v64
  v_mul_f32 v116, v108, v116
  v_exp_f32 v65, v65
  v_mul_f32 v117, v109, v117
  v_mfma_f32_32x32x16_bf16 v[232:247], a[108:111], a[40:43], v[232:247]
  ds_read_b128 a[4:7], v16 offset:24576
  buffer_store_dwordx4 v[248:251], v1, s[60:63], s91 offen offset:1024 sc1
  v_fma_f32 v64, v64, v46, v46
  v_fma_f32 v65, v65, v46, v46
  v_rcp_f32 v64, v64
  v_rcp_f32 v65, v65
  s_waitcnt lgkmcnt(3)
  s_waitcnt vmcnt(63)
  v_mfma_f32_32x32x16_bf16 v[184:199], a[112:115], a[44:47], v[184:199]
  ds_read_b128 a[8:11], v16 offset:28672
  s_add_u32 s25, s100, 0xe000
  v_mul_f32 v116, v116, v64
  v_mul_f32 v117, v117, v65
  v_cvt_pk_bf16_f32 v106, v116, v117
  v_mul_f32 v64, v110, v110
  v_mfma_f32_32x32x16_bf16 v[200:215], a[112:115], a[48:51], v[200:215]
  ds_read_b128 a[12:15], v17 offset:16384
  s_and_b32 s25, s25, 0xffff
  s_add_u32 s25, s25, s79
  v_mul_f32 v65, v111, v111
  v_fma_f32 v64, v64, v45, v44
  v_fma_f32 v65, v65, v45, v44
  v_mul_f32 v64, v64, v110
  v_mfma_f32_32x32x16_bf16 v[216:231], a[112:115], a[52:55], v[216:231]
  ds_read_b128 a[16:19], v17 offset:20480
  buffer_load_dwordx4 a[64:67], v1, s[60:63], s25 offen sc1
  v_mul_f32 v65, v65, v111
  v_exp_f32 v64, v64
  v_mul_f32 v118, v110, v118
  v_exp_f32 v65, v65
  v_mfma_f32_32x32x16_bf16 v[232:247], a[112:115], a[56:59], v[232:247]
  ds_read_b128 a[20:23], v17 offset:24576
  buffer_load_dwordx4 a[68:71], v1, s[60:63], s25 offen offset:1024 sc1
  buffer_load_dwordx4 a[72:75], v1, s[60:63], s25 offen offset:2048 sc1
  v_mul_f32 v119, v111, v119
  v_fma_f32 v64, v64, v46, v46
  v_fma_f32 v65, v65, v46, v46
  v_rcp_f32 v64, v64
  s_waitcnt lgkmcnt(3)
  s_waitcnt vmcnt(63)
  v_mfma_f32_32x32x16_bf16 v[184:199], a[116:119], a[60:63], v[184:199]
  ds_read_b128 a[24:27], v17 offset:28672
  buffer_load_dwordx4 a[76:79], v1, s[60:63], s25 offen offset:3072 sc1
  v_rcp_f32 v65, v65
  v_mul_f32 v118, v118, v64
  v_mul_f32 v119, v119, v65
  v_cvt_pk_bf16_f32 v107, v118, v119
  v_mfma_f32_32x32x16_bf16 v[200:215], a[116:119], a[0:3], v[200:215]
  ds_read_b128 a[28:31], v18 offset:16384
  s_add_u32 s25, s25, 0x1000
  buffer_load_dwordx4 a[80:83], v1, s[60:63], s25 offen sc1
  v_mul_f32 v64, v120, v120
  v_mul_f32 v65, v121, v121
  v_fma_f32 v64, v64, v45, v44
  v_fma_f32 v65, v65, v45, v44
  v_mfma_f32_32x32x16_bf16 v[216:231], a[116:119], a[4:7], v[216:231]
  ds_read_b128 a[32:35], v18 offset:20480
  ds_read_b128 a[36:39], v18 offset:24576
  ds_read_b128 a[40:43], v18 offset:28672
  buffer_load_dwordx4 a[84:87], v1, s[60:63], s25 offen offset:1024 sc1
  v_mul_f32 v64, v64, v120
  v_mul_f32 v65, v65, v121
  v_exp_f32 v64, v64
  v_mul_f32 v128, v120, v128
  v_mfma_f32_32x32x16_bf16 v[232:247], a[116:119], a[8:11], v[232:247]
  buffer_load_dwordx4 a[88:91], v1, s[60:63], s25 offen offset:2048 sc1
  buffer_load_dwordx4 a[92:95], v1, s[60:63], s25 offen offset:3072 sc1
  v_exp_f32 v65, v65
  v_mul_f32 v129, v121, v129
  v_fma_f32 v64, v64, v46, v46
  v_fma_f32 v65, v65, v46, v46
  s_waitcnt lgkmcnt(4)
  v_mfma_f32_32x32x16_bf16 v[184:199], a[120:123], a[12:15], v[184:199]
  v_rcp_f32 v64, v64
  v_rcp_f32 v65, v65
  v_mul_f32 v128, v128, v64
  v_mul_f32 v129, v129, v65
  s_waitcnt vmcnt(52) lgkmcnt(0)
  s_barrier
  v_mfma_f32_32x32x16_bf16 v[200:215], a[120:123], a[16:19], v[200:215]
  ds_read_b128 a[44:47], v7
  s_add_u32 s95, s98, 0x700
  v_cvt_pk_bf16_f32 v120, v128, v129
  v_mul_f32 v64, v122, v122
  v_mul_f32 v65, v123, v123
  v_fma_f32 v64, v64, v45, v44
  v_mfma_f32_32x32x16_bf16 v[216:231], a[120:123], a[20:23], v[216:231]
  ds_read_b128 a[48:51], v7 offset:4096
  s_and_b32 s95, s95, 0x7ff
  v_fma_f32 v65, v65, v45, v44
  v_mul_f32 v64, v64, v122
  v_mul_f32 v65, v65, v123
  v_exp_f32 v64, v64
  v_mfma_f32_32x32x16_bf16 v[232:247], a[120:123], a[24:27], v[232:247]
  ds_read_b128 a[52:55], v7 offset:8192
  s_add_u32 s95, s95, s80
  v_mul_f32 v130, v122, v130
  v_exp_f32 v65, v65
  v_mul_f32 v131, v123, v131
  v_fma_f32 v64, v64, v46, v46
  v_mfma_f32_32x32x16_bf16 v[184:199], a[124:127], a[28:31], v[184:199]
  ds_read_b128 a[56:59], v7 offset:12288
  s_add_u32 m0, s72, 0x20000
  v_fma_f32 v65, v65, v46, v46
  v_rcp_f32 v64, v64
  v_rcp_f32 v65, v65
  v_mul_f32 v130, v130, v64
  v_mfma_f32_32x32x16_bf16 v[200:215], a[124:127], a[32:35], v[200:215]
  ds_read_b128 a[60:63], v8
  buffer_load_dwordx4 v22, s[52:55], s95 offen lds
  v_mul_f32 v131, v131, v65
  v_cvt_pk_bf16_f32 v121, v130, v131
  v_mul_f32 v64, v124, v124
  v_mul_f32 v65, v125, v125
  v_mfma_f32_32x32x16_bf16 v[216:231], a[124:127], a[36:39], v[216:231]
  ds_read_b128 a[0:3], v8 offset:4096
  buffer_load_dwordx4 v23, s[52:55], s95 offen offset:1024 lds
  v_fma_f32 v64, v64, v45, v44
  v_fma_f32 v65, v65, v45, v44
  v_mul_f32 v64, v64, v124
  v_mul_f32 v65, v65, v125
  v_mfma_f32_32x32x16_bf16 v[232:247], a[124:127], a[40:43], v[232:247]
  ds_read_b128 a[4:7], v8 offset:8192
  buffer_load_dwordx4 v24, s[52:55], s95 offen offset:2048 lds
  v_exp_f32 v64, v64
  v_mul_f32 v132, v124, v132
  v_exp_f32 v65, v65
  v_mul_f32 v133, v125, v133
  s_waitcnt lgkmcnt(3)
  v_mfma_f32_32x32x16_bf16 v[184:199], a[128:131], a[44:47], v[184:199]
  ds_read_b128 a[8:11], v8 offset:12288
  buffer_load_dwordx4 v25, s[52:55], s95 offen offset:3072 lds
  s_add_u32 m0, s72, 0x24000
  v_fma_f32 v64, v64, v46, v46
  v_fma_f32 v65, v65, v46, v46
  v_rcp_f32 v64, v64
  v_rcp_f32 v65, v65
  v_mfma_f32_32x32x16_bf16 v[200:215], a[128:131], a[48:51], v[200:215]
  ds_read_b128 a[12:15], v9
  s_add_u32 s95, s95, 0x80
  v_mul_f32 v132, v132, v64
  v_mul_f32 v133, v133, v65
  v_cvt_pk_bf16_f32 v122, v132, v133
  v_mul_f32 v64, v126, v126
  v_mfma_f32_32x32x16_bf16 v[216:231], a[128:131], a[52:55], v[216:231]
  ds_read_b128 a[16:19], v9 offset:4096
  buffer_load_dwordx4 v22, s[52:55], s95 offen lds
  v_mul_f32 v65, v127, v127
  v_fma_f32 v64, v64, v45, v44
  v_fma_f32 v65, v65, v45, v44
  v_mul_f32 v64, v64, v126
  v_mfma_f32_32x32x16_bf16 v[232:247], a[128:131], a[56:59], v[232:247]
  ds_read_b128 a[20:23], v9 offset:8192
  buffer_load_dwordx4 v23, s[52:55], s95 offen offset:1024 lds
  v_mul_f32 v65, v65, v127
  v_exp_f32 v64, v64
  v_mul_f32 v134, v126, v134
  v_exp_f32 v65, v65
  s_waitcnt lgkmcnt(3)
  v_mfma_f32_32x32x16_bf16 v[184:199], a[132:135], a[60:63], v[184:199]
  ds_read_b128 a[24:27], v9 offset:12288
  buffer_load_dwordx4 v24, s[52:55], s95 offen offset:2048 lds
  v_mul_f32 v135, v127, v135
  v_fma_f32 v64, v64, v46, v46
  v_fma_f32 v65, v65, v46, v46
  v_rcp_f32 v64, v64
  v_mfma_f32_32x32x16_bf16 v[200:215], a[132:135], a[0:3], v[200:215]
  ds_read_b128 a[28:31], v10
  buffer_load_dwordx4 v25, s[52:55], s95 offen offset:3072 lds
  v_rcp_f32 v65, v65
  v_mul_f32 v134, v134, v64
  v_mul_f32 v135, v135, v65
  v_cvt_pk_bf16_f32 v123, v134, v135
  v_mfma_f32_32x32x16_bf16 v[216:231], a[132:135], a[4:7], v[216:231]
  ds_read_b128 a[32:35], v10 offset:4096
  buffer_store_dwordx4 v[248:251], v1, s[60:63], s92 offen sc1
  v_mul_f32 v64, v136, v136
  v_mul_f32 v65, v137, v137
  v_fma_f32 v64, v64, v45, v44
  v_fma_f32 v65, v65, v45, v44
  v_mfma_f32_32x32x16_bf16 v[232:247], a[132:135], a[8:11], v[232:247]
  ds_read_b128 a[36:39], v10 offset:8192
  buffer_store_dwordx4 v[248:251], v1, s[60:63], s92 offen offset:1024 sc1
  v_mul_f32 v64, v64, v136
  v_mul_f32 v65, v65, v137
  v_exp_f32 v64, v64
  v_mul_f32 v144, v136, v144
  s_waitcnt lgkmcnt(3)
  v_mfma_f32_32x32x16_bf16 v[184:199], a[136:139], a[12:15], v[184:199]
  ds_read_b128 a[40:43], v10 offset:12288
  v_exp_f32 v65, v65
  v_mul_f32 v145, v137, v145
  v_fma_f32 v64, v64, v46, v46
  v_fma_f32 v65, v65, v46, v46
  v_mfma_f32_32x32x16_bf16 v[200:215], a[136:139], a[16:19], v[200:215]
  ds_read_b128 a[44:47], v7 offset:16384
  s_add_u32 s25, s100, 0x8000
  v_rcp_f32 v64, v64
  v_rcp_f32 v65, v65
  v_mul_f32 v144, v144, v64
  v_mul_f32 v145, v145, v65
  v_mfma_f32_32x32x16_bf16 v[216:231], a[136:139], a[20:23], v[216:231]
  ds_read_b128 a[48:51], v7 offset:20480
  s_and_b32 s25, s25, 0xffff
  v_cvt_pk_bf16_f32 v136, v144, v145
  v_mul_f32 v64, v138, v138
  v_mul_f32 v65, v139, v139
  v_fma_f32 v64, v64, v45, v44
  v_mfma_f32_32x32x16_bf16 v[232:247], a[136:139], a[24:27], v[232:247]
  ds_read_b128 a[52:55], v7 offset:24576
  s_add_u32 s25, s25, s79
  v_fma_f32 v65, v65, v45, v44
  v_mul_f32 v64, v64, v138
  v_mul_f32 v65, v65, v139
  v_exp_f32 v64, v64
  s_waitcnt lgkmcnt(3)
  v_mfma_f32_32x32x16_bf16 v[184:199], a[140:143], a[28:31], v[184:199]
  ds_read_b128 a[56:59], v7 offset:28672
  v_mul_f32 v146, v138, v146
  v_exp_f32 v65, v65
  v_mul_f32 v147, v139, v147
  v_fma_f32 v64, v64, v46, v46
  v_mfma_f32_32x32x16_bf16 v[200:215], a[140:143], a[32:35], v[200:215]
  ds_read_b128 a[60:63], v8 offset:16384
  buffer_load_dwordx4 a[96:99], v1, s[60:63], s25 offen sc1
  v_fma_f32 v65, v65, v46, v46
  v_rcp_f32 v64, v64
  v_rcp_f32 v65, v65
  v_mul_f32 v146, v146, v64
  v_mfma_f32_32x32x16_bf16 v[216:231], a[140:143], a[36:39], v[216:231]
  ds_read_b128 a[0:3], v8 offset:20480
  buffer_load_dwordx4 a[100:103], v1, s[60:63], s25 offen offset:1024 sc1
  v_mul_f32 v147, v147, v65
  v_cvt_pk_bf16_f32 v137, v146, v147
  v_mul_f32 v64, v140, v140
  v_mul_f32 v65, v141, v141
  v_mfma_f32_32x32x16_bf16 v[232:247], a[140:143], a[40:43], v[232:247]
  ds_read_b128 a[4:7], v8 offset:24576
  buffer_load_dwordx4 a[104:107], v1, s[60:63], s25 offen offset:2048 sc1
  v_fma_f32 v64, v64, v45, v44
  v_fma_f32 v65, v65, v45, v44
  v_mul_f32 v64, v64, v140
  v_mul_f32 v65, v65, v141
  s_waitcnt lgkmcnt(3)
  v_mfma_f32_32x32x16_bf16 v[184:199], a[144:147], a[44:47], v[184:199]
  ds_read_b128 a[8:11], v8 offset:28672
  v_exp_f32 v64, v64
  v_mul_f32 v148, v140, v148
  v_exp_f32 v65, v65
  v_mul_f32 v149, v141, v149
  v_mfma_f32_32x32x16_bf16 v[200:215], a[144:147], a[48:51], v[200:215]
  ds_read_b128 a[12:15], v9 offset:16384
  buffer_load_dwordx4 a[108:111], v1, s[60:63], s25 offen offset:3072 sc1
  v_fma_f32 v64, v64, v46, v46
  v_fma_f32 v65, v65, v46, v46
  v_rcp_f32 v64, v64
  v_rcp_f32 v65, v65
  v_mfma_f32_32x32x16_bf16 v[216:231], a[144:147], a[52:55], v[216:231]
  ds_read_b128 a[16:19], v9 offset:20480
  s_add_u32 s25, s25, 0x1000
  v_mul_f32 v148, v148, v64
  v_mul_f32 v149, v149, v65
  v_cvt_pk_bf16_f32 v138, v148, v149
  v_mul_f32 v64, v142, v142
  v_mfma_f32_32x32x16_bf16 v[232:247], a[144:147], a[56:59], v[232:247]
  ds_read_b128 a[20:23], v9 offset:24576
  buffer_load_dwordx4 a[112:115], v1, s[60:63], s25 offen sc1
  v_mul_f32 v65, v143, v143
  v_fma_f32 v64, v64, v45, v44
  v_fma_f32 v65, v65, v45, v44
  v_mul_f32 v64, v64, v142
  s_waitcnt lgkmcnt(3)
  v_mfma_f32_32x32x16_bf16 v[184:199], a[148:151], a[60:63], v[184:199]
  ds_read_b128 a[24:27], v9 offset:28672
  v_mul_f32 v65, v65, v143
  v_exp_f32 v64, v64
  v_mul_f32 v150, v142, v150
  v_exp_f32 v65, v65
  v_mfma_f32_32x32x16_bf16 v[200:215], a[148:151], a[0:3], v[200:215]
  ds_read_b128 a[28:31], v10 offset:16384
  buffer_load_dwordx4 a[116:119], v1, s[60:63], s25 offen offset:1024 sc1
  v_mul_f32 v151, v143, v151
  v_fma_f32 v64, v64, v46, v46
  v_fma_f32 v65, v65, v46, v46
  v_rcp_f32 v64, v64
  v_mfma_f32_32x32x16_bf16 v[216:231], a[148:151], a[4:7], v[216:231]
  ds_read_b128 a[32:35], v10 offset:20480
  ds_read_b128 a[36:39], v10 offset:24576
  ds_read_b128 a[40:43], v10 offset:28672
  buffer_load_dwordx4 a[120:123], v1, s[60:63], s25 offen offset:2048 sc1
  v_rcp_f32 v65, v65
  v_mul_f32 v150, v150, v64
  v_mul_f32 v151, v151, v65
  v_cvt_pk_bf16_f32 v139, v150, v151
  v_mfma_f32_32x32x16_bf16 v[232:247], a[148:151], a[8:11], v[232:247]
  buffer_load_dwordx4 a[124:127], v1, s[60:63], s25 offen offset:3072 sc1
  v_mul_f32 v64, v152, v152
  v_mul_f32 v65, v153, v153
  v_fma_f32 v64, v64, v45, v44
  v_fma_f32 v65, v65, v45, v44
  s_waitcnt lgkmcnt(4)
  v_mfma_f32_32x32x16_bf16 v[184:199], a[152:155], a[12:15], v[184:199]
  v_mul_f32 v64, v64, v152
  v_mul_f32 v65, v65, v153
  v_exp_f32 v64, v64
  v_mul_f32 v160, v152, v160
  s_waitcnt vmcnt(54) lgkmcnt(0)
  s_barrier
  v_mfma_f32_32x32x16_bf16 v[200:215], a[152:155], a[16:19], v[200:215]
  ds_read_b128 a[44:47], v7 offset:32768
  v_exp_f32 v65, v65
  v_mul_f32 v161, v153, v161
  v_fma_f32 v64, v64, v46, v46
  v_fma_f32 v65, v65, v46, v46
  v_mfma_f32_32x32x16_bf16 v[216:231], a[152:155], a[20:23], v[216:231]
  ds_read_b128 a[48:51], v7 offset:36864
  s_add_u32 s95, s98, 0x400
  v_rcp_f32 v64, v64
  v_rcp_f32 v65, v65
  v_mul_f32 v160, v160, v64
  v_mul_f32 v161, v161, v65
  v_mfma_f32_32x32x16_bf16 v[232:247], a[152:155], a[24:27], v[232:247]
  ds_read_b128 a[52:55], v7 offset:40960
  s_and_b32 s95, s95, 0x7ff
  v_cvt_pk_bf16_f32 v152, v160, v161
  v_mul_f32 v64, v154, v154
  v_mul_f32 v65, v155, v155
  v_fma_f32 v64, v64, v45, v44
  v_mfma_f32_32x32x16_bf16 v[184:199], a[156:159], a[28:31], v[184:199]
  ds_read_b128 a[56:59], v7 offset:45056
  s_add_u32 s95, s95, s80
  v_fma_f32 v65, v65, v45, v44
  v_mul_f32 v64, v64, v154
  v_mul_f32 v65, v65, v155
  v_exp_f32 v64, v64
  v_mfma_f32_32x32x16_bf16 v[200:215], a[156:159], a[32:35], v[200:215]
  ds_read_b128 a[60:63], v8 offset:32768
  v_mul_f32 v162, v154, v162
  v_exp_f32 v65, v65
  v_mul_f32 v163, v155, v163
  v_fma_f32 v64, v64, v46, v46
  v_mfma_f32_32x32x16_bf16 v[216:231], a[156:159], a[36:39], v[216:231]
  ds_read_b128 a[0:3], v8 offset:36864
  s_add_u32 m0, s72, 0
  v_fma_f32 v65, v65, v46, v46
  v_rcp_f32 v64, v64
  v_rcp_f32 v65, v65
  v_mul_f32 v162, v162, v64
  v_mfma_f32_32x32x16_bf16 v[232:247], a[156:159], a[40:43], v[232:247]
  ds_read_b128 a[4:7], v8 offset:40960
  buffer_load_dwordx4 v22, s[52:55], s95 offen lds
  v_mul_f32 v163, v163, v65
  v_cvt_pk_bf16_f32 v153, v162, v163
  v_mul_f32 v64, v156, v156
  v_mul_f32 v65, v157, v157
  s_waitcnt lgkmcnt(3)
  v_mfma_f32_32x32x16_bf16 v[184:199], a[160:163], a[44:47], v[184:199]
  ds_read_b128 a[8:11], v8 offset:45056
  buffer_load_dwordx4 v23, s[52:55], s95 offen offset:1024 lds
  v_fma_f32 v64, v64, v45, v44
  v_fma_f32 v65, v65, v45, v44
  v_mul_f32 v64, v64, v156
  v_mul_f32 v65, v65, v157
  v_mfma_f32_32x32x16_bf16 v[200:215], a[160:163], a[48:51], v[200:215]
  ds_read_b128 a[12:15], v9 offset:32768
  v_exp_f32 v64, v64
  v_mul_f32 v164, v156, v164
  v_exp_f32 v65, v65
  v_mul_f32 v165, v157, v165
  v_mfma_f32_32x32x16_bf16 v[216:231], a[160:163], a[52:55], v[216:231]
  ds_read_b128 a[16:19], v9 offset:36864
  buffer_load_dwordx4 v24, s[52:55], s95 offen offset:2048 lds
  v_fma_f32 v64, v64, v46, v46
  v_fma_f32 v65, v65, v46, v46
  v_rcp_f32 v64, v64
  v_rcp_f32 v65, v65
  v_mfma_f32_32x32x16_bf16 v[232:247], a[160:163], a[56:59], v[232:247]
  ds_read_b128 a[20:23], v9 offset:40960
  buffer_load_dwordx4 v25, s[52:55], s95 offen offset:3072 lds
  v_mul_f32 v164, v164, v64
  v_mul_f32 v165, v165, v65
  v_cvt_pk_bf16_f32 v154, v164, v165
  v_mul_f32 v64, v158, v158
  s_waitcnt lgkmcnt(3)
  v_mfma_f32_32x32x16_bf16 v[184:199], a[164:167], a[60:63], v[184:199]
  ds_read_b128 a[24:27], v9 offset:45056
  s_add_u32 m0, s72, 0x4000
  v_mul_f32 v65, v159, v159
  v_fma_f32 v64, v64, v45, v44
  v_fma_f32 v65, v65, v45, v44
  v_mul_f32 v64, v64, v158
  v_mfma_f32_32x32x16_bf16 v[200:215], a[164:167], a[0:3], v[200:215]
  ds_read_b128 a[28:31], v10 offset:32768
  v_mul_f32 v65, v65, v159
  v_exp_f32 v64, v64
  v_mul_f32 v166, v158, v166
  v_exp_f32 v65, v65
  v_mfma_f32_32x32x16_bf16 v[216:231], a[164:167], a[4:7], v[216:231]
  ds_read_b128 a[32:35], v10 offset:36864
  s_add_u32 s95, s95, 0x80
  v_mul_f32 v167, v159, v167
  v_fma_f32 v64, v64, v46, v46
  v_fma_f32 v65, v65, v46, v46
  v_rcp_f32 v64, v64
  v_mfma_f32_32x32x16_bf16 v[232:247], a[164:167], a[8:11], v[232:247]
  ds_read_b128 a[36:39], v10 offset:40960
  buffer_load_dwordx4 v22, s[52:55], s95 offen lds
  v_rcp_f32 v65, v65
  v_mul_f32 v166, v166, v64
  v_mul_f32 v167, v167, v65
  v_cvt_pk_bf16_f32 v155, v166, v167
  s_waitcnt lgkmcnt(3)
  v_mfma_f32_32x32x16_bf16 v[184:199], a[168:171], a[12:15], v[184:199]
  ds_read_b128 a[40:43], v10 offset:45056
  buffer_load_dwordx4 v23, s[52:55], s95 offen offset:1024 lds
  v_mul_f32 v64, v168, v168
  v_mul_f32 v65, v169, v169
  v_fma_f32 v64, v64, v45, v44
  v_fma_f32 v65, v65, v45, v44
  v_mfma_f32_32x32x16_bf16 v[200:215], a[168:171], a[16:19], v[200:215]
  ds_read_b128 a[44:47], v7 offset:49152
  v_mul_f32 v64, v64, v168
  v_mul_f32 v65, v65, v169
  v_exp_f32 v64, v64
  v_mul_f32 v176, v168, v176
  v_mfma_f32_32x32x16_bf16 v[216:231], a[168:171], a[20:23], v[216:231]
  ds_read_b128 a[48:51], v7 offset:53248
  buffer_load_dwordx4 v24, s[52:55], s95 offen offset:2048 lds
  v_exp_f32 v65, v65
  v_mul_f32 v177, v169, v177
  v_fma_f32 v64, v64, v46, v46
  v_fma_f32 v65, v65, v46, v46
  v_mfma_f32_32x32x16_bf16 v[232:247], a[168:171], a[24:27], v[232:247]
  ds_read_b128 a[52:55], v7 offset:57344
  buffer_load_dwordx4 v25, s[52:55], s95 offen offset:3072 lds
  v_rcp_f32 v64, v64
  v_rcp_f32 v65, v65
  v_mul_f32 v176, v176, v64
  v_mul_f32 v177, v177, v65
  s_waitcnt lgkmcnt(3)
  v_mfma_f32_32x32x16_bf16 v[184:199], a[172:175], a[28:31], v[184:199]
  ds_read_b128 a[56:59], v7 offset:61440
  v_cvt_pk_bf16_f32 v168, v176, v177
  v_mul_f32 v64, v170, v170
  v_mul_f32 v65, v171, v171
  v_fma_f32 v64, v64, v45, v44
  v_mfma_f32_32x32x16_bf16 v[200:215], a[172:175], a[32:35], v[200:215]
  ds_read_b128 a[60:63], v8 offset:49152
  v_fma_f32 v65, v65, v45, v44
  v_mul_f32 v64, v64, v170
  v_mul_f32 v65, v65, v171
  v_exp_f32 v64, v64
  v_mfma_f32_32x32x16_bf16 v[216:231], a[172:175], a[36:39], v[216:231]
  ds_read_b128 a[0:3], v8 offset:53248
  v_mul_f32 v178, v170, v178
  v_exp_f32 v65, v65
  v_mul_f32 v179, v171, v179
  v_fma_f32 v64, v64, v46, v46
  v_mfma_f32_32x32x16_bf16 v[232:247], a[172:175], a[40:43], v[232:247]
  ds_read_b128 a[4:7], v8 offset:57344
  v_fma_f32 v65, v65, v46, v46
  v_rcp_f32 v64, v64
  v_rcp_f32 v65, v65
  v_mul_f32 v178, v178, v64
  s_waitcnt lgkmcnt(3)
  v_mfma_f32_32x32x16_bf16 v[184:199], a[176:179], a[44:47], v[184:199]
  ds_read_b128 a[8:11], v8 offset:61440
  v_mul_f32 v179, v179, v65
  v_cvt_pk_bf16_f32 v169, v178, v179
  v_mul_f32 v64, v172, v172
  v_mul_f32 v65, v173, v173
  v_mfma_f32_32x32x16_bf16 v[200:215], a[176:179], a[48:51], v[200:215]
  ds_read_b128 a[12:15], v9 offset:49152
  v_fma_f32 v64, v64, v45, v44
  v_fma_f32 v65, v65, v45, v44
  v_mul_f32 v64, v64, v172
  v_mul_f32 v65, v65, v173
  v_mfma_f32_32x32x16_bf16 v[216:231], a[176:179], a[52:55], v[216:231]
  ds_read_b128 a[16:19], v9 offset:53248
  v_exp_f32 v64, v64
  v_mul_f32 v180, v172, v180
  v_exp_f32 v65, v65
  v_mul_f32 v181, v173, v181
  v_mfma_f32_32x32x16_bf16 v[232:247], a[176:179], a[56:59], v[232:247]
  ds_read_b128 a[20:23], v9 offset:57344
  v_fma_f32 v64, v64, v46, v46
  v_fma_f32 v65, v65, v46, v46
  v_rcp_f32 v64, v64
  v_rcp_f32 v65, v65
  s_waitcnt lgkmcnt(3)
  v_mfma_f32_32x32x16_bf16 v[184:199], a[180:183], a[60:63], v[184:199]
  ds_read_b128 a[24:27], v9 offset:61440
  v_mul_f32 v180, v180, v64
  v_mul_f32 v181, v181, v65
  v_cvt_pk_bf16_f32 v170, v180, v181
  v_mul_f32 v64, v174, v174
  v_mfma_f32_32x32x16_bf16 v[200:215], a[180:183], a[0:3], v[200:215]
  ds_read_b128 a[28:31], v10 offset:49152
  v_mul_f32 v65, v175, v175
  v_fma_f32 v64, v64, v45, v44
  v_fma_f32 v65, v65, v45, v44
  v_mul_f32 v64, v64, v174
  v_mfma_f32_32x32x16_bf16 v[216:231], a[180:183], a[4:7], v[216:231]
  ds_read_b128 a[32:35], v10 offset:53248
  ds_read_b128 a[36:39], v10 offset:57344
  ds_read_b128 a[40:43], v10 offset:61440
  v_mul_f32 v65, v65, v175
  v_exp_f32 v64, v64
  v_mul_f32 v182, v174, v182
  v_exp_f32 v65, v65
  v_mfma_f32_32x32x16_bf16 v[232:247], a[180:183], a[8:11], v[232:247]
  v_mul_f32 v183, v175, v183
  v_fma_f32 v64, v64, v46, v46
  v_fma_f32 v65, v65, v46, v46
  v_rcp_f32 v64, v64
  s_waitcnt lgkmcnt(4)
  v_mfma_f32_32x32x16_bf16 v[184:199], a[184:187], a[12:15], v[184:199]
  v_rcp_f32 v65, v65
  v_mul_f32 v182, v182, v64
  v_mul_f32 v183, v183, v65
  v_cvt_pk_bf16_f32 v171, v182, v183
  s_waitcnt lgkmcnt(0)
  s_barrier
  v_mfma_f32_32x32x16_bf16 v[200:215], a[184:187], a[16:19], v[200:215]
  ds_read_b128 a[44:47], v11
  buffer_store_dwordx4 v[72:75], v1, s[60:63], s86 offen sc1
  buffer_store_dwordx4 v[88:91], v1, s[60:63], s86 offen offset:1024 sc1
  buffer_store_dwordx4 v[104:107], v1, s[60:63], s86 offen offset:2048 sc1
  buffer_store_dwordx4 v[120:123], v1, s[60:63], s86 offen offset:3072 sc1
  v_mfma_f32_32x32x16_bf16 v[216:231], a[184:187], a[20:23], v[216:231]
  ds_read_b128 a[48:51], v11 offset:4096
  s_add_u32 s86, s86, 0x1000
  buffer_store_dwordx4 v[136:139], v1, s[60:63], s86 offen sc1
  buffer_store_dwordx4 v[152:155], v1, s[60:63], s86 offen offset:1024 sc1
  buffer_store_dwordx4 v[168:171], v1, s[60:63], s86 offen offset:2048 sc1
  v_mfma_f32_32x32x16_bf16 v[232:247], a[184:187], a[24:27], v[232:247]
  ds_read_b128 a[52:55], v11 offset:8192
  v_mfma_f32_32x32x16_bf16 v[184:199], a[188:191], a[28:31], v[184:199]
  ds_read_b128 a[56:59], v11 offset:12288
  v_lshrrev_b32 v82, 5, v0
  v_bfe_u32 v65, v0, 2, 2
  v_mfma_f32_32x32x16_bf16 v[200:215], a[188:191], a[32:35], v[200:215]
  ds_read_b128 a[60:63], v12
  v_lshl_add_u32 v64, v82, 2, v65
  v_lshlrev_b32 v64, 7, v64
  v_mfma_f32_32x32x16_bf16 v[216:231], a[188:191], a[36:39], v[216:231]
  ds_read_b128 a[0:3], v12 offset:4096
  v_bfe_u32 v65, v0, 4, 1
  v_lshlrev_b32 v65, 1, v65
  v_mfma_f32_32x32x16_bf16 v[232:247], a[188:191], a[40:43], v[232:247]
  ds_read_b128 a[4:7], v12 offset:8192
  v_bfe_u32 v66, v0, 1, 1
  v_add_u32 v65, v65, v66
  s_waitcnt lgkmcnt(3)
  s_waitcnt vmcnt(63)
  v_mfma_f32_32x32x16_bf16 v[184:199], a[192:195], a[44:47], v[184:199]
  ds_read_b128 a[8:11], v12 offset:12288
  s_and_b32 s8, s3, 1
  s_lshl_b32 s8, s8, 2
  v_mfma_f32_32x32x16_bf16 v[200:215], a[192:195], a[48:51], v[200:215]
  ds_read_b128 a[12:15], v13
  v_add_u32 v65, s8, v65
  v_bfe_u32 v66, v0, 3, 1
  v_mfma_f32_32x32x16_bf16 v[216:231], a[192:195], a[52:55], v[216:231]
  ds_read_b128 a[16:19], v13 offset:4096
  v_lshlrev_b32 v66, 2, v66
  v_xor_b32 v65, v65, v66
  v_mfma_f32_32x32x16_bf16 v[232:247], a[192:195], a[56:59], v[232:247]
  ds_read_b128 a[20:23], v13 offset:8192
  v_lshl_add_u32 v64, v65, 4, v64
  s_lshr_b32 s9, s3, 1
  s_waitcnt lgkmcnt(3)
  v_mfma_f32_32x32x16_bf16 v[184:199], a[196:199], a[60:63], v[184:199]
  ds_read_b128 a[24:27], v13 offset:12288
  s_lshl_b32 s9, s9, 13
  v_add_u32 v64, s9, v64
  v_mfma_f32_32x32x16_bf16 v[200:215], a[196:199], a[0:3], v[200:215]
  ds_read_b128 a[28:31], v14
  v_and_b32 v66, 1, v0
  v_lshl_add_u32 v72, v66, 3, v64
  v_mfma_f32_32x32x16_bf16 v[216:231], a[196:199], a[4:7], v[216:231]
  ds_read_b128 a[32:35], v14 offset:4096
  v_add_u32 v73, 0x10000, v72
  v_add_u32 v74, 0x20000, v72
  v_mfma_f32_32x32x16_bf16 v[232:247], a[196:199], a[8:11], v[232:247]
  ds_read_b128 a[36:39], v14 offset:8192
  v_mov_b32 v75, v1
  v_add_u32 v76, 0x10000, v1
  s_waitcnt lgkmcnt(3)
  v_mfma_f32_32x32x16_bf16 v[184:199], a[200:203], a[12:15], v[184:199]
  ds_read_b128 a[40:43], v14 offset:12288
  v_add_u32 v77, 0x20000, v1
  v_lshlrev_b32 v81, 6, v47
  v_mfma_f32_32x32x16_bf16 v[200:215], a[200:203], a[16:19], v[200:215]
  ds_read_b128 a[44:47], v11 offset:16384
  v_lshl_add_u32 v81, v82, 3, v81
  buffer_load_dwordx2 v[124:125], v81, s[40:43], s93 offen
  v_mfma_f32_32x32x16_bf16 v[216:231], a[200:203], a[20:23], v[216:231]
  ds_read_b128 a[48:51], v11 offset:20480
  buffer_load_dwordx2 v[126:127], v81, s[40:43], s93 offen offset:16
  buffer_load_dwordx2 v[128:129], v81, s[40:43], s93 offen offset:32
  v_mfma_f32_32x32x16_bf16 v[232:247], a[200:203], a[24:27], v[232:247]
  ds_read_b128 a[52:55], v11 offset:24576
  buffer_load_dwordx2 v[130:131], v81, s[40:43], s93 offen offset:48
  s_waitcnt lgkmcnt(3)
  v_mfma_f32_32x32x16_bf16 v[184:199], a[204:207], a[28:31], v[184:199]
  ds_read_b128 a[56:59], v11 offset:28672
  v_mfma_f32_32x32x16_bf16 v[200:215], a[204:207], a[32:35], v[200:215]
  ds_read_b128 a[60:63], v12 offset:16384
  v_mfma_f32_32x32x16_bf16 v[216:231], a[204:207], a[36:39], v[216:231]
  ds_read_b128 a[0:3], v12 offset:20480
  v_mfma_f32_32x32x16_bf16 v[232:247], a[204:207], a[40:43], v[232:247]
  ds_read_b128 a[4:7], v12 offset:24576
  s_waitcnt lgkmcnt(3)
  v_mfma_f32_32x32x16_bf16 v[184:199], a[208:211], a[44:47], v[184:199]
  ds_read_b128 a[8:11], v12 offset:28672
  s_waitcnt vmcnt(4)
  s_barrier
  s_mov_b32 s94, 0x8000
  buffer_store_dwordx2 v[34:35], v33, s[60:63], s94 offen sc1
  v_mfma_f32_32x32x16_bf16 v[200:215], a[208:211], a[48:51], v[200:215]
  ds_read_b128 a[12:15], v13 offset:16384
  v_mfma_f32_32x32x16_bf16 v[216:231], a[208:211], a[52:55], v[216:231]
  ds_read_b128 a[16:19], v13 offset:20480
  v_mfma_f32_32x32x16_bf16 v[232:247], a[208:211], a[56:59], v[232:247]
  ds_read_b128 a[20:23], v13 offset:24576
  buffer_load_dword v49, v6, s[56:59], 0 offen
  s_waitcnt lgkmcnt(3)
  v_mfma_f32_32x32x16_bf16 v[184:199], a[212:215], a[60:63], v[184:199]
  ds_read_b128 a[24:27], v13 offset:28672
  v_mfma_f32_32x32x16_bf16 v[200:215], a[212:215], a[0:3], v[200:215]
  ds_read_b128 a[28:31], v14 offset:16384
  v_mfma_f32_32x32x16_bf16 v[216:231], a[212:215], a[4:7], v[216:231]
  ds_read_b128 a[32:35], v14 offset:20480
  ds_read_b128 a[36:39], v14 offset:24576
  ds_read_b128 a[40:43], v14 offset:28672
  v_mfma_f32_32x32x16_bf16 v[232:247], a[212:215], a[8:11], v[232:247]
  s_waitcnt lgkmcnt(4)
  v_mfma_f32_32x32x16_bf16 v[184:199], a[216:219], a[12:15], v[184:199]
  s_waitcnt lgkmcnt(0)
  s_barrier
  v_mfma_f32_32x32x16_bf16 v[200:215], a[216:219], a[16:19], v[200:215]
  ds_read_b128 a[44:47], v11 offset:32768
  v_mfma_f32_32x32x16_bf16 v[216:231], a[216:219], a[20:23], v[216:231]
  ds_read_b128 a[48:51], v11 offset:36864
  s_add_u32 m0, s72, 0x8000
  v_mfma_f32_32x32x16_bf16 v[232:247], a[216:219], a[24:27], v[232:247]
  ds_read_b128 a[52:55], v11 offset:40960
  s_add_u32 s95, s101, 0
  v_mfma_f32_32x32x16_bf16 v[184:199], a[220:223], a[28:31], v[184:199]
  ds_read_b128 a[56:59], v11 offset:45056
  s_sub_u32 s12, s95, 6
  v_mfma_f32_32x32x16_bf16 v[200:215], a[220:223], a[32:35], v[200:215]
  ds_read_b128 a[60:63], v12 offset:32768
  v_mfma_f32_32x32x16_bf16 v[216:231], a[220:223], a[36:39], v[216:231]
  ds_read_b128 a[0:3], v12 offset:36864
  s_min_u32 s95, s95, s12
  v_mfma_f32_32x32x16_bf16 v[232:247], a[220:223], a[40:43], v[232:247]
  ds_read_b128 a[4:7], v12 offset:40960
  s_mul_i32 s95, s95, 0x10000
  s_waitcnt lgkmcnt(3)
  v_mfma_f32_32x32x16_bf16 v[184:199], a[224:227], a[44:47], v[184:199]
  ds_read_b128 a[8:11], v12 offset:45056
  s_add_u32 s95, s95, s81
  v_mfma_f32_32x32x16_bf16 v[200:215], a[224:227], a[48:51], v[200:215]
  ds_read_b128 a[12:15], v13 offset:32768
  v_mfma_f32_32x32x16_bf16 v[216:231], a[224:227], a[52:55], v[216:231]
  ds_read_b128 a[16:19], v13 offset:36864
  buffer_load_dwordx4 v2, s[56:59], s95 offen lds
  v_mfma_f32_32x32x16_bf16 v[232:247], a[224:227], a[56:59], v[232:247]
  ds_read_b128 a[20:23], v13 offset:40960
  buffer_load_dwordx4 v3, s[56:59], s95 offen offset:1024 lds
  s_waitcnt lgkmcnt(3)
  v_mfma_f32_32x32x16_bf16 v[184:199], a[228:231], a[60:63], v[184:199]
  ds_read_b128 a[24:27], v13 offset:45056
  buffer_load_dwordx4 v4, s[56:59], s95 offen offset:2048 lds
  v_mfma_f32_32x32x16_bf16 v[200:215], a[228:231], a[0:3], v[200:215]
  ds_read_b128 a[28:31], v14 offset:32768
  v_mfma_f32_32x32x16_bf16 v[216:231], a[228:231], a[4:7], v[216:231]
  ds_read_b128 a[32:35], v14 offset:36864
  buffer_load_dwordx4 v5, s[56:59], s95 offen offset:3072 lds
  v_mfma_f32_32x32x16_bf16 v[232:247], a[228:231], a[8:11], v[232:247]
  ds_read_b128 a[36:39], v14 offset:40960
  s_waitcnt lgkmcnt(3)
  v_mfma_f32_32x32x16_bf16 v[184:199], a[232:235], a[12:15], v[184:199]
  ds_read_b128 a[40:43], v14 offset:45056
  v_mfma_f32_32x32x16_bf16 v[200:215], a[232:235], a[16:19], v[200:215]
  ds_read_b128 a[44:47], v11 offset:49152
  v_mfma_f32_32x32x16_bf16 v[216:231], a[232:235], a[20:23], v[216:231]
  ds_read_b128 a[48:51], v11 offset:53248
  v_mfma_f32_32x32x16_bf16 v[232:247], a[232:235], a[24:27], v[232:247]
  ds_read_b128 a[52:55], v11 offset:57344
  s_waitcnt lgkmcnt(3)
  v_mfma_f32_32x32x16_bf16 v[184:199], a[236:239], a[28:31], v[184:199]
  ds_read_b128 a[56:59], v11 offset:61440
  v_mfma_f32_32x32x16_bf16 v[200:215], a[236:239], a[32:35], v[200:215]
  ds_read_b128 a[60:63], v12 offset:49152
  s_add_u32 m0, s72, 0x10000
  v_mfma_f32_32x32x16_bf16 v[216:231], a[236:239], a[36:39], v[216:231]
  ds_read_b128 a[0:3], v12 offset:53248
  s_add_u32 s95, s101, 1
  v_mfma_f32_32x32x16_bf16 v[232:247], a[236:239], a[40:43], v[232:247]
  ds_read_b128 a[4:7], v12 offset:57344
  s_sub_u32 s12, s95, 6
  s_waitcnt lgkmcnt(3)
  v_mfma_f32_32x32x16_bf16 v[184:199], a[240:243], a[44:47], v[184:199]
  ds_read_b128 a[8:11], v12 offset:61440
  s_min_u32 s95, s95, s12
  v_mfma_f32_32x32x16_bf16 v[200:215], a[240:243], a[48:51], v[200:215]
  ds_read_b128 a[12:15], v13 offset:49152
  s_mul_i32 s95, s95, 0x10000
  v_mfma_f32_32x32x16_bf16 v[216:231], a[240:243], a[52:55], v[216:231]
  ds_read_b128 a[16:19], v13 offset:53248
  v_mfma_f32_32x32x16_bf16 v[232:247], a[240:243], a[56:59], v[232:247]
  ds_read_b128 a[20:23], v13 offset:57344
  s_add_u32 s95, s95, s81
  s_waitcnt lgkmcnt(3)
  v_mfma_f32_32x32x16_bf16 v[184:199], a[244:247], a[60:63], v[184:199]
  ds_read_b128 a[24:27], v13 offset:61440
  buffer_load_dwordx4 v2, s[56:59], s95 offen lds
  v_mfma_f32_32x32x16_bf16 v[200:215], a[244:247], a[0:3], v[200:215]
  ds_read_b128 a[28:31], v14 offset:49152
  buffer_load_dwordx4 v3, s[56:59], s95 offen offset:1024 lds
  v_mfma_f32_32x32x16_bf16 v[216:231], a[244:247], a[4:7], v[216:231]
  ds_read_b128 a[32:35], v14 offset:53248
  ds_read_b128 a[36:39], v14 offset:57344
  ds_read_b128 a[40:43], v14 offset:61440
  buffer_load_dwordx4 v4, s[56:59], s95 offen offset:2048 lds
  v_mfma_f32_32x32x16_bf16 v[232:247], a[244:247], a[8:11], v[232:247]
  buffer_load_dwordx4 v5, s[56:59], s95 offen offset:3072 lds
  s_waitcnt lgkmcnt(4)
  v_mfma_f32_32x32x16_bf16 v[184:199], a[248:251], a[12:15], v[184:199]
  s_waitcnt lgkmcnt(0)
  s_barrier
  v_mfma_f32_32x32x16_bf16 v[200:215], a[248:251], a[16:19], v[200:215]
  ds_read_b128 a[44:47], v15 offset:4096
  v_mfma_f32_32x32x16_bf16 v[216:231], a[248:251], a[20:23], v[216:231]
  ds_read_b128 a[48:51], v15 offset:8192
  s_add_u32 m0, s72, 0x18000
  v_mfma_f32_32x32x16_bf16 v[232:247], a[248:251], a[24:27], v[232:247]
  ds_read_b128 a[52:55], v15 offset:12288
  ds_read_b128 a[224:227], v15
  s_add_u32 s95, s101, 2
  v_mfma_f32_32x32x16_bf16 v[184:199], a[252:255], a[28:31], v[184:199]
  ds_read_b128 a[56:59], v16 offset:4096
  s_sub_u32 s12, s95, 6
  v_mfma_f32_32x32x16_bf16 v[200:215], a[252:255], a[32:35], v[200:215]
  ds_read_b128 a[60:63], v16 offset:8192
  s_min_u32 s95, s95, s12
  v_mfma_f32_32x32x16_bf16 v[216:231], a[252:255], a[36:39], v[216:231]
  ds_read_b128 a[0:3], v16 offset:12288
  ds_read_b128 a[228:231], v16
  s_mul_i32 s95, s95, 0x10000
  v_mfma_f32_32x32x16_bf16 v[232:247], a[252:255], a[40:43], v[232:247]
  ds_read_b128 a[4:7], v17 offset:4096
  s_waitcnt lgkmcnt(4)
  v_mfma_f32_32x32x16_bf16 v[200:215], a[64:67], a[44:47], v[200:215]
  ds_read_b128 a[8:11], v17 offset:8192
  s_add_u32 s95, s95, s81
  v_mfma_f32_32x32x16_bf16 v[216:231], a[64:67], a[48:51], v[216:231]
  ds_read_b128 a[12:15], v17 offset:12288
  ds_read_b128 a[232:235], v17
  buffer_load_dwordx4 v2, s[56:59], s95 offen lds
  v_mfma_f32_32x32x16_bf16 v[232:247], a[64:67], a[52:55], v[232:247]
  ds_read_b128 a[16:19], v18 offset:4096
  buffer_load_dwordx4 v3, s[56:59], s95 offen offset:1024 lds
  v_mfma_f32_32x32x16_bf16 v[200:215], a[68:71], a[56:59], v[200:215]
  ds_read_b128 a[20:23], v18 offset:8192
  buffer_load_dwordx4 v4, s[56:59], s95 offen offset:2048 lds
  s_waitcnt lgkmcnt(4)
  v_mfma_f32_32x32x16_bf16 v[216:231], a[68:71], a[60:63], v[216:231]
  ds_read_b128 a[24:27], v18 offset:12288
  ds_read_b128 a[236:239], v18
  buffer_load_dwordx4 v5, s[56:59], s95 offen offset:3072 lds
  v_mfma_f32_32x32x16_bf16 v[232:247], a[68:71], a[0:3], v[232:247]
  ds_read_b128 a[28:31], v15 offset:20480
  v_mfma_f32_32x32x16_bf16 v[200:215], a[72:75], a[4:7], v[200:215]
  ds_read_b128 a[32:35], v15 offset:24576
  v_mfma_f32_32x32x16_bf16 v[216:231], a[72:75], a[8:11], v[216:231]
  ds_read_b128 a[36:39], v15 offset:28672
  ds_read_b128 a[240:243], v15 offset:16384
  buffer_load_dwordx2 v[36:37], v31, s[60:63], 0 offen sc1
  s_waitcnt lgkmcnt(4)
  v_mfma_f32_32x32x16_bf16 v[232:247], a[72:75], a[12:15], v[232:247]
  ds_read_b128 a[40:43], v16 offset:20480
  s_mov_b32 s94, 0x3f80
  s_mov_b32 s99, 0x3f800000
  v_mfma_f32_32x32x16_bf16 v[200:215], a[76:79], a[16:19], v[200:215]
  ds_read_b128 a[44:47], v16 offset:24576
  s_waitcnt vmcnt(18)
  v_dot2c_f32_bf16 v184, s94, v124
  v_dot2c_f32_bf16 v185, s99, v124
  v_mfma_f32_32x32x16_bf16 v[216:231], a[76:79], a[20:23], v[216:231]
  ds_read_b128 a[48:51], v16 offset:28672
  ds_read_b128 a[244:247], v16 offset:16384
  v_dot2c_f32_bf16 v186, s94, v125
  v_dot2c_f32_bf16 v187, s99, v125
  v_mfma_f32_32x32x16_bf16 v[232:247], a[76:79], a[24:27], v[232:247]
  ds_read_b128 a[52:55], v17 offset:20480
  s_waitcnt vmcnt(17)
  v_dot2c_f32_bf16 v188, s94, v126
  v_dot2c_f32_bf16 v189, s99, v126
  s_waitcnt lgkmcnt(4)
  v_mfma_f32_32x32x16_bf16 v[200:215], a[80:83], a[28:31], v[200:215]
  ds_read_b128 a[56:59], v17 offset:24576
  v_dot2c_f32_bf16 v190, s94, v127
  v_dot2c_f32_bf16 v191, s99, v127
  v_mfma_f32_32x32x16_bf16 v[216:231], a[80:83], a[32:35], v[216:231]
  ds_read_b128 a[60:63], v17 offset:28672
  ds_read_b128 a[248:251], v17 offset:16384
  s_waitcnt vmcnt(16)
  v_dot2c_f32_bf16 v192, s94, v128
  v_dot2c_f32_bf16 v193, s99, v128
  v_mfma_f32_32x32x16_bf16 v[232:247], a[80:83], a[36:39], v[232:247]
  ds_read_b128 a[0:3], v18 offset:20480
  ds_read_b128 a[4:7], v18 offset:24576
  ds_read_b128 a[8:11], v18 offset:28672
  ds_read_b128 a[252:255], v18 offset:16384
  v_dot2c_f32_bf16 v194, s94, v129
  v_dot2c_f32_bf16 v195, s99, v129
  v_mfma_f32_32x32x16_bf16 v[200:215], a[84:87], a[40:43], v[200:215]
  s_waitcnt vmcnt(15)
  v_dot2c_f32_bf16 v196, s94, v130
  v_dot2c_f32_bf16 v197, s99, v130
  s_waitcnt lgkmcnt(6)
  v_mfma_f32_32x32x16_bf16 v[216:231], a[84:87], a[44:47], v[216:231]
  v_dot2c_f32_bf16 v198, s94, v131
  v_dot2c_f32_bf16 v199, s99, v131
  s_waitcnt lgkmcnt(0)
  s_barrier
  v_mfma_f32_32x32x16_bf16 v[232:247], a[84:87], a[48:51], v[232:247]
  ds_read_b128 a[12:15], v7 offset:4096
  s_waitcnt vmcnt(0)
  v_cmp_eq_u64 vcc, v[36:37], v[34:35]
  s_nop 0
  s_cmp_eq_u64 vcc, -1
  s_cbranch_scc0 L1_slow_kh
L1_res_kh:
  s_add_u32 m0, s72, 0xc000
  s_add_u32 s95, s101, 0
  s_sub_u32 s12, s95, 6
  v_lshl_add_u32 v81, v82, 3, v81
  v_mfma_f32_32x32x16_bf16 v[200:215], a[88:91], a[52:55], v[200:215]
  ds_read_b128 a[16:19], v7 offset:8192
  s_min_u32 s95, s95, s12
  s_mul_i32 s95, s95, 0x1000
  s_add_u32 s95, s95, s82
  buffer_load_dwordx4 v1, s[60:63], s95 offen sc1 lds
  v_mfma_f32_32x32x16_bf16 v[216:231], a[88:91], a[56:59], v[216:231]
  ds_read_b128 a[20:23], v7 offset:12288
  ds_read_b128 a[192:195], v7
  buffer_load_dwordx4 v1, s[60:63], s95 offen offset:1024 sc1 lds
  buffer_load_dwordx4 v1, s[60:63], s95 offen offset:2048 sc1 lds
  buffer_load_dwordx4 v1, s[60:63], s95 offen offset:3072 sc1 lds
  s_add_u32 m0, s72, 0x14000
  v_mfma_f32_32x32x16_bf16 v[232:247], a[88:91], a[60:63], v[232:247]
  ds_read_b128 a[24:27], v8 offset:4096
  s_add_u32 s95, s101, 1
  s_sub_u32 s12, s95, 6
  s_min_u32 s95, s95, s12
  s_mul_i32 s95, s95, 0x1000
  v_mfma_f32_32x32x16_bf16 v[200:215], a[92:95], a[0:3], v[200:215]
  ds_read_b128 a[28:31], v8 offset:8192
  s_add_u32 s95, s95, s82
  buffer_load_dwordx4 v1, s[60:63], s95 offen sc1 lds
  buffer_load_dwordx4 v1, s[60:63], s95 offen offset:1024 sc1 lds
  buffer_load_dwordx4 v1, s[60:63], s95 offen offset:2048 sc1 lds
  v_mfma_f32_32x32x16_bf16 v[216:231], a[92:95], a[4:7], v[216:231]
  ds_read_b128 a[32:35], v8 offset:12288
  ds_read_b128 a[196:199], v8
  buffer_load_dwordx4 v1, s[60:63], s95 offen offset:3072 sc1 lds
  v_mfma_f32_32x32x16_bf16 v[232:247], a[92:95], a[8:11], v[232:247]
  ds_read_b128 a[36:39], v9 offset:4096
  s_waitcnt lgkmcnt(4)
  v_mfma_f32_32x32x16_bf16 v[200:215], a[96:99], a[12:15], v[200:215]
  ds_read_b128 a[40:43], v9 offset:8192
  v_mfma_f32_32x32x16_bf16 v[216:231], a[96:99], a[16:19], v[216:231]
  ds_read_b128 a[44:47], v9 offset:12288
  ds_read_b128 a[200:203], v9
  v_mfma_f32_32x32x16_bf16 v[232:247], a[96:99], a[20:23], v[232:247]
  ds_read_b128 a[48:51], v10 offset:4096
  v_mfma_f32_32x32x16_bf16 v[200:215], a[100:103], a[24:27], v[200:215]
  ds_read_b128 a[52:55], v10 offset:8192
  s_waitcnt lgkmcnt(4)
  v_mfma_f32_32x32x16_bf16 v[216:231], a[100:103], a[28:31], v[216:231]
  ds_read_b128 a[56:59], v10 offset:12288
  ds_read_b128 a[204:207], v10
  v_mfma_f32_32x32x16_bf16 v[232:247], a[100:103], a[32:35], v[232:247]
  ds_read_b128 a[60:63], v7 offset:20480
  v_mfma_f32_32x32x16_bf16 v[200:215], a[104:107], a[36:39], v[200:215]
  ds_read_b128 a[0:3], v7 offset:24576
  s_add_u32 m0, s72, 0x1c000
  s_add_u32 s95, s101, 2
  s_sub_u32 s12, s95, 6
  v_mfma_f32_32x32x16_bf16 v[216:231], a[104:107], a[40:43], v[216:231]
  ds_read_b128 a[4:7], v7 offset:28672
  ds_read_b128 a[208:211], v7 offset:16384
  s_min_u32 s95, s95, s12
  s_mul_i32 s95, s95, 0x1000
  s_add_u32 s95, s95, s82
  s_waitcnt lgkmcnt(4)
  v_mfma_f32_32x32x16_bf16 v[232:247], a[104:107], a[44:47], v[232:247]
  ds_read_b128 a[8:11], v8 offset:20480
  buffer_load_dwordx4 v1, s[60:63], s95 offen sc1 lds
  buffer_load_dwordx4 v1, s[60:63], s95 offen offset:1024 sc1 lds
  buffer_load_dwordx4 v1, s[60:63], s95 offen offset:2048 sc1 lds
  v_mfma_f32_32x32x16_bf16 v[200:215], a[108:111], a[48:51], v[200:215]
  ds_read_b128 a[12:15], v8 offset:24576
  buffer_load_dwordx4 v1, s[60:63], s95 offen offset:3072 sc1 lds
  s_add_u32 m0, s72, 0x20000
  s_add_u32 s95, s101, 3
  v_mfma_f32_32x32x16_bf16 v[216:231], a[108:111], a[52:55], v[216:231]
  ds_read_b128 a[16:19], v8 offset:28672
  ds_read_b128 a[212:215], v8 offset:16384
  s_sub_u32 s12, s95, 6
  s_min_u32 s95, s95, s12
  s_mul_i32 s95, s95, 0x10000
  v_mfma_f32_32x32x16_bf16 v[232:247], a[108:111], a[56:59], v[232:247]
  ds_read_b128 a[20:23], v9 offset:20480
  s_add_u32 s95, s95, s81
  buffer_load_dwordx4 v2, s[56:59], s95 offen lds
  buffer_load_dwordx4 v3, s[56:59], s95 offen offset:1024 lds
  s_waitcnt lgkmcnt(4)
  v_mfma_f32_32x32x16_bf16 v[200:215], a[112:115], a[60:63], v[200:215]
  ds_read_b128 a[24:27], v9 offset:24576
  buffer_load_dwordx4 v4, s[56:59], s95 offen offset:2048 lds
  buffer_load_dwordx4 v5, s[56:59], s95 offen offset:3072 lds
  s_add_u32 m0, s72, 0x24000
  v_mfma_f32_32x32x16_bf16 v[216:231], a[112:115], a[0:3], v[216:231]
  ds_read_b128 a[28:31], v9 offset:28672
  ds_read_b128 a[216:219], v9 offset:16384
  s_add_u32 s95, s101, 3
  s_sub_u32 s12, s95, 6
  s_min_u32 s95, s95, s12
  v_mfma_f32_32x32x16_bf16 v[232:247], a[112:115], a[4:7], v[232:247]
  ds_read_b128 a[32:35], v10 offset:20480
  ds_read_b128 a[36:39], v10 offset:24576
  ds_read_b128 a[40:43], v10 offset:28672
  ds_read_b128 a[220:223], v10 offset:16384
  s_mul_i32 s95, s95, 0x1000
  s_add_u32 s95, s95, s82
  buffer_load_dwordx4 v1, s[60:63], s95 offen sc1 lds
  v_mfma_f32_32x32x16_bf16 v[200:215], a[116:119], a[8:11], v[200:215]
  buffer_load_dwordx4 v1, s[60:63], s95 offen offset:1024 sc1 lds
  buffer_load_dwordx4 v1, s[60:63], s95 offen offset:2048 sc1 lds
  buffer_load_dwordx4 v1, s[60:63], s95 offen offset:3072 sc1 lds
  s_waitcnt lgkmcnt(6)
  v_mfma_f32_32x32x16_bf16 v[216:231], a[116:119], a[12:15], v[216:231]
  s_waitcnt vmcnt(16) lgkmcnt(0)
  s_barrier
  v_mfma_f32_32x32x16_bf16 v[232:247], a[116:119], a[16:19], v[232:247]
  ds_read_b64_tr_b16 a[44:45], v72 offset:32768
  ds_read_b64_tr_b16 a[46:47], v72 offset:33792
  ds_read_b128 a[48:51], v75 offset:49152
  s_add_u32 m0, s72, 0
  v_mfma_f32_32x32x16_bf16 v[200:215], a[120:123], a[20:23], v[200:215]
  ds_read_b128 a[52:55], v75 offset:53248
  s_add_u32 s95, s101, 4
  v_mfma_f32_32x32x16_bf16 v[216:231], a[120:123], a[24:27], v[216:231]
  ds_read_b128 a[56:59], v75 offset:57344
  s_sub_u32 s12, s95, 6
  v_mfma_f32_32x32x16_bf16 v[232:247], a[120:123], a[28:31], v[232:247]
  ds_read_b128 a[60:63], v75 offset:61440
  s_min_u32 s95, s95, s12
  s_mul_i32 s95, s95, 0x10000
  v_mfma_f32_32x32x16_bf16 v[200:215], a[124:127], a[32:35], v[200:215]
  ds_read_b64_tr_b16 a[0:1], v72 offset:34816
  ds_read_b64_tr_b16 a[2:3], v72 offset:35840
  ds_read_b128 a[4:7], v75 offset:50176
  s_add_u32 s95, s95, s81
  v_mfma_f32_32x32x16_bf16 v[216:231], a[124:127], a[36:39], v[216:231]
  ds_read_b128 a[8:11], v75 offset:54272
  buffer_load_dwordx4 v2, s[56:59], s95 offen lds
  v_mfma_f32_32x32x16_bf16 v[232:247], a[124:127], a[40:43], v[232:247]
  ds_read_b128 a[12:15], v75 offset:58368
  buffer_load_dwordx4 v3, s[56:59], s95 offen offset:1024 lds
  buffer_load_dwordx4 v4, s[56:59], s95 offen offset:2048 lds
  s_waitcnt lgkmcnt(5)
  v_mfma_f32_32x32x16_bf16 v[184:199], a[44:47], a[48:51], v[184:199]
  ds_read_b128 a[16:19], v75 offset:62464
  buffer_load_dwordx4 v5, s[56:59], s95 offen offset:3072 lds
  v_mfma_f32_32x32x16_bf16 v[200:215], a[44:47], a[52:55], v[200:215]
  ds_read_b64_tr_b16 a[20:21], v72 offset:36864
  ds_read_b64_tr_b16 a[22:23], v72 offset:37888
  ds_read_b128 a[24:27], v75 offset:51200
  s_add_u32 m0, s72, 0x4000
  v_mfma_f32_32x32x16_bf16 v[216:231], a[44:47], a[56:59], v[216:231]
  ds_read_b128 a[28:31], v75 offset:55296
  s_add_u32 s95, s101, 4
  s_sub_u32 s12, s95, 6
  v_mfma_f32_32x32x16_bf16 v[232:247], a[44:47], a[60:63], v[232:247]
  ds_read_b128 a[32:35], v75 offset:59392
  s_min_u32 s95, s95, s12
  s_waitcnt lgkmcnt(5)
  v_mfma_f32_32x32x16_bf16 v[184:199], a[0:3], a[4:7], v[184:199]
  ds_read_b128 a[36:39], v75 offset:63488
  s_mul_i32 s95, s95, 0x1000
  v_mfma_f32_32x32x16_bf16 v[200:215], a[0:3], a[8:11], v[200:215]
  ds_read_b64_tr_b16 a[40:41], v72 offset:38912
  ds_read_b64_tr_b16 a[42:43], v72 offset:39936
  ds_read_b128 a[44:47], v75 offset:52224
  s_add_u32 s95, s95, s82
  buffer_load_dwordx4 v1, s[60:63], s95 offen sc1 lds
  v_mfma_f32_32x32x16_bf16 v[216:231], a[0:3], a[12:15], v[216:231]
  ds_read_b128 a[48:51], v75 offset:56320
  ds_read_b128 a[52:55], v75 offset:60416
  ds_read_b128 a[56:59], v75 offset:64512
  buffer_load_dwordx4 v1, s[60:63], s95 offen offset:1024 sc1 lds
  v_mfma_f32_32x32x16_bf16 v[232:247], a[0:3], a[16:19], v[232:247]
  buffer_load_dwordx4 v1, s[60:63], s95 offen offset:2048 sc1 lds
  s_waitcnt lgkmcnt(6)
  v_mfma_f32_32x32x16_bf16 v[184:199], a[20:23], a[24:27], v[184:199]
  buffer_load_dwordx4 v1, s[60:63], s95 offen offset:3072 sc1 lds
  s_waitcnt vmcnt(20) lgkmcnt(0)
  s_barrier
  v_mfma_f32_32x32x16_bf16 v[200:215], a[20:23], a[28:31], v[200:215]
  ds_read_b64_tr_b16 a[60:61], v73
  ds_read_b64_tr_b16 a[62:63], v73 offset:1024
  ds_read_b128 a[0:3], v76 offset:16384
  s_add_u32 m0, s72, 0x8000
  v_mfma_f32_32x32x16_bf16 v[216:231], a[20:23], a[32:35], v[216:231]
  ds_read_b128 a[4:7], v76 offset:20480
  s_add_u32 s95, s101, 5
  v_mfma_f32_32x32x16_bf16 v[232:247], a[20:23], a[36:39], v[232:247]
  ds_read_b128 a[8:11], v76 offset:24576
  s_sub_u32 s12, s95, 6
  v_mfma_f32_32x32x16_bf16 v[184:199], a[40:43], a[44:47], v[184:199]
  ds_read_b128 a[12:15], v76 offset:28672
  s_min_u32 s95, s95, s12
  s_mul_i32 s95, s95, 0x10000
  v_mfma_f32_32x32x16_bf16 v[200:215], a[40:43], a[48:51], v[200:215]
  ds_read_b64_tr_b16 a[16:17], v73 offset:2048
  ds_read_b64_tr_b16 a[18:19], v73 offset:3072
  ds_read_b128 a[20:23], v76 offset:17408
  s_add_u32 s95, s95, s81
  v_mfma_f32_32x32x16_bf16 v[216:231], a[40:43], a[52:55], v[216:231]
  ds_read_b128 a[24:27], v76 offset:21504
  buffer_load_dwordx4 v2, s[56:59], s95 offen lds
  v_mfma_f32_32x32x16_bf16 v[232:247], a[40:43], a[56:59], v[232:247]
  ds_read_b128 a[28:31], v76 offset:25600
  buffer_load_dwordx4 v3, s[56:59], s95 offen offset:1024 lds
  buffer_load_dwordx4 v4, s[56:59], s95 offen offset:2048 lds
  s_waitcnt lgkmcnt(5)
  v_mfma_f32_32x32x16_bf16 v[184:199], a[60:63], a[0:3], v[184:199]
  ds_read_b128 a[32:35], v76 offset:29696
  buffer_load_dwordx4 v5, s[56:59], s95 offen offset:3072 lds
  v_mfma_f32_32x32x16_bf16 v[200:215], a[60:63], a[4:7], v[200:215]
  ds_read_b64_tr_b16 a[36:37], v73 offset:4096
  ds_read_b64_tr_b16 a[38:39], v73 offset:5120
  ds_read_b128 a[40:43], v76 offset:18432
  s_add_u32 m0, s72, 0xc000
  v_mfma_f32_32x32x16_bf16 v[216:231], a[60:63], a[8:11], v[216:231]
  ds_read_b128 a[44:47], v76 offset:22528
  s_add_u32 s95, s101, 5
  s_sub_u32 s12, s95, 6
  v_mfma_f32_32x32x16_bf16 v[232:247], a[60:63], a[12:15], v[232:247]
  ds_read_b128 a[48:51], v76 offset:26624
  s_min_u32 s95, s95, s12
  s_waitcnt lgkmcnt(5)
  v_mfma_f32_32x32x16_bf16 v[184:199], a[16:19], a[20:23], v[184:199]
  ds_read_b128 a[52:55], v76 offset:30720
  s_mul_i32 s95, s95, 0x1000
  v_mfma_f32_32x32x16_bf16 v[200:215], a[16:19], a[24:27], v[200:215]
  ds_read_b64_tr_b16 a[56:57], v73 offset:6144
  ds_read_b64_tr_b16 a[58:59], v73 offset:7168
  ds_read_b128 a[60:63], v76 offset:19456
  s_add_u32 s95, s95, s82
  buffer_load_dwordx4 v1, s[60:63], s95 offen sc1 lds
  v_mfma_f32_32x32x16_bf16 v[216:231], a[16:19], a[28:31], v[216:231]
  ds_read_b128 a[0:3], v76 offset:23552
  ds_read_b128 a[4:7], v76 offset:27648
  ds_read_b128 a[8:11], v76 offset:31744
  buffer_load_dwordx4 v1, s[60:63], s95 offen offset:1024 sc1 lds
  v_mfma_f32_32x32x16_bf16 v[232:247], a[16:19], a[32:35], v[232:247]
  buffer_load_dwordx4 v1, s[60:63], s95 offen offset:2048 sc1 lds
  s_waitcnt lgkmcnt(6)
  v_mfma_f32_32x32x16_bf16 v[184:199], a[36:39], a[40:43], v[184:199]
  buffer_load_dwordx4 v1, s[60:63], s95 offen offset:3072 sc1 lds
  s_waitcnt vmcnt(24) lgkmcnt(0)
  s_barrier
  v_mfma_f32_32x32x16_bf16 v[200:215], a[36:39], a[44:47], v[200:215]
  ds_read_b64_tr_b16 a[160:161], v73 offset:32768
  ds_read_b64_tr_b16 a[162:163], v73 offset:33792
  ds_read_b128 a[12:15], v76 offset:53248
  v_mfma_f32_32x32x16_bf16 v[216:231], a[36:39], a[48:51], v[216:231]
  ds_read_b128 a[16:19], v76 offset:57344
  s_mul_i32 s12, s3, 0x1000
  v_mfma_f32_32x32x16_bf16 v[232:247], a[36:39], a[52:55], v[232:247]
  ds_read_b128 a[20:23], v76 offset:61440
  ds_read_b128 a[176:179], v76 offset:49152
  s_add_u32 m0, s12, 0x10000
  v_mfma_f32_32x32x16_bf16 v[184:199], a[56:59], a[60:63], v[184:199]
  ds_read_b64_tr_b16 a[164:165], v73 offset:34816
  ds_read_b64_tr_b16 a[166:167], v73 offset:35840
  ds_read_b128 a[24:27], v76 offset:54272
  s_add_u32 s95, s17, 0
  v_mfma_f32_32x32x16_bf16 v[200:215], a[56:59], a[0:3], v[200:215]
  ds_read_b128 a[28:31], v76 offset:58368
  v_mfma_f32_32x32x16_bf16 v[216:231], a[56:59], a[4:7], v[216:231]
  ds_read_b128 a[32:35], v76 offset:62464
  ds_read_b128 a[180:183], v76 offset:50176
  buffer_load_dwordx4 v1, s[60:63], s95 offen sc1 lds
  v_mfma_f32_32x32x16_bf16 v[232:247], a[56:59], a[8:11], v[232:247]
  ds_read_b64_tr_b16 a[168:169], v73 offset:36864
  ds_read_b64_tr_b16 a[170:171], v73 offset:37888
  ds_read_b128 a[36:39], v76 offset:55296
  buffer_load_dwordx4 v1, s[60:63], s95 offen offset:1024 sc1 lds
  s_waitcnt lgkmcnt(6)
  v_mfma_f32_32x32x16_bf16 v[200:215], a[160:163], a[12:15], v[200:215]
  ds_read_b128 a[40:43], v76 offset:59392
  buffer_load_dwordx4 v1, s[60:63], s95 offen offset:2048 sc1 lds
  v_mfma_f32_32x32x16_bf16 v[216:231], a[160:163], a[16:19], v[216:231]
  ds_read_b128 a[44:47], v76 offset:63488
  ds_read_b128 a[184:187], v76 offset:51200
  v_mfma_f32_32x32x16_bf16 v[232:247], a[160:163], a[20:23], v[232:247]
  ds_read_b64_tr_b16 a[172:173], v73 offset:38912
  ds_read_b64_tr_b16 a[174:175], v73 offset:39936
  ds_read_b128 a[48:51], v76 offset:56320
  ds_read_b128 a[52:55], v76 offset:60416
  ds_read_b128 a[56:59], v76 offset:64512
  ds_read_b128 a[188:191], v76 offset:52224
  buffer_load_dwordx4 v1, s[60:63], s95 offen offset:3072 sc1 lds
  v_mfma_f32_32x32x16_bf16 v[200:215], a[164:167], a[24:27], v[200:215]
  s_waitcnt lgkmcnt(8)
  v_mfma_f32_32x32x16_bf16 v[216:231], a[164:167], a[28:31], v[216:231]
  s_waitcnt vmcnt(20) lgkmcnt(0)
  s_barrier
  v_mfma_f32_32x32x16_bf16 v[232:247], a[164:167], a[32:35], v[232:247]
  ds_read_b64_tr_b16 v[148:149], v74
  ds_read_b64_tr_b16 v[150:151], v74 offset:1024
  ds_read_b128 a[60:63], v77 offset:20480
  s_add_u32 m0, s72, 0x18000
  v_mfma_f32_32x32x16_bf16 v[200:215], a[168:171], a[36:39], v[200:215]
  ds_read_b128 a[0:3], v77 offset:24576
  s_add_u32 s95, s16, 0
  v_mfma_f32_32x32x16_bf16 v[216:231], a[168:171], a[40:43], v[216:231]
  ds_read_b128 a[4:7], v77 offset:28672
  ds_read_b128 v[164:167], v77 offset:16384
  buffer_load_dwordx4 v2, s[56:59], s95 offen lds
  v_mfma_f32_32x32x16_bf16 v[232:247], a[168:171], a[44:47], v[232:247]
  ds_read_b64_tr_b16 v[152:153], v74 offset:2048
  ds_read_b64_tr_b16 v[154:155], v74 offset:3072
  ds_read_b128 a[8:11], v77 offset:21504
  buffer_load_dwordx4 v3, s[56:59], s95 offen offset:1024 lds
  v_mfma_f32_32x32x16_bf16 v[200:215], a[172:175], a[48:51], v[200:215]
  ds_read_b128 a[12:15], v77 offset:25600
  buffer_load_dwordx4 v4, s[56:59], s95 offen offset:2048 lds
  v_mfma_f32_32x32x16_bf16 v[216:231], a[172:175], a[52:55], v[216:231]
  ds_read_b128 a[16:19], v77 offset:29696
  ds_read_b128 v[168:171], v77 offset:17408
  buffer_load_dwordx4 v5, s[56:59], s95 offen offset:3072 lds
  v_mfma_f32_32x32x16_bf16 v[232:247], a[172:175], a[56:59], v[232:247]
  ds_read_b64_tr_b16 v[156:157], v74 offset:4096
  ds_read_b64_tr_b16 v[158:159], v74 offset:5120
  ds_read_b128 a[20:23], v77 offset:22528
  s_add_u32 m0, s72, 0x1c000
  s_waitcnt lgkmcnt(6)
  v_mfma_f32_32x32x16_bf16 v[200:215], v[148:151], a[60:63], v[200:215]
  ds_read_b128 a[24:27], v77 offset:26624
  s_add_u32 s95, s16, 0x10000
  v_mfma_f32_32x32x16_bf16 v[216:231], v[148:151], a[0:3], v[216:231]
  ds_read_b128 a[28:31], v77 offset:30720
  ds_read_b128 v[172:175], v77 offset:18432
  buffer_load_dwordx4 v2, s[56:59], s95 offen lds
  v_mfma_f32_32x32x16_bf16 v[232:247], v[148:151], a[4:7], v[232:247]
  ds_read_b64_tr_b16 v[160:161], v74 offset:6144
  ds_read_b64_tr_b16 v[162:163], v74 offset:7168
  ds_read_b128 a[32:35], v77 offset:23552
  ds_read_b128 a[36:39], v77 offset:27648
  ds_read_b128 a[40:43], v77 offset:31744
  ds_read_b128 v[176:179], v77 offset:19456
  buffer_load_dwordx4 v3, s[56:59], s95 offen offset:1024 lds
  v_mfma_f32_32x32x16_bf16 v[200:215], v[152:155], a[8:11], v[200:215]
  buffer_load_dwordx4 v4, s[56:59], s95 offen offset:2048 lds
  s_waitcnt lgkmcnt(8)
  v_mfma_f32_32x32x16_bf16 v[216:231], v[152:155], a[12:15], v[216:231]
  buffer_load_dwordx4 v5, s[56:59], s95 offen offset:3072 lds
  s_waitcnt vmcnt(20) lgkmcnt(0)
  s_barrier
  v_mfma_f32_32x32x16_bf16 v[232:247], v[152:155], a[16:19], v[232:247]
  ds_read_b64_tr_b16 v[84:85], v72
  ds_read_b64_tr_b16 v[86:87], v72 offset:1024
  ds_read_b128 a[44:47], v75 offset:20480
  v_mfma_f32_32x32x16_bf16 v[200:215], v[156:159], a[20:23], v[200:215]
  ds_read_b128 a[48:51], v75 offset:24576
  s_add_u32 m0, s72, 0x20000
  v_mfma_f32_32x32x16_bf16 v[216:231], v[156:159], a[24:27], v[216:231]
  ds_read_b128 a[52:55], v75 offset:28672
  ds_read_b128 v[52:55], v75 offset:16384
  s_add_u32 s95, s16, 0x20000
  v_mfma_f32_32x32x16_bf16 v[232:247], v[156:159], a[28:31], v[232:247]
  ds_read_b64_tr_b16 v[88:89], v72 offset:2048
  ds_read_b64_tr_b16 v[90:91], v72 offset:3072
  ds_read_b128 a[56:59], v75 offset:21504
  buffer_load_dwordx4 v2, s[56:59], s95 offen lds
  v_mfma_f32_32x32x16_bf16 v[200:215], v[160:163], a[32:35], v[200:215]
  ds_read_b128 a[60:63], v75 offset:25600
  v_mfma_f32_32x32x16_bf16 v[216:231], v[160:163], a[36:39], v[216:231]
  ds_read_b128 a[0:3], v75 offset:29696
  ds_read_b128 v[56:59], v75 offset:17408
  buffer_load_dwordx4 v3, s[56:59], s95 offen offset:1024 lds
  v_mfma_f32_32x32x16_bf16 v[232:247], v[160:163], a[40:43], v[232:247]
  ds_read_b64_tr_b16 v[92:93], v72 offset:4096
  ds_read_b64_tr_b16 v[94:95], v72 offset:5120
  ds_read_b128 a[4:7], v75 offset:22528
  buffer_load_dwordx4 v4, s[56:59], s95 offen offset:2048 lds
  s_waitcnt lgkmcnt(6)
  v_mfma_f32_32x32x16_bf16 v[200:215], v[84:87], a[44:47], v[200:215]
  ds_read_b128 a[8:11], v75 offset:26624
  buffer_load_dwordx4 v5, s[56:59], s95 offen offset:3072 lds
  v_mfma_f32_32x32x16_bf16 v[216:231], v[84:87], a[48:51], v[216:231]
  ds_read_b128 a[12:15], v75 offset:30720
  ds_read_b128 v[248:251], v75 offset:18432
  v_mfma_f32_32x32x16_bf16 v[232:247], v[84:87], a[52:55], v[232:247]
  ds_read_b64_tr_b16 v[96:97], v72 offset:6144
  ds_read_b64_tr_b16 v[98:99], v72 offset:7168
  ds_read_b128 a[16:19], v75 offset:23552
  ds_read_b128 a[20:23], v75 offset:27648
  ds_read_b128 a[24:27], v75 offset:31744
  ds_read_b128 v[252:255], v75 offset:19456
  s_add_u32 m0, s72, 0x24000
  v_mfma_f32_32x32x16_bf16 v[200:215], v[88:91], a[56:59], v[200:215]
  s_add_u32 s95, s16, 0x30000
  s_waitcnt lgkmcnt(8)
  v_mfma_f32_32x32x16_bf16 v[216:231], v[88:91], a[60:63], v[216:231]
  buffer_load_dwordx4 v2, s[56:59], s95 offen lds
  s_waitcnt vmcnt(17) lgkmcnt(0)
  s_barrier
  v_mfma_f32_32x32x16_bf16 v[232:247], v[88:91], a[0:3], v[232:247]
  ds_read_b64_tr_b16 v[132:133], v72 offset:32768
  ds_read_b64_tr_b16 v[134:135], v72 offset:33792
  ds_read_b128 a[28:31], v75 offset:53248
  v_mfma_f32_32x32x16_bf16 v[200:215], v[92:95], a[4:7], v[200:215]
  ds_read_b64_tr_b16 v[136:137], v72 offset:34816
  ds_read_b64_tr_b16 v[138:139], v72 offset:35840
  ds_read_b128 a[32:35], v75 offset:54272
  buffer_load_dwordx4 v3, s[56:59], s95 offen offset:1024 lds
  v_mfma_f32_32x32x16_bf16 v[216:231], v[92:95], a[8:11], v[216:231]
  ds_read_b64_tr_b16 v[140:141], v72 offset:36864
  ds_read_b64_tr_b16 v[142:143], v72 offset:37888
  ds_read_b128 a[36:39], v75 offset:55296
  buffer_load_dwordx4 v4, s[56:59], s95 offen offset:2048 lds
  v_mfma_f32_32x32x16_bf16 v[232:247], v[92:95], a[12:15], v[232:247]
  ds_read_b64_tr_b16 v[144:145], v72 offset:38912
  ds_read_b64_tr_b16 v[146:147], v72 offset:39936
  ds_read_b128 a[40:43], v75 offset:56320
  buffer_load_dwordx4 v5, s[56:59], s95 offen offset:3072 lds
  v_mfma_f32_32x32x16_bf16 v[200:215], v[96:99], a[16:19], v[200:215]
  ds_read_b128 a[44:47], v75 offset:57344
  v_mfma_f32_32x32x16_bf16 v[216:231], v[96:99], a[20:23], v[216:231]
  ds_read_b128 a[48:51], v75 offset:58368
  v_mfma_f32_32x32x16_bf16 v[232:247], v[96:99], a[24:27], v[232:247]
  ds_read_b128 a[52:55], v75 offset:59392
  s_waitcnt lgkmcnt(3)
  v_mfma_f32_32x32x16_bf16 v[200:215], v[132:135], a[28:31], v[200:215]
  ds_read_b128 a[56:59], v75 offset:60416
  v_mfma_f32_32x32x16_bf16 v[200:215], v[136:139], a[32:35], v[200:215]
  ds_read_b128 a[60:63], v75 offset:61440
  v_mfma_f32_32x32x16_bf16 v[200:215], v[140:143], a[36:39], v[200:215]
  ds_read_b128 a[0:3], v75 offset:62464
  v_mfma_f32_32x32x16_bf16 v[200:215], v[144:147], a[40:43], v[200:215]
  ds_read_b128 a[4:7], v75 offset:63488
  s_waitcnt lgkmcnt(3)
  v_mfma_f32_32x32x16_bf16 v[216:231], v[132:135], a[44:47], v[216:231]
  ds_read_b128 a[8:11], v75 offset:64512
  v_mfma_f32_32x32x16_bf16 v[216:231], v[136:139], a[48:51], v[216:231]
  ds_read_b128 a[12:15], v75 offset:49152
  v_mfma_f32_32x32x16_bf16 v[216:231], v[140:143], a[52:55], v[216:231]
  ds_read_b128 a[16:19], v75 offset:50176
  s_xor_b32 s8, s6, 1
  s_lshl_b32 s8, s8, 13
  s_add_u32 s8, s8, s87
  s_nop 0
  v_cvt_pk_bf16_f32 v100, v200, v201
  v_cvt_pk_bf16_f32 v101, v202, v203
  v_cvt_pk_bf16_f32 v102, v204, v205
  v_cvt_pk_bf16_f32 v103, v206, v207
  buffer_store_dwordx4 v[100:103], v1, s[60:63], s8 offen sc1
  v_mfma_f32_32x32x16_bf16 v[216:231], v[144:147], a[56:59], v[216:231]
  ds_read_b128 a[20:23], v75 offset:51200
  v_cvt_pk_bf16_f32 v104, v208, v209
  v_cvt_pk_bf16_f32 v105, v210, v211
  v_cvt_pk_bf16_f32 v106, v212, v213
  v_cvt_pk_bf16_f32 v107, v214, v215
  buffer_store_dwordx4 v[104:107], v1, s[60:63], s8 offen offset:1024 sc1
  s_waitcnt lgkmcnt(3)
  v_mfma_f32_32x32x16_bf16 v[232:247], v[132:135], a[60:63], v[232:247]
  ds_read_b128 a[24:27], v75 offset:52224
  v_mfma_f32_32x32x16_bf16 v[232:247], v[136:139], a[0:3], v[232:247]
  v_mfma_f32_32x32x16_bf16 v[232:247], v[140:143], a[4:7], v[232:247]
  s_xor_b32 s8, s6, 2
  s_lshl_b32 s8, s8, 13
  s_add_u32 s8, s8, s87
  v_cvt_pk_bf16_f32 v108, v216, v217
  v_cvt_pk_bf16_f32 v109, v218, v219
  v_cvt_pk_bf16_f32 v110, v220, v221
  v_cvt_pk_bf16_f32 v111, v222, v223
  buffer_store_dwordx4 v[108:111], v1, s[60:63], s8 offen sc1
  v_mfma_f32_32x32x16_bf16 v[232:247], v[144:147], a[8:11], v[232:247]
  v_cvt_pk_bf16_f32 v112, v224, v225
  v_cvt_pk_bf16_f32 v113, v226, v227
  v_cvt_pk_bf16_f32 v114, v228, v229
  v_cvt_pk_bf16_f32 v115, v230, v231
  buffer_store_dwordx4 v[112:115], v1, s[60:63], s8 offen offset:1024 sc1
  s_waitcnt lgkmcnt(0)
  v_mfma_f32_32x32x16_bf16 v[184:199], v[132:135], a[12:15], v[184:199]
  v_mfma_f32_32x32x16_bf16 v[184:199], v[136:139], a[16:19], v[184:199]
  v_mfma_f32_32x32x16_bf16 v[184:199], v[140:143], a[20:23], v[184:199]
  s_xor_b32 s8, s6, 3
  s_lshl_b32 s8, s8, 13
  s_add_u32 s8, s8, s87
  v_cvt_pk_bf16_f32 v116, v232, v233
  v_cvt_pk_bf16_f32 v117, v234, v235
  v_cvt_pk_bf16_f32 v118, v236, v237
  v_cvt_pk_bf16_f32 v119, v238, v239
  buffer_store_dwordx4 v[116:119], v1, s[60:63], s8 offen sc1
  v_mfma_f32_32x32x16_bf16 v[184:199], v[144:147], a[24:27], v[184:199]
  v_cvt_pk_bf16_f32 v120, v240, v241
  v_cvt_pk_bf16_f32 v121, v242, v243
  v_cvt_pk_bf16_f32 v122, v244, v245
  v_cvt_pk_bf16_f32 v123, v246, v247
  buffer_store_dwordx4 v[120:123], v1, s[60:63], s8 offen offset:1024 sc1
  v_mfma_f32_32x32x16_bf16 v[184:199], a[64:67], a[224:227], v[184:199]
  v_mfma_f32_32x32x16_bf16 v[184:199], a[68:71], a[228:231], v[184:199]
  v_mfma_f32_32x32x16_bf16 v[184:199], a[72:75], a[232:235], v[184:199]
  v_mfma_f32_32x32x16_bf16 v[184:199], a[76:79], a[236:239], v[184:199]
  v_mfma_f32_32x32x16_bf16 v[184:199], a[80:83], a[240:243], v[184:199]
  v_mfma_f32_32x32x16_bf16 v[184:199], a[84:87], a[244:247], v[184:199]
  v_mfma_f32_32x32x16_bf16 v[184:199], a[88:91], a[248:251], v[184:199]
  v_mfma_f32_32x32x16_bf16 v[184:199], a[92:95], a[252:255], v[184:199]
  v_mfma_f32_32x32x16_bf16 v[184:199], a[96:99], a[192:195], v[184:199]
  v_mfma_f32_32x32x16_bf16 v[184:199], a[100:103], a[196:199], v[184:199]
  v_mfma_f32_32x32x16_bf16 v[184:199], a[104:107], a[200:203], v[184:199]
  v_mfma_f32_32x32x16_bf16 v[184:199], a[108:111], a[204:207], v[184:199]
  v_mfma_f32_32x32x16_bf16 v[184:199], a[112:115], a[208:211], v[184:199]
  v_mfma_f32_32x32x16_bf16 v[184:199], a[116:119], a[212:215], v[184:199]
  v_mfma_f32_32x32x16_bf16 v[184:199], a[120:123], a[216:219], v[184:199]
  v_mfma_f32_32x32x16_bf16 v[184:199], a[124:127], a[220:223], v[184:199]
  v_mfma_f32_32x32x16_bf16 v[184:199], a[160:163], a[176:179], v[184:199]
  v_mfma_f32_32x32x16_bf16 v[184:199], a[164:167], a[180:183], v[184:199]
  v_mfma_f32_32x32x16_bf16 v[184:199], a[168:171], a[184:187], v[184:199]
  v_mfma_f32_32x32x16_bf16 v[184:199], a[172:175], a[188:191], v[184:199]
  v_mfma_f32_32x32x16_bf16 v[184:199], v[148:151], v[164:167], v[184:199]
  v_mfma_f32_32x32x16_bf16 v[184:199], v[152:155], v[168:171], v[184:199]
  v_mfma_f32_32x32x16_bf16 v[184:199], v[156:159], v[172:175], v[184:199]
  v_mfma_f32_32x32x16_bf16 v[184:199], v[160:163], v[176:179], v[184:199]
  s_waitcnt vmcnt(14)
  s_barrier
  v_mfma_f32_32x32x16_bf16 v[184:199], v[84:87], v[52:55], v[184:199]
  ds_read_b64_tr_b16 a[28:29], v73 offset:32768
  ds_read_b64_tr_b16 a[30:31], v73 offset:33792
  ds_read_b128 a[32:35], v76
  v_mfma_f32_32x32x16_bf16 v[184:199], v[88:91], v[56:59], v[184:199]
  ds_read_b64_tr_b16 a[36:37], v73 offset:34816
  ds_read_b64_tr_b16 a[38:39], v73 offset:35840
  ds_read_b128 a[40:43], v76 offset:1024
  v_mfma_f32_32x32x16_bf16 v[184:199], v[92:95], v[248:251], v[184:199]
  ds_read_b64_tr_b16 a[44:45], v73 offset:36864
  ds_read_b64_tr_b16 a[46:47], v73 offset:37888
  ds_read_b128 a[48:51], v76 offset:2048
  v_mfma_f32_32x32x16_bf16 v[184:199], v[96:99], v[252:255], v[184:199]
  ds_read_b64_tr_b16 a[52:53], v73 offset:38912
  ds_read_b64_tr_b16 a[54:55], v73 offset:39936
  ds_read_b128 a[56:59], v76 offset:3072
  s_waitcnt lgkmcnt(6)
  v_mfma_f32_32x32x16_bf16 v[184:199], a[28:31], a[32:35], v[184:199]
  ds_read_b64_tr_b16 a[60:61], v73 offset:49152
  ds_read_b64_tr_b16 a[62:63], v73 offset:50176
  ds_read_b128 a[0:3], v76 offset:4096
  buffer_load_dwordx4 v[200:203], v1, s[60:63], s90 offen sc1
  buffer_load_dwordx4 v[204:207], v1, s[60:63], s90 offen offset:1024 sc1
  buffer_load_dwordx4 v[208:211], v1, s[60:63], s91 offen sc1
  buffer_load_dwordx4 v[212:215], v1, s[60:63], s91 offen offset:1024 sc1
  buffer_load_dwordx4 v[216:219], v1, s[60:63], s92 offen sc1
  buffer_load_dwordx4 v[220:223], v1, s[60:63], s92 offen offset:1024 sc1
  v_mfma_f32_32x32x16_bf16 v[184:199], a[36:39], a[40:43], v[184:199]
  ds_read_b64_tr_b16 a[4:5], v73 offset:51200
  ds_read_b64_tr_b16 a[6:7], v73 offset:52224
  ds_read_b128 a[8:11], v76 offset:5120
  ds_read_b64_tr_b16 a[12:13], v73 offset:53248
  ds_read_b64_tr_b16 a[14:15], v73 offset:54272
  ds_read_b128 a[16:19], v76 offset:6144
  ds_read_b64_tr_b16 a[20:21], v73 offset:55296
  ds_read_b64_tr_b16 a[22:23], v73 offset:56320
  ds_read_b128 a[24:27], v76 offset:7168
  s_waitcnt lgkmcnt(12)
  v_mfma_f32_32x32x16_bf16 v[184:199], a[44:47], a[48:51], v[184:199]
  v_mfma_f32_32x32x16_bf16 v[184:199], a[52:55], a[56:59], v[184:199]
  s_waitcnt vmcnt(12) lgkmcnt(0)
  s_barrier
  v_mfma_f32_32x32x16_bf16 v[184:199], a[60:63], a[0:3], v[184:199]
  ds_read_b64_tr_b16 a[28:29], v74
  ds_read_b64_tr_b16 a[30:31], v74 offset:1024
  ds_read_b128 a[32:35], v76 offset:8192
  v_mfma_f32_32x32x16_bf16 v[184:199], a[4:7], a[8:11], v[184:199]
  ds_read_b64_tr_b16 a[36:37], v74 offset:2048
  ds_read_b64_tr_b16 a[38:39], v74 offset:3072
  ds_read_b128 a[40:43], v76 offset:9216
  v_mfma_f32_32x32x16_bf16 v[184:199], a[12:15], a[16:19], v[184:199]
  ds_read_b64_tr_b16 a[44:45], v74 offset:4096
  ds_read_b64_tr_b16 a[46:47], v74 offset:5120
  ds_read_b128 a[48:51], v76 offset:10240
  v_mfma_f32_32x32x16_bf16 v[184:199], a[20:23], a[24:27], v[184:199]
  ds_read_b64_tr_b16 a[52:53], v74 offset:6144
  ds_read_b64_tr_b16 a[54:55], v74 offset:7168
  ds_read_b128 a[56:59], v76 offset:11264
  s_waitcnt lgkmcnt(6)
  v_mfma_f32_32x32x16_bf16 v[184:199], a[28:31], a[32:35], v[184:199]
  ds_read_b64_tr_b16 a[60:61], v74 offset:16384
  ds_read_b64_tr_b16 a[62:63], v74 offset:17408
  ds_read_b128 a[0:3], v76 offset:12288
  v_mfma_f32_32x32x16_bf16 v[184:199], a[36:39], a[40:43], v[184:199]
  ds_read_b64_tr_b16 a[4:5], v74 offset:18432
  ds_read_b64_tr_b16 a[6:7], v74 offset:19456
  ds_read_b128 a[8:11], v76 offset:13312
  s_waitcnt lgkmcnt(6)
  v_mfma_f32_32x32x16_bf16 v[184:199], a[44:47], a[48:51], v[184:199]
  ds_read_b64_tr_b16 a[12:13], v74 offset:20480
  ds_read_b64_tr_b16 a[14:15], v74 offset:21504
  ds_read_b128 a[16:19], v76 offset:14336
  v_mfma_f32_32x32x16_bf16 v[184:199], a[52:55], a[56:59], v[184:199]
  ds_read_b64_tr_b16 a[20:21], v74 offset:22528
  ds_read_b64_tr_b16 a[22:23], v74 offset:23552
  ds_read_b128 a[24:27], v76 offset:15360
  s_waitcnt lgkmcnt(6)
  v_mfma_f32_32x32x16_bf16 v[184:199], a[60:63], a[0:3], v[184:199]
  v_mfma_f32_32x32x16_bf16 v[184:199], a[4:7], a[8:11], v[184:199]
  s_waitcnt lgkmcnt(0)
  v_mfma_f32_32x32x16_bf16 v[184:199], a[12:15], a[16:19], v[184:199]
  v_mfma_f32_32x32x16_bf16 v[184:199], a[20:23], a[24:27], v[184:199]
  s_waitcnt vmcnt(5)
  v_max3_u32 v64, v200, v201, v202
  s_waitcnt vmcnt(4)
  v_max3_u32 v65, v203, v204, v205
  v_max3_u32 v64, v64, v206, v207
  s_waitcnt vmcnt(3)
  v_max3_u32 v65, v65, v208, v209
  v_max3_u32 v64, v64, v210, v211
  s_waitcnt vmcnt(2)
  v_max3_u32 v65, v65, v212, v213
  v_max3_u32 v64, v64, v214, v215
  s_waitcnt vmcnt(1)
  v_max3_u32 v65, v65, v216, v217
  v_max3_u32 v64, v64, v218, v219
  s_waitcnt vmcnt(0)
  v_max3_u32 v65, v65, v220, v221
  v_max3_u32 v64, v64, v222, v223
  v_max_u32 v64, v64, v65
  v_cmp_eq_u32 vcc, -1, v64
  s_nop 0
  s_cbranch_vccnz L1_slow_p
L1_res_p:
  v_dot2c_f32_bf16 v184, s94, v200
  v_dot2c_f32_bf16 v185, s99, v200
  v_dot2c_f32_bf16 v186, s94, v201
  v_dot2c_f32_bf16 v187, s99, v201
  v_dot2c_f32_bf16 v188, s94, v202
  v_dot2c_f32_bf16 v189, s99, v202
  v_dot2c_f32_bf16 v190, s94, v203
  v_dot2c_f32_bf16 v191, s99, v203
  v_dot2c_f32_bf16 v192, s94, v204
  v_dot2c_f32_bf16 v193, s99, v204
  v_dot2c_f32_bf16 v194, s94, v205
  v_dot2c_f32_bf16 v195, s99, v205
  v_dot2c_f32_bf16 v196, s94, v206
  v_dot2c_f32_bf16 v197, s99, v206
  v_dot2c_f32_bf16 v198, s94, v207
  v_dot2c_f32_bf16 v199, s99, v207
  v_dot2c_f32_bf16 v184, s94, v208
  v_dot2c_f32_bf16 v185, s99, v208
  v_dot2c_f32_bf16 v186, s94, v209
  v_dot2c_f32_bf16 v187, s99, v209
  v_dot2c_f32_bf16 v188, s94, v210
  v_dot2c_f32_bf16 v189, s99, v210
  v_dot2c_f32_bf16 v190, s94, v211
  v_dot2c_f32_bf16 v191, s99, v211
  v_dot2c_f32_bf16 v192, s94, v212
  v_dot2c_f32_bf16 v193, s99, v212
  v_dot2c_f32_bf16 v194, s94, v213
  v_dot2c_f32_bf16 v195, s99, v213
  v_dot2c_f32_bf16 v196, s94, v214
  v_dot2c_f32_bf16 v197, s99, v214
  v_dot2c_f32_bf16 v198, s94, v215
  v_dot2c_f32_bf16 v199, s99, v215
  v_dot2c_f32_bf16 v184, s94, v216
  v_dot2c_f32_bf16 v185, s99, v216
  v_dot2c_f32_bf16 v186, s94, v217
  v_dot2c_f32_bf16 v187, s99, v217
  v_dot2c_f32_bf16 v188, s94, v218
  v_dot2c_f32_bf16 v189, s99, v218
  v_dot2c_f32_bf16 v190, s94, v219
  v_dot2c_f32_bf16 v191, s99, v219
  v_dot2c_f32_bf16 v192, s94, v220
  v_dot2c_f32_bf16 v193, s99, v220
  v_dot2c_f32_bf16 v194, s94, v221
  v_dot2c_f32_bf16 v195, s99, v221
  v_dot2c_f32_bf16 v196, s94, v222
  v_dot2c_f32_bf16 v197, s99, v222
  v_dot2c_f32_bf16 v198, s94, v223
  v_dot2c_f32_bf16 v199, s99, v223
  v_cvt_pk_bf16_f32 v100, v184, v185
  v_cvt_pk_bf16_f32 v101, v186, v187
  v_cvt_pk_bf16_f32 v102, v188, v189
  v_cvt_pk_bf16_f32 v103, v190, v191
  s_nop 0
  v_permlane32_swap_b32 v100, v102
  v_permlane32_swap_b32 v101, v103
  buffer_store_dwordx4 v[100:103], v81, s[64:67], s93 offen
  v_cvt_pk_bf16_f32 v104, v192, v193
  v_cvt_pk_bf16_f32 v105, v194, v195
  v_cvt_pk_bf16_f32 v106, v196, v197
  v_cvt_pk_bf16_f32 v107, v198, v199
  s_nop 0
  v_permlane32_swap_b32 v104, v106
  v_permlane32_swap_b32 v105, v107
  buffer_store_dwordx4 v[104:107], v81, s[64:67], s93 offen offset:32
  s_endpgm
L1_slow_ka:
  s_mov_b32 s18, 20000
L1_slowl_ka:
  s_sleep 1
  buffer_load_dwordx2 v[36:37], v30, s[60:63], 0 offen sc1
  s_waitcnt vmcnt(0)
  v_cmp_eq_u64 vcc, v[36:37], v[34:35]
  s_nop 1
  s_cmp_eq_u64 vcc, -1
  s_cbranch_scc1 L1_res_ka
  s_sub_u32 s18, s18, 1
  s_cmp_lg_u32 s18, 0
  s_cbranch_scc1 L1_slowl_ka
  s_branch L1_res_ka
L1_slow_kh:
  s_mov_b32 s18, 20000
L1_slowl_kh:
  s_sleep 1
  buffer_load_dwordx2 v[36:37], v31, s[60:63], 0 offen sc1
  s_waitcnt vmcnt(0)
  v_cmp_eq_u64 vcc, v[36:37], v[34:35]
  s_nop 1
  s_cmp_eq_u64 vcc, -1
  s_cbranch_scc1 L1_res_kh
  s_sub_u32 s18, s18, 1
  s_cmp_lg_u32 s18, 0
  s_cbranch_scc1 L1_slowl_kh
  s_branch L1_res_kh
L1_slow_nonce:
  s_mov_b32 s18, 20000
L1_slowl_nonce:
  s_sleep 1
  v_mov_b32 v71, 0
  buffer_load_dwordx2 v[34:35], v71, s[68:71], 0 offen sc1
  s_waitcnt vmcnt(0)
  v_cmp_ne_u32 vcc, 0, v34
  s_nop 1
  s_cmp_eq_u64 vcc, -1
  s_cbranch_scc1 L1_res_nonce
  s_sub_u32 s18, s18, 1
  s_cmp_lg_u32 s18, 0
  s_cbranch_scc1 L1_slowl_nonce
  s_branch L1_res_nonce
L1_slow_p:
  s_mov_b32 s18, 20000
L1_slowl_p:
  buffer_load_dwordx4 v[200:203], v1, s[60:63], s90 offen sc1
  buffer_load_dwordx4 v[204:207], v1, s[60:63], s90 offen offset:1024 sc1
  buffer_load_dwordx4 v[208:211], v1, s[60:63], s91 offen sc1
  buffer_load_dwordx4 v[212:215], v1, s[60:63], s91 offen offset:1024 sc1
  buffer_load_dwordx4 v[216:219], v1, s[60:63], s92 offen sc1
  buffer_load_dwordx4 v[220:223], v1, s[60:63], s92 offen offset:1024 sc1
  s_waitcnt vmcnt(0)
  v_max3_u32 v64, v200, v201, v202
  v_max3_u32 v65, v203, v204, v205
  v_max3_u32 v64, v64, v206, v207
  v_max3_u32 v65, v65, v208, v209
  v_max3_u32 v64, v64, v210, v211
  v_max3_u32 v65, v65, v212, v213
  v_max3_u32 v64, v64, v214, v215
  v_max3_u32 v65, v65, v216, v217
  v_max3_u32 v64, v64, v218, v219
  v_max3_u32 v65, v65, v220, v221
  v_max3_u32 v64, v64, v222, v223
  v_max_u32 v64, v64, v65
  v_cmp_eq_u32 vcc, -1, v64
  s_nop 1
  s_cbranch_vccz L1_res_p
  s_sub_u32 s18, s18, 1
  s_cmp_lg_u32 s18, 0
  s_cbranch_scc1 L1_slowl_p
  s_branch L1_res_p
Lc_body2:
  s_waitcnt vmcnt(14)
  ds_read_b128 v[72:75], v14
  ds_read_b128 v[76:79], v15
  ds_read_b128 v[80:83], v16
  ds_read_b128 v[84:87], v17
  ds_read_b128 v[88:91], v14 offset:4096
  ds_read_b128 v[92:95], v15 offset:4096
  ds_read_b128 v[96:99], v16 offset:4096
  ds_read_b128 v[100:103], v17 offset:4096
  ds_read_b128 a[128:131], v14
  ds_read_b128 a[144:147], v14 offset:4096
  ds_read_b128 a[132:135], v15
  ds_read_b128 a[136:139], v16
  ds_read_b128 a[140:143], v17
  ds_read_b128 a[148:151], v15 offset:4096
  ds_read_b128 a[152:155], v16 offset:4096
  ds_read_b128 a[156:159], v17 offset:4096
  s_waitcnt vmcnt(12)
  s_barrier
  ds_read_b128 v[136:139], v18
  ds_read_b128 v[140:143], v18 offset:4096
  ds_read_b128 v[144:147], v18 offset:8192
  s_waitcnt lgkmcnt(3)
  s_add_u32 m0, s75, 0
  s_add_u32 s95, s94, 0x200
  s_and_b32 s95, s95, 0x3ff
  s_add_u32 s95, s95, s76
  buffer_load_dwordx4 v2, s[40:43], s95 offen lds
  buffer_load_dwordx4 v3, s[40:43], s95 offen offset:1024 lds
  buffer_load_dwordx4 v4, s[40:43], s95 offen offset:2048 lds
  buffer_load_dwordx4 v5, s[40:43], s95 offen offset:3072 lds
  s_add_u32 m0, s75, 0x1000
  s_add_u32 s95, s94, 0x280
  s_and_b32 s95, s95, 0x3ff
  v_dot2c_f32_bf16 v60, s99, v72
  v_dot2c_f32_bf16 v62, v72, v72
  v_dot2c_f32_bf16 v61, s99, v73
  v_dot2c_f32_bf16 v63, v73, v73
  v_dot2c_f32_bf16 v60, s99, v74
  v_dot2c_f32_bf16 v62, v74, v74
  v_dot2c_f32_bf16 v61, s99, v75
  v_dot2c_f32_bf16 v63, v75, v75
  v_dot2c_f32_bf16 v60, s99, v76
  v_dot2c_f32_bf16 v62, v76, v76
  v_dot2c_f32_bf16 v61, s99, v77
  v_dot2c_f32_bf16 v63, v77, v77
  v_dot2c_f32_bf16 v60, s99, v78
  v_dot2c_f32_bf16 v62, v78, v78
  v_dot2c_f32_bf16 v61, s99, v79
  v_dot2c_f32_bf16 v63, v79, v79
  v_dot2c_f32_bf16 v60, s99, v80
  v_dot2c_f32_bf16 v62, v80, v80
  v_dot2c_f32_bf16 v61, s99, v81
  v_dot2c_f32_bf16 v63, v81, v81
  v_dot2c_f32_bf16 v60, s99, v82
  v_dot2c_f32_bf16 v62, v82, v82
  v_dot2c_f32_bf16 v61, s99, v83
  v_dot2c_f32_bf16 v63, v83, v83
  v_dot2c_f32_bf16 v60, s99, v84
  v_dot2c_f32_bf16 v62, v84, v84
  v_dot2c_f32_bf16 v61, s99, v85
  v_dot2c_f32_bf16 v63, v85, v85
  v_dot2c_f32_bf16 v60, s99, v86
  v_dot2c_f32_bf16 v62, v86, v86
  v_dot2c_f32_bf16 v61, s99, v87
  v_dot2c_f32_bf16 v63, v87, v87
  v_dot2c_f32_bf16 v60, s99, v88
  v_dot2c_f32_bf16 v62, v88, v88
  v_dot2c_f32_bf16 v61, s99, v89
  v_dot2c_f32_bf16 v63, v89, v89
  v_dot2c_f32_bf16 v60, s99, v90
  v_dot2c_f32_bf16 v62, v90, v90
  v_dot2c_f32_bf16 v61, s99, v91
  v_dot2c_f32_bf16 v63, v91, v91
  v_dot2c_f32_bf16 v60, s99, v92
  v_dot2c_f32_bf16 v62, v92, v92
  v_dot2c_f32_bf16 v61, s99, v93
  v_dot2c_f32_bf16 v63, v93, v93
  v_dot2c_f32_bf16 v60, s99, v94
  v_dot2c_f32_bf16 v62, v94, v94
  v_dot2c_f32_bf16 v61, s99, v95
  v_dot2c_f32_bf16 v63, v95, v95
  v_dot2c_f32_bf16 v60, s99, v96
  v_dot2c_f32_bf16 v62, v96, v96
  v_dot2c_f32_bf16 v61, s99, v97
  v_dot2c_f32_bf16 v63, v97, v97
  v_dot2c_f32_bf16 v60, s99, v98
  v_dot2c_f32_bf16 v62, v98, v98
  v_dot2c_f32_bf16 v61, s99, v99
  v_dot2c_f32_bf16 v63, v99, v99
  v_dot2c_f32_bf16 v60, s99, v100
  v_dot2c_f32_bf16 v62, v100, v100
  v_dot2c_f32_bf16 v61, s99, v101
  v_dot2c_f32_bf16 v63, v101, v101
  v_dot2c_f32_bf16 v60, s99, v102
  v_dot2c_f32_bf16 v62, v102, v102
  v_dot2c_f32_bf16 v61, s99, v103
  v_dot2c_f32_bf16 v63, v103, v103
  s_waitcnt lgkmcnt(2)
  v_mfma_f32_32x32x16_bf16 v[184:199], a[128:131], v[136:139], 0
  ds_read_b128 v[148:151], v18 offset:12288
  s_add_u32 s95, s95, s76
  buffer_load_dwordx4 v2, s[40:43], s95 offen lds
  s_waitcnt lgkmcnt(2)
  v_mfma_f32_32x32x16_bf16 v[200:215], a[128:131], v[140:143], 0
  ds_read_b128 a[0:3], v19
  buffer_load_dwordx4 v3, s[40:43], s95 offen offset:1024 lds
  buffer_load_dwordx4 v4, s[40:43], s95 offen offset:2048 lds
  s_waitcnt lgkmcnt(2)
  v_mfma_f32_32x32x16_bf16 v[184:199], a[144:147], v[144:147], v[184:199]
  ds_read_b128 a[4:7], v19 offset:4096
  buffer_load_dwordx4 v5, s[40:43], s95 offen offset:3072 lds
  s_add_u32 m0, s73, 0x18000
  s_waitcnt lgkmcnt(2)
  v_mfma_f32_32x32x16_bf16 v[200:215], a[144:147], v[148:151], v[200:215]
  ds_read_b128 a[8:11], v20
  s_add_u32 s95, s94, 0x200
  s_and_b32 s95, s95, 0x3ff
  s_waitcnt lgkmcnt(2)
  v_mfma_f32_32x32x16_bf16 v[184:199], a[132:135], a[0:3], v[184:199]
  ds_read_b128 a[12:15], v20 offset:4096
  s_add_u32 s95, s95, s77
  buffer_load_dwordx4 v2, s[44:47], s95 offen lds
  s_waitcnt lgkmcnt(2)
  v_mfma_f32_32x32x16_bf16 v[200:215], a[132:135], a[4:7], v[200:215]
  ds_read_b128 a[16:19], v21
  buffer_load_dwordx4 v3, s[44:47], s95 offen offset:1024 lds
  s_add_u32 m0, s73, 0x1a000
  s_waitcnt lgkmcnt(2)
  v_mfma_f32_32x32x16_bf16 v[184:199], a[136:139], a[8:11], v[184:199]
  ds_read_b128 a[20:23], v21 offset:4096
  s_add_u32 s95, s94, 0x280
  s_and_b32 s95, s95, 0x3ff
  s_waitcnt lgkmcnt(2)
  v_mfma_f32_32x32x16_bf16 v[200:215], a[136:139], a[12:15], v[200:215]
  ds_read_b128 a[24:27], v19 offset:8192
  s_add_u32 s95, s95, s77
  buffer_load_dwordx4 v2, s[44:47], s95 offen lds
  s_waitcnt lgkmcnt(2)
  v_mfma_f32_32x32x16_bf16 v[184:199], a[140:143], a[16:19], v[184:199]
  ds_read_b128 a[28:31], v19 offset:12288
  buffer_load_dwordx4 v3, s[44:47], s95 offen offset:1024 lds
  s_waitcnt lgkmcnt(2)
  v_mfma_f32_32x32x16_bf16 v[200:215], a[140:143], a[20:23], v[200:215]
  ds_read_b128 a[32:35], v20 offset:8192
  s_waitcnt lgkmcnt(2)
  v_mfma_f32_32x32x16_bf16 v[184:199], a[148:151], a[24:27], v[184:199]
  ds_read_b128 a[36:39], v20 offset:12288
  s_waitcnt lgkmcnt(2)
  v_mfma_f32_32x32x16_bf16 v[200:215], a[148:151], a[28:31], v[200:215]
  ds_read_b128 a[40:43], v21 offset:8192
  s_waitcnt vmcnt(16)
  ds_read_b128 v[104:107], v14 offset:32768
  ds_read_b128 v[108:111], v15 offset:32768
  ds_read_b128 v[112:115], v16 offset:32768
  s_waitcnt lgkmcnt(5)
  v_mfma_f32_32x32x16_bf16 v[184:199], a[152:155], a[32:35], v[184:199]
  ds_read_b128 a[44:47], v21 offset:12288
  ds_read_b128 v[116:119], v17 offset:32768
  ds_read_b128 v[120:123], v14 offset:36864
  ds_read_b128 v[124:127], v15 offset:36864
  ds_read_b128 v[128:131], v16 offset:36864
  s_waitcnt lgkmcnt(9)
  v_mfma_f32_32x32x16_bf16 v[200:215], a[152:155], a[36:39], v[200:215]
  ds_read_b128 v[132:135], v17 offset:36864
  ds_read_b128 a[160:163], v14 offset:32768
  ds_read_b128 a[176:179], v14 offset:36864
  ds_read_b128 a[164:167], v15 offset:32768
  s_waitcnt lgkmcnt(12)
  v_mfma_f32_32x32x16_bf16 v[184:199], a[156:159], a[40:43], v[184:199]
  ds_read_b128 a[168:171], v16 offset:32768
  ds_read_b128 a[172:175], v17 offset:32768
  ds_read_b128 a[180:183], v15 offset:36864
  ds_read_b128 a[184:187], v16 offset:36864
  s_waitcnt lgkmcnt(12)
  v_mfma_f32_32x32x16_bf16 v[200:215], a[156:159], a[44:47], v[200:215]
  ds_read_b128 a[188:191], v17 offset:36864
  s_waitcnt vmcnt(12) lgkmcnt(0)
  s_barrier
  ds_read_b128 v[152:155], v18 offset:16384
  ds_read_b128 v[156:159], v18 offset:20480
  ds_read_b128 v[160:163], v18 offset:24576
  s_add_u32 m0, s75, 0x8000
  s_add_u32 s95, s94, 0x300
  s_and_b32 s95, s95, 0x3ff
  s_add_u32 s95, s95, s76
  buffer_load_dwordx4 v2, s[40:43], s95 offen lds
  buffer_load_dwordx4 v3, s[40:43], s95 offen offset:1024 lds
  buffer_load_dwordx4 v4, s[40:43], s95 offen offset:2048 lds
  buffer_load_dwordx4 v5, s[40:43], s95 offen offset:3072 lds
  s_add_u32 m0, s75, 0x9000
  s_add_u32 s95, s94, 0x380
  s_and_b32 s95, s95, 0x3ff
  v_dot2c_f32_bf16 v60, s99, v104
  v_dot2c_f32_bf16 v62, v104, v104
  v_dot2c_f32_bf16 v61, s99, v105
  v_dot2c_f32_bf16 v63, v105, v105
  v_dot2c_f32_bf16 v60, s99, v106
  v_dot2c_f32_bf16 v62, v106, v106
  v_dot2c_f32_bf16 v61, s99, v107
  v_dot2c_f32_bf16 v63, v107, v107
  v_dot2c_f32_bf16 v60, s99, v108
  v_dot2c_f32_bf16 v62, v108, v108
  v_dot2c_f32_bf16 v61, s99, v109
  v_dot2c_f32_bf16 v63, v109, v109
  v_dot2c_f32_bf16 v60, s99, v110
  v_dot2c_f32_bf16 v62, v110, v110
  v_dot2c_f32_bf16 v61, s99, v111
  v_dot2c_f32_bf16 v63, v111, v111
  v_dot2c_f32_bf16 v60, s99, v112
  v_dot2c_f32_bf16 v62, v112, v112
  v_dot2c_f32_bf16 v61, s99, v113
  v_dot2c_f32_bf16 v63, v113, v113
  v_dot2c_f32_bf16 v60, s99, v114
  v_dot2c_f32_bf16 v62, v114, v114
  v_dot2c_f32_bf16 v61, s99, v115
  v_dot2c_f32_bf16 v63, v115, v115
  v_dot2c_f32_bf16 v60, s99, v116
  v_dot2c_f32_bf16 v62, v116, v116
  v_dot2c_f32_bf16 v61, s99, v117
  v_dot2c_f32_bf16 v63, v117, v117
  v_dot2c_f32_bf16 v60, s99, v118
  v_dot2c_f32_bf16 v62, v118, v118
  v_dot2c_f32_bf16 v61, s99, v119
  v_dot2c_f32_bf16 v63, v119, v119
  v_dot2c_f32_bf16 v60, s99, v120
  v_dot2c_f32_bf16 v62, v120, v120
  v_dot2c_f32_bf16 v61, s99, v121
  v_dot2c_f32_bf16 v63, v121, v121
  v_dot2c_f32_bf16 v60, s99, v122
  v_dot2c_f32_bf16 v62, v122, v122
  v_dot2c_f32_bf16 v61, s99, v123
  v_dot2c_f32_bf16 v63, v123, v123
  v_dot2c_f32_bf16 v60, s99, v124
  v_dot2c_f32_bf16 v62, v124, v124
  v_dot2c_f32_bf16 v61, s99, v125
  v_dot2c_f32_bf16 v63, v125, v125
  v_dot2c_f32_bf16 v60, s99, v126
  v_dot2c_f32_bf16 v62, v126, v126
  v_dot2c_f32_bf16 v61, s99, v127
  v_dot2c_f32_bf16 v63, v127, v127
  v_dot2c_f32_bf16 v60, s99, v128
  v_dot2c_f32_bf16 v62, v128, v128
  v_dot2c_f32_bf16 v61, s99, v129
  v_dot2c_f32_bf16 v63, v129, v129
  v_dot2c_f32_bf16 v60, s99, v130
  v_dot2c_f32_bf16 v62, v130, v130
  v_dot2c_f32_bf16 v61, s99, v131
  v_dot2c_f32_bf16 v63, v131, v131
  v_dot2c_f32_bf16 v60, s99, v132
  v_dot2c_f32_bf16 v62, v132, v132
  v_dot2c_f32_bf16 v61, s99, v133
  v_dot2c_f32_bf16 v63, v133, v133
  v_dot2c_f32_bf16 v60, s99, v134
  v_dot2c_f32_bf16 v62, v134, v134
  v_dot2c_f32_bf16 v61, s99, v135
  v_dot2c_f32_bf16 v63, v135, v135
  v_dot2c_f32_bf16 v52, s99, v136
  v_dot2c_f32_bf16 v52, s99, v137
  v_dot2c_f32_bf16 v52, s99, v138
  v_dot2c_f32_bf16 v52, s99, v139
  v_dot2c_f32_bf16 v53, s99, v140
  v_dot2c_f32_bf16 v53, s99, v141
  v_dot2c_f32_bf16 v53, s99, v142
  v_dot2c_f32_bf16 v53, s99, v143
  v_dot2c_f32_bf16 v52, s99, v144
  v_dot2c_f32_bf16 v52, s99, v145
  v_dot2c_f32_bf16 v52, s99, v146
  v_dot2c_f32_bf16 v52, s99, v147
  v_dot2c_f32_bf16 v53, s99, v148
  v_dot2c_f32_bf16 v53, s99, v149
  v_dot2c_f32_bf16 v53, s99, v150
  v_dot2c_f32_bf16 v53, s99, v151
  s_waitcnt lgkmcnt(2)
  v_mfma_f32_32x32x16_bf16 v[184:199], a[160:163], v[152:155], v[184:199]
  ds_read_b128 v[164:167], v18 offset:28672
  s_add_u32 s95, s95, s76
  buffer_load_dwordx4 v2, s[40:43], s95 offen lds
  s_waitcnt lgkmcnt(2)
  v_mfma_f32_32x32x16_bf16 v[200:215], a[160:163], v[156:159], v[200:215]
  ds_read_b128 a[48:51], v19 offset:16384
  buffer_load_dwordx4 v3, s[40:43], s95 offen offset:1024 lds
  buffer_load_dwordx4 v4, s[40:43], s95 offen offset:2048 lds
  s_waitcnt lgkmcnt(2)
  v_mfma_f32_32x32x16_bf16 v[184:199], a[176:179], v[160:163], v[184:199]
  ds_read_b128 a[52:55], v19 offset:20480
  buffer_load_dwordx4 v5, s[40:43], s95 offen offset:3072 lds
  s_add_u32 m0, s73, 0x1c000
  s_waitcnt lgkmcnt(2)
  v_mfma_f32_32x32x16_bf16 v[200:215], a[176:179], v[164:167], v[200:215]
  ds_read_b128 a[56:59], v20 offset:16384
  s_add_u32 s95, s94, 0x300
  s_and_b32 s95, s95, 0x3ff
  s_waitcnt lgkmcnt(2)
  v_mfma_f32_32x32x16_bf16 v[184:199], a[164:167], a[48:51], v[184:199]
  ds_read_b128 a[60:63], v20 offset:20480
  s_add_u32 s95, s95, s77
  buffer_load_dwordx4 v2, s[44:47], s95 offen lds
  s_waitcnt lgkmcnt(2)
  v_mfma_f32_32x32x16_bf16 v[200:215], a[164:167], a[52:55], v[200:215]
  ds_read_b128 a[0:3], v21 offset:16384
  buffer_load_dwordx4 v3, s[44:47], s95 offen offset:1024 lds
  s_add_u32 m0, s73, 0x1e000
  s_waitcnt lgkmcnt(2)
  v_mfma_f32_32x32x16_bf16 v[184:199], a[168:171], a[56:59], v[184:199]
  ds_read_b128 a[4:7], v21 offset:20480
  s_add_u32 s95, s94, 0x380
  s_and_b32 s95, s95, 0x3ff
  s_waitcnt lgkmcnt(2)
  v_mfma_f32_32x32x16_bf16 v[200:215], a[168:171], a[60:63], v[200:215]
  ds_read_b128 a[8:11], v19 offset:24576
  s_add_u32 s95, s95, s77
  buffer_load_dwordx4 v2, s[44:47], s95 offen lds
  s_waitcnt lgkmcnt(2)
  v_mfma_f32_32x32x16_bf16 v[184:199], a[172:175], a[0:3], v[184:199]
  ds_read_b128 a[12:15], v19 offset:28672
  buffer_load_dwordx4 v3, s[44:47], s95 offen offset:1024 lds
  s_add_u32 m0, s83, 0x20000
  s_waitcnt lgkmcnt(2)
  v_mfma_f32_32x32x16_bf16 v[200:215], a[172:175], a[4:7], v[200:215]
  ds_read_b128 a[16:19], v20 offset:24576
  s_add_u32 s95, s19, 0
  s_and_b32 s95, s95, 7
  s_waitcnt lgkmcnt(2)
  v_mfma_f32_32x32x16_bf16 v[184:199], a[180:183], a[8:11], v[184:199]
  ds_read_b128 a[20:23], v20 offset:28672
  s_mul_i32 s95, s95, 0x38000
  s_add_u32 s95, s95, s78
  buffer_load_dwordx4 v7, s[48:51], s95 offen lds
  buffer_load_dwordx4 v8, s[48:51], s95 offen offset:1024 lds
  buffer_load_dwordx4 v9, s[48:51], s95 offen offset:2048 lds
  buffer_load_dwordx4 v10, s[48:51], s95 offen offset:3072 lds
  s_add_u32 m0, s83, 0x21000
  s_nop 0
  buffer_load_dwordx4 v11, s[48:51], s95 offen lds
  buffer_load_dwordx4 v12, s[48:51], s95 offen offset:1024 lds
  buffer_load_dwordx4 v13, s[48:51], s95 offen offset:2048 lds
  v_mov_b32 v71, 0
  buffer_load_dwordx2 v[34:35], v71, s[68:71], 0 offen sc1
  s_waitcnt lgkmcnt(2)
  v_mfma_f32_32x32x16_bf16 v[200:215], a[180:183], a[12:15], v[200:215]
  ds_read_b128 a[24:27], v21 offset:24576
  s_waitcnt vmcnt(24)
  ds_read_b128 v[72:75], v14
  ds_read_b128 v[76:79], v15
  ds_read_b128 v[80:83], v16
  s_waitcnt lgkmcnt(5)
  v_mfma_f32_32x32x16_bf16 v[184:199], a[184:187], a[16:19], v[184:199]
  ds_read_b128 a[28:31], v21 offset:28672
  ds_read_b128 v[84:87], v17
  ds_read_b128 v[88:91], v14 offset:4096
  ds_read_b128 v[92:95], v15 offset:4096
  ds_read_b128 v[96:99], v16 offset:4096
  s_waitcnt lgkmcnt(9)
  v_mfma_f32_32x32x16_bf16 v[200:215], a[184:187], a[20:23], v[200:215]
  ds_read_b128 v[100:103], v17 offset:4096
  ds_read_b128 a[192:195], v14
  ds_read_b128 a[208:211], v14 offset:4096
  ds_read_b128 a[196:199], v15
  s_waitcnt lgkmcnt(12)
  v_mfma_f32_32x32x16_bf16 v[184:199], a[188:191], a[24:27], v[184:199]
  ds_read_b128 a[200:203], v16
  ds_read_b128 a[204:207], v17
  ds_read_b128 a[212:215], v15 offset:4096
  ds_read_b128 a[216:219], v16 offset:4096
  s_waitcnt lgkmcnt(12)
  v_mfma_f32_32x32x16_bf16 v[200:215], a[188:191], a[28:31], v[200:215]
  ds_read_b128 a[220:223], v17 offset:4096
  s_waitcnt vmcnt(20) lgkmcnt(0)
  s_barrier
  ds_read_b128 v[136:139], v18 offset:32768
  ds_read_b128 v[140:143], v18 offset:36864
  ds_read_b128 v[144:147], v18 offset:40960
  v_dot2c_f32_bf16 v60, s99, v72
  v_dot2c_f32_bf16 v62, v72, v72
  v_dot2c_f32_bf16 v61, s99, v73
  v_dot2c_f32_bf16 v63, v73, v73
  v_dot2c_f32_bf16 v60, s99, v74
  v_dot2c_f32_bf16 v62, v74, v74
  v_dot2c_f32_bf16 v61, s99, v75
  v_dot2c_f32_bf16 v63, v75, v75
  v_dot2c_f32_bf16 v60, s99, v76
  v_dot2c_f32_bf16 v62, v76, v76
  v_dot2c_f32_bf16 v61, s99, v77
  v_dot2c_f32_bf16 v63, v77, v77
  v_dot2c_f32_bf16 v60, s99, v78
  v_dot2c_f32_bf16 v62, v78, v78
  v_dot2c_f32_bf16 v61, s99, v79
  v_dot2c_f32_bf16 v63, v79, v79
  v_dot2c_f32_bf16 v60, s99, v80
  v_dot2c_f32_bf16 v62, v80, v80
  v_dot2c_f32_bf16 v61, s99, v81
  v_dot2c_f32_bf16 v63, v81, v81
  v_dot2c_f32_bf16 v60, s99, v82
  v_dot2c_f32_bf16 v62, v82, v82
  v_dot2c_f32_bf16 v61, s99, v83
  v_dot2c_f32_bf16 v63, v83, v83
  v_dot2c_f32_bf16 v60, s99, v84
  v_dot2c_f32_bf16 v62, v84, v84
  v_dot2c_f32_bf16 v61, s99, v85
  v_dot2c_f32_bf16 v63, v85, v85
  v_dot2c_f32_bf16 v60, s99, v86
  v_dot2c_f32_bf16 v62, v86, v86
  v_dot2c_f32_bf16 v61, s99, v87
  v_dot2c_f32_bf16 v63, v87, v87
  v_dot2c_f32_bf16 v60, s99, v88
  v_dot2c_f32_bf16 v62, v88, v88
  v_dot2c_f32_bf16 v61, s99, v89
  v_dot2c_f32_bf16 v63, v89, v89
  v_dot2c_f32_bf16 v60, s99, v90
  v_dot2c_f32_bf16 v62, v90, v90
  v_dot2c_f32_bf16 v61, s99, v91
  v_dot2c_f32_bf16 v63, v91, v91
  v_dot2c_f32_bf16 v60, s99, v92
  v_dot2c_f32_bf16 v62, v92, v92
  v_dot2c_f32_bf16 v61, s99, v93
  v_dot2c_f32_bf16 v63, v93, v93
  v_dot2c_f32_bf16 v60, s99, v94
  v_dot2c_f32_bf16 v62, v94, v94
  v_dot2c_f32_bf16 v61, s99, v95
  v_dot2c_f32_bf16 v63, v95, v95
  v_dot2c_f32_bf16 v60, s99, v96
  v_dot2c_f32_bf16 v62, v96, v96
  v_dot2c_f32_bf16 v61, s99, v97
  v_dot2c_f32_bf16 v63, v97, v97
  v_dot2c_f32_bf16 v60, s99, v98
  v_dot2c_f32_bf16 v62, v98, v98
  v_dot2c_f32_bf16 v61, s99, v99
  v_dot2c_f32_bf16 v63, v99, v99
  v_dot2c_f32_bf16 v60, s99, v100
  v_dot2c_f32_bf16 v62, v100, v100
  v_dot2c_f32_bf16 v61, s99, v101
  v_dot2c_f32_bf16 v63, v101, v101
  v_dot2c_f32_bf16 v60, s99, v102
  v_dot2c_f32_bf16 v62, v102, v102
  v_dot2c_f32_bf16 v61, s99, v103
  v_dot2c_f32_bf16 v63, v103, v103
  v_dot2c_f32_bf16 v52, s99, v152
  v_dot2c_f32_bf16 v52, s99, v153
  v_dot2c_f32_bf16 v52, s99, v154
  v_dot2c_f32_bf16 v52, s99, v155
  v_dot2c_f32_bf16 v53, s99, v156
  v_dot2c_f32_bf16 v53, s99, v157
  v_dot2c_f32_bf16 v53, s99, v158
  v_dot2c_f32_bf16 v53, s99, v159
  v_dot2c_f32_bf16 v52, s99, v160
  v_dot2c_f32_bf16 v52, s99, v161
  v_dot2c_f32_bf16 v52, s99, v162
  v_dot2c_f32_bf16 v52, s99, v163
  v_dot2c_f32_bf16 v53, s99, v164
  v_dot2c_f32_bf16 v53, s99, v165
  v_dot2c_f32_bf16 v53, s99, v166
  v_dot2c_f32_bf16 v53, s99, v167
  s_waitcnt lgkmcnt(2)
  v_mfma_f32_32x32x16_bf16 v[184:199], a[192:195], v[136:139], v[184:199]
  ds_read_b128 v[148:151], v18 offset:45056
  s_waitcnt lgkmcnt(2)
  v_mfma_f32_32x32x16_bf16 v[200:215], a[192:195], v[140:143], v[200:215]
  ds_read_b128 a[32:35], v19 offset:32768
  s_waitcnt lgkmcnt(2)
  v_mfma_f32_32x32x16_bf16 v[184:199], a[208:211], v[144:147], v[184:199]
  ds_read_b128 a[36:39], v19 offset:36864
  s_waitcnt lgkmcnt(2)
  v_mfma_f32_32x32x16_bf16 v[200:215], a[208:211], v[148:151], v[200:215]
  ds_read_b128 a[40:43], v20 offset:32768
  s_waitcnt lgkmcnt(2)
  v_mfma_f32_32x32x16_bf16 v[184:199], a[196:199], a[32:35], v[184:199]
  ds_read_b128 a[44:47], v20 offset:36864
  s_waitcnt lgkmcnt(2)
  v_mfma_f32_32x32x16_bf16 v[200:215], a[196:199], a[36:39], v[200:215]
  ds_read_b128 a[48:51], v21 offset:32768
  s_waitcnt lgkmcnt(2)
  v_mfma_f32_32x32x16_bf16 v[184:199], a[200:203], a[40:43], v[184:199]
  ds_read_b128 a[52:55], v21 offset:36864
  s_waitcnt lgkmcnt(2)
  v_mfma_f32_32x32x16_bf16 v[200:215], a[200:203], a[44:47], v[200:215]
  ds_read_b128 a[56:59], v19 offset:40960
  s_waitcnt lgkmcnt(2)
  v_mfma_f32_32x32x16_bf16 v[184:199], a[204:207], a[48:51], v[184:199]
  ds_read_b128 a[60:63], v19 offset:45056
  s_waitcnt lgkmcnt(2)
  v_mfma_f32_32x32x16_bf16 v[200:215], a[204:207], a[52:55], v[200:215]
  ds_read_b128 a[0:3], v20 offset:40960
  s_waitcnt lgkmcnt(2)
  v_mfma_f32_32x32x16_bf16 v[184:199], a[212:215], a[56:59], v[184:199]
  ds_read_b128 a[4:7], v20 offset:45056
  s_waitcnt lgkmcnt(2)
  v_mfma_f32_32x32x16_bf16 v[200:215], a[212:215], a[60:63], v[200:215]
  ds_read_b128 a[8:11], v21 offset:40960
  s_waitcnt vmcnt(12)
  ds_read_b128 v[104:107], v14 offset:32768
  ds_read_b128 v[108:111], v15 offset:32768
  ds_read_b128 v[112:115], v16 offset:32768
  s_waitcnt lgkmcnt(5)
  v_mfma_f32_32x32x16_bf16 v[184:199], a[216:219], a[0:3], v[184:199]
  ds_read_b128 a[12:15], v21 offset:45056
  ds_read_b128 v[116:119], v17 offset:32768
  ds_read_b128 v[120:123], v14 offset:36864
  ds_read_b128 v[124:127], v15 offset:36864
  ds_read_b128 v[128:131], v16 offset:36864
  s_waitcnt lgkmcnt(9)
  v_mfma_f32_32x32x16_bf16 v[200:215], a[216:219], a[4:7], v[200:215]
  ds_read_b128 v[132:135], v17 offset:36864
  ds_read_b128 a[224:227], v14 offset:32768
  ds_read_b128 a[240:243], v14 offset:36864
  ds_read_b128 a[228:231], v15 offset:32768
  s_waitcnt lgkmcnt(12)
  v_mfma_f32_32x32x16_bf16 v[184:199], a[220:223], a[8:11], v[184:199]
  ds_read_b128 a[232:235], v16 offset:32768
  ds_read_b128 a[236:239], v17 offset:32768
  ds_read_b128 a[244:247], v15 offset:36864
  ds_read_b128 a[248:251], v16 offset:36864
  s_waitcnt lgkmcnt(12)
  v_mfma_f32_32x32x16_bf16 v[200:215], a[220:223], a[12:15], v[200:215]
  ds_read_b128 a[252:255], v17 offset:36864
  s_waitcnt vmcnt(8) lgkmcnt(0)
  s_barrier
  ds_read_b128 v[152:155], v18 offset:49152
  ds_read_b128 v[156:159], v18 offset:53248
  ds_read_b128 v[160:163], v18 offset:57344
  v_dot2c_f32_bf16 v60, s99, v104
  v_dot2c_f32_bf16 v62, v104, v104
  v_dot2c_f32_bf16 v61, s99, v105
  v_dot2c_f32_bf16 v63, v105, v105
  v_dot2c_f32_bf16 v60, s99, v106
  v_dot2c_f32_bf16 v62, v106, v106
  v_dot2c_f32_bf16 v61, s99, v107
  v_dot2c_f32_bf16 v63, v107, v107
  v_dot2c_f32_bf16 v60, s99, v108
  v_dot2c_f32_bf16 v62, v108, v108
  v_dot2c_f32_bf16 v61, s99, v109
  v_dot2c_f32_bf16 v63, v109, v109
  v_dot2c_f32_bf16 v60, s99, v110
  v_dot2c_f32_bf16 v62, v110, v110
  v_dot2c_f32_bf16 v61, s99, v111
  v_dot2c_f32_bf16 v63, v111, v111
  v_dot2c_f32_bf16 v60, s99, v112
  v_dot2c_f32_bf16 v62, v112, v112
  v_dot2c_f32_bf16 v61, s99, v113
  v_dot2c_f32_bf16 v63, v113, v113
  v_dot2c_f32_bf16 v60, s99, v114
  v_dot2c_f32_bf16 v62, v114, v114
  v_dot2c_f32_bf16 v61, s99, v115
  v_dot2c_f32_bf16 v63, v115, v115
  v_dot2c_f32_bf16 v60, s99, v116
  v_dot2c_f32_bf16 v62, v116, v116
  v_dot2c_f32_bf16 v61, s99, v117
  v_dot2c_f32_bf16 v63, v117, v117
  v_dot2c_f32_bf16 v60, s99, v118
  v_dot2c_f32_bf16 v62, v118, v118
  v_dot2c_f32_bf16 v61, s99, v119
  v_dot2c_f32_bf16 v63, v119, v119
  v_dot2c_f32_bf16 v60, s99, v120
  v_dot2c_f32_bf16 v62, v120, v120
  v_dot2c_f32_bf16 v61, s99, v121
  v_dot2c_f32_bf16 v63, v121, v121
  v_dot2c_f32_bf16 v60, s99, v122
  v_dot2c_f32_bf16 v62, v122, v122
  v_dot2c_f32_bf16 v61, s99, v123
  v_dot2c_f32_bf16 v63, v123, v123
  v_dot2c_f32_bf16 v60, s99, v124
  v_dot2c_f32_bf16 v62, v124, v124
  v_dot2c_f32_bf16 v61, s99, v125
  v_dot2c_f32_bf16 v63, v125, v125
  v_dot2c_f32_bf16 v60, s99, v126
  v_dot2c_f32_bf16 v62, v126, v126
  v_dot2c_f32_bf16 v61, s99, v127
  v_dot2c_f32_bf16 v63, v127, v127
  v_dot2c_f32_bf16 v60, s99, v128
  v_dot2c_f32_bf16 v62, v128, v128
  v_dot2c_f32_bf16 v61, s99, v129
  v_dot2c_f32_bf16 v63, v129, v129
  v_dot2c_f32_bf16 v60, s99, v130
  v_dot2c_f32_bf16 v62, v130, v130
  v_dot2c_f32_bf16 v61, s99, v131
  v_dot2c_f32_bf16 v63, v131, v131
  v_dot2c_f32_bf16 v60, s99, v132
  v_dot2c_f32_bf16 v62, v132, v132
  v_dot2c_f32_bf16 v61, s99, v133
  v_dot2c_f32_bf16 v63, v133, v133
  v_dot2c_f32_bf16 v60, s99, v134
  v_dot2c_f32_bf16 v62, v134, v134
  v_dot2c_f32_bf16 v61, s99, v135
  v_dot2c_f32_bf16 v63, v135, v135
  v_dot2c_f32_bf16 v52, s99, v136
  v_dot2c_f32_bf16 v52, s99, v137
  v_dot2c_f32_bf16 v52, s99, v138
  v_dot2c_f32_bf16 v52, s99, v139
  v_dot2c_f32_bf16 v53, s99, v140
  v_dot2c_f32_bf16 v53, s99, v141
  v_dot2c_f32_bf16 v53, s99, v142
  v_dot2c_f32_bf16 v53, s99, v143
  v_dot2c_f32_bf16 v52, s99, v144
  v_dot2c_f32_bf16 v52, s99, v145
  v_dot2c_f32_bf16 v52, s99, v146
  v_dot2c_f32_bf16 v52, s99, v147
  v_dot2c_f32_bf16 v53, s99, v148
  v_dot2c_f32_bf16 v53, s99, v149
  v_dot2c_f32_bf16 v53, s99, v150
  v_dot2c_f32_bf16 v53, s99, v151
  s_waitcnt lgkmcnt(2)
  v_mfma_f32_32x32x16_bf16 v[184:199], a[224:227], v[152:155], v[184:199]
  ds_read_b128 v[164:167], v18 offset:61440
  v_add_f32 v60, v60, v61
  v_add_f32 v62, v62, v63
  v_mov_b32 v61, v60
  v_mov_b32 v63, v62
  s_waitcnt lgkmcnt(2)
  v_mfma_f32_32x32x16_bf16 v[200:215], a[224:227], v[156:159], v[200:215]
  ds_read_b128 a[16:19], v19 offset:49152
  v_permlane32_swap_b32 v60, v61
  v_permlane32_swap_b32 v62, v63
  v_add_f32 v60, v60, v61
  v_add_f32 v62, v62, v63
  s_waitcnt lgkmcnt(2)
  v_mfma_f32_32x32x16_bf16 v[184:199], a[240:243], v[160:163], v[184:199]
  ds_read_b128 a[20:23], v19 offset:53248
  v_mul_f32 v60, 0x3b000000, v60
  v_mul_f32 v62, 0x3b000000, v62
  v_fma_f32 v62, -v60, v60, v62
  v_max_f32 v62, 0, v62
  s_waitcnt lgkmcnt(2)
  v_mfma_f32_32x32x16_bf16 v[200:215], a[240:243], v[164:167], v[200:215]
  ds_read_b128 a[24:27], v20 offset:49152
  v_cvt_pk_bf16_f32 v40, -v60, -v60
  v_cvt_pk_bf16_f32 v62, v62, v62
  v_lshlrev_b32 v62, 16, v62
  v_add_f32 v62, 0x3727c5ac, v62
  s_waitcnt lgkmcnt(2)
  v_mfma_f32_32x32x16_bf16 v[184:199], a[228:231], a[16:19], v[184:199]
  ds_read_b128 a[28:31], v20 offset:53248
  v_dot2c_f32_bf16 v52, s99, v152
  v_dot2c_f32_bf16 v52, s99, v153
  v_dot2c_f32_bf16 v52, s99, v154
  v_dot2c_f32_bf16 v52, s99, v155
  v_dot2c_f32_bf16 v53, s99, v156
  v_dot2c_f32_bf16 v53, s99, v157
  v_dot2c_f32_bf16 v53, s99, v158
  v_dot2c_f32_bf16 v53, s99, v159
  v_dot2c_f32_bf16 v52, s99, v160
  v_dot2c_f32_bf16 v52, s99, v161
  v_dot2c_f32_bf16 v52, s99, v162
  v_dot2c_f32_bf16 v52, s99, v163
  v_dot2c_f32_bf16 v53, s99, v164
  v_dot2c_f32_bf16 v53, s99, v165
  v_dot2c_f32_bf16 v53, s99, v166
  v_dot2c_f32_bf16 v53, s99, v167
  s_waitcnt lgkmcnt(2)
  v_mfma_f32_32x32x16_bf16 v[200:215], a[228:231], a[20:23], v[200:215]
  ds_read_b128 a[32:35], v21 offset:49152
  v_cvt_pk_bf16_f32 v62, v62, v62
  v_lshlrev_b32 v62, 16, v62
  v_sqrt_f32 v62, v62
  v_mov_b32 v41, v40
  s_waitcnt lgkmcnt(2)
  v_mfma_f32_32x32x16_bf16 v[184:199], a[232:235], a[24:27], v[184:199]
  ds_read_b128 a[36:39], v21 offset:53248
  v_mov_b32 v42, v40
  v_mov_b32 v43, v40
  v_cvt_pk_bf16_f32 v62, v62, v62
  v_lshlrev_b32 v62, 16, v62
  s_waitcnt lgkmcnt(2)
  v_mfma_f32_32x32x16_bf16 v[200:215], a[232:235], a[28:31], v[200:215]
  ds_read_b128 a[40:43], v19 offset:57344
  v_rcp_f32 v64, v62
  v_mul_f32 v46, v62, v62
  v_mul_f32 v44, 0xc0135761, v64
  v_mul_f32 v45, v64, v64
  s_waitcnt lgkmcnt(2)
  v_mfma_f32_32x32x16_bf16 v[184:199], a[236:239], a[32:35], v[184:199]
  ds_read_b128 a[44:47], v19 offset:61440
  v_mul_f32 v45, v45, v64
  v_mul_f32 v45, 0xbdd2d3e8, v45
  v_xor_b32 v64, s84, v64
  v_lshrrev_b32 v65, 2, v47
  s_waitcnt lgkmcnt(2)
  v_mfma_f32_32x32x16_bf16 v[200:215], a[236:239], a[36:39], v[200:215]
  ds_read_b128 a[48:51], v20 offset:57344
  s_lshl_b32 s15, s3, 7
  v_add_u32 v65, s15, v65
  ds_write_b32 v65, v64 offset:30848
  s_lshl_b32 s15, s3, 2
  s_waitcnt lgkmcnt(3)
  v_mfma_f32_32x32x16_bf16 v[184:199], a[244:247], a[40:43], v[184:199]
  ds_read_b128 a[52:55], v20 offset:61440
  v_add_u32 v66, s15, v48
  v_cvt_pk_bf16_f32 v67, v52, v52
  v_and_b32 v67, 0xffff0000, v67
  v_sub_f32 v67, v52, v67
  s_waitcnt lgkmcnt(3)
  v_mfma_f32_32x32x16_bf16 v[200:215], a[244:247], a[44:47], v[200:215]
  ds_read_b128 a[56:59], v21 offset:57344
  v_cvt_pk_bf16_f32 v67, v52, v67
  ds_write_b32 v66, v67 offset:28800
  v_mov_b32 v52, 0
  v_cvt_pk_bf16_f32 v68, v53, v53
  s_waitcnt lgkmcnt(4)
  v_mfma_f32_32x32x16_bf16 v[184:199], a[248:251], a[48:51], v[184:199]
  ds_read_b128 a[60:63], v21 offset:61440
  s_add_u32 m0, s83, 0
  s_add_u32 s95, s19, 1
  s_and_b32 s95, s95, 7
  s_mul_i32 s95, s95, 0x38000
  v_and_b32 v68, 0xffff0000, v68
  v_sub_f32 v68, v53, v68
  v_cvt_pk_bf16_f32 v68, v53, v68
  ds_write_b32 v66, v68 offset:29824
  s_waitcnt lgkmcnt(4)
  v_mfma_f32_32x32x16_bf16 v[200:215], a[248:251], a[52:55], v[200:215]
  s_add_u32 s95, s95, s78
  buffer_load_dwordx4 v7, s[48:51], s95 offen lds
  buffer_load_dwordx4 v8, s[48:51], s95 offen offset:1024 lds
  buffer_load_dwordx4 v9, s[48:51], s95 offen offset:2048 lds
  v_mov_b32 v53, 0
  s_waitcnt lgkmcnt(3)
  v_mfma_f32_32x32x16_bf16 v[184:199], a[252:255], a[56:59], v[184:199]
  buffer_load_dwordx4 v10, s[48:51], s95 offen offset:3072 lds
  s_add_u32 m0, s83, 0x1000
  s_nop 0
  buffer_load_dwordx4 v11, s[48:51], s95 offen lds
  buffer_load_dwordx4 v12, s[48:51], s95 offen offset:1024 lds
  s_waitcnt lgkmcnt(1)
  v_mfma_f32_32x32x16_bf16 v[200:215], a[252:255], a[60:63], v[200:215]
  buffer_load_dwordx4 v13, s[48:51], s95 offen offset:2048 lds
  s_add_u32 m0, s83, 0x8000
  s_add_u32 s95, s19, 2
  s_and_b32 s95, s95, 7
  s_mul_i32 s95, s95, 0x38000
  s_add_u32 s95, s95, s78
  buffer_load_dwordx4 v7, s[48:51], s95 offen lds
  buffer_load_dwordx4 v8, s[48:51], s95 offen offset:1024 lds
  buffer_load_dwordx4 v9, s[48:51], s95 offen offset:2048 lds
  buffer_load_dwordx4 v10, s[48:51], s95 offen offset:3072 lds
  s_add_u32 m0, s83, 0x9000
  s_nop 0
  buffer_load_dwordx4 v11, s[48:51], s95 offen lds
  buffer_load_dwordx4 v12, s[48:51], s95 offen offset:1024 lds
  buffer_load_dwordx4 v13, s[48:51], s95 offen offset:2048 lds
  s_add_u32 s95, s98, 0x300
  s_and_b32 s95, s95, 0x7ff
  s_add_u32 s95, s95, s80
  buffer_load_dword v49, v51, s[52:55], s95 offen
  s_waitcnt vmcnt(16)
  s_waitcnt lgkmcnt(0)
  s_barrier
  ds_read_b64_tr_b16 v[216:217], v26
  ds_read_b64_tr_b16 v[218:219], v26 offset:896
  ds_read_b64_tr_b16 v[220:221], v26 offset:32
  ds_read_b64_tr_b16 v[222:223], v26 offset:928
  ds_read_b64_tr_b16 v[224:225], v26 offset:64
  ds_read_b64_tr_b16 v[226:227], v26 offset:960
  ds_read_b64_tr_b16 v[228:229], v26 offset:96
  ds_read_b64_tr_b16 v[230:231], v26 offset:992
  s_waitcnt lgkmcnt(6)
  v_mfma_f32_32x32x16_bf16 v[72:87], v[216:219], a[128:131], 0
  ds_read_b64_tr_b16 v[232:233], v26 offset:128
  ds_read_b64_tr_b16 v[234:235], v26 offset:1024
  ds_read_b64_tr_b16 v[236:237], v26 offset:160
  ds_read_b64_tr_b16 v[238:239], v26 offset:1056
  v_lshrrev_b32 v68, 5, v0
  v_lshlrev_b32 v68, 4, v68
  s_waitcnt lgkmcnt(8)
  v_mfma_f32_32x32x16_bf16 v[88:103], v[220:223], a[128:131], 0
  ds_read_b128 a[0:3], v48 offset:28800
  ds_read_b64_tr_b16 v[240:241], v26 offset:192
  ds_read_b64_tr_b16 v[242:243], v26 offset:1088
  s_lshl_b32 s15, s3, 7
  v_add_u32 v68, s15, v68
  s_waitcnt lgkmcnt(9)
  v_mfma_f32_32x32x16_bf16 v[104:119], v[224:227], a[128:131], 0
  ds_read_b128 a[4:7], v48 offset:29824
  ds_read_b64_tr_b16 a[8:9], v27
  ds_read_b64_tr_b16 a[10:11], v27 offset:896
  ds_read_b128 v[248:251], v68 offset:30848
  ds_read_b128 v[252:255], v68 offset:30880
  s_waitcnt lgkmcnt(12)
  v_mfma_f32_32x32x16_bf16 v[120:135], v[228:231], a[128:131], 0
  ds_read_b64_tr_b16 a[12:13], v27 offset:32
  ds_read_b64_tr_b16 a[14:15], v27 offset:928
  s_waitcnt lgkmcnt(12)
  v_mfma_f32_32x32x16_bf16 v[136:151], v[232:235], a[128:131], 0
  ds_read_b64_tr_b16 a[16:17], v27 offset:64
  ds_read_b64_tr_b16 a[18:19], v27 offset:960
  s_waitcnt lgkmcnt(11)
  v_mfma_f32_32x32x16_bf16 v[184:199], v[40:43], a[0:3], v[184:199]
  ds_read_b64_tr_b16 a[20:21], v27 offset:96
  ds_read_b64_tr_b16 a[22:23], v27 offset:992
  s_waitcnt lgkmcnt(10)
  v_mfma_f32_32x32x16_bf16 v[200:215], v[40:43], a[4:7], v[200:215]
  ds_read_b64_tr_b16 a[24:25], v27 offset:128
  ds_read_b64_tr_b16 a[26:27], v27 offset:1024
  v_mfma_f32_32x32x16_bf16 v[152:167], v[236:239], a[128:131], 0
  ds_read_b64_tr_b16 a[28:29], v27 offset:160
  ds_read_b64_tr_b16 a[30:31], v27 offset:1056
  v_mfma_f32_32x32x16_bf16 v[168:183], v[240:243], a[128:131], 0
  ds_read_b64_tr_b16 a[32:33], v27 offset:192
  ds_read_b64_tr_b16 a[34:35], v27 offset:1088
  s_waitcnt lgkmcnt(6)
  v_mfma_f32_32x32x16_bf16 v[72:87], a[8:11], a[132:135], v[72:87]
  ds_read_b64_tr_b16 a[36:37], v28
  ds_read_b64_tr_b16 a[38:39], v28 offset:896
  v_dot2c_f32_bf16 v52, s99, v216
  v_dot2c_f32_bf16 v52, s99, v217
  v_dot2c_f32_bf16 v52, s99, v218
  v_dot2c_f32_bf16 v52, s99, v219
  v_dot2c_f32_bf16 v53, s99, v220
  v_dot2c_f32_bf16 v53, s99, v221
  v_dot2c_f32_bf16 v53, s99, v222
  v_dot2c_f32_bf16 v53, s99, v223
  v_dot2c_f32_bf16 v54, s99, v224
  v_dot2c_f32_bf16 v54, s99, v225
  v_dot2c_f32_bf16 v54, s99, v226
  v_dot2c_f32_bf16 v54, s99, v227
  v_dot2c_f32_bf16 v55, s99, v228
  v_dot2c_f32_bf16 v55, s99, v229
  v_dot2c_f32_bf16 v55, s99, v230
  v_dot2c_f32_bf16 v55, s99, v231
  v_dot2c_f32_bf16 v56, s99, v232
  v_dot2c_f32_bf16 v56, s99, v233
  v_dot2c_f32_bf16 v56, s99, v234
  v_dot2c_f32_bf16 v56, s99, v235
  v_dot2c_f32_bf16 v57, s99, v236
  v_dot2c_f32_bf16 v57, s99, v237
  v_dot2c_f32_bf16 v57, s99, v238
  v_dot2c_f32_bf16 v57, s99, v239
  v_dot2c_f32_bf16 v58, s99, v240
  v_dot2c_f32_bf16 v58, s99, v241
  v_dot2c_f32_bf16 v58, s99, v242
  v_dot2c_f32_bf16 v58, s99, v243
  v_lshrrev_b32 v69, 5, v0
  v_lshl_add_u32 v69, v69, 9, v47
  s_lshl_b32 s14, s3, 2
  v_add_u32 v69, s14, v69
  v_permlane32_swap_b32 v52, v53
  v_add_f32 v52, v52, v53
  ds_write_b32 v69, v52 offset:61568
  v_permlane32_swap_b32 v54, v55
  v_mfma_f32_32x32x16_bf16 v[88:103], a[12:15], a[132:135], v[88:103]
  ds_read_b64_tr_b16 a[40:41], v28 offset:32
  ds_read_b64_tr_b16 a[42:43], v28 offset:928
  v_add_f32 v54, v54, v55
  ds_write_b32 v69, v54 offset:62592
  v_permlane32_swap_b32 v56, v57
  v_add_f32 v56, v56, v57
  ds_write_b32 v69, v56 offset:63616
  v_mov_b32 v59, v58
  v_add_u32 v69, s14, v47
  s_nop 0
  v_permlane32_swap_b32 v58, v59
  v_mfma_f32_32x32x16_bf16 v[104:119], a[16:19], a[132:135], v[104:119]
  ds_read_b64_tr_b16 a[44:45], v28 offset:64
  ds_read_b64_tr_b16 a[46:47], v28 offset:960
  v_add_f32 v58, v58, v59
  ds_write_b32 v69, v58 offset:64640
  v_mfma_f32_32x32x16_bf16 v[120:135], a[20:23], a[132:135], v[120:135]
  ds_read_b64_tr_b16 a[48:49], v28 offset:96
  ds_read_b64_tr_b16 a[50:51], v28 offset:992
  s_waitcnt lgkmcnt(10)
  v_mfma_f32_32x32x16_bf16 v[136:151], a[24:27], a[132:135], v[136:151]
  ds_read_b64_tr_b16 a[52:53], v28 offset:128
  ds_read_b64_tr_b16 a[54:55], v28 offset:1024
  v_mul_f32 v184, v184, v248
  v_mul_f32 v185, v185, v249
  v_mul_f32 v186, v186, v250
  v_mul_f32 v187, v187, v251
  v_mul_f32 v188, v188, v252
  v_mul_f32 v189, v189, v253
  v_mul_f32 v190, v190, v254
  v_mul_f32 v191, v191, v255
  v_mfma_f32_32x32x16_bf16 v[152:167], a[28:31], a[132:135], v[152:167]
  ds_read_b64_tr_b16 a[56:57], v28 offset:160
  ds_read_b64_tr_b16 a[58:59], v28 offset:1056
  v_cvt_pk_bf16_f32 v60, v184, v185
  v_cvt_pk_bf16_f32 v61, v186, v187
  v_cvt_pk_bf16_f32 v62, v188, v189
  v_cvt_pk_bf16_f32 v63, v190, v191
  s_nop 0
  v_permlane32_swap_b32 v60, v62
  v_permlane32_swap_b32 v61, v63
  s_add_u32 s15, s85, 0
  buffer_store_dwordx4 v[60:63], v1, s[60:63], s15 offen sc1
  v_mfma_f32_32x32x16_bf16 v[168:183], a[32:35], a[132:135], v[168:183]
  ds_read_b64_tr_b16 a[60:61], v28 offset:192
  ds_read_b64_tr_b16 a[62:63], v28 offset:1088
  v_mul_f32 v200, v200, v248
  v_mul_f32 v201, v201, v249
  v_mul_f32 v202, v202, v250
  v_mul_f32 v203, v203, v251
  v_mul_f32 v204, v204, v252
  v_mul_f32 v205, v205, v253
  v_mul_f32 v206, v206, v254
  v_mul_f32 v207, v207, v255
  v_mfma_f32_32x32x16_bf16 v[72:87], a[36:39], a[136:139], v[72:87]
  ds_read_b64_tr_b16 a[0:1], v29
  ds_read_b64_tr_b16 a[2:3], v29 offset:896
  v_cvt_pk_bf16_f32 v64, v200, v201
  v_cvt_pk_bf16_f32 v65, v202, v203
  v_cvt_pk_bf16_f32 v66, v204, v205
  v_cvt_pk_bf16_f32 v67, v206, v207
  s_nop 0
  v_permlane32_swap_b32 v64, v66
  v_permlane32_swap_b32 v65, v67
  s_add_u32 s15, s85, 0x20000
  buffer_store_dwordx4 v[64:67], v1, s[60:63], s15 offen sc1
  s_waitcnt lgkmcnt(6)
  v_mfma_f32_32x32x16_bf16 v[88:103], a[40:43], a[136:139], v[88:103]
  ds_read_b64_tr_b16 a[4:5], v29 offset:32
  ds_read_b64_tr_b16 a[6:7], v29 offset:928
  ds_read_b128 v[248:251], v68 offset:30912
  ds_read_b128 v[252:255], v68 offset:30944
  s_waitcnt lgkmcnt(1)
  v_mul_f32 v192, v192, v248
  v_mul_f32 v193, v193, v249
  v_mul_f32 v194, v194, v250
  v_mul_f32 v195, v195, v251
  s_waitcnt lgkmcnt(0)
  v_mul_f32 v196, v196, v252
  v_mul_f32 v197, v197, v253
  v_mfma_f32_32x32x16_bf16 v[104:119], a[44:47], a[136:139], v[104:119]
  ds_read_b64_tr_b16 a[8:9], v29 offset:64
  ds_read_b64_tr_b16 a[10:11], v29 offset:960
  v_mul_f32 v198, v198, v254
  v_mul_f32 v199, v199, v255
  v_cvt_pk_bf16_f32 v60, v192, v193
  v_cvt_pk_bf16_f32 v61, v194, v195
  v_cvt_pk_bf16_f32 v62, v196, v197
  v_cvt_pk_bf16_f32 v63, v198, v199
  s_nop 0
  v_permlane32_swap_b32 v60, v62
  v_permlane32_swap_b32 v61, v63
  v_mfma_f32_32x32x16_bf16 v[120:135], a[48:51], a[136:139], v[120:135]
  ds_read_b64_tr_b16 a[12:13], v29 offset:96
  ds_read_b64_tr_b16 a[14:15], v29 offset:992
  s_add_u32 s15, s85, 0
  buffer_store_dwordx4 v[60:63], v1, s[60:63], s15 offen offset:1024 sc1
  v_mul_f32 v208, v208, v248
  v_mul_f32 v209, v209, v249
  v_mul_f32 v210, v210, v250
  v_mul_f32 v211, v211, v251
  v_mul_f32 v212, v212, v252
  v_mul_f32 v213, v213, v253
  v_mfma_f32_32x32x16_bf16 v[136:151], a[52:55], a[136:139], v[136:151]
  ds_read_b64_tr_b16 a[16:17], v29 offset:128
  ds_read_b64_tr_b16 a[18:19], v29 offset:1024
  ds_read_b64_tr_b16 a[20:21], v29 offset:160
  ds_read_b64_tr_b16 a[22:23], v29 offset:1056
  ds_read_b64_tr_b16 a[24:25], v29 offset:192
  ds_read_b64_tr_b16 a[26:27], v29 offset:1088
  v_mul_f32 v214, v214, v254
  v_mul_f32 v215, v215, v255
  v_cvt_pk_bf16_f32 v64, v208, v209
  v_cvt_pk_bf16_f32 v65, v210, v211
  v_cvt_pk_bf16_f32 v66, v212, v213
  v_cvt_pk_bf16_f32 v67, v214, v215
  s_nop 0
  v_permlane32_swap_b32 v64, v66
  v_permlane32_swap_b32 v65, v67
  v_mfma_f32_32x32x16_bf16 v[152:167], a[56:59], a[136:139], v[152:167]
  s_add_u32 s15, s85, 0x20000
  buffer_store_dwordx4 v[64:67], v1, s[60:63], s15 offen offset:1024 sc1
  v_mfma_f32_32x32x16_bf16 v[168:183], a[60:63], a[136:139], v[168:183]
  s_waitcnt vmcnt(12) lgkmcnt(0)
  s_barrier
  v_mfma_f32_32x32x16_bf16 v[72:87], a[0:3], a[140:143], v[72:87]
  v_subrev_u32 v26, 0x20000, v26
  ds_read_b64_tr_b16 a[28:29], v26
  ds_read_b64_tr_b16 a[30:31], v26 offset:896
  s_lshl_b32 s14, s3, 10
  v_add_u32 v69, s14, v1
  ds_read_b128 v[52:55], v69 offset:61568
  v_mfma_f32_32x32x16_bf16 v[88:103], a[4:7], a[140:143], v[88:103]
  ds_read_b64_tr_b16 a[32:33], v26 offset:32
  ds_read_b64_tr_b16 a[34:35], v26 offset:928
  v_mfma_f32_32x32x16_bf16 v[104:119], a[8:11], a[140:143], v[104:119]
  ds_read_b64_tr_b16 a[36:37], v26 offset:64
  ds_read_b64_tr_b16 a[38:39], v26 offset:960
  v_mfma_f32_32x32x16_bf16 v[120:135], a[12:15], a[140:143], v[120:135]
  ds_read_b64_tr_b16 a[40:41], v26 offset:96
  ds_read_b64_tr_b16 a[42:43], v26 offset:992
  v_lshrrev_b32 v69, 2, v69
  v_cmp_gt_u32 vcc, 0x380, v69
  s_nop 1
  v_cndmask_b32 v69, v33, v69, vcc
  s_lshl_b32 s14, s19, 10
  s_add_u32 s14, s14, s20
  s_waitcnt lgkmcnt(6)
  v_add_f32 v52, v52, v53
  v_add_f32 v54, v54, v55
  v_add_f32 v52, v52, v54
  v_cvt_pk_bf16_f32 v53, v52, v52
  v_mfma_f32_32x32x16_bf16 v[136:151], a[16:19], a[140:143], v[136:151]
  ds_read_b64_tr_b16 a[44:45], v26 offset:128
  ds_read_b64_tr_b16 a[46:47], v26 offset:1024
  v_and_b32 v53, 0xffff0000, v53
  v_sub_f32 v53, v52, v53
  v_cvt_pk_bf16_f32 v53, v52, v53
  buffer_store_dword v53, v69, s[60:63], s14 offen sc1
  v_mfma_f32_32x32x16_bf16 v[152:167], a[20:23], a[140:143], v[152:167]
  ds_read_b64_tr_b16 a[48:49], v26 offset:160
  ds_read_b64_tr_b16 a[50:51], v26 offset:1056
  v_mfma_f32_32x32x16_bf16 v[168:183], a[24:27], a[140:143], v[168:183]
  ds_read_b64_tr_b16 a[52:53], v26 offset:192
  ds_read_b64_tr_b16 a[54:55], v26 offset:1088
  s_waitcnt lgkmcnt(8)
  v_mfma_f32_32x32x16_bf16 v[72:87], a[28:31], a[144:147], v[72:87]
  v_subrev_u32 v27, 0x20000, v27
  ds_read_b64_tr_b16 a[56:57], v27
  ds_read_b64_tr_b16 a[58:59], v27 offset:896
  v_mfma_f32_32x32x16_bf16 v[88:103], a[32:35], a[144:147], v[88:103]
  ds_read_b64_tr_b16 a[60:61], v27 offset:32
  ds_read_b64_tr_b16 a[62:63], v27 offset:928
  v_mfma_f32_32x32x16_bf16 v[104:119], a[36:39], a[144:147], v[104:119]
  ds_read_b64_tr_b16 a[0:1], v27 offset:64
  ds_read_b64_tr_b16 a[2:3], v27 offset:960
  s_waitcnt lgkmcnt(6)
  v_mfma_f32_32x32x16_bf16 v[120:135], a[40:43], a[144:147], v[120:135]
  ds_read_b64_tr_b16 a[4:5], v27 offset:96
  ds_read_b64_tr_b16 a[6:7], v27 offset:992
  v_mfma_f32_32x32x16_bf16 v[136:151], a[44:47], a[144:147], v[136:151]
  ds_read_b64_tr_b16 a[8:9], v27 offset:128
  ds_read_b64_tr_b16 a[10:11], v27 offset:1024
  v_mfma_f32_32x32x16_bf16 v[152:167], a[48:51], a[144:147], v[152:167]
  ds_read_b64_tr_b16 a[12:13], v27 offset:160
  ds_read_b64_tr_b16 a[14:15], v27 offset:1056
  v_mfma_f32_32x32x16_bf16 v[168:183], a[52:55], a[144:147], v[168:183]
  ds_read_b64_tr_b16 a[16:17], v27 offset:192
  ds_read_b64_tr_b16 a[18:19], v27 offset:1088
  s_waitcnt lgkmcnt(6)
  v_mfma_f32_32x32x16_bf16 v[72:87], a[56:59], a[148:151], v[72:87]
  v_subrev_u32 v28, 0x20000, v28
  ds_read_b64_tr_b16 a[20:21], v28
  ds_read_b64_tr_b16 a[22:23], v28 offset:896
  s_waitcnt vmcnt(0)
  s_barrier
  v_cmp_ne_u32 vcc, 0, v34
  s_nop 0
  s_cmp_eq_u64 vcc, -1
  s_cbranch_scc0 L2_slow_nonce
L2_res_nonce:
  s_mov_b32 s94, 0
  buffer_store_dwordx2 v[34:35], v33, s[60:63], s94 offen sc1
  v_mfma_f32_32x32x16_bf16 v[88:103], a[60:63], a[148:151], v[88:103]
  ds_read_b64_tr_b16 a[24:25], v28 offset:32
  ds_read_b64_tr_b16 a[26:27], v28 offset:928
  s_add_u32 m0, s83, 0x10000
  v_mfma_f32_32x32x16_bf16 v[104:119], a[0:3], a[148:151], v[104:119]
  ds_read_b64_tr_b16 a[28:29], v28 offset:64
  ds_read_b64_tr_b16 a[30:31], v28 offset:960
  s_add_u32 s95, s19, 3
  v_mfma_f32_32x32x16_bf16 v[120:135], a[4:7], a[148:151], v[120:135]
  ds_read_b64_tr_b16 a[32:33], v28 offset:96
  ds_read_b64_tr_b16 a[34:35], v28 offset:992
  s_and_b32 s95, s95, 7
  s_waitcnt lgkmcnt(6)
  v_mfma_f32_32x32x16_bf16 v[136:151], a[8:11], a[148:151], v[136:151]
  ds_read_b64_tr_b16 a[36:37], v28 offset:128
  ds_read_b64_tr_b16 a[38:39], v28 offset:1024
  s_mul_i32 s95, s95, 0x38000
  v_mfma_f32_32x32x16_bf16 v[152:167], a[12:15], a[148:151], v[152:167]
  ds_read_b64_tr_b16 a[40:41], v28 offset:160
  ds_read_b64_tr_b16 a[42:43], v28 offset:1056
  s_add_u32 s95, s95, s78
  v_mfma_f32_32x32x16_bf16 v[168:183], a[16:19], a[148:151], v[168:183]
  ds_read_b64_tr_b16 a[44:45], v28 offset:192
  ds_read_b64_tr_b16 a[46:47], v28 offset:1088
  buffer_load_dwordx4 v7, s[48:51], s95 offen lds
  v_mfma_f32_32x32x16_bf16 v[72:87], a[20:23], a[152:155], v[72:87]
  v_subrev_u32 v29, 0x20000, v29
  ds_read_b64_tr_b16 a[48:49], v29
  ds_read_b64_tr_b16 a[50:51], v29 offset:896
  buffer_load_dwordx4 v8, s[48:51], s95 offen offset:1024 lds
  s_waitcnt lgkmcnt(6)
  v_mfma_f32_32x32x16_bf16 v[88:103], a[24:27], a[152:155], v[88:103]
  ds_read_b64_tr_b16 a[52:53], v29 offset:32
  ds_read_b64_tr_b16 a[54:55], v29 offset:928
  buffer_load_dwordx4 v9, s[48:51], s95 offen offset:2048 lds
  v_mfma_f32_32x32x16_bf16 v[104:119], a[28:31], a[152:155], v[104:119]
  ds_read_b64_tr_b16 a[56:57], v29 offset:64
  ds_read_b64_tr_b16 a[58:59], v29 offset:960
  buffer_load_dwordx4 v10, s[48:51], s95 offen offset:3072 lds
  v_mfma_f32_32x32x16_bf16 v[120:135], a[32:35], a[152:155], v[120:135]
  ds_read_b64_tr_b16 a[60:61], v29 offset:96
  ds_read_b64_tr_b16 a[62:63], v29 offset:992
  s_add_u32 m0, s83, 0x11000
  v_mfma_f32_32x32x16_bf16 v[136:151], a[36:39], a[152:155], v[136:151]
  ds_read_b64_tr_b16 a[0:1], v29 offset:128
  ds_read_b64_tr_b16 a[2:3], v29 offset:1024
  ds_read_b64_tr_b16 a[4:5], v29 offset:160
  ds_read_b64_tr_b16 a[6:7], v29 offset:1056
  ds_read_b64_tr_b16 a[8:9], v29 offset:192
  ds_read_b64_tr_b16 a[10:11], v29 offset:1088
  buffer_load_dwordx4 v11, s[48:51], s95 offen lds
  s_waitcnt lgkmcnt(10)
  v_mfma_f32_32x32x16_bf16 v[152:167], a[40:43], a[152:155], v[152:167]
  buffer_load_dwordx4 v12, s[48:51], s95 offen offset:1024 lds
  v_mfma_f32_32x32x16_bf16 v[168:183], a[44:47], a[152:155], v[168:183]
  s_waitcnt lgkmcnt(0)
  s_barrier
  v_mfma_f32_32x32x16_bf16 v[72:87], a[48:51], a[156:159], v[72:87]
  v_add_u32 v26, 0x8000, v26
  ds_read_b64_tr_b16 a[12:13], v26
  ds_read_b64_tr_b16 a[14:15], v26 offset:896
  buffer_load_dwordx4 v13, s[48:51], s95 offen offset:2048 lds
  v_mfma_f32_32x32x16_bf16 v[88:103], a[52:55], a[156:159], v[88:103]
  ds_read_b64_tr_b16 a[16:17], v26 offset:32
  ds_read_b64_tr_b16 a[18:19], v26 offset:928
  s_add_u32 m0, s83, 0x18000
  v_mfma_f32_32x32x16_bf16 v[104:119], a[56:59], a[156:159], v[104:119]
  ds_read_b64_tr_b16 a[20:21], v26 offset:64
  ds_read_b64_tr_b16 a[22:23], v26 offset:960
  s_add_u32 s95, s19, 4
  v_mfma_f32_32x32x16_bf16 v[120:135], a[60:63], a[156:159], v[120:135]
  ds_read_b64_tr_b16 a[24:25], v26 offset:96
  ds_read_b64_tr_b16 a[26:27], v26 offset:992
  s_and_b32 s95, s95, 7
  v_mfma_f32_32x32x16_bf16 v[136:151], a[0:3], a[156:159], v[136:151]
  ds_read_b64_tr_b16 a[28:29], v26 offset:128
  ds_read_b64_tr_b16 a[30:31], v26 offset:1024
  s_mul_i32 s95, s95, 0x38000
  v_mfma_f32_32x32x16_bf16 v[152:167], a[4:7], a[156:159], v[152:167]
  ds_read_b64_tr_b16 a[32:33], v26 offset:160
  ds_read_b64_tr_b16 a[34:35], v26 offset:1056
  s_add_u32 s95, s95, s78
  v_mfma_f32_32x32x16_bf16 v[168:183], a[8:11], a[156:159], v[168:183]
  ds_read_b64_tr_b16 a[36:37], v26 offset:192
  ds_read_b64_tr_b16 a[38:39], v26 offset:1088
  buffer_load_dwordx4 v7, s[48:51], s95 offen lds
  s_waitcnt lgkmcnt(8)
  v_mfma_f32_32x32x16_bf16 v[72:87], a[12:15], a[160:163], v[72:87]
  v_add_u32 v27, 0x8000, v27
  ds_read_b64_tr_b16 a[40:41], v27
  ds_read_b64_tr_b16 a[42:43], v27 offset:896
  buffer_load_dwordx4 v8, s[48:51], s95 offen offset:1024 lds
  v_mfma_f32_32x32x16_bf16 v[88:103], a[16:19], a[160:163], v[88:103]
  ds_read_b64_tr_b16 a[44:45], v27 offset:32
  ds_read_b64_tr_b16 a[46:47], v27 offset:928
  buffer_load_dwordx4 v9, s[48:51], s95 offen offset:2048 lds
  v_mfma_f32_32x32x16_bf16 v[104:119], a[20:23], a[160:163], v[104:119]
  ds_read_b64_tr_b16 a[48:49], v27 offset:64
  ds_read_b64_tr_b16 a[50:51], v27 offset:960
  buffer_load_dwordx4 v10, s[48:51], s95 offen offset:3072 lds
  s_waitcnt lgkmcnt(6)
  v_mfma_f32_32x32x16_bf16 v[120:135], a[24:27], a[160:163], v[120:135]
  ds_read_b64_tr_b16 a[52:53], v27 offset:96
  ds_read_b64_tr_b16 a[54:55], v27 offset:992
  s_add_u32 m0, s83, 0x19000
  v_mfma_f32_32x32x16_bf16 v[136:151], a[28:31], a[160:163], v[136:151]
  ds_read_b64_tr_b16 a[56:57], v27 offset:128
  ds_read_b64_tr_b16 a[58:59], v27 offset:1024
  buffer_load_dwordx4 v11, s[48:51], s95 offen lds
  v_mfma_f32_32x32x16_bf16 v[152:167], a[32:35], a[160:163], v[152:167]
  ds_read_b64_tr_b16 a[60:61], v27 offset:160
  ds_read_b64_tr_b16 a[62:63], v27 offset:1056
  buffer_load_dwordx4 v12, s[48:51], s95 offen offset:1024 lds
  v_mfma_f32_32x32x16_bf16 v[168:183], a[36:39], a[160:163], v[168:183]
  ds_read_b64_tr_b16 a[0:1], v27 offset:192
  ds_read_b64_tr_b16 a[2:3], v27 offset:1088
  s_waitcnt lgkmcnt(6)
  v_mfma_f32_32x32x16_bf16 v[72:87], a[40:43], a[164:167], v[72:87]
  v_add_u32 v28, 0x8000, v28
  ds_read_b64_tr_b16 a[4:5], v28
  ds_read_b64_tr_b16 a[6:7], v28 offset:896
  buffer_load_dwordx4 v13, s[48:51], s95 offen offset:2048 lds
  v_mfma_f32_32x32x16_bf16 v[88:103], a[44:47], a[164:167], v[88:103]
  ds_read_b64_tr_b16 a[8:9], v28 offset:32
  ds_read_b64_tr_b16 a[10:11], v28 offset:928
  s_add_u32 m0, s83, 0x20000
  s_add_u32 s95, s19, 5
  v_mfma_f32_32x32x16_bf16 v[104:119], a[48:51], a[164:167], v[104:119]
  ds_read_b64_tr_b16 a[12:13], v28 offset:64
  ds_read_b64_tr_b16 a[14:15], v28 offset:960
  s_and_b32 s95, s95, 7
  s_mul_i32 s95, s95, 0x38000
  v_mfma_f32_32x32x16_bf16 v[120:135], a[52:55], a[164:167], v[120:135]
  ds_read_b64_tr_b16 a[16:17], v28 offset:96
  ds_read_b64_tr_b16 a[18:19], v28 offset:992
  s_add_u32 s95, s95, s78
  buffer_load_dwordx4 v7, s[48:51], s95 offen lds
  s_waitcnt lgkmcnt(6)
  v_mfma_f32_32x32x16_bf16 v[136:151], a[56:59], a[164:167], v[136:151]
  ds_read_b64_tr_b16 a[20:21], v28 offset:128
  ds_read_b64_tr_b16 a[22:23], v28 offset:1024
  buffer_load_dwordx4 v8, s[48:51], s95 offen offset:1024 lds
  buffer_load_dwordx4 v9, s[48:51], s95 offen offset:2048 lds
  v_mfma_f32_32x32x16_bf16 v[152:167], a[60:63], a[164:167], v[152:167]
  ds_read_b64_tr_b16 a[24:25], v28 offset:160
  ds_read_b64_tr_b16 a[26:27], v28 offset:1056
  buffer_load_dwordx4 v10, s[48:51], s95 offen offset:3072 lds
  s_add_u32 m0, s83, 0x21000
  v_mfma_f32_32x32x16_bf16 v[168:183], a[0:3], a[164:167], v[168:183]
  ds_read_b64_tr_b16 a[28:29], v28 offset:192
  ds_read_b64_tr_b16 a[30:31], v28 offset:1088
  buffer_load_dwordx4 v11, s[48:51], s95 offen lds
  buffer_load_dwordx4 v12, s[48:51], s95 offen offset:1024 lds
  v_mfma_f32_32x32x16_bf16 v[72:87], a[4:7], a[168:171], v[72:87]
  v_add_u32 v29, 0x8000, v29
  ds_read_b64_tr_b16 a[32:33], v29
  ds_read_b64_tr_b16 a[34:35], v29 offset:896
  buffer_load_dwordx4 v13, s[48:51], s95 offen offset:2048 lds
  s_add_u32 m0, s83, 0
  s_add_u32 s95, s19, 6
  s_waitcnt lgkmcnt(6)
  v_mfma_f32_32x32x16_bf16 v[88:103], a[8:11], a[168:171], v[88:103]
  ds_read_b64_tr_b16 a[36:37], v29 offset:32
  ds_read_b64_tr_b16 a[38:39], v29 offset:928
  s_and_b32 s95, s95, 7
  s_mul_i32 s95, s95, 0x38000
  v_mfma_f32_32x32x16_bf16 v[104:119], a[12:15], a[168:171], v[104:119]
  ds_read_b64_tr_b16 a[40:41], v29 offset:64
  ds_read_b64_tr_b16 a[42:43], v29 offset:960
  s_add_u32 s95, s95, s78
  buffer_load_dwordx4 v7, s[48:51], s95 offen lds
  v_mfma_f32_32x32x16_bf16 v[120:135], a[16:19], a[168:171], v[120:135]
  ds_read_b64_tr_b16 a[44:45], v29 offset:96
  ds_read_b64_tr_b16 a[46:47], v29 offset:992
  buffer_load_dwordx4 v8, s[48:51], s95 offen offset:1024 lds
  buffer_load_dwordx4 v9, s[48:51], s95 offen offset:2048 lds
  v_mfma_f32_32x32x16_bf16 v[136:151], a[20:23], a[168:171], v[136:151]
  ds_read_b64_tr_b16 a[48:49], v29 offset:128
  ds_read_b64_tr_b16 a[50:51], v29 offset:1024
  ds_read_b64_tr_b16 a[52:53], v29 offset:160
  ds_read_b64_tr_b16 a[54:55], v29 offset:1056
  ds_read_b64_tr_b16 a[56:57], v29 offset:192
  ds_read_b64_tr_b16 a[58:59], v29 offset:1088
  buffer_load_dwordx4 v10, s[48:51], s95 offen offset:3072 lds
  s_add_u32 m0, s83, 0x1000
  s_waitcnt lgkmcnt(10)
  v_mfma_f32_32x32x16_bf16 v[152:167], a[24:27], a[168:171], v[152:167]
  buffer_load_dwordx4 v11, s[48:51], s95 offen lds
  buffer_load_dwordx4 v12, s[48:51], s95 offen offset:1024 lds
  v_mfma_f32_32x32x16_bf16 v[168:183], a[28:31], a[168:171], v[168:183]
  buffer_load_dwordx4 v13, s[48:51], s95 offen offset:2048 lds
  s_waitcnt vmcnt(21) lgkmcnt(0)
  s_barrier
  v_mfma_f32_32x32x16_bf16 v[72:87], a[32:35], a[172:175], v[72:87]
  v_add_u32 v26, 0x8000, v26
  ds_read_b64_tr_b16 a[60:61], v26
  ds_read_b64_tr_b16 a[62:63], v26 offset:896
  v_mfma_f32_32x32x16_bf16 v[88:103], a[36:39], a[172:175], v[88:103]
  ds_read_b64_tr_b16 a[0:1], v26 offset:32
  ds_read_b64_tr_b16 a[2:3], v26 offset:928
  s_add_u32 m0, s83, 0x8000
  v_mfma_f32_32x32x16_bf16 v[104:119], a[40:43], a[172:175], v[104:119]
  ds_read_b64_tr_b16 a[4:5], v26 offset:64
  ds_read_b64_tr_b16 a[6:7], v26 offset:960
  s_add_u32 s95, s19, 7
  v_mfma_f32_32x32x16_bf16 v[120:135], a[44:47], a[172:175], v[120:135]
  ds_read_b64_tr_b16 a[8:9], v26 offset:96
  ds_read_b64_tr_b16 a[10:11], v26 offset:992
  s_and_b32 s95, s95, 7
  v_mfma_f32_32x32x16_bf16 v[136:151], a[48:51], a[172:175], v[136:151]
  ds_read_b64_tr_b16 a[12:13], v26 offset:128
  ds_read_b64_tr_b16 a[14:15], v26 offset:1024
  s_mul_i32 s95, s95, 0x38000
  v_mfma_f32_32x32x16_bf16 v[152:167], a[52:55], a[172:175], v[152:167]
  ds_read_b64_tr_b16 a[16:17], v26 offset:160
  ds_read_b64_tr_b16 a[18:19], v26 offset:1056
  s_add_u32 s95, s95, s78
  v_mfma_f32_32x32x16_bf16 v[168:183], a[56:59], a[172:175], v[168:183]
  ds_read_b64_tr_b16 a[20:21], v26 offset:192
  ds_read_b64_tr_b16 a[22:23], v26 offset:1088
  buffer_load_dwordx4 v7, s[48:51], s95 offen lds
  s_waitcnt lgkmcnt(8)
  v_mfma_f32_32x32x16_bf16 v[72:87], a[60:63], a[176:179], v[72:87]
  v_add_u32 v27, 0x8000, v27
  ds_read_b64_tr_b16 a[24:25], v27
  ds_read_b64_tr_b16 a[26:27], v27 offset:896
  buffer_load_dwordx4 v8, s[48:51], s95 offen offset:1024 lds
  v_mfma_f32_32x32x16_bf16 v[88:103], a[0:3], a[176:179], v[88:103]
  ds_read_b64_tr_b16 a[28:29], v27 offset:32
  ds_read_b64_tr_b16 a[30:31], v27 offset:928
  buffer_load_dwordx4 v9, s[48:51], s95 offen offset:2048 lds
  v_mfma_f32_32x32x16_bf16 v[104:119], a[4:7], a[176:179], v[104:119]
  ds_read_b64_tr_b16 a[32:33], v27 offset:64
  ds_read_b64_tr_b16 a[34:35], v27 offset:960
  buffer_load_dwordx4 v10, s[48:51], s95 offen offset:3072 lds
  s_waitcnt lgkmcnt(6)
  v_mfma_f32_32x32x16_bf16 v[120:135], a[8:11], a[176:179], v[120:135]
  ds_read_b64_tr_b16 a[36:37], v27 offset:96
  ds_read_b64_tr_b16 a[38:39], v27 offset:992
  s_add_u32 m0, s83, 0x9000
  v_mfma_f32_32x32x16_bf16 v[136:151], a[12:15], a[176:179], v[136:151]
  ds_read_b64_tr_b16 a[40:41], v27 offset:128
  ds_read_b64_tr_b16 a[42:43], v27 offset:1024
  buffer_load_dwordx4 v11, s[48:51], s95 offen lds
  v_mfma_f32_32x32x16_bf16 v[152:167], a[16:19], a[176:179], v[152:167]
  ds_read_b64_tr_b16 a[44:45], v27 offset:160
  ds_read_b64_tr_b16 a[46:47], v27 offset:1056
  buffer_load_dwordx4 v12, s[48:51], s95 offen offset:1024 lds
  v_mfma_f32_32x32x16_bf16 v[168:183], a[20:23], a[176:179], v[168:183]
  ds_read_b64_tr_b16 a[48:49], v27 offset:192
  ds_read_b64_tr_b16 a[50:51], v27 offset:1088
  buffer_load_dwordx4 v13, s[48:51], s95 offen offset:2048 lds
  s_waitcnt lgkmcnt(6)
  v_mfma_f32_32x32x16_bf16 v[72:87], a[24:27], a[180:183], v[72:87]
  v_add_u32 v28, 0x8000, v28
  ds_read_b64_tr_b16 a[52:53], v28
  ds_read_b64_tr_b16 a[54:55], v28 offset:896
  v_mfma_f32_32x32x16_bf16 v[88:103], a[28:31], a[180:183], v[88:103]
  ds_read_b64_tr_b16 a[56:57], v28 offset:32
  ds_read_b64_tr_b16 a[58:59], v28 offset:928
  v_mfma_f32_32x32x16_bf16 v[104:119], a[32:35], a[180:183], v[104:119]
  ds_read_b64_tr_b16 a[60:61], v28 offset:64
  ds_read_b64_tr_b16 a[62:63], v28 offset:960
  buffer_load_dwordx2 v[36:37], v30, s[60:63], 0 offen sc1
  v_mfma_f32_32x32x16_bf16 v[120:135], a[36:39], a[180:183], v[120:135]
  ds_read_b64_tr_b16 a[0:1], v28 offset:96
  ds_read_b64_tr_b16 a[2:3], v28 offset:992
  s_waitcnt lgkmcnt(6)
  v_mfma_f32_32x32x16_bf16 v[136:151], a[40:43], a[180:183], v[136:151]
  ds_read_b64_tr_b16 a[4:5], v28 offset:128
  ds_read_b64_tr_b16 a[6:7], v28 offset:1024
  v_mfma_f32_32x32x16_bf16 v[152:167], a[44:47], a[180:183], v[152:167]
  ds_read_b64_tr_b16 a[8:9], v28 offset:160
  ds_read_b64_tr_b16 a[10:11], v28 offset:1056
  v_mfma_f32_32x32x16_bf16 v[168:183], a[48:51], a[180:183], v[168:183]
  ds_read_b64_tr_b16 a[12:13], v28 offset:192
  ds_read_b64_tr_b16 a[14:15], v28 offset:1088
  v_mfma_f32_32x32x16_bf16 v[72:87], a[52:55], a[184:187], v[72:87]
  v_add_u32 v29, 0x8000, v29
  ds_read_b64_tr_b16 a[16:17], v29
  ds_read_b64_tr_b16 a[18:19], v29 offset:896
  s_waitcnt lgkmcnt(6)
  v_mfma_f32_32x32x16_bf16 v[88:103], a[56:59], a[184:187], v[88:103]
  ds_read_b64_tr_b16 a[20:21], v29 offset:32
  ds_read_b64_tr_b16 a[22:23], v29 offset:928
  v_mfma_f32_32x32x16_bf16 v[104:119], a[60:63], a[184:187], v[104:119]
  ds_read_b64_tr_b16 a[24:25], v29 offset:64
  ds_read_b64_tr_b16 a[26:27], v29 offset:960
  v_mfma_f32_32x32x16_bf16 v[120:135], a[0:3], a[184:187], v[120:135]
  ds_read_b64_tr_b16 a[28:29], v29 offset:96
  ds_read_b64_tr_b16 a[30:31], v29 offset:992
  v_mfma_f32_32x32x16_bf16 v[136:151], a[4:7], a[184:187], v[136:151]
  ds_read_b64_tr_b16 a[32:33], v29 offset:128
  ds_read_b64_tr_b16 a[34:35], v29 offset:1024
  ds_read_b64_tr_b16 a[36:37], v29 offset:160
  ds_read_b64_tr_b16 a[38:39], v29 offset:1056
  ds_read_b64_tr_b16 a[40:41], v29 offset:192
  ds_read_b64_tr_b16 a[42:43], v29 offset:1088
  s_waitcnt lgkmcnt(10)
  v_mfma_f32_32x32x16_bf16 v[152:167], a[8:11], a[184:187], v[152:167]
  v_mfma_f32_32x32x16_bf16 v[168:183], a[12:15], a[184:187], v[168:183]
  s_waitcnt vmcnt(22) lgkmcnt(0)
  s_barrier
  v_mfma_f32_32x32x16_bf16 v[72:87], a[16:19], a[188:191], v[72:87]
  v_add_u32 v26, 0x8000, v26
  ds_read_b64_tr_b16 a[44:45], v26
  ds_read_b64_tr_b16 a[46:47], v26 offset:896
  v_mfma_f32_32x32x16_bf16 v[88:103], a[20:23], a[188:191], v[88:103]
  ds_read_b64_tr_b16 a[48:49], v26 offset:32
  ds_read_b64_tr_b16 a[50:51], v26 offset:928
  s_add_u32 s95, s98, 0
  v_mfma_f32_32x32x16_bf16 v[104:119], a[24:27], a[188:191], v[104:119]
  ds_read_b64_tr_b16 a[52:53], v26 offset:64
  ds_read_b64_tr_b16 a[54:55], v26 offset:960
  s_and_b32 s95, s95, 0x7ff
  v_mfma_f32_32x32x16_bf16 v[120:135], a[28:31], a[188:191], v[120:135]
  ds_read_b64_tr_b16 a[56:57], v26 offset:96
  ds_read_b64_tr_b16 a[58:59], v26 offset:992
  s_add_u32 s95, s95, s80
  v_mfma_f32_32x32x16_bf16 v[136:151], a[32:35], a[188:191], v[136:151]
  ds_read_b64_tr_b16 a[60:61], v26 offset:128
  ds_read_b64_tr_b16 a[62:63], v26 offset:1024
  v_mfma_f32_32x32x16_bf16 v[152:167], a[36:39], a[188:191], v[152:167]
  ds_read_b64_tr_b16 a[0:1], v26 offset:160
  ds_read_b64_tr_b16 a[2:3], v26 offset:1056
  s_add_u32 m0, s72, 0x10000
  v_mfma_f32_32x32x16_bf16 v[168:183], a[40:43], a[188:191], v[168:183]
  ds_read_b64_tr_b16 a[4:5], v26 offset:192
  ds_read_b64_tr_b16 a[6:7], v26 offset:1088
  buffer_load_dwordx4 v22, s[52:55], s95 offen lds
  s_waitcnt lgkmcnt(8)
  v_mfma_f32_32x32x16_bf16 v[72:87], a[44:47], a[192:195], v[72:87]
  v_add_u32 v27, 0x8000, v27
  ds_read_b64_tr_b16 a[8:9], v27
  ds_read_b64_tr_b16 a[10:11], v27 offset:896
  buffer_load_dwordx4 v23, s[52:55], s95 offen offset:1024 lds
  v_mfma_f32_32x32x16_bf16 v[88:103], a[48:51], a[192:195], v[88:103]
  ds_read_b64_tr_b16 a[12:13], v27 offset:32
  ds_read_b64_tr_b16 a[14:15], v27 offset:928
  v_mfma_f32_32x32x16_bf16 v[104:119], a[52:55], a[192:195], v[104:119]
  ds_read_b64_tr_b16 a[16:17], v27 offset:64
  ds_read_b64_tr_b16 a[18:19], v27 offset:960
  buffer_load_dwordx4 v24, s[52:55], s95 offen offset:2048 lds
  s_waitcnt lgkmcnt(6)
  v_mfma_f32_32x32x16_bf16 v[120:135], a[56:59], a[192:195], v[120:135]
  ds_read_b64_tr_b16 a[20:21], v27 offset:96
  ds_read_b64_tr_b16 a[22:23], v27 offset:992
  buffer_load_dwordx4 v25, s[52:55], s95 offen offset:3072 lds
  v_mfma_f32_32x32x16_bf16 v[136:151], a[60:63], a[192:195], v[136:151]
  ds_read_b64_tr_b16 a[24:25], v27 offset:128
  ds_read_b64_tr_b16 a[26:27], v27 offset:1024
  s_add_u32 m0, s72, 0x14000
  v_mfma_f32_32x32x16_bf16 v[152:167], a[0:3], a[192:195], v[152:167]
  ds_read_b64_tr_b16 a[28:29], v27 offset:160
  ds_read_b64_tr_b16 a[30:31], v27 offset:1056
  v_mfma_f32_32x32x16_bf16 v[168:183], a[4:7], a[192:195], v[168:183]
  ds_read_b64_tr_b16 a[32:33], v27 offset:192
  ds_read_b64_tr_b16 a[34:35], v27 offset:1088
  s_add_u32 s95, s95, 0x80
  s_waitcnt lgkmcnt(6)
  v_mfma_f32_32x32x16_bf16 v[72:87], a[8:11], a[196:199], v[72:87]
  v_add_u32 v28, 0x8000, v28
  ds_read_b64_tr_b16 a[36:37], v28
  ds_read_b64_tr_b16 a[38:39], v28 offset:896
  buffer_load_dwordx4 v22, s[52:55], s95 offen lds
  v_mfma_f32_32x32x16_bf16 v[88:103], a[12:15], a[196:199], v[88:103]
  ds_read_b64_tr_b16 a[40:41], v28 offset:32
  ds_read_b64_tr_b16 a[42:43], v28 offset:928
  buffer_load_dwordx4 v23, s[52:55], s95 offen offset:1024 lds
  v_mfma_f32_32x32x16_bf16 v[104:119], a[16:19], a[196:199], v[104:119]
  ds_read_b64_tr_b16 a[44:45], v28 offset:64
  ds_read_b64_tr_b16 a[46:47], v28 offset:960
  v_mfma_f32_32x32x16_bf16 v[120:135], a[20:23], a[196:199], v[120:135]
  ds_read_b64_tr_b16 a[48:49], v28 offset:96
  ds_read_b64_tr_b16 a[50:51], v28 offset:992
  buffer_load_dwordx4 v24, s[52:55], s95 offen offset:2048 lds
  s_waitcnt lgkmcnt(6)
  v_mfma_f32_32x32x16_bf16 v[136:151], a[24:27], a[196:199], v[136:151]
  ds_read_b64_tr_b16 a[52:53], v28 offset:128
  ds_read_b64_tr_b16 a[54:55], v28 offset:1024
  buffer_load_dwordx4 v25, s[52:55], s95 offen offset:3072 lds
  v_mfma_f32_32x32x16_bf16 v[152:167], a[28:31], a[196:199], v[152:167]
  ds_read_b64_tr_b16 a[56:57], v28 offset:160
  ds_read_b64_tr_b16 a[58:59], v28 offset:1056
  v_mfma_f32_32x32x16_bf16 v[168:183], a[32:35], a[196:199], v[168:183]
  ds_read_b64_tr_b16 a[60:61], v28 offset:192
  ds_read_b64_tr_b16 a[62:63], v28 offset:1088
  v_mfma_f32_32x32x16_bf16 v[72:87], a[36:39], a[200:203], v[72:87]
  v_add_u32 v29, 0x8000, v29
  ds_read_b64_tr_b16 a[0:1], v29
  ds_read_b64_tr_b16 a[2:3], v29 offset:896
  s_waitcnt lgkmcnt(6)
  v_mfma_f32_32x32x16_bf16 v[88:103], a[40:43], a[200:203], v[88:103]
  ds_read_b64_tr_b16 a[4:5], v29 offset:32
  ds_read_b64_tr_b16 a[6:7], v29 offset:928
  v_mfma_f32_32x32x16_bf16 v[104:119], a[44:47], a[200:203], v[104:119]
  ds_read_b64_tr_b16 a[8:9], v29 offset:64
  ds_read_b64_tr_b16 a[10:11], v29 offset:960
  s_waitcnt vmcnt(8)
  v_cmp_eq_u64 vcc, v[36:37], v[34:35]
  s_nop 0
  s_cmp_eq_u64 vcc, -1
  s_cbranch_scc0 L2_slow_ka
L2_res_ka:
  s_add_u32 s25, s100, 0
  s_and_b32 s25, s25, 0xffff
  s_add_u32 s25, s25, s79
  buffer_load_dwordx4 a[64:67], v1, s[60:63], s25 offen sc1
  buffer_load_dwordx4 a[68:71], v1, s[60:63], s25 offen offset:1024 sc1
  v_mfma_f32_32x32x16_bf16 v[120:135], a[48:51], a[200:203], v[120:135]
  ds_read_b64_tr_b16 a[12:13], v29 offset:96
  ds_read_b64_tr_b16 a[14:15], v29 offset:992
  buffer_load_dwordx4 a[72:75], v1, s[60:63], s25 offen offset:2048 sc1
  buffer_load_dwordx4 a[76:79], v1, s[60:63], s25 offen offset:3072 sc1
  s_add_u32 s25, s25, 0x1000
  buffer_load_dwordx4 a[80:83], v1, s[60:63], s25 offen sc1
  buffer_load_dwordx4 a[84:87], v1, s[60:63], s25 offen offset:1024 sc1
  buffer_load_dwordx4 a[88:91], v1, s[60:63], s25 offen offset:2048 sc1
  v_mfma_f32_32x32x16_bf16 v[136:151], a[52:55], a[200:203], v[136:151]
  ds_read_b64_tr_b16 a[16:17], v29 offset:128
  ds_read_b64_tr_b16 a[18:19], v29 offset:1024
  ds_read_b64_tr_b16 a[20:21], v29 offset:160
  ds_read_b64_tr_b16 a[22:23], v29 offset:1056
  ds_read_b64_tr_b16 a[24:25], v29 offset:192
  ds_read_b64_tr_b16 a[26:27], v29 offset:1088
  buffer_load_dwordx4 a[92:95], v1, s[60:63], s25 offen offset:3072 sc1
  v_mov_b32 v68, 0x7fff0000
  v_cmp_gt_u32 vcc, 0x380, v1
  s_nop 1
  v_cndmask_b32 v68, v68, v1, vcc
  s_add_u32 s14, s20, 0x1000
  buffer_load_dwordx4 v[216:219], v68, s[60:63], s20 offen sc1
  buffer_load_dwordx4 v[220:223], v68, s[60:63], s20 offen offset:1024 sc1
  s_waitcnt lgkmcnt(10)
  v_mfma_f32_32x32x16_bf16 v[152:167], a[56:59], a[200:203], v[152:167]
  buffer_load_dwordx4 v[224:227], v68, s[60:63], s20 offen offset:2048 sc1
  buffer_load_dwordx4 v[228:231], v68, s[60:63], s20 offen offset:3072 sc1
  buffer_load_dwordx4 v[232:235], v68, s[60:63], s14 offen sc1
  buffer_load_dwordx4 v[236:239], v68, s[60:63], s14 offen offset:1024 sc1
  buffer_load_dwordx4 v[240:243], v68, s[60:63], s14 offen offset:2048 sc1
  buffer_load_dwordx4 v[244:247], v68, s[60:63], s14 offen offset:3072 sc1
  v_mfma_f32_32x32x16_bf16 v[168:183], a[60:63], a[200:203], v[168:183]
  s_waitcnt lgkmcnt(0)
  s_barrier
  v_mfma_f32_32x32x16_bf16 v[72:87], a[0:3], a[204:207], v[72:87]
  v_add_u32 v26, 0x8000, v26
  ds_read_b64_tr_b16 a[28:29], v26
  ds_read_b64_tr_b16 a[30:31], v26 offset:896
  v_mfma_f32_32x32x16_bf16 v[88:103], a[4:7], a[204:207], v[88:103]
  ds_read_b64_tr_b16 a[32:33], v26 offset:32
  ds_read_b64_tr_b16 a[34:35], v26 offset:928
  s_add_u32 s95, s98, 0x100
  v_mfma_f32_32x32x16_bf16 v[104:119], a[8:11], a[204:207], v[104:119]
  ds_read_b64_tr_b16 a[36:37], v26 offset:64
  ds_read_b64_tr_b16 a[38:39], v26 offset:960
  s_and_b32 s95, s95, 0x7ff
  v_mfma_f32_32x32x16_bf16 v[120:135], a[12:15], a[204:207], v[120:135]
  ds_read_b64_tr_b16 a[40:41], v26 offset:96
  ds_read_b64_tr_b16 a[42:43], v26 offset:992
  s_add_u32 s95, s95, s80
  v_mfma_f32_32x32x16_bf16 v[136:151], a[16:19], a[204:207], v[136:151]
  ds_read_b64_tr_b16 a[44:45], v26 offset:128
  ds_read_b64_tr_b16 a[46:47], v26 offset:1024
  v_mfma_f32_32x32x16_bf16 v[152:167], a[20:23], a[204:207], v[152:167]
  ds_read_b64_tr_b16 a[48:49], v26 offset:160
  ds_read_b64_tr_b16 a[50:51], v26 offset:1056
  s_add_u32 m0, s72, 0x18000
  v_mfma_f32_32x32x16_bf16 v[168:183], a[24:27], a[204:207], v[168:183]
  ds_read_b64_tr_b16 a[52:53], v26 offset:192
  ds_read_b64_tr_b16 a[54:55], v26 offset:1088
  buffer_load_dwordx4 v22, s[52:55], s95 offen lds
  s_waitcnt lgkmcnt(8)
  v_mfma_f32_32x32x16_bf16 v[72:87], a[28:31], a[208:211], v[72:87]
  v_add_u32 v27, 0x8000, v27
  ds_read_b64_tr_b16 a[56:57], v27
  ds_read_b64_tr_b16 a[58:59], v27 offset:896
  buffer_load_dwordx4 v23, s[52:55], s95 offen offset:1024 lds
  v_mfma_f32_32x32x16_bf16 v[88:103], a[32:35], a[208:211], v[88:103]
  ds_read_b64_tr_b16 a[60:61], v27 offset:32
  ds_read_b64_tr_b16 a[62:63], v27 offset:928
  v_mfma_f32_32x32x16_bf16 v[104:119], a[36:39], a[208:211], v[104:119]
  ds_read_b64_tr_b16 a[0:1], v27 offset:64
  ds_read_b64_tr_b16 a[2:3], v27 offset:960
  buffer_load_dwordx4 v24, s[52:55], s95 offen offset:2048 lds
  s_waitcnt lgkmcnt(6)
  v_mfma_f32_32x32x16_bf16 v[120:135], a[40:43], a[208:211], v[120:135]
  ds_read_b64_tr_b16 a[4:5], v27 offset:96
  ds_read_b64_tr_b16 a[6:7], v27 offset:992
  buffer_load_dwordx4 v25, s[52:55], s95 offen offset:3072 lds
  v_mfma_f32_32x32x16_bf16 v[136:151], a[44:47], a[208:211], v[136:151]
  ds_read_b64_tr_b16 a[8:9], v27 offset:128
  ds_read_b64_tr_b16 a[10:11], v27 offset:1024
  s_add_u32 m0, s72, 0x1c000
  v_mfma_f32_32x32x16_bf16 v[152:167], a[48:51], a[208:211], v[152:167]
  ds_read_b64_tr_b16 a[12:13], v27 offset:160
  ds_read_b64_tr_b16 a[14:15], v27 offset:1056
  v_mfma_f32_32x32x16_bf16 v[168:183], a[52:55], a[208:211], v[168:183]
  ds_read_b64_tr_b16 a[16:17], v27 offset:192
  ds_read_b64_tr_b16 a[18:19], v27 offset:1088
  s_add_u32 s95, s95, 0x80
  s_waitcnt lgkmcnt(6)
  v_mfma_f32_32x32x16_bf16 v[72:87], a[56:59], a[212:215], v[72:87]
  v_add_u32 v28, 0x8000, v28
  ds_read_b64_tr_b16 a[20:21], v28
  ds_read_b64_tr_b16 a[22:23], v28 offset:896
  buffer_load_dwordx4 v22, s[52:55], s95 offen lds
  v_mfma_f32_32x32x16_bf16 v[88:103], a[60:63], a[212:215], v[88:103]
  ds_read_b64_tr_b16 a[24:25], v28 offset:32
  ds_read_b64_tr_b16 a[26:27], v28 offset:928
  buffer_load_dwordx4 v23, s[52:55], s95 offen offset:1024 lds
  v_mfma_f32_32x32x16_bf16 v[104:119], a[0:3], a[212:215], v[104:119]
  ds_read_b64_tr_b16 a[28:29], v28 offset:64
  ds_read_b64_tr_b16 a[30:31], v28 offset:960
  v_mfma_f32_32x32x16_bf16 v[120:135], a[4:7], a[212:215], v[120:135]
  ds_read_b64_tr_b16 a[32:33], v28 offset:96
  ds_read_b64_tr_b16 a[34:35], v28 offset:992
  buffer_load_dwordx4 v24, s[52:55], s95 offen offset:2048 lds
  s_waitcnt lgkmcnt(6)
  v_mfma_f32_32x32x16_bf16 v[136:151], a[8:11], a[212:215], v[136:151]
  ds_read_b64_tr_b16 a[36:37], v28 offset:128
  ds_read_b64_tr_b16 a[38:39], v28 offset:1024
  buffer_load_dwordx4 v25, s[52:55], s95 offen offset:3072 lds
  v_mfma_f32_32x32x16_bf16 v[152:167], a[12:15], a[212:215], v[152:167]
  ds_read_b64_tr_b16 a[40:41], v28 offset:160
  ds_read_b64_tr_b16 a[42:43], v28 offset:1056
  v_mfma_f32_32x32x16_bf16 v[168:183], a[16:19], a[212:215], v[168:183]
  ds_read_b64_tr_b16 a[44:45], v28 offset:192
  ds_read_b64_tr_b16 a[46:47], v28 offset:1088
  v_mfma_f32_32x32x16_bf16 v[72:87], a[20:23], a[216:219], v[72:87]
  v_add_u32 v29, 0x8000, v29
  ds_read_b64_tr_b16 a[48:49], v29
  ds_read_b64_tr_b16 a[50:51], v29 offset:896
  s_waitcnt lgkmcnt(6)
  v_mfma_f32_32x32x16_bf16 v[88:103], a[24:27], a[216:219], v[88:103]
  ds_read_b64_tr_b16 a[52:53], v29 offset:32
  ds_read_b64_tr_b16 a[54:55], v29 offset:928
  v_mfma_f32_32x32x16_bf16 v[104:119], a[28:31], a[216:219], v[104:119]
  ds_read_b64_tr_b16 a[56:57], v29 offset:64
  ds_read_b64_tr_b16 a[58:59], v29 offset:960
  v_mfma_f32_32x32x16_bf16 v[120:135], a[32:35], a[216:219], v[120:135]
  ds_read_b64_tr_b16 a[60:61], v29 offset:96
  ds_read_b64_tr_b16 a[62:63], v29 offset:992
  v_mfma_f32_32x32x16_bf16 v[136:151], a[36:39], a[216:219], v[136:151]
  ds_read_b64_tr_b16 a[0:1], v29 offset:128
  ds_read_b64_tr_b16 a[2:3], v29 offset:1024
  ds_read_b64_tr_b16 a[4:5], v29 offset:160
  ds_read_b64_tr_b16 a[6:7], v29 offset:1056
  ds_read_b64_tr_b16 a[8:9], v29 offset:192
  ds_read_b64_tr_b16 a[10:11], v29 offset:1088
  s_waitcnt lgkmcnt(10)
  v_mfma_f32_32x32x16_bf16 v[152:167], a[40:43], a[216:219], v[152:167]
  v_mfma_f32_32x32x16_bf16 v[168:183], a[44:47], a[216:219], v[168:183]
  s_waitcnt lgkmcnt(0)
  s_barrier
  v_mfma_f32_32x32x16_bf16 v[72:87], a[48:51], a[220:223], v[72:87]
  v_subrev_u32 v26, 0x20000, v26
  ds_read_b64_tr_b16 a[12:13], v26
  ds_read_b64_tr_b16 a[14:15], v26 offset:896
  s_add_u32 s25, s100, 0x2000
  v_mfma_f32_32x32x16_bf16 v[88:103], a[52:55], a[220:223], v[88:103]
  ds_read_b64_tr_b16 a[16:17], v26 offset:32
  ds_read_b64_tr_b16 a[18:19], v26 offset:928
  s_and_b32 s25, s25, 0xffff
  v_mfma_f32_32x32x16_bf16 v[104:119], a[56:59], a[220:223], v[104:119]
  ds_read_b64_tr_b16 a[20:21], v26 offset:64
  ds_read_b64_tr_b16 a[22:23], v26 offset:960
  s_add_u32 s25, s25, s79
  buffer_load_dwordx4 a[96:99], v1, s[60:63], s25 offen sc1
  v_mfma_f32_32x32x16_bf16 v[120:135], a[60:63], a[220:223], v[120:135]
  ds_read_b64_tr_b16 a[24:25], v26 offset:96
  ds_read_b64_tr_b16 a[26:27], v26 offset:992
  buffer_load_dwordx4 a[100:103], v1, s[60:63], s25 offen offset:1024 sc1
  v_mfma_f32_32x32x16_bf16 v[136:151], a[0:3], a[220:223], v[136:151]
  ds_read_b64_tr_b16 a[28:29], v26 offset:128
  ds_read_b64_tr_b16 a[30:31], v26 offset:1024
  buffer_load_dwordx4 a[104:107], v1, s[60:63], s25 offen offset:2048 sc1
  buffer_load_dwordx4 a[108:111], v1, s[60:63], s25 offen offset:3072 sc1
  v_mfma_f32_32x32x16_bf16 v[152:167], a[4:7], a[220:223], v[152:167]
  ds_read_b64_tr_b16 a[32:33], v26 offset:160
  ds_read_b64_tr_b16 a[34:35], v26 offset:1056
  s_add_u32 s25, s25, 0x1000
  v_mfma_f32_32x32x16_bf16 v[168:183], a[8:11], a[220:223], v[168:183]
  ds_read_b64_tr_b16 a[36:37], v26 offset:192
  ds_read_b64_tr_b16 a[38:39], v26 offset:1088
  buffer_load_dwordx4 a[112:115], v1, s[60:63], s25 offen sc1
  buffer_load_dwordx4 a[116:119], v1, s[60:63], s25 offen offset:1024 sc1
  s_waitcnt lgkmcnt(8)
  v_mfma_f32_32x32x16_bf16 v[72:87], a[12:15], a[224:227], v[72:87]
  v_subrev_u32 v27, 0x20000, v27
  ds_read_b64_tr_b16 a[40:41], v27
  ds_read_b64_tr_b16 a[42:43], v27 offset:896
  buffer_load_dwordx4 a[120:123], v1, s[60:63], s25 offen offset:2048 sc1
  v_lshlrev_b32 v69, 3, v47
  v_lshrrev_b32 v71, 5, v0
  v_mfma_f32_32x32x16_bf16 v[88:103], a[16:19], a[224:227], v[88:103]
  ds_read_b64_tr_b16 a[44:45], v27 offset:32
  ds_read_b64_tr_b16 a[46:47], v27 offset:928
  buffer_load_dwordx4 a[124:127], v1, s[60:63], s25 offen offset:3072 sc1
  s_add_u32 s25, s100, 0x4000
  v_bfe_u32 v70, v0, 1, 3
  v_xor_b32 v70, v70, v71
  v_mfma_f32_32x32x16_bf16 v[104:119], a[20:23], a[224:227], v[104:119]
  ds_read_b64_tr_b16 a[48:49], v27 offset:64
  ds_read_b64_tr_b16 a[50:51], v27 offset:960
  s_and_b32 s25, s25, 0xffff
  v_xor_b32 v71, 0, v70
  v_lshl_add_u32 v7, v71, 4, v69
  s_waitcnt lgkmcnt(6)
  v_mfma_f32_32x32x16_bf16 v[120:135], a[24:27], a[224:227], v[120:135]
  ds_read_b64_tr_b16 a[52:53], v27 offset:96
  ds_read_b64_tr_b16 a[54:55], v27 offset:992
  s_add_u32 s25, s25, s79
  buffer_load_dwordx4 a[128:131], v1, s[60:63], s25 offen sc1
  v_add_u32 v11, 0x10000, v7
  v_add_u32 v15, 0x20000, v7
  v_mfma_f32_32x32x16_bf16 v[136:151], a[28:31], a[224:227], v[136:151]
  ds_read_b64_tr_b16 a[56:57], v27 offset:128
  ds_read_b64_tr_b16 a[58:59], v27 offset:1024
  buffer_load_dwordx4 a[132:135], v1, s[60:63], s25 offen offset:1024 sc1
  v_xor_b32 v71, 2, v70
  v_lshl_add_u32 v8, v71, 4, v69
  v_mfma_f32_32x32x16_bf16 v[152:167], a[32:35], a[224:227], v[152:167]
  ds_read_b64_tr_b16 a[60:61], v27 offset:160
  ds_read_b64_tr_b16 a[62:63], v27 offset:1056
  buffer_load_dwordx4 a[136:139], v1, s[60:63], s25 offen offset:2048 sc1
  v_add_u32 v12, 0x10000, v8
  v_add_u32 v16, 0x20000, v8
  v_mfma_f32_32x32x16_bf16 v[168:183], a[36:39], a[224:227], v[168:183]
  ds_read_b64_tr_b16 a[0:1], v27 offset:192
  ds_read_b64_tr_b16 a[2:3], v27 offset:1088
  buffer_load_dwordx4 a[140:143], v1, s[60:63], s25 offen offset:3072 sc1
  s_add_u32 s25, s25, 0x1000
  v_xor_b32 v71, 4, v70
  v_lshl_add_u32 v9, v71, 4, v69
  s_waitcnt lgkmcnt(6)
  v_mfma_f32_32x32x16_bf16 v[72:87], a[40:43], a[228:231], v[72:87]
  v_subrev_u32 v28, 0x20000, v28
  ds_read_b64_tr_b16 a[4:5], v28
  ds_read_b64_tr_b16 a[6:7], v28 offset:896
  buffer_load_dwordx4 a[144:147], v1, s[60:63], s25 offen sc1
  v_add_u32 v13, 0x10000, v9
  v_add_u32 v17, 0x20000, v9
  v_mfma_f32_32x32x16_bf16 v[88:103], a[44:47], a[228:231], v[88:103]
  ds_read_b64_tr_b16 a[8:9], v28 offset:32
  ds_read_b64_tr_b16 a[10:11], v28 offset:928
  buffer_load_dwordx4 a[148:151], v1, s[60:63], s25 offen offset:1024 sc1
  buffer_load_dwordx4 a[152:155], v1, s[60:63], s25 offen offset:2048 sc1
  v_xor_b32 v71, 6, v70
  v_lshl_add_u32 v10, v71, 4, v69
  v_mfma_f32_32x32x16_bf16 v[104:119], a[48:51], a[228:231], v[104:119]
  ds_read_b64_tr_b16 a[12:13], v28 offset:64
  ds_read_b64_tr_b16 a[14:15], v28 offset:960
  buffer_load_dwordx4 a[156:159], v1, s[60:63], s25 offen offset:3072 sc1
  v_add_u32 v14, 0x10000, v10
  v_add_u32 v18, 0x20000, v10
  v_mfma_f32_32x32x16_bf16 v[120:135], a[52:55], a[228:231], v[120:135]
  ds_read_b64_tr_b16 a[16:17], v28 offset:96
  ds_read_b64_tr_b16 a[18:19], v28 offset:992
  s_add_u32 s95, s98, 0x600
  s_and_b32 s95, s95, 0x7ff
  s_waitcnt lgkmcnt(6)
  v_mfma_f32_32x32x16_bf16 v[136:151], a[56:59], a[228:231], v[136:151]
  ds_read_b64_tr_b16 a[20:21], v28 offset:128
  ds_read_b64_tr_b16 a[22:23], v28 offset:1024
  s_add_u32 s95, s95, s80
  v_mfma_f32_32x32x16_bf16 v[152:167], a[60:63], a[228:231], v[152:167]
  ds_read_b64_tr_b16 a[24:25], v28 offset:160
  ds_read_b64_tr_b16 a[26:27], v28 offset:1056
  s_add_u32 m0, s72, 0x20000
  s_nop 0
  buffer_load_dwordx4 v22, s[52:55], s95 offen lds
  v_mfma_f32_32x32x16_bf16 v[168:183], a[0:3], a[228:231], v[168:183]
  ds_read_b64_tr_b16 a[28:29], v28 offset:192
  ds_read_b64_tr_b16 a[30:31], v28 offset:1088
  buffer_load_dwordx4 v23, s[52:55], s95 offen offset:1024 lds
  v_mfma_f32_32x32x16_bf16 v[72:87], a[4:7], a[232:235], v[72:87]
  v_subrev_u32 v29, 0x20000, v29
  ds_read_b64_tr_b16 a[32:33], v29
  ds_read_b64_tr_b16 a[34:35], v29 offset:896
  buffer_load_dwordx4 v24, s[52:55], s95 offen offset:2048 lds
  buffer_load_dwordx4 v25, s[52:55], s95 offen offset:3072 lds
  s_waitcnt lgkmcnt(6)
  v_mfma_f32_32x32x16_bf16 v[88:103], a[8:11], a[232:235], v[88:103]
  ds_read_b64_tr_b16 a[36:37], v29 offset:32
  ds_read_b64_tr_b16 a[38:39], v29 offset:928
  s_add_u32 m0, s72, 0x24000
  v_mfma_f32_32x32x16_bf16 v[104:119], a[12:15], a[232:235], v[104:119]
  ds_read_b64_tr_b16 a[40:41], v29 offset:64
  ds_read_b64_tr_b16 a[42:43], v29 offset:960
  s_add_u32 s95, s95, 0x80
  buffer_load_dwordx4 v22, s[52:55], s95 offen lds
  v_mfma_f32_32x32x16_bf16 v[120:135], a[16:19], a[232:235], v[120:135]
  ds_read_b64_tr_b16 a[44:45], v29 offset:96
  ds_read_b64_tr_b16 a[46:47], v29 offset:992
  buffer_load_dwordx4 v23, s[52:55], s95 offen offset:1024 lds
  v_mfma_f32_32x32x16_bf16 v[136:151], a[20:23], a[232:235], v[136:151]
  ds_read_b64_tr_b16 a[48:49], v29 offset:128
  ds_read_b64_tr_b16 a[50:51], v29 offset:1024
  ds_read_b64_tr_b16 a[52:53], v29 offset:160
  ds_read_b64_tr_b16 a[54:55], v29 offset:1056
  ds_read_b64_tr_b16 a[56:57], v29 offset:192
  ds_read_b64_tr_b16 a[58:59], v29 offset:1088
  buffer_load_dwordx4 v24, s[52:55], s95 offen offset:2048 lds
  s_waitcnt lgkmcnt(10)
  v_mfma_f32_32x32x16_bf16 v[152:167], a[24:27], a[232:235], v[152:167]
  buffer_load_dwordx4 v25, s[52:55], s95 offen offset:3072 lds
  v_mfma_f32_32x32x16_bf16 v[168:183], a[28:31], a[232:235], v[168:183]
  v_mov_b32 v60, 0
  v_mov_b32 v61, 0
  v_mov_b32 v62, 0
  v_mov_b32 v63, 0
  s_waitcnt lgkmcnt(0)
  s_barrier
  v_mfma_f32_32x32x16_bf16 v[72:87], a[32:35], a[236:239], v[72:87]
  v_add_u32 v26, 0x8000, v26
  ds_read_b64_tr_b16 a[60:61], v26
  ds_read_b64_tr_b16 a[62:63], v26 offset:896
  s_waitcnt vmcnt(39)
  v_dot2c_f32_bf16 v60, 0x3f803f80, v216
  v_dot2c_f32_bf16 v61, 0x3f803f80, v217
  v_dot2c_f32_bf16 v62, 0x3f803f80, v218
  v_dot2c_f32_bf16 v63, 0x3f803f80, v219
  v_mfma_f32_32x32x16_bf16 v[88:103], a[36:39], a[236:239], v[88:103]
  ds_read_b64_tr_b16 a[0:1], v26 offset:32
  ds_read_b64_tr_b16 a[2:3], v26 offset:928
  s_waitcnt vmcnt(38)
  v_dot2c_f32_bf16 v60, 0x3f803f80, v220
  v_dot2c_f32_bf16 v61, 0x3f803f80, v221
  v_dot2c_f32_bf16 v62, 0x3f803f80, v222
  v_dot2c_f32_bf16 v63, 0x3f803f80, v223
  s_waitcnt vmcnt(37)
  v_dot2c_f32_bf16 v60, 0x3f803f80, v224
  v_mfma_f32_32x32x16_bf16 v[104:119], a[40:43], a[236:239], v[104:119]
  ds_read_b64_tr_b16 a[4:5], v26 offset:64
  ds_read_b64_tr_b16 a[6:7], v26 offset:960
  v_dot2c_f32_bf16 v61, 0x3f803f80, v225
  v_dot2c_f32_bf16 v62, 0x3f803f80, v226
  v_dot2c_f32_bf16 v63, 0x3f803f80, v227
  s_waitcnt vmcnt(36)
  v_dot2c_f32_bf16 v60, 0x3f803f80, v228
  v_mfma_f32_32x32x16_bf16 v[120:135], a[44:47], a[236:239], v[120:135]
  ds_read_b64_tr_b16 a[8:9], v26 offset:96
  ds_read_b64_tr_b16 a[10:11], v26 offset:992
  v_dot2c_f32_bf16 v61, 0x3f803f80, v229
  v_dot2c_f32_bf16 v62, 0x3f803f80, v230
  v_dot2c_f32_bf16 v63, 0x3f803f80, v231
  s_waitcnt vmcnt(35)
  v_dot2c_f32_bf16 v60, 0x3f803f80, v232
  v_dot2c_f32_bf16 v61, 0x3f803f80, v233
  v_mfma_f32_32x32x16_bf16 v[136:151], a[48:51], a[236:239], v[136:151]
  ds_read_b64_tr_b16 a[12:13], v26 offset:128
  ds_read_b64_tr_b16 a[14:15], v26 offset:1024
  v_dot2c_f32_bf16 v62, 0x3f803f80, v234
  v_dot2c_f32_bf16 v63, 0x3f803f80, v235
  s_waitcnt vmcnt(34)
  v_dot2c_f32_bf16 v60, 0x3f803f80, v236
  v_dot2c_f32_bf16 v61, 0x3f803f80, v237
  v_mfma_f32_32x32x16_bf16 v[152:167], a[52:55], a[236:239], v[152:167]
  ds_read_b64_tr_b16 a[16:17], v26 offset:160
  ds_read_b64_tr_b16 a[18:19], v26 offset:1056
  v_dot2c_f32_bf16 v62, 0x3f803f80, v238
  v_dot2c_f32_bf16 v63, 0x3f803f80, v239
  s_waitcnt vmcnt(33)
  v_dot2c_f32_bf16 v60, 0x3f803f80, v240
  v_dot2c_f32_bf16 v61, 0x3f803f80, v241
  v_dot2c_f32_bf16 v62, 0x3f803f80, v242
  v_mfma_f32_32x32x16_bf16 v[168:183], a[56:59], a[236:239], v[168:183]
  ds_read_b64_tr_b16 a[20:21], v26 offset:192
  ds_read_b64_tr_b16 a[22:23], v26 offset:1088
  v_dot2c_f32_bf16 v63, 0x3f803f80, v243
  s_waitcnt vmcnt(32)
  v_dot2c_f32_bf16 v60, 0x3f803f80, v244
  v_dot2c_f32_bf16 v61, 0x3f803f80, v245
  v_dot2c_f32_bf16 v62, 0x3f803f80, v246
  s_waitcnt lgkmcnt(8)
  v_mfma_f32_32x32x16_bf16 v[72:87], a[60:63], a[240:243], v[72:87]
  v_add_u32 v27, 0x8000, v27
  ds_read_b64_tr_b16 a[24:25], v27
  ds_read_b64_tr_b16 a[26:27], v27 offset:896
  v_dot2c_f32_bf16 v63, 0x3f803f80, v247
  v_cvt_pk_bf16_f32 v64, v60, v60
  v_and_b32 v64, 0xffff0000, v64
  v_sub_f32 v64, v60, v64
  v_cvt_pk_bf16_f32 v64, v60, v64
  v_mfma_f32_32x32x16_bf16 v[88:103], a[0:3], a[240:243], v[88:103]
  ds_read_b64_tr_b16 a[28:29], v27 offset:32
  ds_read_b64_tr_b16 a[30:31], v27 offset:928
  v_cvt_pk_bf16_f32 v65, v61, v61
  v_and_b32 v65, 0xffff0000, v65
  v_sub_f32 v65, v61, v65
  v_cvt_pk_bf16_f32 v65, v61, v65
  v_mfma_f32_32x32x16_bf16 v[104:119], a[4:7], a[240:243], v[104:119]
  ds_read_b64_tr_b16 a[32:33], v27 offset:64
  ds_read_b64_tr_b16 a[34:35], v27 offset:960
  v_cvt_pk_bf16_f32 v66, v62, v62
  v_and_b32 v66, 0xffff0000, v66
  v_sub_f32 v66, v62, v66
  v_cvt_pk_bf16_f32 v66, v62, v66
  v_cvt_pk_bf16_f32 v67, v63, v63
  s_waitcnt lgkmcnt(6)
  v_mfma_f32_32x32x16_bf16 v[120:135], a[8:11], a[240:243], v[120:135]
  ds_read_b64_tr_b16 a[36:37], v27 offset:96
  ds_read_b64_tr_b16 a[38:39], v27 offset:992
  v_and_b32 v67, 0xffff0000, v67
  v_sub_f32 v67, v63, v67
  v_cvt_pk_bf16_f32 v67, v63, v67
  v_add_u32 v68, 0xf080, v1
  v_mfma_f32_32x32x16_bf16 v[136:151], a[12:15], a[240:243], v[136:151]
  ds_read_b64_tr_b16 a[40:41], v27 offset:128
  ds_read_b64_tr_b16 a[42:43], v27 offset:1024
  ds_write_b128 v68, v[64:67]
  v_lshrrev_b32 v68, 2, v47
  v_add_u32 v68, 0xf080, v68
  ds_read_b32 v216, v68
  ds_read_b32 v220, v68 offset:128
  v_mfma_f32_32x32x16_bf16 v[152:167], a[16:19], a[240:243], v[152:167]
  ds_read_b64_tr_b16 a[44:45], v27 offset:160
  ds_read_b64_tr_b16 a[46:47], v27 offset:1056
  ds_read_b32 v224, v68 offset:256
  ds_read_b32 v228, v68 offset:384
  ds_read_b32 v232, v68 offset:512
  ds_read_b32 v236, v68 offset:640
  v_mfma_f32_32x32x16_bf16 v[168:183], a[20:23], a[240:243], v[168:183]
  ds_read_b64_tr_b16 a[48:49], v27 offset:192
  ds_read_b64_tr_b16 a[50:51], v27 offset:1088
  ds_read_b32 v240, v68 offset:768
  v_mov_b32 v41, 0
  v_mov_b32 v42, 0
  v_mov_b32 v43, 0
  v_cmp_gt_u32 vcc, 32, v0
  s_nop 1
  v_cndmask_b32 v40, 0, v40, vcc
  s_waitcnt lgkmcnt(14)
  v_mfma_f32_32x32x16_bf16 v[72:87], a[24:27], a[244:247], v[72:87]
  v_add_u32 v28, 0x8000, v28
  ds_read_b64_tr_b16 a[52:53], v28
  ds_read_b64_tr_b16 a[54:55], v28 offset:896
  v_mfma_f32_32x32x16_bf16 v[88:103], a[28:31], a[244:247], v[88:103]
  ds_read_b64_tr_b16 a[56:57], v28 offset:32
  ds_read_b64_tr_b16 a[58:59], v28 offset:928
  s_add_u32 s95, s98, 0x200
  v_mfma_f32_32x32x16_bf16 v[104:119], a[32:35], a[244:247], v[104:119]
  ds_read_b64_tr_b16 a[60:61], v28 offset:64
  ds_read_b64_tr_b16 a[62:63], v28 offset:960
  s_and_b32 s95, s95, 0x7ff
  s_add_u32 s95, s95, s80
  v_mfma_f32_32x32x16_bf16 v[120:135], a[36:39], a[244:247], v[120:135]
  ds_read_b64_tr_b16 a[0:1], v28 offset:96
  ds_read_b64_tr_b16 a[2:3], v28 offset:992
  s_add_u32 m0, s72, 0
  s_nop 0
  buffer_load_dwordx4 v22, s[52:55], s95 offen lds
  s_waitcnt lgkmcnt(6)
  v_mfma_f32_32x32x16_bf16 v[136:151], a[40:43], a[244:247], v[136:151]
  ds_read_b64_tr_b16 a[4:5], v28 offset:128
  ds_read_b64_tr_b16 a[6:7], v28 offset:1024
  buffer_load_dwordx4 v23, s[52:55], s95 offen offset:1024 lds
  buffer_load_dwordx4 v24, s[52:55], s95 offen offset:2048 lds
  v_mfma_f32_32x32x16_bf16 v[152:167], a[44:47], a[244:247], v[152:167]
  ds_read_b64_tr_b16 a[8:9], v28 offset:160
  ds_read_b64_tr_b16 a[10:11], v28 offset:1056
  buffer_load_dwordx4 v25, s[52:55], s95 offen offset:3072 lds
  s_add_u32 m0, s72, 0x4000
  v_mfma_f32_32x32x16_bf16 v[168:183], a[48:51], a[244:247], v[168:183]
  ds_read_b64_tr_b16 a[12:13], v28 offset:192
  ds_read_b64_tr_b16 a[14:15], v28 offset:1088
  s_add_u32 s95, s95, 0x80
  buffer_load_dwordx4 v22, s[52:55], s95 offen lds
  v_mfma_f32_32x32x16_bf16 v[72:87], a[52:55], a[248:251], v[72:87]
  v_add_u32 v29, 0x8000, v29
  ds_read_b64_tr_b16 a[16:17], v29
  ds_read_b64_tr_b16 a[18:19], v29 offset:896
  buffer_load_dwordx4 v23, s[52:55], s95 offen offset:1024 lds
  buffer_load_dwordx4 v24, s[52:55], s95 offen offset:2048 lds
  s_waitcnt lgkmcnt(6)
  v_mfma_f32_32x32x16_bf16 v[88:103], a[56:59], a[248:251], v[88:103]
  ds_read_b64_tr_b16 a[20:21], v29 offset:32
  ds_read_b64_tr_b16 a[22:23], v29 offset:928
  buffer_load_dwordx4 v25, s[52:55], s95 offen offset:3072 lds
  s_add_u32 s25, s100, 0x6000
  v_mfma_f32_32x32x16_bf16 v[104:119], a[60:63], a[248:251], v[104:119]
  ds_read_b64_tr_b16 a[24:25], v29 offset:64
  ds_read_b64_tr_b16 a[26:27], v29 offset:960
  s_and_b32 s25, s25, 0xffff
  s_add_u32 s25, s25, s79
  v_mfma_f32_32x32x16_bf16 v[120:135], a[0:3], a[248:251], v[120:135]
  ds_read_b64_tr_b16 a[28:29], v29 offset:96
  ds_read_b64_tr_b16 a[30:31], v29 offset:992
  buffer_load_dwordx4 a[160:163], v1, s[60:63], s25 offen sc1
  v_mfma_f32_32x32x16_bf16 v[136:151], a[4:7], a[248:251], v[136:151]
  ds_read_b64_tr_b16 a[32:33], v29 offset:128
  ds_read_b64_tr_b16 a[34:35], v29 offset:1024
  buffer_load_dwordx4 a[164:167], v1, s[60:63], s25 offen offset:1024 sc1
  buffer_load_dwordx4 a[168:171], v1, s[60:63], s25 offen offset:2048 sc1
  s_waitcnt lgkmcnt(6)
  v_mfma_f32_32x32x16_bf16 v[152:167], a[8:11], a[248:251], v[152:167]
  ds_read_b64_tr_b16 a[36:37], v29 offset:160
  ds_read_b64_tr_b16 a[38:39], v29 offset:1056
  buffer_load_dwordx4 a[172:175], v1, s[60:63], s25 offen offset:3072 sc1
  s_add_u32 s25, s25, 0x1000
  v_mfma_f32_32x32x16_bf16 v[168:183], a[12:15], a[248:251], v[168:183]
  ds_read_b64_tr_b16 a[40:41], v29 offset:192
  ds_read_b64_tr_b16 a[42:43], v29 offset:1088
  buffer_load_dwordx4 a[176:179], v1, s[60:63], s25 offen sc1
  buffer_load_dwordx4 a[180:183], v1, s[60:63], s25 offen offset:1024 sc1
  v_mfma_f32_32x32x16_bf16 v[72:87], a[16:19], a[252:255], v[72:87]
  buffer_load_dwordx4 a[184:187], v1, s[60:63], s25 offen offset:2048 sc1
  buffer_load_dwordx4 a[188:191], v1, s[60:63], s25 offen offset:3072 sc1
  v_mfma_f32_32x32x16_bf16 v[88:103], a[20:23], a[252:255], v[88:103]
  v_lshrrev_b32 v5, 3, v0
  v_lshlrev_b32 v5, 10, v5
  s_waitcnt lgkmcnt(2)
  v_mfma_f32_32x32x16_bf16 v[104:119], a[24:27], a[252:255], v[104:119]
  v_bfe_u32 v3, v0, 4, 1
  v_lshlrev_b32 v3, 2, v3
  v_mfma_f32_32x32x16_bf16 v[120:135], a[28:31], a[252:255], v[120:135]
  v_and_b32 v4, 7, v0
  v_xor_b32 v3, v3, v4
  v_mfma_f32_32x32x16_bf16 v[136:151], a[32:35], a[252:255], v[136:151]
  v_lshl_add_u32 v2, v3, 4, v5
  v_add_u32 v3, 0x1c00, v2
  v_mfma_f32_32x32x16_bf16 v[152:167], a[36:39], a[252:255], v[152:167]
  v_add_u32 v4, 0x3800, v2
  s_waitcnt lgkmcnt(0)
  v_mfma_f32_32x32x16_bf16 v[168:183], a[40:43], a[252:255], v[168:183]
  v_add_u32 v5, 0x5400, v2
  s_barrier
  v_mfma_f32_32x32x16_bf16 v[72:87], v[216:219], v[40:43], v[72:87]
  ds_read_b128 a[44:47], v11
  s_add_u32 s95, s98, 0x300
  v_mfma_f32_32x32x16_bf16 v[88:103], v[220:223], v[40:43], v[88:103]
  ds_read_b128 a[48:51], v11 offset:4096
  s_and_b32 s95, s95, 0x7ff
  v_mfma_f32_32x32x16_bf16 v[104:119], v[224:227], v[40:43], v[104:119]
  ds_read_b128 a[52:55], v11 offset:8192
  s_add_u32 s95, s95, s80
  v_mfma_f32_32x32x16_bf16 v[120:135], v[228:231], v[40:43], v[120:135]
  ds_read_b128 a[56:59], v11 offset:12288
  s_add_u32 m0, s72, 0x8000
  v_mfma_f32_32x32x16_bf16 v[136:151], v[232:235], v[40:43], v[136:151]
  ds_read_b128 a[60:63], v12
  buffer_load_dwordx4 v22, s[52:55], s95 offen lds
  v_mfma_f32_32x32x16_bf16 v[152:167], v[236:239], v[40:43], v[152:167]
  ds_read_b128 a[0:3], v12 offset:4096
  buffer_load_dwordx4 v23, s[52:55], s95 offen offset:1024 lds
  v_mfma_f32_32x32x16_bf16 v[168:183], v[240:243], v[40:43], v[168:183]
  ds_read_b128 a[4:7], v12 offset:8192
  buffer_load_dwordx4 v24, s[52:55], s95 offen offset:2048 lds
  s_waitcnt lgkmcnt(3)
  v_mfma_f32_32x32x16_bf16 v[184:199], a[64:67], a[44:47], 0
  ds_read_b128 a[8:11], v12 offset:12288
  buffer_load_dwordx4 v25, s[52:55], s95 offen offset:3072 lds
  v_mfma_f32_32x32x16_bf16 v[200:215], a[64:67], a[48:51], 0
  ds_read_b128 a[12:15], v13
  s_add_u32 m0, s72, 0xc000
  v_mfma_f32_32x32x16_bf16 v[216:231], a[64:67], a[52:55], 0
  ds_read_b128 a[16:19], v13 offset:4096
  s_add_u32 s95, s95, 0x80
  v_mul_f32 v64, v72, v72
  v_mul_f32 v65, v73, v73
  v_fma_f32 v64, v64, v45, v44
  v_fma_f32 v65, v65, v45, v44
  v_mfma_f32_32x32x16_bf16 v[232:247], a[64:67], a[56:59], 0
  ds_read_b128 a[20:23], v13 offset:8192
  buffer_load_dwordx4 v22, s[52:55], s95 offen lds
  v_mul_f32 v64, v64, v72
  v_mul_f32 v65, v65, v73
  v_exp_f32 v64, v64
  v_mul_f32 v80, v72, v80
  s_waitcnt lgkmcnt(3)
  v_mfma_f32_32x32x16_bf16 v[184:199], a[68:71], a[60:63], v[184:199]
  ds_read_b128 a[24:27], v13 offset:12288
  buffer_load_dwordx4 v23, s[52:55], s95 offen offset:1024 lds
  v_exp_f32 v65, v65
  v_mul_f32 v81, v73, v81
  v_fma_f32 v64, v64, v46, v46
  v_fma_f32 v65, v65, v46, v46
  v_mfma_f32_32x32x16_bf16 v[200:215], a[68:71], a[0:3], v[200:215]
  ds_read_b128 a[28:31], v14
  buffer_load_dwordx4 v24, s[52:55], s95 offen offset:2048 lds
  v_rcp_f32 v64, v64
  v_rcp_f32 v65, v65
  v_mul_f32 v80, v80, v64
  v_mul_f32 v81, v81, v65
  v_mfma_f32_32x32x16_bf16 v[216:231], a[68:71], a[4:7], v[216:231]
  ds_read_b128 a[32:35], v14 offset:4096
  buffer_load_dwordx4 v25, s[52:55], s95 offen offset:3072 lds
  v_cvt_pk_bf16_f32 v72, v80, v81
  v_mul_f32 v64, v74, v74
  v_mul_f32 v65, v75, v75
  v_fma_f32 v64, v64, v45, v44
  v_mfma_f32_32x32x16_bf16 v[232:247], a[68:71], a[8:11], v[232:247]
  ds_read_b128 a[36:39], v14 offset:8192
  s_add_u32 s25, s100, 0xc000
  v_fma_f32 v65, v65, v45, v44
  v_mul_f32 v64, v64, v74
  v_mul_f32 v65, v65, v75
  v_exp_f32 v64, v64
  s_waitcnt lgkmcnt(3)
  v_mfma_f32_32x32x16_bf16 v[184:199], a[72:75], a[12:15], v[184:199]
  ds_read_b128 a[40:43], v14 offset:12288
  s_and_b32 s25, s25, 0xffff
  v_mul_f32 v82, v74, v82
  v_exp_f32 v65, v65
  v_mul_f32 v83, v75, v83
  v_fma_f32 v64, v64, v46, v46
  v_mfma_f32_32x32x16_bf16 v[200:215], a[72:75], a[16:19], v[200:215]
  ds_read_b128 a[44:47], v11 offset:16384
  s_add_u32 s25, s25, s79
  v_fma_f32 v65, v65, v46, v46
  v_rcp_f32 v64, v64
  v_rcp_f32 v65, v65
  v_mul_f32 v82, v82, v64
  v_mfma_f32_32x32x16_bf16 v[216:231], a[72:75], a[20:23], v[216:231]
  ds_read_b128 a[48:51], v11 offset:20480
  buffer_load_dwordx4 a[192:195], v1, s[60:63], s25 offen sc1
  v_mul_f32 v83, v83, v65
  v_cvt_pk_bf16_f32 v73, v82, v83
  v_mul_f32 v64, v76, v76
  v_mul_f32 v65, v77, v77
  v_mfma_f32_32x32x16_bf16 v[232:247], a[72:75], a[24:27], v[232:247]
  ds_read_b128 a[52:55], v11 offset:24576
  buffer_load_dwordx4 a[196:199], v1, s[60:63], s25 offen offset:1024 sc1
  v_fma_f32 v64, v64, v45, v44
  v_fma_f32 v65, v65, v45, v44
  v_mul_f32 v64, v64, v76
  v_mul_f32 v65, v65, v77
  s_waitcnt lgkmcnt(3)
  v_mfma_f32_32x32x16_bf16 v[184:199], a[76:79], a[28:31], v[184:199]
  ds_read_b128 a[56:59], v11 offset:28672
  buffer_load_dwordx4 a[200:203], v1, s[60:63], s25 offen offset:2048 sc1
  v_exp_f32 v64, v64
  v_mul_f32 v84, v76, v84
  v_exp_f32 v65, v65
  v_mul_f32 v85, v77, v85
  v_mfma_f32_32x32x16_bf16 v[200:215], a[76:79], a[32:35], v[200:215]
  ds_read_b128 a[60:63], v12 offset:16384
  buffer_load_dwordx4 a[204:207], v1, s[60:63], s25 offen offset:3072 sc1
  v_fma_f32 v64, v64, v46, v46
  v_fma_f32 v65, v65, v46, v46
  v_rcp_f32 v64, v64
  v_rcp_f32 v65, v65
  v_mfma_f32_32x32x16_bf16 v[216:231], a[76:79], a[36:39], v[216:231]
  ds_read_b128 a[0:3], v12 offset:20480
  s_add_u32 s25, s25, 0x1000
  v_mul_f32 v84, v84, v64
  v_mul_f32 v85, v85, v65
  v_cvt_pk_bf16_f32 v74, v84, v85
  v_mul_f32 v64, v78, v78
  v_mfma_f32_32x32x16_bf16 v[232:247], a[76:79], a[40:43], v[232:247]
  ds_read_b128 a[4:7], v12 offset:24576
  buffer_load_dwordx4 a[208:211], v1, s[60:63], s25 offen sc1
  v_mul_f32 v65, v79, v79
  v_fma_f32 v64, v64, v45, v44
  v_fma_f32 v65, v65, v45, v44
  v_mul_f32 v64, v64, v78
  s_waitcnt lgkmcnt(3)
  v_mfma_f32_32x32x16_bf16 v[184:199], a[80:83], a[44:47], v[184:199]
  ds_read_b128 a[8:11], v12 offset:28672
  buffer_load_dwordx4 a[212:215], v1, s[60:63], s25 offen offset:1024 sc1
  v_mul_f32 v65, v65, v79
  v_exp_f32 v64, v64
  v_mul_f32 v86, v78, v86
  v_exp_f32 v65, v65
  v_mfma_f32_32x32x16_bf16 v[200:215], a[80:83], a[48:51], v[200:215]
  ds_read_b128 a[12:15], v13 offset:16384
  buffer_load_dwordx4 a[216:219], v1, s[60:63], s25 offen offset:2048 sc1
  v_mul_f32 v87, v79, v87
  v_fma_f32 v64, v64, v46, v46
  v_fma_f32 v65, v65, v46, v46
  v_rcp_f32 v64, v64
  v_mfma_f32_32x32x16_bf16 v[216:231], a[80:83], a[52:55], v[216:231]
  ds_read_b128 a[16:19], v13 offset:20480
  buffer_load_dwordx4 a[220:223], v1, s[60:63], s25 offen offset:3072 sc1
  v_rcp_f32 v65, v65
  v_mul_f32 v86, v86, v64
  v_mul_f32 v87, v87, v65
  v_cvt_pk_bf16_f32 v75, v86, v87
  v_mfma_f32_32x32x16_bf16 v[232:247], a[80:83], a[56:59], v[232:247]
  ds_read_b128 a[20:23], v13 offset:24576
  v_mov_b32 v248, -1
  v_mul_f32 v64, v88, v88
  v_mul_f32 v65, v89, v89
  v_fma_f32 v64, v64, v45, v44
  v_fma_f32 v65, v65, v45, v44
  s_waitcnt lgkmcnt(3)
  v_mfma_f32_32x32x16_bf16 v[184:199], a[84:87], a[60:63], v[184:199]
  ds_read_b128 a[24:27], v13 offset:28672
  v_mov_b32 v249, -1
  v_mul_f32 v64, v64, v88
  v_mul_f32 v65, v65, v89
  v_exp_f32 v64, v64
  v_mul_f32 v96, v88, v96
  v_mfma_f32_32x32x16_bf16 v[200:215], a[84:87], a[0:3], v[200:215]
  ds_read_b128 a[28:31], v14 offset:16384
  v_mov_b32 v250, -1
  v_exp_f32 v65, v65
  v_mul_f32 v97, v89, v97
  v_fma_f32 v64, v64, v46, v46
  v_fma_f32 v65, v65, v46, v46
  v_mfma_f32_32x32x16_bf16 v[216:231], a[84:87], a[4:7], v[216:231]
  ds_read_b128 a[32:35], v14 offset:20480
  ds_read_b128 a[36:39], v14 offset:24576
  ds_read_b128 a[40:43], v14 offset:28672
  v_mov_b32 v251, -1
  v_rcp_f32 v64, v64
  v_rcp_f32 v65, v65
  v_mul_f32 v96, v96, v64
  v_mul_f32 v97, v97, v65
  v_mfma_f32_32x32x16_bf16 v[232:247], a[84:87], a[8:11], v[232:247]
  buffer_store_dwordx4 v[248:251], v1, s[60:63], s90 offen sc1
  v_cvt_pk_bf16_f32 v88, v96, v97
  v_mul_f32 v64, v90, v90
  v_mul_f32 v65, v91, v91
  v_fma_f32 v64, v64, v45, v44
  s_waitcnt lgkmcnt(4)
  v_mfma_f32_32x32x16_bf16 v[184:199], a[88:91], a[12:15], v[184:199]
  buffer_store_dwordx4 v[248:251], v1, s[60:63], s90 offen offset:1024 sc1
  v_fma_f32 v65, v65, v45, v44
  v_mul_f32 v64, v64, v90
  v_mul_f32 v65, v65, v91
  v_exp_f32 v64, v64
  s_waitcnt vmcnt(58) lgkmcnt(0)
  s_barrier
  v_mfma_f32_32x32x16_bf16 v[200:215], a[88:91], a[16:19], v[200:215]
  ds_read_b128 a[44:47], v11 offset:32768
  s_add_u32 s95, s98, 0x700
  v_mul_f32 v98, v90, v98
  v_exp_f32 v65, v65
  v_mul_f32 v99, v91, v99
  v_fma_f32 v64, v64, v46, v46
  v_mfma_f32_32x32x16_bf16 v[216:231], a[88:91], a[20:23], v[216:231]
  ds_read_b128 a[48:51], v11 offset:36864
  s_and_b32 s95, s95, 0x7ff
  v_fma_f32 v65, v65, v46, v46
  v_rcp_f32 v64, v64
  v_rcp_f32 v65, v65
  v_mul_f32 v98, v98, v64
  v_mfma_f32_32x32x16_bf16 v[232:247], a[88:91], a[24:27], v[232:247]
  ds_read_b128 a[52:55], v11 offset:40960
  s_add_u32 s95, s95, s80
  v_mul_f32 v99, v99, v65
  v_cvt_pk_bf16_f32 v89, v98, v99
  v_mul_f32 v64, v92, v92
  v_mul_f32 v65, v93, v93
  v_mfma_f32_32x32x16_bf16 v[184:199], a[92:95], a[28:31], v[184:199]
  ds_read_b128 a[56:59], v11 offset:45056
  s_add_u32 m0, s72, 0x10000
  s_nop 0
  buffer_load_dwordx4 v22, s[52:55], s95 offen lds
  v_fma_f32 v64, v64, v45, v44
  v_fma_f32 v65, v65, v45, v44
  v_mul_f32 v64, v64, v92
  v_mul_f32 v65, v65, v93
  v_mfma_f32_32x32x16_bf16 v[200:215], a[92:95], a[32:35], v[200:215]
  ds_read_b128 a[60:63], v12 offset:32768
  buffer_load_dwordx4 v23, s[52:55], s95 offen offset:1024 lds
  v_exp_f32 v64, v64
  v_mul_f32 v100, v92, v100
  v_exp_f32 v65, v65
  v_mul_f32 v101, v93, v101
  v_mfma_f32_32x32x16_bf16 v[216:231], a[92:95], a[36:39], v[216:231]
  ds_read_b128 a[0:3], v12 offset:36864
  buffer_load_dwordx4 v24, s[52:55], s95 offen offset:2048 lds
  v_fma_f32 v64, v64, v46, v46
  v_fma_f32 v65, v65, v46, v46
  v_rcp_f32 v64, v64
  v_rcp_f32 v65, v65
  v_mfma_f32_32x32x16_bf16 v[232:247], a[92:95], a[40:43], v[232:247]
  ds_read_b128 a[4:7], v12 offset:40960
  buffer_load_dwordx4 v25, s[52:55], s95 offen offset:3072 lds
  v_mul_f32 v100, v100, v64
  v_mul_f32 v101, v101, v65
  v_cvt_pk_bf16_f32 v90, v100, v101
  v_mul_f32 v64, v94, v94
  s_waitcnt lgkmcnt(3)
  s_waitcnt vmcnt(61)
  v_mfma_f32_32x32x16_bf16 v[184:199], a[96:99], a[44:47], v[184:199]
  ds_read_b128 a[8:11], v12 offset:45056
  s_add_u32 m0, s72, 0x14000
  s_add_u32 s95, s95, 0x80
  v_mul_f32 v65, v95, v95
  v_fma_f32 v64, v64, v45, v44
  v_fma_f32 v65, v65, v45, v44
  v_mul_f32 v64, v64, v94
  v_mfma_f32_32x32x16_bf16 v[200:215], a[96:99], a[48:51], v[200:215]
  ds_read_b128 a[12:15], v13 offset:32768
  buffer_load_dwordx4 v22, s[52:55], s95 offen lds
  v_mul_f32 v65, v65, v95
  v_exp_f32 v64, v64
  v_mul_f32 v102, v94, v102
  v_exp_f32 v65, v65
  v_mfma_f32_32x32x16_bf16 v[216:231], a[96:99], a[52:55], v[216:231]
  ds_read_b128 a[16:19], v13 offset:36864
  buffer_load_dwordx4 v23, s[52:55], s95 offen offset:1024 lds
  v_mul_f32 v103, v95, v103
  v_fma_f32 v64, v64, v46, v46
  v_fma_f32 v65, v65, v46, v46
  v_rcp_f32 v64, v64
  v_mfma_f32_32x32x16_bf16 v[232:247], a[96:99], a[56:59], v[232:247]
  ds_read_b128 a[20:23], v13 offset:40960
  buffer_load_dwordx4 v24, s[52:55], s95 offen offset:2048 lds
  v_rcp_f32 v65, v65
  v_mul_f32 v102, v102, v64
  v_mul_f32 v103, v103, v65
  v_cvt_pk_bf16_f32 v91, v102, v103
  s_waitcnt lgkmcnt(3)
  s_waitcnt vmcnt(63)
  v_mfma_f32_32x32x16_bf16 v[184:199], a[100:103], a[60:63], v[184:199]
  ds_read_b128 a[24:27], v13 offset:45056
  buffer_load_dwordx4 v25, s[52:55], s95 offen offset:3072 lds
  s_add_u32 s25, s100, 0xe000
  v_mul_f32 v64, v104, v104
  v_mul_f32 v65, v105, v105
  v_fma_f32 v64, v64, v45, v44
  v_fma_f32 v65, v65, v45, v44
  v_mfma_f32_32x32x16_bf16 v[200:215], a[100:103], a[0:3], v[200:215]
  ds_read_b128 a[28:31], v14 offset:32768
  s_and_b32 s25, s25, 0xffff
  v_mul_f32 v64, v64, v104
  v_mul_f32 v65, v65, v105
  v_exp_f32 v64, v64
  v_mul_f32 v112, v104, v112
  v_mfma_f32_32x32x16_bf16 v[216:231], a[100:103], a[4:7], v[216:231]
  ds_read_b128 a[32:35], v14 offset:36864
  s_add_u32 s25, s25, s79
  v_exp_f32 v65, v65
  v_mul_f32 v113, v105, v113
  v_fma_f32 v64, v64, v46, v46
  v_fma_f32 v65, v65, v46, v46
  v_mfma_f32_32x32x16_bf16 v[232:247], a[100:103], a[8:11], v[232:247]
  ds_read_b128 a[36:39], v14 offset:40960
  buffer_load_dwordx4 a[224:227], v1, s[60:63], s25 offen sc1
  buffer_load_dwordx4 a[228:231], v1, s[60:63], s25 offen offset:1024 sc1
  v_rcp_f32 v64, v64
  v_rcp_f32 v65, v65
  v_mul_f32 v112, v112, v64
  v_mul_f32 v113, v113, v65
  s_waitcnt lgkmcnt(3)
  s_waitcnt vmcnt(63)
  v_mfma_f32_32x32x16_bf16 v[184:199], a[104:107], a[12:15], v[184:199]
  ds_read_b128 a[40:43], v14 offset:45056
  buffer_load_dwordx4 a[232:235], v1, s[60:63], s25 offen offset:2048 sc1
  v_cvt_pk_bf16_f32 v104, v112, v113
  v_mul_f32 v64, v106, v106
  v_mul_f32 v65, v107, v107
  v_fma_f32 v64, v64, v45, v44
  v_mfma_f32_32x32x16_bf16 v[200:215], a[104:107], a[16:19], v[200:215]
  ds_read_b128 a[44:47], v11 offset:49152
  buffer_load_dwordx4 a[236:239], v1, s[60:63], s25 offen offset:3072 sc1
  v_fma_f32 v65, v65, v45, v44
  v_mul_f32 v64, v64, v106
  v_mul_f32 v65, v65, v107
  v_exp_f32 v64, v64
  v_mfma_f32_32x32x16_bf16 v[216:231], a[104:107], a[20:23], v[216:231]
  ds_read_b128 a[48:51], v11 offset:53248
  s_add_u32 s25, s25, 0x1000
  v_mul_f32 v114, v106, v114
  v_exp_f32 v65, v65
  v_mul_f32 v115, v107, v115
  v_fma_f32 v64, v64, v46, v46
  v_mfma_f32_32x32x16_bf16 v[232:247], a[104:107], a[24:27], v[232:247]
  ds_read_b128 a[52:55], v11 offset:57344
  buffer_load_dwordx4 a[240:243], v1, s[60:63], s25 offen sc1
  buffer_load_dwordx4 a[244:247], v1, s[60:63], s25 offen offset:1024 sc1
  v_fma_f32 v65, v65, v46, v46
  v_rcp_f32 v64, v64
  v_rcp_f32 v65, v65
  v_mul_f32 v114, v114, v64
  s_waitcnt lgkmcnt(3)
  v_mfma_f32_32x32x16_bf16 v[184:199], a[108:111], a[28:31], v[184:199]
  ds_read_b128 a[56:59], v11 offset:61440
  buffer_load_dwordx4 a[248:251], v1, s[60:63], s25 offen offset:2048 sc1
  v_mul_f32 v115, v115, v65
  v_cvt_pk_bf16_f32 v105, v114, v115
  v_mul_f32 v64, v108, v108
  v_mul_f32 v65, v109, v109
  v_mfma_f32_32x32x16_bf16 v[200:215], a[108:111], a[32:35], v[200:215]
  ds_read_b128 a[60:63], v12 offset:49152
  buffer_load_dwordx4 a[252:255], v1, s[60:63], s25 offen offset:3072 sc1
  v_fma_f32 v64, v64, v45, v44
  v_fma_f32 v65, v65, v45, v44
  v_mul_f32 v64, v64, v108
  v_mul_f32 v65, v65, v109
  v_mfma_f32_32x32x16_bf16 v[216:231], a[108:111], a[36:39], v[216:231]
  ds_read_b128 a[0:3], v12 offset:53248
  buffer_store_dwordx4 v[248:251], v1, s[60:63], s91 offen sc1
  v_exp_f32 v64, v64
  v_mul_f32 v116, v108, v116
  v_exp_f32 v65, v65
  v_mul_f32 v117, v109, v117
  v_mfma_f32_32x32x16_bf16 v[232:247], a[108:111], a[40:43], v[232:247]
  ds_read_b128 a[4:7], v12 offset:57344
  buffer_store_dwordx4 v[248:251], v1, s[60:63], s91 offen offset:1024 sc1
  v_fma_f32 v64, v64, v46, v46
  v_fma_f32 v65, v65, v46, v46
  v_rcp_f32 v64, v64
  v_rcp_f32 v65, v65
  s_waitcnt lgkmcnt(3)
  v_mfma_f32_32x32x16_bf16 v[184:199], a[112:115], a[44:47], v[184:199]
  ds_read_b128 a[8:11], v12 offset:61440
  s_add_u32 s25, s100, 0x8000
  v_mul_f32 v116, v116, v64
  v_mul_f32 v117, v117, v65
  v_cvt_pk_bf16_f32 v106, v116, v117
  v_mul_f32 v64, v110, v110
  v_mfma_f32_32x32x16_bf16 v[200:215], a[112:115], a[48:51], v[200:215]
  ds_read_b128 a[12:15], v13 offset:49152
  s_and_b32 s25, s25, 0xffff
  s_add_u32 s25, s25, s79
  v_mul_f32 v65, v111, v111
  v_fma_f32 v64, v64, v45, v44
  v_fma_f32 v65, v65, v45, v44
  v_mul_f32 v64, v64, v110
  v_mfma_f32_32x32x16_bf16 v[216:231], a[112:115], a[52:55], v[216:231]
  ds_read_b128 a[16:19], v13 offset:53248
  buffer_load_dwordx4 a[64:67], v1, s[60:63], s25 offen sc1
  v_mul_f32 v65, v65, v111
  v_exp_f32 v64, v64
  v_mul_f32 v118, v110, v118
  v_exp_f32 v65, v65
  v_mfma_f32_32x32x16_bf16 v[232:247], a[112:115], a[56:59], v[232:247]
  ds_read_b128 a[20:23], v13 offset:57344
  buffer_load_dwordx4 a[68:71], v1, s[60:63], s25 offen offset:1024 sc1
  buffer_load_dwordx4 a[72:75], v1, s[60:63], s25 offen offset:2048 sc1
  v_mul_f32 v119, v111, v119
  v_fma_f32 v64, v64, v46, v46
  v_fma_f32 v65, v65, v46, v46
  v_rcp_f32 v64, v64
  s_waitcnt lgkmcnt(3)
  s_waitcnt vmcnt(63)
  v_mfma_f32_32x32x16_bf16 v[184:199], a[116:119], a[60:63], v[184:199]
  ds_read_b128 a[24:27], v13 offset:61440
  buffer_load_dwordx4 a[76:79], v1, s[60:63], s25 offen offset:3072 sc1
  v_rcp_f32 v65, v65
  v_mul_f32 v118, v118, v64
  v_mul_f32 v119, v119, v65
  v_cvt_pk_bf16_f32 v107, v118, v119
  v_mfma_f32_32x32x16_bf16 v[200:215], a[116:119], a[0:3], v[200:215]
  ds_read_b128 a[28:31], v14 offset:49152
  s_add_u32 s25, s25, 0x1000
  buffer_load_dwordx4 a[80:83], v1, s[60:63], s25 offen sc1
  v_mul_f32 v64, v120, v120
  v_mul_f32 v65, v121, v121
  v_fma_f32 v64, v64, v45, v44
  v_fma_f32 v65, v65, v45, v44
  v_mfma_f32_32x32x16_bf16 v[216:231], a[116:119], a[4:7], v[216:231]
  ds_read_b128 a[32:35], v14 offset:53248
  ds_read_b128 a[36:39], v14 offset:57344
  ds_read_b128 a[40:43], v14 offset:61440
  buffer_load_dwordx4 a[84:87], v1, s[60:63], s25 offen offset:1024 sc1
  v_mul_f32 v64, v64, v120
  v_mul_f32 v65, v65, v121
  v_exp_f32 v64, v64
  v_mul_f32 v128, v120, v128
  v_mfma_f32_32x32x16_bf16 v[232:247], a[116:119], a[8:11], v[232:247]
  buffer_load_dwordx4 a[88:91], v1, s[60:63], s25 offen offset:2048 sc1
  buffer_load_dwordx4 a[92:95], v1, s[60:63], s25 offen offset:3072 sc1
  v_exp_f32 v65, v65
  v_mul_f32 v129, v121, v129
  v_fma_f32 v64, v64, v46, v46
  v_fma_f32 v65, v65, v46, v46
  s_waitcnt lgkmcnt(4)
  v_mfma_f32_32x32x16_bf16 v[184:199], a[120:123], a[12:15], v[184:199]
  v_rcp_f32 v64, v64
  v_rcp_f32 v65, v65
  v_mul_f32 v128, v128, v64
  v_mul_f32 v129, v129, v65
  s_waitcnt vmcnt(52) lgkmcnt(0)
  s_barrier
  v_mfma_f32_32x32x16_bf16 v[200:215], a[120:123], a[16:19], v[200:215]
  ds_read_b128 a[44:47], v7
  s_add_u32 s95, s98, 0x400
  v_cvt_pk_bf16_f32 v120, v128, v129
  v_mul_f32 v64, v122, v122
  v_mul_f32 v65, v123, v123
  v_fma_f32 v64, v64, v45, v44
  v_mfma_f32_32x32x16_bf16 v[216:231], a[120:123], a[20:23], v[216:231]
  ds_read_b128 a[48:51], v7 offset:4096
  s_and_b32 s95, s95, 0x7ff
  v_fma_f32 v65, v65, v45, v44
  v_mul_f32 v64, v64, v122
  v_mul_f32 v65, v65, v123
  v_exp_f32 v64, v64
  v_mfma_f32_32x32x16_bf16 v[232:247], a[120:123], a[24:27], v[232:247]
  ds_read_b128 a[52:55], v7 offset:8192
  s_add_u32 s95, s95, s80
  v_mul_f32 v130, v122, v130
  v_exp_f32 v65, v65
  v_mul_f32 v131, v123, v131
  v_fma_f32 v64, v64, v46, v46
  v_mfma_f32_32x32x16_bf16 v[184:199], a[124:127], a[28:31], v[184:199]
  ds_read_b128 a[56:59], v7 offset:12288
  s_add_u32 m0, s72, 0x18000
  v_fma_f32 v65, v65, v46, v46
  v_rcp_f32 v64, v64
  v_rcp_f32 v65, v65
  v_mul_f32 v130, v130, v64
  v_mfma_f32_32x32x16_bf16 v[200:215], a[124:127], a[32:35], v[200:215]
  ds_read_b128 a[60:63], v8
  buffer_load_dwordx4 v22, s[52:55], s95 offen lds
  v_mul_f32 v131, v131, v65
  v_cvt_pk_bf16_f32 v121, v130, v131
  v_mul_f32 v64, v124, v124
  v_mul_f32 v65, v125, v125
  v_mfma_f32_32x32x16_bf16 v[216:231], a[124:127], a[36:39], v[216:231]
  ds_read_b128 a[0:3], v8 offset:4096
  buffer_load_dwordx4 v23, s[52:55], s95 offen offset:1024 lds
  v_fma_f32 v64, v64, v45, v44
  v_fma_f32 v65, v65, v45, v44
  v_mul_f32 v64, v64, v124
  v_mul_f32 v65, v65, v125
  v_mfma_f32_32x32x16_bf16 v[232:247], a[124:127], a[40:43], v[232:247]
  ds_read_b128 a[4:7], v8 offset:8192
  buffer_load_dwordx4 v24, s[52:55], s95 offen offset:2048 lds
  v_exp_f32 v64, v64
  v_mul_f32 v132, v124, v132
  v_exp_f32 v65, v65
  v_mul_f32 v133, v125, v133
  s_waitcnt lgkmcnt(3)
  v_mfma_f32_32x32x16_bf16 v[184:199], a[128:131], a[44:47], v[184:199]
  ds_read_b128 a[8:11], v8 offset:12288
  buffer_load_dwordx4 v25, s[52:55], s95 offen offset:3072 lds
  s_add_u32 m0, s72, 0x1c000
  v_fma_f32 v64, v64, v46, v46
  v_fma_f32 v65, v65, v46, v46
  v_rcp_f32 v64, v64
  v_rcp_f32 v65, v65
  v_mfma_f32_32x32x16_bf16 v[200:215], a[128:131], a[48:51], v[200:215]
  ds_read_b128 a[12:15], v9
  s_add_u32 s95, s95, 0x80
  v_mul_f32 v132, v132, v64
  v_mul_f32 v133, v133, v65
  v_cvt_pk_bf16_f32 v122, v132, v133
  v_mul_f32 v64, v126, v126
  v_mfma_f32_32x32x16_bf16 v[216:231], a[128:131], a[52:55], v[216:231]
  ds_read_b128 a[16:19], v9 offset:4096
  buffer_load_dwordx4 v22, s[52:55], s95 offen lds
  v_mul_f32 v65, v127, v127
  v_fma_f32 v64, v64, v45, v44
  v_fma_f32 v65, v65, v45, v44
  v_mul_f32 v64, v64, v126
  v_mfma_f32_32x32x16_bf16 v[232:247], a[128:131], a[56:59], v[232:247]
  ds_read_b128 a[20:23], v9 offset:8192
  buffer_load_dwordx4 v23, s[52:55], s95 offen offset:1024 lds
  v_mul_f32 v65, v65, v127
  v_exp_f32 v64, v64
  v_mul_f32 v134, v126, v134
  v_exp_f32 v65, v65
  s_waitcnt lgkmcnt(3)
  v_mfma_f32_32x32x16_bf16 v[184:199], a[132:135], a[60:63], v[184:199]
  ds_read_b128 a[24:27], v9 offset:12288
  buffer_load_dwordx4 v24, s[52:55], s95 offen offset:2048 lds
  v_mul_f32 v135, v127, v135
  v_fma_f32 v64, v64, v46, v46
  v_fma_f32 v65, v65, v46, v46
  v_rcp_f32 v64, v64
  v_mfma_f32_32x32x16_bf16 v[200:215], a[132:135], a[0:3], v[200:215]
  ds_read_b128 a[28:31], v10
  buffer_load_dwordx4 v25, s[52:55], s95 offen offset:3072 lds
  v_rcp_f32 v65, v65
  v_mul_f32 v134, v134, v64
  v_mul_f32 v135, v135, v65
  v_cvt_pk_bf16_f32 v123, v134, v135
  v_mfma_f32_32x32x16_bf16 v[216:231], a[132:135], a[4:7], v[216:231]
  ds_read_b128 a[32:35], v10 offset:4096
  buffer_store_dwordx4 v[248:251], v1, s[60:63], s92 offen sc1
  v_mul_f32 v64, v136, v136
  v_mul_f32 v65, v137, v137
  v_fma_f32 v64, v64, v45, v44
  v_fma_f32 v65, v65, v45, v44
  v_mfma_f32_32x32x16_bf16 v[232:247], a[132:135], a[8:11], v[232:247]
  ds_read_b128 a[36:39], v10 offset:8192
  buffer_store_dwordx4 v[248:251], v1, s[60:63], s92 offen offset:1024 sc1
  v_mul_f32 v64, v64, v136
  v_mul_f32 v65, v65, v137
  v_exp_f32 v64, v64
  v_mul_f32 v144, v136, v144
  s_waitcnt lgkmcnt(3)
  v_mfma_f32_32x32x16_bf16 v[184:199], a[136:139], a[12:15], v[184:199]
  ds_read_b128 a[40:43], v10 offset:12288
  v_exp_f32 v65, v65
  v_mul_f32 v145, v137, v145
  v_fma_f32 v64, v64, v46, v46
  v_fma_f32 v65, v65, v46, v46
  v_mfma_f32_32x32x16_bf16 v[200:215], a[136:139], a[16:19], v[200:215]
  ds_read_b128 a[44:47], v7 offset:16384
  s_add_u32 s25, s100, 0xa000
  v_rcp_f32 v64, v64
  v_rcp_f32 v65, v65
  v_mul_f32 v144, v144, v64
  v_mul_f32 v145, v145, v65
  v_mfma_f32_32x32x16_bf16 v[216:231], a[136:139], a[20:23], v[216:231]
  ds_read_b128 a[48:51], v7 offset:20480
  s_and_b32 s25, s25, 0xffff
  v_cvt_pk_bf16_f32 v136, v144, v145
  v_mul_f32 v64, v138, v138
  v_mul_f32 v65, v139, v139
  v_fma_f32 v64, v64, v45, v44
  v_mfma_f32_32x32x16_bf16 v[232:247], a[136:139], a[24:27], v[232:247]
  ds_read_b128 a[52:55], v7 offset:24576
  s_add_u32 s25, s25, s79
  v_fma_f32 v65, v65, v45, v44
  v_mul_f32 v64, v64, v138
  v_mul_f32 v65, v65, v139
  v_exp_f32 v64, v64
  s_waitcnt lgkmcnt(3)
  v_mfma_f32_32x32x16_bf16 v[184:199], a[140:143], a[28:31], v[184:199]
  ds_read_b128 a[56:59], v7 offset:28672
  v_mul_f32 v146, v138, v146
  v_exp_f32 v65, v65
  v_mul_f32 v147, v139, v147
  v_fma_f32 v64, v64, v46, v46
  v_mfma_f32_32x32x16_bf16 v[200:215], a[140:143], a[32:35], v[200:215]
  ds_read_b128 a[60:63], v8 offset:16384
  buffer_load_dwordx4 a[96:99], v1, s[60:63], s25 offen sc1
  v_fma_f32 v65, v65, v46, v46
  v_rcp_f32 v64, v64
  v_rcp_f32 v65, v65
  v_mul_f32 v146, v146, v64
  v_mfma_f32_32x32x16_bf16 v[216:231], a[140:143], a[36:39], v[216:231]
  ds_read_b128 a[0:3], v8 offset:20480
  buffer_load_dwordx4 a[100:103], v1, s[60:63], s25 offen offset:1024 sc1
  v_mul_f32 v147, v147, v65
  v_cvt_pk_bf16_f32 v137, v146, v147
  v_mul_f32 v64, v140, v140
  v_mul_f32 v65, v141, v141
  v_mfma_f32_32x32x16_bf16 v[232:247], a[140:143], a[40:43], v[232:247]
  ds_read_b128 a[4:7], v8 offset:24576
  buffer_load_dwordx4 a[104:107], v1, s[60:63], s25 offen offset:2048 sc1
  v_fma_f32 v64, v64, v45, v44
  v_fma_f32 v65, v65, v45, v44
  v_mul_f32 v64, v64, v140
  v_mul_f32 v65, v65, v141
  s_waitcnt lgkmcnt(3)
  v_mfma_f32_32x32x16_bf16 v[184:199], a[144:147], a[44:47], v[184:199]
  ds_read_b128 a[8:11], v8 offset:28672
  v_exp_f32 v64, v64
  v_mul_f32 v148, v140, v148
  v_exp_f32 v65, v65
  v_mul_f32 v149, v141, v149
  v_mfma_f32_32x32x16_bf16 v[200:215], a[144:147], a[48:51], v[200:215]
  ds_read_b128 a[12:15], v9 offset:16384
  buffer_load_dwordx4 a[108:111], v1, s[60:63], s25 offen offset:3072 sc1
  v_fma_f32 v64, v64, v46, v46
  v_fma_f32 v65, v65, v46, v46
  v_rcp_f32 v64, v64
  v_rcp_f32 v65, v65
  v_mfma_f32_32x32x16_bf16 v[216:231], a[144:147], a[52:55], v[216:231]
  ds_read_b128 a[16:19], v9 offset:20480
  s_add_u32 s25, s25, 0x1000
  v_mul_f32 v148, v148, v64
  v_mul_f32 v149, v149, v65
  v_cvt_pk_bf16_f32 v138, v148, v149
  v_mul_f32 v64, v142, v142
  v_mfma_f32_32x32x16_bf16 v[232:247], a[144:147], a[56:59], v[232:247]
  ds_read_b128 a[20:23], v9 offset:24576
  buffer_load_dwordx4 a[112:115], v1, s[60:63], s25 offen sc1
  v_mul_f32 v65, v143, v143
  v_fma_f32 v64, v64, v45, v44
  v_fma_f32 v65, v65, v45, v44
  v_mul_f32 v64, v64, v142
  s_waitcnt lgkmcnt(3)
  v_mfma_f32_32x32x16_bf16 v[184:199], a[148:151], a[60:63], v[184:199]
  ds_read_b128 a[24:27], v9 offset:28672
  v_mul_f32 v65, v65, v143
  v_exp_f32 v64, v64
  v_mul_f32 v150, v142, v150
  v_exp_f32 v65, v65
  v_mfma_f32_32x32x16_bf16 v[200:215], a[148:151], a[0:3], v[200:215]
  ds_read_b128 a[28:31], v10 offset:16384
  buffer_load_dwordx4 a[116:119], v1, s[60:63], s25 offen offset:1024 sc1
  v_mul_f32 v151, v143, v151
  v_fma_f32 v64, v64, v46, v46
  v_fma_f32 v65, v65, v46, v46
  v_rcp_f32 v64, v64
  v_mfma_f32_32x32x16_bf16 v[216:231], a[148:151], a[4:7], v[216:231]
  ds_read_b128 a[32:35], v10 offset:20480
  ds_read_b128 a[36:39], v10 offset:24576
  ds_read_b128 a[40:43], v10 offset:28672
  buffer_load_dwordx4 a[120:123], v1, s[60:63], s25 offen offset:2048 sc1
  v_rcp_f32 v65, v65
  v_mul_f32 v150, v150, v64
  v_mul_f32 v151, v151, v65
  v_cvt_pk_bf16_f32 v139, v150, v151
  v_mfma_f32_32x32x16_bf16 v[232:247], a[148:151], a[8:11], v[232:247]
  buffer_load_dwordx4 a[124:127], v1, s[60:63], s25 offen offset:3072 sc1
  v_mul_f32 v64, v152, v152
  v_mul_f32 v65, v153, v153
  v_fma_f32 v64, v64, v45, v44
  v_fma_f32 v65, v65, v45, v44
  s_waitcnt lgkmcnt(4)
  v_mfma_f32_32x32x16_bf16 v[184:199], a[152:155], a[12:15], v[184:199]
  v_mul_f32 v64, v64, v152
  v_mul_f32 v65, v65, v153
  v_exp_f32 v64, v64
  v_mul_f32 v160, v152, v160
  s_waitcnt vmcnt(54) lgkmcnt(0)
  s_barrier
  v_mfma_f32_32x32x16_bf16 v[200:215], a[152:155], a[16:19], v[200:215]
  ds_read_b128 a[44:47], v7 offset:32768
  v_exp_f32 v65, v65
  v_mul_f32 v161, v153, v161
  v_fma_f32 v64, v64, v46, v46
  v_fma_f32 v65, v65, v46, v46
  v_mfma_f32_32x32x16_bf16 v[216:231], a[152:155], a[20:23], v[216:231]
  ds_read_b128 a[48:51], v7 offset:36864
  s_add_u32 s95, s98, 0x500
  v_rcp_f32 v64, v64
  v_rcp_f32 v65, v65
  v_mul_f32 v160, v160, v64
  v_mul_f32 v161, v161, v65
  v_mfma_f32_32x32x16_bf16 v[232:247], a[152:155], a[24:27], v[232:247]
  ds_read_b128 a[52:55], v7 offset:40960
  s_and_b32 s95, s95, 0x7ff
  v_cvt_pk_bf16_f32 v152, v160, v161
  v_mul_f32 v64, v154, v154
  v_mul_f32 v65, v155, v155
  v_fma_f32 v64, v64, v45, v44
  v_mfma_f32_32x32x16_bf16 v[184:199], a[156:159], a[28:31], v[184:199]
  ds_read_b128 a[56:59], v7 offset:45056
  s_add_u32 s95, s95, s80
  v_fma_f32 v65, v65, v45, v44
  v_mul_f32 v64, v64, v154
  v_mul_f32 v65, v65, v155
  v_exp_f32 v64, v64
  v_mfma_f32_32x32x16_bf16 v[200:215], a[156:159], a[32:35], v[200:215]
  ds_read_b128 a[60:63], v8 offset:32768
  v_mul_f32 v162, v154, v162
  v_exp_f32 v65, v65
  v_mul_f32 v163, v155, v163
  v_fma_f32 v64, v64, v46, v46
  v_mfma_f32_32x32x16_bf16 v[216:231], a[156:159], a[36:39], v[216:231]
  ds_read_b128 a[0:3], v8 offset:36864
  s_add_u32 m0, s72, 0
  v_fma_f32 v65, v65, v46, v46
  v_rcp_f32 v64, v64
  v_rcp_f32 v65, v65
  v_mul_f32 v162, v162, v64
  v_mfma_f32_32x32x16_bf16 v[232:247], a[156:159], a[40:43], v[232:247]
  ds_read_b128 a[4:7], v8 offset:40960
  buffer_load_dwordx4 v22, s[52:55], s95 offen lds
  v_mul_f32 v163, v163, v65
  v_cvt_pk_bf16_f32 v153, v162, v163
  v_mul_f32 v64, v156, v156
  v_mul_f32 v65, v157, v157
  s_waitcnt lgkmcnt(3)
  v_mfma_f32_32x32x16_bf16 v[184:199], a[160:163], a[44:47], v[184:199]
  ds_read_b128 a[8:11], v8 offset:45056
  buffer_load_dwordx4 v23, s[52:55], s95 offen offset:1024 lds
  v_fma_f32 v64, v64, v45, v44
  v_fma_f32 v65, v65, v45, v44
  v_mul_f32 v64, v64, v156
  v_mul_f32 v65, v65, v157
  v_mfma_f32_32x32x16_bf16 v[200:215], a[160:163], a[48:51], v[200:215]
  ds_read_b128 a[12:15], v9 offset:32768
  v_exp_f32 v64, v64
  v_mul_f32 v164, v156, v164
  v_exp_f32 v65, v65
  v_mul_f32 v165, v157, v165
  v_mfma_f32_32x32x16_bf16 v[216:231], a[160:163], a[52:55], v[216:231]
  ds_read_b128 a[16:19], v9 offset:36864
  buffer_load_dwordx4 v24, s[52:55], s95 offen offset:2048 lds
  v_fma_f32 v64, v64, v46, v46
  v_fma_f32 v65, v65, v46, v46
  v_rcp_f32 v64, v64
  v_rcp_f32 v65, v65
  v_mfma_f32_32x32x16_bf16 v[232:247], a[160:163], a[56:59], v[232:247]
  ds_read_b128 a[20:23], v9 offset:40960
  buffer_load_dwordx4 v25, s[52:55], s95 offen offset:3072 lds
  v_mul_f32 v164, v164, v64
  v_mul_f32 v165, v165, v65
  v_cvt_pk_bf16_f32 v154, v164, v165
  v_mul_f32 v64, v158, v158
  s_waitcnt lgkmcnt(3)
  v_mfma_f32_32x32x16_bf16 v[184:199], a[164:167], a[60:63], v[184:199]
  ds_read_b128 a[24:27], v9 offset:45056
  s_add_u32 m0, s72, 0x4000
  v_mul_f32 v65, v159, v159
  v_fma_f32 v64, v64, v45, v44
  v_fma_f32 v65, v65, v45, v44
  v_mul_f32 v64, v64, v158
  v_mfma_f32_32x32x16_bf16 v[200:215], a[164:167], a[0:3], v[200:215]
  ds_read_b128 a[28:31], v10 offset:32768
  v_mul_f32 v65, v65, v159
  v_exp_f32 v64, v64
  v_mul_f32 v166, v158, v166
  v_exp_f32 v65, v65
  v_mfma_f32_32x32x16_bf16 v[216:231], a[164:167], a[4:7], v[216:231]
  ds_read_b128 a[32:35], v10 offset:36864
  s_add_u32 s95, s95, 0x80
  v_mul_f32 v167, v159, v167
  v_fma_f32 v64, v64, v46, v46
  v_fma_f32 v65, v65, v46, v46
  v_rcp_f32 v64, v64
  v_mfma_f32_32x32x16_bf16 v[232:247], a[164:167], a[8:11], v[232:247]
  ds_read_b128 a[36:39], v10 offset:40960
  buffer_load_dwordx4 v22, s[52:55], s95 offen lds
  v_rcp_f32 v65, v65
  v_mul_f32 v166, v166, v64
  v_mul_f32 v167, v167, v65
  v_cvt_pk_bf16_f32 v155, v166, v167
  s_waitcnt lgkmcnt(3)
  v_mfma_f32_32x32x16_bf16 v[184:199], a[168:171], a[12:15], v[184:199]
  ds_read_b128 a[40:43], v10 offset:45056
  buffer_load_dwordx4 v23, s[52:55], s95 offen offset:1024 lds
  v_mul_f32 v64, v168, v168
  v_mul_f32 v65, v169, v169
  v_fma_f32 v64, v64, v45, v44
  v_fma_f32 v65, v65, v45, v44
  v_mfma_f32_32x32x16_bf16 v[200:215], a[168:171], a[16:19], v[200:215]
  ds_read_b128 a[44:47], v7 offset:49152
  v_mul_f32 v64, v64, v168
  v_mul_f32 v65, v65, v169
  v_exp_f32 v64, v64
  v_mul_f32 v176, v168, v176
  v_mfma_f32_32x32x16_bf16 v[216:231], a[168:171], a[20:23], v[216:231]
  ds_read_b128 a[48:51], v7 offset:53248
  buffer_load_dwordx4 v24, s[52:55], s95 offen offset:2048 lds
  v_exp_f32 v65, v65
  v_mul_f32 v177, v169, v177
  v_fma_f32 v64, v64, v46, v46
  v_fma_f32 v65, v65, v46, v46
  v_mfma_f32_32x32x16_bf16 v[232:247], a[168:171], a[24:27], v[232:247]
  ds_read_b128 a[52:55], v7 offset:57344
  buffer_load_dwordx4 v25, s[52:55], s95 offen offset:3072 lds
  v_rcp_f32 v64, v64
  v_rcp_f32 v65, v65
  v_mul_f32 v176, v176, v64
  v_mul_f32 v177, v177, v65
  s_waitcnt lgkmcnt(3)
  v_mfma_f32_32x32x16_bf16 v[184:199], a[172:175], a[28:31], v[184:199]
  ds_read_b128 a[56:59], v7 offset:61440
  v_cvt_pk_bf16_f32 v168, v176, v177
  v_mul_f32 v64, v170, v170
  v_mul_f32 v65, v171, v171
  v_fma_f32 v64, v64, v45, v44
  v_mfma_f32_32x32x16_bf16 v[200:215], a[172:175], a[32:35], v[200:215]
  ds_read_b128 a[60:63], v8 offset:49152
  v_fma_f32 v65, v65, v45, v44
  v_mul_f32 v64, v64, v170
  v_mul_f32 v65, v65, v171
  v_exp_f32 v64, v64
  v_mfma_f32_32x32x16_bf16 v[216:231], a[172:175], a[36:39], v[216:231]
  ds_read_b128 a[0:3], v8 offset:53248
  v_mul_f32 v178, v170, v178
  v_exp_f32 v65, v65
  v_mul_f32 v179, v171, v179
  v_fma_f32 v64, v64, v46, v46
  v_mfma_f32_32x32x16_bf16 v[232:247], a[172:175], a[40:43], v[232:247]
  ds_read_b128 a[4:7], v8 offset:57344
  v_fma_f32 v65, v65, v46, v46
  v_rcp_f32 v64, v64
  v_rcp_f32 v65, v65
  v_mul_f32 v178, v178, v64
  s_waitcnt lgkmcnt(3)
  v_mfma_f32_32x32x16_bf16 v[184:199], a[176:179], a[44:47], v[184:199]
  ds_read_b128 a[8:11], v8 offset:61440
  v_mul_f32 v179, v179, v65
  v_cvt_pk_bf16_f32 v169, v178, v179
  v_mul_f32 v64, v172, v172
  v_mul_f32 v65, v173, v173
  v_mfma_f32_32x32x16_bf16 v[200:215], a[176:179], a[48:51], v[200:215]
  ds_read_b128 a[12:15], v9 offset:49152
  v_fma_f32 v64, v64, v45, v44
  v_fma_f32 v65, v65, v45, v44
  v_mul_f32 v64, v64, v172
  v_mul_f32 v65, v65, v173
  v_mfma_f32_32x32x16_bf16 v[216:231], a[176:179], a[52:55], v[216:231]
  ds_read_b128 a[16:19], v9 offset:53248
  v_exp_f32 v64, v64
  v_mul_f32 v180, v172, v180
  v_exp_f32 v65, v65
  v_mul_f32 v181, v173, v181
  v_mfma_f32_32x32x16_bf16 v[232:247], a[176:179], a[56:59], v[232:247]
  ds_read_b128 a[20:23], v9 offset:57344
  v_fma_f32 v64, v64, v46, v46
  v_fma_f32 v65, v65, v46, v46
  v_rcp_f32 v64, v64
  v_rcp_f32 v65, v65
  s_waitcnt lgkmcnt(3)
  v_mfma_f32_32x32x16_bf16 v[184:199], a[180:183], a[60:63], v[184:199]
  ds_read_b128 a[24:27], v9 offset:61440
  v_mul_f32 v180, v180, v64
  v_mul_f32 v181, v181, v65
  v_cvt_pk_bf16_f32 v170, v180, v181
  v_mul_f32 v64, v174, v174
  v_mfma_f32_32x32x16_bf16 v[200:215], a[180:183], a[0:3], v[200:215]
  ds_read_b128 a[28:31], v10 offset:49152
  v_mul_f32 v65, v175, v175
  v_fma_f32 v64, v64, v45, v44
  v_fma_f32 v65, v65, v45, v44
  v_mul_f32 v64, v64, v174
  v_mfma_f32_32x32x16_bf16 v[216:231], a[180:183], a[4:7], v[216:231]
  ds_read_b128 a[32:35], v10 offset:53248
  ds_read_b128 a[36:39], v10 offset:57344
  ds_read_b128 a[40:43], v10 offset:61440
  v_mul_f32 v65, v65, v175
  v_exp_f32 v64, v64
  v_mul_f32 v182, v174, v182
  v_exp_f32 v65, v65
  v_mfma_f32_32x32x16_bf16 v[232:247], a[180:183], a[8:11], v[232:247]
  v_mul_f32 v183, v175, v183
  v_fma_f32 v64, v64, v46, v46
  v_fma_f32 v65, v65, v46, v46
  v_rcp_f32 v64, v64
  s_waitcnt lgkmcnt(4)
  v_mfma_f32_32x32x16_bf16 v[184:199], a[184:187], a[12:15], v[184:199]
  v_rcp_f32 v65, v65
  v_mul_f32 v182, v182, v64
  v_mul_f32 v183, v183, v65
  v_cvt_pk_bf16_f32 v171, v182, v183
  s_waitcnt lgkmcnt(0)
  s_barrier
  v_mfma_f32_32x32x16_bf16 v[200:215], a[184:187], a[16:19], v[200:215]
  ds_read_b128 a[44:47], v15
  buffer_store_dwordx4 v[72:75], v1, s[60:63], s86 offen sc1
  buffer_store_dwordx4 v[88:91], v1, s[60:63], s86 offen offset:1024 sc1
  buffer_store_dwordx4 v[104:107], v1, s[60:63], s86 offen offset:2048 sc1
  buffer_store_dwordx4 v[120:123], v1, s[60:63], s86 offen offset:3072 sc1
  v_mfma_f32_32x32x16_bf16 v[216:231], a[184:187], a[20:23], v[216:231]
  ds_read_b128 a[48:51], v15 offset:4096
  s_add_u32 s86, s86, 0x1000
  buffer_store_dwordx4 v[136:139], v1, s[60:63], s86 offen sc1
  buffer_store_dwordx4 v[152:155], v1, s[60:63], s86 offen offset:1024 sc1
  buffer_store_dwordx4 v[168:171], v1, s[60:63], s86 offen offset:2048 sc1
  v_mfma_f32_32x32x16_bf16 v[232:247], a[184:187], a[24:27], v[232:247]
  ds_read_b128 a[52:55], v15 offset:8192
  v_mfma_f32_32x32x16_bf16 v[184:199], a[188:191], a[28:31], v[184:199]
  ds_read_b128 a[56:59], v15 offset:12288
  v_lshrrev_b32 v82, 5, v0
  v_bfe_u32 v65, v0, 2, 2
  v_mfma_f32_32x32x16_bf16 v[200:215], a[188:191], a[32:35], v[200:215]
  ds_read_b128 a[60:63], v16
  v_lshl_add_u32 v64, v82, 2, v65
  v_lshlrev_b32 v64, 7, v64
  v_mfma_f32_32x32x16_bf16 v[216:231], a[188:191], a[36:39], v[216:231]
  ds_read_b128 a[0:3], v16 offset:4096
  v_bfe_u32 v65, v0, 4, 1
  v_lshlrev_b32 v65, 1, v65
  v_mfma_f32_32x32x16_bf16 v[232:247], a[188:191], a[40:43], v[232:247]
  ds_read_b128 a[4:7], v16 offset:8192
  v_bfe_u32 v66, v0, 1, 1
  v_add_u32 v65, v65, v66
  s_waitcnt lgkmcnt(3)
  s_waitcnt vmcnt(63)
  v_mfma_f32_32x32x16_bf16 v[184:199], a[192:195], a[44:47], v[184:199]
  ds_read_b128 a[8:11], v16 offset:12288
  s_and_b32 s8, s3, 1
  s_lshl_b32 s8, s8, 2
  v_mfma_f32_32x32x16_bf16 v[200:215], a[192:195], a[48:51], v[200:215]
  ds_read_b128 a[12:15], v17
  v_add_u32 v65, s8, v65
  v_bfe_u32 v66, v0, 3, 1
  v_mfma_f32_32x32x16_bf16 v[216:231], a[192:195], a[52:55], v[216:231]
  ds_read_b128 a[16:19], v17 offset:4096
  v_lshlrev_b32 v66, 2, v66
  v_xor_b32 v65, v65, v66
  v_mfma_f32_32x32x16_bf16 v[232:247], a[192:195], a[56:59], v[232:247]
  ds_read_b128 a[20:23], v17 offset:8192
  v_lshl_add_u32 v64, v65, 4, v64
  s_lshr_b32 s9, s3, 1
  s_waitcnt lgkmcnt(3)
  v_mfma_f32_32x32x16_bf16 v[184:199], a[196:199], a[60:63], v[184:199]
  ds_read_b128 a[24:27], v17 offset:12288
  s_lshl_b32 s9, s9, 13
  v_add_u32 v64, s9, v64
  v_mfma_f32_32x32x16_bf16 v[200:215], a[196:199], a[0:3], v[200:215]
  ds_read_b128 a[28:31], v18
  v_and_b32 v66, 1, v0
  v_lshl_add_u32 v72, v66, 3, v64
  v_mfma_f32_32x32x16_bf16 v[216:231], a[196:199], a[4:7], v[216:231]
  ds_read_b128 a[32:35], v18 offset:4096
  v_add_u32 v73, 0x10000, v72
  v_add_u32 v74, 0x20000, v72
  v_mfma_f32_32x32x16_bf16 v[232:247], a[196:199], a[8:11], v[232:247]
  ds_read_b128 a[36:39], v18 offset:8192
  v_mov_b32 v75, v1
  v_add_u32 v76, 0x10000, v1
  s_waitcnt lgkmcnt(3)
  v_mfma_f32_32x32x16_bf16 v[184:199], a[200:203], a[12:15], v[184:199]
  ds_read_b128 a[40:43], v18 offset:12288
  v_add_u32 v77, 0x20000, v1
  v_lshlrev_b32 v81, 6, v47
  v_mfma_f32_32x32x16_bf16 v[200:215], a[200:203], a[16:19], v[200:215]
  ds_read_b128 a[44:47], v15 offset:16384
  v_lshl_add_u32 v81, v82, 3, v81
  buffer_load_dwordx2 v[124:125], v81, s[40:43], s93 offen
  v_mfma_f32_32x32x16_bf16 v[216:231], a[200:203], a[20:23], v[216:231]
  ds_read_b128 a[48:51], v15 offset:20480
  buffer_load_dwordx2 v[126:127], v81, s[40:43], s93 offen offset:16
  buffer_load_dwordx2 v[128:129], v81, s[40:43], s93 offen offset:32
  v_mfma_f32_32x32x16_bf16 v[232:247], a[200:203], a[24:27], v[232:247]
  ds_read_b128 a[52:55], v15 offset:24576
  buffer_load_dwordx2 v[130:131], v81, s[40:43], s93 offen offset:48
  s_waitcnt lgkmcnt(3)
  v_mfma_f32_32x32x16_bf16 v[184:199], a[204:207], a[28:31], v[184:199]
  ds_read_b128 a[56:59], v15 offset:28672
  v_mfma_f32_32x32x16_bf16 v[200:215], a[204:207], a[32:35], v[200:215]
  ds_read_b128 a[60:63], v16 offset:16384
  v_mfma_f32_32x32x16_bf16 v[216:231], a[204:207], a[36:39], v[216:231]
  ds_read_b128 a[0:3], v16 offset:20480
  v_mfma_f32_32x32x16_bf16 v[232:247], a[204:207], a[40:43], v[232:247]
  ds_read_b128 a[4:7], v16 offset:24576
  s_waitcnt lgkmcnt(3)
  v_mfma_f32_32x32x16_bf16 v[184:199], a[208:211], a[44:47], v[184:199]
  ds_read_b128 a[8:11], v16 offset:28672
  s_waitcnt vmcnt(4)
  s_barrier
  s_mov_b32 s94, 0x8000
  buffer_store_dwordx2 v[34:35], v33, s[60:63], s94 offen sc1
  v_mfma_f32_32x32x16_bf16 v[200:215], a[208:211], a[48:51], v[200:215]
  ds_read_b128 a[12:15], v17 offset:16384
  v_mfma_f32_32x32x16_bf16 v[216:231], a[208:211], a[52:55], v[216:231]
  ds_read_b128 a[16:19], v17 offset:20480
  v_mfma_f32_32x32x16_bf16 v[232:247], a[208:211], a[56:59], v[232:247]
  ds_read_b128 a[20:23], v17 offset:24576
  buffer_load_dword v49, v6, s[56:59], 0 offen
  s_waitcnt lgkmcnt(3)
  v_mfma_f32_32x32x16_bf16 v[184:199], a[212:215], a[60:63], v[184:199]
  ds_read_b128 a[24:27], v17 offset:28672
  v_mfma_f32_32x32x16_bf16 v[200:215], a[212:215], a[0:3], v[200:215]
  ds_read_b128 a[28:31], v18 offset:16384
  v_mfma_f32_32x32x16_bf16 v[216:231], a[212:215], a[4:7], v[216:231]
  ds_read_b128 a[32:35], v18 offset:20480
  ds_read_b128 a[36:39], v18 offset:24576
  ds_read_b128 a[40:43], v18 offset:28672
  v_mfma_f32_32x32x16_bf16 v[232:247], a[212:215], a[8:11], v[232:247]
  s_waitcnt lgkmcnt(4)
  v_mfma_f32_32x32x16_bf16 v[184:199], a[216:219], a[12:15], v[184:199]
  s_waitcnt lgkmcnt(0)
  s_barrier
  v_mfma_f32_32x32x16_bf16 v[200:215], a[216:219], a[16:19], v[200:215]
  ds_read_b128 a[44:47], v11
  v_mfma_f32_32x32x16_bf16 v[216:231], a[216:219], a[20:23], v[216:231]
  ds_read_b128 a[48:51], v11 offset:4096
  s_add_u32 m0, s72, 0x8000
  v_mfma_f32_32x32x16_bf16 v[232:247], a[216:219], a[24:27], v[232:247]
  ds_read_b128 a[52:55], v11 offset:8192
  s_add_u32 s95, s101, 0
  v_mfma_f32_32x32x16_bf16 v[184:199], a[220:223], a[28:31], v[184:199]
  ds_read_b128 a[56:59], v11 offset:12288
  s_sub_u32 s12, s95, 6
  v_mfma_f32_32x32x16_bf16 v[200:215], a[220:223], a[32:35], v[200:215]
  ds_read_b128 a[60:63], v12
  v_mfma_f32_32x32x16_bf16 v[216:231], a[220:223], a[36:39], v[216:231]
  ds_read_b128 a[0:3], v12 offset:4096
  s_min_u32 s95, s95, s12
  v_mfma_f32_32x32x16_bf16 v[232:247], a[220:223], a[40:43], v[232:247]
  ds_read_b128 a[4:7], v12 offset:8192
  s_mul_i32 s95, s95, 0x10000
  s_waitcnt lgkmcnt(3)
  v_mfma_f32_32x32x16_bf16 v[184:199], a[224:227], a[44:47], v[184:199]
  ds_read_b128 a[8:11], v12 offset:12288
  s_add_u32 s95, s95, s81
  v_mfma_f32_32x32x16_bf16 v[200:215], a[224:227], a[48:51], v[200:215]
  ds_read_b128 a[12:15], v13
  v_mfma_f32_32x32x16_bf16 v[216:231], a[224:227], a[52:55], v[216:231]
  ds_read_b128 a[16:19], v13 offset:4096
  buffer_load_dwordx4 v2, s[56:59], s95 offen lds
  v_mfma_f32_32x32x16_bf16 v[232:247], a[224:227], a[56:59], v[232:247]
  ds_read_b128 a[20:23], v13 offset:8192
  buffer_load_dwordx4 v3, s[56:59], s95 offen offset:1024 lds
  s_waitcnt lgkmcnt(3)
  v_mfma_f32_32x32x16_bf16 v[184:199], a[228:231], a[60:63], v[184:199]
  ds_read_b128 a[24:27], v13 offset:12288
  buffer_load_dwordx4 v4, s[56:59], s95 offen offset:2048 lds
  v_mfma_f32_32x32x16_bf16 v[200:215], a[228:231], a[0:3], v[200:215]
  ds_read_b128 a[28:31], v14
  v_mfma_f32_32x32x16_bf16 v[216:231], a[228:231], a[4:7], v[216:231]
  ds_read_b128 a[32:35], v14 offset:4096
  buffer_load_dwordx4 v5, s[56:59], s95 offen offset:3072 lds
  v_mfma_f32_32x32x16_bf16 v[232:247], a[228:231], a[8:11], v[232:247]
  ds_read_b128 a[36:39], v14 offset:8192
  s_waitcnt lgkmcnt(3)
  v_mfma_f32_32x32x16_bf16 v[184:199], a[232:235], a[12:15], v[184:199]
  ds_read_b128 a[40:43], v14 offset:12288
  v_mfma_f32_32x32x16_bf16 v[200:215], a[232:235], a[16:19], v[200:215]
  ds_read_b128 a[44:47], v11 offset:16384
  v_mfma_f32_32x32x16_bf16 v[216:231], a[232:235], a[20:23], v[216:231]
  ds_read_b128 a[48:51], v11 offset:20480
  v_mfma_f32_32x32x16_bf16 v[232:247], a[232:235], a[24:27], v[232:247]
  ds_read_b128 a[52:55], v11 offset:24576
  s_waitcnt lgkmcnt(3)
  v_mfma_f32_32x32x16_bf16 v[184:199], a[236:239], a[28:31], v[184:199]
  ds_read_b128 a[56:59], v11 offset:28672
  v_mfma_f32_32x32x16_bf16 v[200:215], a[236:239], a[32:35], v[200:215]
  ds_read_b128 a[60:63], v12 offset:16384
  s_add_u32 m0, s72, 0x20000
  v_mfma_f32_32x32x16_bf16 v[216:231], a[236:239], a[36:39], v[216:231]
  ds_read_b128 a[0:3], v12 offset:20480
  s_add_u32 s95, s101, 1
  v_mfma_f32_32x32x16_bf16 v[232:247], a[236:239], a[40:43], v[232:247]
  ds_read_b128 a[4:7], v12 offset:24576
  s_sub_u32 s12, s95, 6
  s_waitcnt lgkmcnt(3)
  v_mfma_f32_32x32x16_bf16 v[184:199], a[240:243], a[44:47], v[184:199]
  ds_read_b128 a[8:11], v12 offset:28672
  s_min_u32 s95, s95, s12
  v_mfma_f32_32x32x16_bf16 v[200:215], a[240:243], a[48:51], v[200:215]
  ds_read_b128 a[12:15], v13 offset:16384
  s_mul_i32 s95, s95, 0x10000
  v_mfma_f32_32x32x16_bf16 v[216:231], a[240:243], a[52:55], v[216:231]
  ds_read_b128 a[16:19], v13 offset:20480
  v_mfma_f32_32x32x16_bf16 v[232:247], a[240:243], a[56:59], v[232:247]
  ds_read_b128 a[20:23], v13 offset:24576
  s_add_u32 s95, s95, s81
  s_waitcnt lgkmcnt(3)
  v_mfma_f32_32x32x16_bf16 v[184:199], a[244:247], a[60:63], v[184:199]
  ds_read_b128 a[24:27], v13 offset:28672
  buffer_load_dwordx4 v2, s[56:59], s95 offen lds
  v_mfma_f32_32x32x16_bf16 v[200:215], a[244:247], a[0:3], v[200:215]
  ds_read_b128 a[28:31], v14 offset:16384
  buffer_load_dwordx4 v3, s[56:59], s95 offen offset:1024 lds
  v_mfma_f32_32x32x16_bf16 v[216:231], a[244:247], a[4:7], v[216:231]
  ds_read_b128 a[32:35], v14 offset:20480
  ds_read_b128 a[36:39], v14 offset:24576
  ds_read_b128 a[40:43], v14 offset:28672
  buffer_load_dwordx4 v4, s[56:59], s95 offen offset:2048 lds
  v_mfma_f32_32x32x16_bf16 v[232:247], a[244:247], a[8:11], v[232:247]
  buffer_load_dwordx4 v5, s[56:59], s95 offen offset:3072 lds
  s_waitcnt lgkmcnt(4)
  v_mfma_f32_32x32x16_bf16 v[184:199], a[248:251], a[12:15], v[184:199]
  s_waitcnt lgkmcnt(0)
  s_barrier
  v_mfma_f32_32x32x16_bf16 v[200:215], a[248:251], a[16:19], v[200:215]
  ds_read_b128 a[44:47], v11 offset:36864
  v_mfma_f32_32x32x16_bf16 v[216:231], a[248:251], a[20:23], v[216:231]
  ds_read_b128 a[48:51], v11 offset:40960
  s_add_u32 m0, s72, 0x10000
  v_mfma_f32_32x32x16_bf16 v[232:247], a[248:251], a[24:27], v[232:247]
  ds_read_b128 a[52:55], v11 offset:45056
  ds_read_b128 a[224:227], v11 offset:32768
  s_add_u32 s95, s101, 2
  v_mfma_f32_32x32x16_bf16 v[184:199], a[252:255], a[28:31], v[184:199]
  ds_read_b128 a[56:59], v12 offset:36864
  s_sub_u32 s12, s95, 6
  v_mfma_f32_32x32x16_bf16 v[200:215], a[252:255], a[32:35], v[200:215]
  ds_read_b128 a[60:63], v12 offset:40960
  s_min_u32 s95, s95, s12
  v_mfma_f32_32x32x16_bf16 v[216:231], a[252:255], a[36:39], v[216:231]
  ds_read_b128 a[0:3], v12 offset:45056
  ds_read_b128 a[228:231], v12 offset:32768
  s_mul_i32 s95, s95, 0x10000
  v_mfma_f32_32x32x16_bf16 v[232:247], a[252:255], a[40:43], v[232:247]
  ds_read_b128 a[4:7], v13 offset:36864
  s_waitcnt lgkmcnt(4)
  v_mfma_f32_32x32x16_bf16 v[200:215], a[64:67], a[44:47], v[200:215]
  ds_read_b128 a[8:11], v13 offset:40960
  s_add_u32 s95, s95, s81
  v_mfma_f32_32x32x16_bf16 v[216:231], a[64:67], a[48:51], v[216:231]
  ds_read_b128 a[12:15], v13 offset:45056
  ds_read_b128 a[232:235], v13 offset:32768
  buffer_load_dwordx4 v2, s[56:59], s95 offen lds
  v_mfma_f32_32x32x16_bf16 v[232:247], a[64:67], a[52:55], v[232:247]
  ds_read_b128 a[16:19], v14 offset:36864
  buffer_load_dwordx4 v3, s[56:59], s95 offen offset:1024 lds
  v_mfma_f32_32x32x16_bf16 v[200:215], a[68:71], a[56:59], v[200:215]
  ds_read_b128 a[20:23], v14 offset:40960
  buffer_load_dwordx4 v4, s[56:59], s95 offen offset:2048 lds
  s_waitcnt lgkmcnt(4)
  v_mfma_f32_32x32x16_bf16 v[216:231], a[68:71], a[60:63], v[216:231]
  ds_read_b128 a[24:27], v14 offset:45056
  ds_read_b128 a[236:239], v14 offset:32768
  buffer_load_dwordx4 v5, s[56:59], s95 offen offset:3072 lds
  v_mfma_f32_32x32x16_bf16 v[232:247], a[68:71], a[0:3], v[232:247]
  ds_read_b128 a[28:31], v11 offset:53248
  v_mfma_f32_32x32x16_bf16 v[200:215], a[72:75], a[4:7], v[200:215]
  ds_read_b128 a[32:35], v11 offset:57344
  v_mfma_f32_32x32x16_bf16 v[216:231], a[72:75], a[8:11], v[216:231]
  ds_read_b128 a[36:39], v11 offset:61440
  ds_read_b128 a[240:243], v11 offset:49152
  buffer_load_dwordx2 v[36:37], v31, s[60:63], 0 offen sc1
  s_waitcnt lgkmcnt(4)
  v_mfma_f32_32x32x16_bf16 v[232:247], a[72:75], a[12:15], v[232:247]
  ds_read_b128 a[40:43], v12 offset:53248
  s_mov_b32 s94, 0x3f80
  s_mov_b32 s99, 0x3f800000
  v_mfma_f32_32x32x16_bf16 v[200:215], a[76:79], a[16:19], v[200:215]
  ds_read_b128 a[44:47], v12 offset:57344
  s_waitcnt vmcnt(18)
  v_dot2c_f32_bf16 v184, s94, v124
  v_dot2c_f32_bf16 v185, s99, v124
  v_mfma_f32_32x32x16_bf16 v[216:231], a[76:79], a[20:23], v[216:231]
  ds_read_b128 a[48:51], v12 offset:61440
  ds_read_b128 a[244:247], v12 offset:49152
  v_dot2c_f32_bf16 v186, s94, v125
  v_dot2c_f32_bf16 v187, s99, v125
  v_mfma_f32_32x32x16_bf16 v[232:247], a[76:79], a[24:27], v[232:247]
  ds_read_b128 a[52:55], v13 offset:53248
  s_waitcnt vmcnt(17)
  v_dot2c_f32_bf16 v188, s94, v126
  v_dot2c_f32_bf16 v189, s99, v126
  s_waitcnt lgkmcnt(4)
  v_mfma_f32_32x32x16_bf16 v[200:215], a[80:83], a[28:31], v[200:215]
  ds_read_b128 a[56:59], v13 offset:57344
  v_dot2c_f32_bf16 v190, s94, v127
  v_dot2c_f32_bf16 v191, s99, v127
  v_mfma_f32_32x32x16_bf16 v[216:231], a[80:83], a[32:35], v[216:231]
  ds_read_b128 a[60:63], v13 offset:61440
  ds_read_b128 a[248:251], v13 offset:49152
  s_waitcnt vmcnt(16)
  v_dot2c_f32_bf16 v192, s94, v128
  v_dot2c_f32_bf16 v193, s99, v128
  v_mfma_f32_32x32x16_bf16 v[232:247], a[80:83], a[36:39], v[232:247]
  ds_read_b128 a[0:3], v14 offset:53248
  ds_read_b128 a[4:7], v14 offset:57344
  ds_read_b128 a[8:11], v14 offset:61440
  ds_read_b128 a[252:255], v14 offset:49152
  v_dot2c_f32_bf16 v194, s94, v129
  v_dot2c_f32_bf16 v195, s99, v129
  v_mfma_f32_32x32x16_bf16 v[200:215], a[84:87], a[40:43], v[200:215]
  s_waitcnt vmcnt(15)
  v_dot2c_f32_bf16 v196, s94, v130
  v_dot2c_f32_bf16 v197, s99, v130
  s_waitcnt lgkmcnt(6)
  v_mfma_f32_32x32x16_bf16 v[216:231], a[84:87], a[44:47], v[216:231]
  v_dot2c_f32_bf16 v198, s94, v131
  v_dot2c_f32_bf16 v199, s99, v131
  s_waitcnt lgkmcnt(0)
  s_barrier
  v_mfma_f32_32x32x16_bf16 v[232:247], a[84:87], a[48:51], v[232:247]
  ds_read_b128 a[12:15], v7 offset:4096
  s_waitcnt vmcnt(0)
  v_cmp_eq_u64 vcc, v[36:37], v[34:35]
  s_nop 0
  s_cmp_eq_u64 vcc, -1
  s_cbranch_scc0 L2_slow_kh
L2_res_kh:
  s_add_u32 m0, s72, 0xc000
  s_add_u32 s95, s101, 0
  s_sub_u32 s12, s95, 6
  v_lshl_add_u32 v81, v82, 3, v81
  v_mfma_f32_32x32x16_bf16 v[200:215], a[88:91], a[52:55], v[200:215]
  ds_read_b128 a[16:19], v7 offset:8192
  s_min_u32 s95, s95, s12
  s_mul_i32 s95, s95, 0x1000
  s_add_u32 s95, s95, s82
  buffer_load_dwordx4 v1, s[60:63], s95 offen sc1 lds
  v_mfma_f32_32x32x16_bf16 v[216:231], a[88:91], a[56:59], v[216:231]
  ds_read_b128 a[20:23], v7 offset:12288
  ds_read_b128 a[192:195], v7
  buffer_load_dwordx4 v1, s[60:63], s95 offen offset:1024 sc1 lds
  buffer_load_dwordx4 v1, s[60:63], s95 offen offset:2048 sc1 lds
  buffer_load_dwordx4 v1, s[60:63], s95 offen offset:3072 sc1 lds
  s_add_u32 m0, s72, 0x24000
  v_mfma_f32_32x32x16_bf16 v[232:247], a[88:91], a[60:63], v[232:247]
  ds_read_b128 a[24:27], v8 offset:4096
  s_add_u32 s95, s101, 1
  s_sub_u32 s12, s95, 6
  s_min_u32 s95, s95, s12
  s_mul_i32 s95, s95, 0x1000
  v_mfma_f32_32x32x16_bf16 v[200:215], a[92:95], a[0:3], v[200:215]
  ds_read_b128 a[28:31], v8 offset:8192
  s_add_u32 s95, s95, s82
  buffer_load_dwordx4 v1, s[60:63], s95 offen sc1 lds
  buffer_load_dwordx4 v1, s[60:63], s95 offen offset:1024 sc1 lds
  buffer_load_dwordx4 v1, s[60:63], s95 offen offset:2048 sc1 lds
  v_mfma_f32_32x32x16_bf16 v[216:231], a[92:95], a[4:7], v[216:231]
  ds_read_b128 a[32:35], v8 offset:12288
  ds_read_b128 a[196:199], v8
  buffer_load_dwordx4 v1, s[60:63], s95 offen offset:3072 sc1 lds
  v_mfma_f32_32x32x16_bf16 v[232:247], a[92:95], a[8:11], v[232:247]
  ds_read_b128 a[36:39], v9 offset:4096
  s_waitcnt lgkmcnt(4)
  v_mfma_f32_32x32x16_bf16 v[200:215], a[96:99], a[12:15], v[200:215]
  ds_read_b128 a[40:43], v9 offset:8192
  v_mfma_f32_32x32x16_bf16 v[216:231], a[96:99], a[16:19], v[216:231]
  ds_read_b128 a[44:47], v9 offset:12288
  ds_read_b128 a[200:203], v9
  v_mfma_f32_32x32x16_bf16 v[232:247], a[96:99], a[20:23], v[232:247]
  ds_read_b128 a[48:51], v10 offset:4096
  v_mfma_f32_32x32x16_bf16 v[200:215], a[100:103], a[24:27], v[200:215]
  ds_read_b128 a[52:55], v10 offset:8192
  s_waitcnt lgkmcnt(4)
  v_mfma_f32_32x32x16_bf16 v[216:231], a[100:103], a[28:31], v[216:231]
  ds_read_b128 a[56:59], v10 offset:12288
  ds_read_b128 a[204:207], v10
  v_mfma_f32_32x32x16_bf16 v[232:247], a[100:103], a[32:35], v[232:247]
  ds_read_b128 a[60:63], v7 offset:20480
  v_mfma_f32_32x32x16_bf16 v[200:215], a[104:107], a[36:39], v[200:215]
  ds_read_b128 a[0:3], v7 offset:24576
  s_add_u32 m0, s72, 0x14000
  s_add_u32 s95, s101, 2
  s_sub_u32 s12, s95, 6
  v_mfma_f32_32x32x16_bf16 v[216:231], a[104:107], a[40:43], v[216:231]
  ds_read_b128 a[4:7], v7 offset:28672
  ds_read_b128 a[208:211], v7 offset:16384
  s_min_u32 s95, s95, s12
  s_mul_i32 s95, s95, 0x1000
  s_add_u32 s95, s95, s82
  s_waitcnt lgkmcnt(4)
  v_mfma_f32_32x32x16_bf16 v[232:247], a[104:107], a[44:47], v[232:247]
  ds_read_b128 a[8:11], v8 offset:20480
  buffer_load_dwordx4 v1, s[60:63], s95 offen sc1 lds
  buffer_load_dwordx4 v1, s[60:63], s95 offen offset:1024 sc1 lds
  buffer_load_dwordx4 v1, s[60:63], s95 offen offset:2048 sc1 lds
  v_mfma_f32_32x32x16_bf16 v[200:215], a[108:111], a[48:51], v[200:215]
  ds_read_b128 a[12:15], v8 offset:24576
  buffer_load_dwordx4 v1, s[60:63], s95 offen offset:3072 sc1 lds
  s_add_u32 m0, s72, 0x18000
  s_add_u32 s95, s101, 3
  v_mfma_f32_32x32x16_bf16 v[216:231], a[108:111], a[52:55], v[216:231]
  ds_read_b128 a[16:19], v8 offset:28672
  ds_read_b128 a[212:215], v8 offset:16384
  s_sub_u32 s12, s95, 6
  s_min_u32 s95, s95, s12
  s_mul_i32 s95, s95, 0x10000
  v_mfma_f32_32x32x16_bf16 v[232:247], a[108:111], a[56:59], v[232:247]
  ds_read_b128 a[20:23], v9 offset:20480
  s_add_u32 s95, s95, s81
  buffer_load_dwordx4 v2, s[56:59], s95 offen lds
  buffer_load_dwordx4 v3, s[56:59], s95 offen offset:1024 lds
  s_waitcnt lgkmcnt(4)
  v_mfma_f32_32x32x16_bf16 v[200:215], a[112:115], a[60:63], v[200:215]
  ds_read_b128 a[24:27], v9 offset:24576
  buffer_load_dwordx4 v4, s[56:59], s95 offen offset:2048 lds
  buffer_load_dwordx4 v5, s[56:59], s95 offen offset:3072 lds
  s_add_u32 m0, s72, 0x1c000
  v_mfma_f32_32x32x16_bf16 v[216:231], a[112:115], a[0:3], v[216:231]
  ds_read_b128 a[28:31], v9 offset:28672
  ds_read_b128 a[216:219], v9 offset:16384
  s_add_u32 s95, s101, 3
  s_sub_u32 s12, s95, 6
  s_min_u32 s95, s95, s12
  v_mfma_f32_32x32x16_bf16 v[232:247], a[112:115], a[4:7], v[232:247]
  ds_read_b128 a[32:35], v10 offset:20480
  ds_read_b128 a[36:39], v10 offset:24576
  ds_read_b128 a[40:43], v10 offset:28672
  ds_read_b128 a[220:223], v10 offset:16384
  s_mul_i32 s95, s95, 0x1000
  s_add_u32 s95, s95, s82
  buffer_load_dwordx4 v1, s[60:63], s95 offen sc1 lds
  v_mfma_f32_32x32x16_bf16 v[200:215], a[116:119], a[8:11], v[200:215]
  buffer_load_dwordx4 v1, s[60:63], s95 offen offset:1024 sc1 lds
  buffer_load_dwordx4 v1, s[60:63], s95 offen offset:2048 sc1 lds
  buffer_load_dwordx4 v1, s[60:63], s95 offen offset:3072 sc1 lds
  s_waitcnt lgkmcnt(6)
  v_mfma_f32_32x32x16_bf16 v[216:231], a[116:119], a[12:15], v[216:231]
  s_waitcnt vmcnt(16) lgkmcnt(0)
  s_barrier
  v_mfma_f32_32x32x16_bf16 v[232:247], a[116:119], a[16:19], v[232:247]
  ds_read_b64_tr_b16 a[44:45], v72 offset:32768
  ds_read_b64_tr_b16 a[46:47], v72 offset:33792
  ds_read_b128 a[48:51], v75 offset:49152
  s_add_u32 m0, s72, 0
  v_mfma_f32_32x32x16_bf16 v[200:215], a[120:123], a[20:23], v[200:215]
  ds_read_b128 a[52:55], v75 offset:53248
  s_add_u32 s95, s101, 4
  v_mfma_f32_32x32x16_bf16 v[216:231], a[120:123], a[24:27], v[216:231]
  ds_read_b128 a[56:59], v75 offset:57344
  s_sub_u32 s12, s95, 6
  v_mfma_f32_32x32x16_bf16 v[232:247], a[120:123], a[28:31], v[232:247]
  ds_read_b128 a[60:63], v75 offset:61440
  s_min_u32 s95, s95, s12
  s_mul_i32 s95, s95, 0x10000
  v_mfma_f32_32x32x16_bf16 v[200:215], a[124:127], a[32:35], v[200:215]
  ds_read_b64_tr_b16 a[0:1], v72 offset:34816
  ds_read_b64_tr_b16 a[2:3], v72 offset:35840
  ds_read_b128 a[4:7], v75 offset:50176
  s_add_u32 s95, s95, s81
  v_mfma_f32_32x32x16_bf16 v[216:231], a[124:127], a[36:39], v[216:231]
  ds_read_b128 a[8:11], v75 offset:54272
  buffer_load_dwordx4 v2, s[56:59], s95 offen lds
  v_mfma_f32_32x32x16_bf16 v[232:247], a[124:127], a[40:43], v[232:247]
  ds_read_b128 a[12:15], v75 offset:58368
  buffer_load_dwordx4 v3, s[56:59], s95 offen offset:1024 lds
  buffer_load_dwordx4 v4, s[56:59], s95 offen offset:2048 lds
  s_waitcnt lgkmcnt(5)
  v_mfma_f32_32x32x16_bf16 v[184:199], a[44:47], a[48:51], v[184:199]
  ds_read_b128 a[16:19], v75 offset:62464
  buffer_load_dwordx4 v5, s[56:59], s95 offen offset:3072 lds
  v_mfma_f32_32x32x16_bf16 v[200:215], a[44:47], a[52:55], v[200:215]
  ds_read_b64_tr_b16 a[20:21], v72 offset:36864
  ds_read_b64_tr_b16 a[22:23], v72 offset:37888
  ds_read_b128 a[24:27], v75 offset:51200
  s_add_u32 m0, s72, 0x4000
  v_mfma_f32_32x32x16_bf16 v[216:231], a[44:47], a[56:59], v[216:231]
  ds_read_b128 a[28:31], v75 offset:55296
  s_add_u32 s95, s101, 4
  s_sub_u32 s12, s95, 6
  v_mfma_f32_32x32x16_bf16 v[232:247], a[44:47], a[60:63], v[232:247]
  ds_read_b128 a[32:35], v75 offset:59392
  s_min_u32 s95, s95, s12
  s_waitcnt lgkmcnt(5)
  v_mfma_f32_32x32x16_bf16 v[184:199], a[0:3], a[4:7], v[184:199]
  ds_read_b128 a[36:39], v75 offset:63488
  s_mul_i32 s95, s95, 0x1000
  v_mfma_f32_32x32x16_bf16 v[200:215], a[0:3], a[8:11], v[200:215]
  ds_read_b64_tr_b16 a[40:41], v72 offset:38912
  ds_read_b64_tr_b16 a[42:43], v72 offset:39936
  ds_read_b128 a[44:47], v75 offset:52224
  s_add_u32 s95, s95, s82
  buffer_load_dwordx4 v1, s[60:63], s95 offen sc1 lds
  v_mfma_f32_32x32x16_bf16 v[216:231], a[0:3], a[12:15], v[216:231]
  ds_read_b128 a[48:51], v75 offset:56320
  ds_read_b128 a[52:55], v75 offset:60416
  ds_read_b128 a[56:59], v75 offset:64512
  buffer_load_dwordx4 v1, s[60:63], s95 offen offset:1024 sc1 lds
  v_mfma_f32_32x32x16_bf16 v[232:247], a[0:3], a[16:19], v[232:247]
  buffer_load_dwordx4 v1, s[60:63], s95 offen offset:2048 sc1 lds
  s_waitcnt lgkmcnt(6)
  v_mfma_f32_32x32x16_bf16 v[184:199], a[20:23], a[24:27], v[184:199]
  buffer_load_dwordx4 v1, s[60:63], s95 offen offset:3072 sc1 lds
  s_waitcnt vmcnt(20) lgkmcnt(0)
  s_barrier
  v_mfma_f32_32x32x16_bf16 v[200:215], a[20:23], a[28:31], v[200:215]
  ds_read_b64_tr_b16 a[60:61], v74
  ds_read_b64_tr_b16 a[62:63], v74 offset:1024
  ds_read_b128 a[0:3], v77 offset:16384
  s_add_u32 m0, s72, 0x8000
  v_mfma_f32_32x32x16_bf16 v[216:231], a[20:23], a[32:35], v[216:231]
  ds_read_b128 a[4:7], v77 offset:20480
  s_add_u32 s95, s101, 5
  v_mfma_f32_32x32x16_bf16 v[232:247], a[20:23], a[36:39], v[232:247]
  ds_read_b128 a[8:11], v77 offset:24576
  s_sub_u32 s12, s95, 6
  v_mfma_f32_32x32x16_bf16 v[184:199], a[40:43], a[44:47], v[184:199]
  ds_read_b128 a[12:15], v77 offset:28672
  s_min_u32 s95, s95, s12
  s_mul_i32 s95, s95, 0x10000
  v_mfma_f32_32x32x16_bf16 v[200:215], a[40:43], a[48:51], v[200:215]
  ds_read_b64_tr_b16 a[16:17], v74 offset:2048
  ds_read_b64_tr_b16 a[18:19], v74 offset:3072
  ds_read_b128 a[20:23], v77 offset:17408
  s_add_u32 s95, s95, s81
  v_mfma_f32_32x32x16_bf16 v[216:231], a[40:43], a[52:55], v[216:231]
  ds_read_b128 a[24:27], v77 offset:21504
  buffer_load_dwordx4 v2, s[56:59], s95 offen lds
  v_mfma_f32_32x32x16_bf16 v[232:247], a[40:43], a[56:59], v[232:247]
  ds_read_b128 a[28:31], v77 offset:25600
  buffer_load_dwordx4 v3, s[56:59], s95 offen offset:1024 lds
  buffer_load_dwordx4 v4, s[56:59], s95 offen offset:2048 lds
  s_waitcnt lgkmcnt(5)
  v_mfma_f32_32x32x16_bf16 v[184:199], a[60:63], a[0:3], v[184:199]
  ds_read_b128 a[32:35], v77 offset:29696
  buffer_load_dwordx4 v5, s[56:59], s95 offen offset:3072 lds
  v_mfma_f32_32x32x16_bf16 v[200:215], a[60:63], a[4:7], v[200:215]
  ds_read_b64_tr_b16 a[36:37], v74 offset:4096
  ds_read_b64_tr_b16 a[38:39], v74 offset:5120
  ds_read_b128 a[40:43], v77 offset:18432
  s_add_u32 m0, s72, 0xc000
  v_mfma_f32_32x32x16_bf16 v[216:231], a[60:63], a[8:11], v[216:231]
  ds_read_b128 a[44:47], v77 offset:22528
  s_add_u32 s95, s101, 5
  s_sub_u32 s12, s95, 6
  v_mfma_f32_32x32x16_bf16 v[232:247], a[60:63], a[12:15], v[232:247]
  ds_read_b128 a[48:51], v77 offset:26624
  s_min_u32 s95, s95, s12
  s_waitcnt lgkmcnt(5)
  v_mfma_f32_32x32x16_bf16 v[184:199], a[16:19], a[20:23], v[184:199]
  ds_read_b128 a[52:55], v77 offset:30720
  s_mul_i32 s95, s95, 0x1000
  v_mfma_f32_32x32x16_bf16 v[200:215], a[16:19], a[24:27], v[200:215]
  ds_read_b64_tr_b16 a[56:57], v74 offset:6144
  ds_read_b64_tr_b16 a[58:59], v74 offset:7168
  ds_read_b128 a[60:63], v77 offset:19456
  s_add_u32 s95, s95, s82
  buffer_load_dwordx4 v1, s[60:63], s95 offen sc1 lds
  v_mfma_f32_32x32x16_bf16 v[216:231], a[16:19], a[28:31], v[216:231]
  ds_read_b128 a[0:3], v77 offset:23552
  ds_read_b128 a[4:7], v77 offset:27648
  ds_read_b128 a[8:11], v77 offset:31744
  buffer_load_dwordx4 v1, s[60:63], s95 offen offset:1024 sc1 lds
  v_mfma_f32_32x32x16_bf16 v[232:247], a[16:19], a[32:35], v[232:247]
  buffer_load_dwordx4 v1, s[60:63], s95 offen offset:2048 sc1 lds
  s_waitcnt lgkmcnt(6)
  v_mfma_f32_32x32x16_bf16 v[184:199], a[36:39], a[40:43], v[184:199]
  buffer_load_dwordx4 v1, s[60:63], s95 offen offset:3072 sc1 lds
  s_waitcnt vmcnt(24) lgkmcnt(0)
  s_barrier
  v_mfma_f32_32x32x16_bf16 v[200:215], a[36:39], a[44:47], v[200:215]
  ds_read_b64_tr_b16 a[160:161], v73
  ds_read_b64_tr_b16 a[162:163], v73 offset:1024
  ds_read_b128 a[12:15], v76 offset:20480
  v_mfma_f32_32x32x16_bf16 v[216:231], a[36:39], a[48:51], v[216:231]
  ds_read_b128 a[16:19], v76 offset:24576
  s_mul_i32 s12, s3, 0x1000
  v_mfma_f32_32x32x16_bf16 v[232:247], a[36:39], a[52:55], v[232:247]
  ds_read_b128 a[20:23], v76 offset:28672
  ds_read_b128 a[176:179], v76 offset:16384
  s_add_u32 m0, s12, 0x20000
  v_mfma_f32_32x32x16_bf16 v[184:199], a[56:59], a[60:63], v[184:199]
  ds_read_b64_tr_b16 a[164:165], v73 offset:2048
  ds_read_b64_tr_b16 a[166:167], v73 offset:3072
  ds_read_b128 a[24:27], v76 offset:21504
  s_add_u32 s95, s17, 0
  v_mfma_f32_32x32x16_bf16 v[200:215], a[56:59], a[0:3], v[200:215]
  ds_read_b128 a[28:31], v76 offset:25600
  v_mfma_f32_32x32x16_bf16 v[216:231], a[56:59], a[4:7], v[216:231]
  ds_read_b128 a[32:35], v76 offset:29696
  ds_read_b128 a[180:183], v76 offset:17408
  buffer_load_dwordx4 v1, s[60:63], s95 offen sc1 lds
  v_mfma_f32_32x32x16_bf16 v[232:247], a[56:59], a[8:11], v[232:247]
  ds_read_b64_tr_b16 a[168:169], v73 offset:4096
  ds_read_b64_tr_b16 a[170:171], v73 offset:5120
  ds_read_b128 a[36:39], v76 offset:22528
  buffer_load_dwordx4 v1, s[60:63], s95 offen offset:1024 sc1 lds
  s_waitcnt lgkmcnt(6)
  v_mfma_f32_32x32x16_bf16 v[200:215], a[160:163], a[12:15], v[200:215]
  ds_read_b128 a[40:43], v76 offset:26624
  buffer_load_dwordx4 v1, s[60:63], s95 offen offset:2048 sc1 lds
  v_mfma_f32_32x32x16_bf16 v[216:231], a[160:163], a[16:19], v[216:231]
  ds_read_b128 a[44:47], v76 offset:30720
  ds_read_b128 a[184:187], v76 offset:18432
  v_mfma_f32_32x32x16_bf16 v[232:247], a[160:163], a[20:23], v[232:247]
  ds_read_b64_tr_b16 a[172:173], v73 offset:6144
  ds_read_b64_tr_b16 a[174:175], v73 offset:7168
  ds_read_b128 a[48:51], v76 offset:23552
  ds_read_b128 a[52:55], v76 offset:27648
  ds_read_b128 a[56:59], v76 offset:31744
  ds_read_b128 a[188:191], v76 offset:19456
  buffer_load_dwordx4 v1, s[60:63], s95 offen offset:3072 sc1 lds
  v_mfma_f32_32x32x16_bf16 v[200:215], a[164:167], a[24:27], v[200:215]
  s_waitcnt lgkmcnt(8)
  v_mfma_f32_32x32x16_bf16 v[216:231], a[164:167], a[28:31], v[216:231]
  s_waitcnt vmcnt(20) lgkmcnt(0)
  s_barrier
  v_mfma_f32_32x32x16_bf16 v[232:247], a[164:167], a[32:35], v[232:247]
  ds_read_b64_tr_b16 v[148:149], v73 offset:32768
  ds_read_b64_tr_b16 v[150:151], v73 offset:33792
  ds_read_b128 a[60:63], v76 offset:53248
  s_add_u32 m0, s72, 0x10000
  v_mfma_f32_32x32x16_bf16 v[200:215], a[168:171], a[36:39], v[200:215]
  ds_read_b128 a[0:3], v76 offset:57344
  s_add_u32 s95, s16, 0
  v_mfma_f32_32x32x16_bf16 v[216:231], a[168:171], a[40:43], v[216:231]
  ds_read_b128 a[4:7], v76 offset:61440
  ds_read_b128 v[164:167], v76 offset:49152
  buffer_load_dwordx4 v2, s[56:59], s95 offen lds
  v_mfma_f32_32x32x16_bf16 v[232:247], a[168:171], a[44:47], v[232:247]
  ds_read_b64_tr_b16 v[152:153], v73 offset:34816
  ds_read_b64_tr_b16 v[154:155], v73 offset:35840
  ds_read_b128 a[8:11], v76 offset:54272
  buffer_load_dwordx4 v3, s[56:59], s95 offen offset:1024 lds
  v_mfma_f32_32x32x16_bf16 v[200:215], a[172:175], a[48:51], v[200:215]
  ds_read_b128 a[12:15], v76 offset:58368
  buffer_load_dwordx4 v4, s[56:59], s95 offen offset:2048 lds
  v_mfma_f32_32x32x16_bf16 v[216:231], a[172:175], a[52:55], v[216:231]
  ds_read_b128 a[16:19], v76 offset:62464
  ds_read_b128 v[168:171], v76 offset:50176
  buffer_load_dwordx4 v5, s[56:59], s95 offen offset:3072 lds
  v_mfma_f32_32x32x16_bf16 v[232:247], a[172:175], a[56:59], v[232:247]
  ds_read_b64_tr_b16 v[156:157], v73 offset:36864
  ds_read_b64_tr_b16 v[158:159], v73 offset:37888
  ds_read_b128 a[20:23], v76 offset:55296
  s_add_u32 m0, s72, 0x14000
  s_waitcnt lgkmcnt(6)
  v_mfma_f32_32x32x16_bf16 v[200:215], v[148:151], a[60:63], v[200:215]
  ds_read_b128 a[24:27], v76 offset:59392
  s_add_u32 s95, s16, 0x10000
  v_mfma_f32_32x32x16_bf16 v[216:231], v[148:151], a[0:3], v[216:231]
  ds_read_b128 a[28:31], v76 offset:63488
  ds_read_b128 v[172:175], v76 offset:51200
  buffer_load_dwordx4 v2, s[56:59], s95 offen lds
  v_mfma_f32_32x32x16_bf16 v[232:247], v[148:151], a[4:7], v[232:247]
  ds_read_b64_tr_b16 v[160:161], v73 offset:38912
  ds_read_b64_tr_b16 v[162:163], v73 offset:39936
  ds_read_b128 a[32:35], v76 offset:56320
  ds_read_b128 a[36:39], v76 offset:60416
  ds_read_b128 a[40:43], v76 offset:64512
  ds_read_b128 v[176:179], v76 offset:52224
  buffer_load_dwordx4 v3, s[56:59], s95 offen offset:1024 lds
  v_mfma_f32_32x32x16_bf16 v[200:215], v[152:155], a[8:11], v[200:215]
  buffer_load_dwordx4 v4, s[56:59], s95 offen offset:2048 lds
  s_waitcnt lgkmcnt(8)
  v_mfma_f32_32x32x16_bf16 v[216:231], v[152:155], a[12:15], v[216:231]
  buffer_load_dwordx4 v5, s[56:59], s95 offen offset:3072 lds
  s_waitcnt vmcnt(20) lgkmcnt(0)
  s_barrier
  v_mfma_f32_32x32x16_bf16 v[232:247], v[152:155], a[16:19], v[232:247]
  ds_read_b64_tr_b16 v[84:85], v72
  ds_read_b64_tr_b16 v[86:87], v72 offset:1024
  ds_read_b128 a[44:47], v75 offset:20480
  v_mfma_f32_32x32x16_bf16 v[200:215], v[156:159], a[20:23], v[200:215]
  ds_read_b128 a[48:51], v75 offset:24576
  s_add_u32 m0, s72, 0x18000
  v_mfma_f32_32x32x16_bf16 v[216:231], v[156:159], a[24:27], v[216:231]
  ds_read_b128 a[52:55], v75 offset:28672
  ds_read_b128 v[52:55], v75 offset:16384
  s_add_u32 s95, s16, 0x20000
  v_mfma_f32_32x32x16_bf16 v[232:247], v[156:159], a[28:31], v[232:247]
  ds_read_b64_tr_b16 v[88:89], v72 offset:2048
  ds_read_b64_tr_b16 v[90:91], v72 offset:3072
  ds_read_b128 a[56:59], v75 offset:21504
  buffer_load_dwordx4 v2, s[56:59], s95 offen lds
  v_mfma_f32_32x32x16_bf16 v[200:215], v[160:163], a[32:35], v[200:215]
  ds_read_b128 a[60:63], v75 offset:25600
  v_mfma_f32_32x32x16_bf16 v[216:231], v[160:163], a[36:39], v[216:231]
  ds_read_b128 a[0:3], v75 offset:29696
  ds_read_b128 v[56:59], v75 offset:17408
  buffer_load_dwordx4 v3, s[56:59], s95 offen offset:1024 lds
  v_mfma_f32_32x32x16_bf16 v[232:247], v[160:163], a[40:43], v[232:247]
  ds_read_b64_tr_b16 v[92:93], v72 offset:4096
  ds_read_b64_tr_b16 v[94:95], v72 offset:5120
  ds_read_b128 a[4:7], v75 offset:22528
  buffer_load_dwordx4 v4, s[56:59], s95 offen offset:2048 lds
  s_waitcnt lgkmcnt(6)
  v_mfma_f32_32x32x16_bf16 v[200:215], v[84:87], a[44:47], v[200:215]
  ds_read_b128 a[8:11], v75 offset:26624
  buffer_load_dwordx4 v5, s[56:59], s95 offen offset:3072 lds
  v_mfma_f32_32x32x16_bf16 v[216:231], v[84:87], a[48:51], v[216:231]
  ds_read_b128 a[12:15], v75 offset:30720
  ds_read_b128 v[248:251], v75 offset:18432
  v_mfma_f32_32x32x16_bf16 v[232:247], v[84:87], a[52:55], v[232:247]
  ds_read_b64_tr_b16 v[96:97], v72 offset:6144
  ds_read_b64_tr_b16 v[98:99], v72 offset:7168
  ds_read_b128 a[16:19], v75 offset:23552
  ds_read_b128 a[20:23], v75 offset:27648
  ds_read_b128 a[24:27], v75 offset:31744
  ds_read_b128 v[252:255], v75 offset:19456
  s_add_u32 m0, s72, 0x1c000
  v_mfma_f32_32x32x16_bf16 v[200:215], v[88:91], a[56:59], v[200:215]
  s_add_u32 s95, s16, 0x30000
  s_waitcnt lgkmcnt(8)
  v_mfma_f32_32x32x16_bf16 v[216:231], v[88:91], a[60:63], v[216:231]
  buffer_load_dwordx4 v2, s[56:59], s95 offen lds
  s_waitcnt vmcnt(17) lgkmcnt(0)
  s_barrier
  v_mfma_f32_32x32x16_bf16 v[232:247], v[88:91], a[0:3], v[232:247]
  ds_read_b64_tr_b16 v[132:133], v72 offset:32768
  ds_read_b64_tr_b16 v[134:135], v72 offset:33792
  ds_read_b128 a[28:31], v75 offset:53248
  v_mfma_f32_32x32x16_bf16 v[200:215], v[92:95], a[4:7], v[200:215]
  ds_read_b64_tr_b16 v[136:137], v72 offset:34816
  ds_read_b64_tr_b16 v[138:139], v72 offset:35840
  ds_read_b128 a[32:35], v75 offset:54272
  buffer_load_dwordx4 v3, s[56:59], s95 offen offset:1024 lds
  v_mfma_f32_32x32x16_bf16 v[216:231], v[92:95], a[8:11], v[216:231]
  ds_read_b64_tr_b16 v[140:141], v72 offset:36864
  ds_read_b64_tr_b16 v[142:143], v72 offset:37888
  ds_read_b128 a[36:39], v75 offset:55296
  buffer_load_dwordx4 v4, s[56:59], s95 offen offset:2048 lds
  v_mfma_f32_32x32x16_bf16 v[232:247], v[92:95], a[12:15], v[232:247]
  ds_read_b64_tr_b16 v[144:145], v72 offset:38912
  ds_read_b64_tr_b16 v[146:147], v72 offset:39936
  ds_read_b128 a[40:43], v75 offset:56320
  buffer_load_dwordx4 v5, s[56:59], s95 offen offset:3072 lds
  v_mfma_f32_32x32x16_bf16 v[200:215], v[96:99], a[16:19], v[200:215]
  ds_read_b128 a[44:47], v75 offset:57344
  v_mfma_f32_32x32x16_bf16 v[216:231], v[96:99], a[20:23], v[216:231]
  ds_read_b128 a[48:51], v75 offset:58368
  v_mfma_f32_32x32x16_bf16 v[232:247], v[96:99], a[24:27], v[232:247]
  ds_read_b128 a[52:55], v75 offset:59392
  s_waitcnt lgkmcnt(3)
  v_mfma_f32_32x32x16_bf16 v[200:215], v[132:135], a[28:31], v[200:215]
  ds_read_b128 a[56:59], v75 offset:60416
  v_mfma_f32_32x32x16_bf16 v[200:215], v[136:139], a[32:35], v[200:215]
  ds_read_b128 a[60:63], v75 offset:61440
  v_mfma_f32_32x32x16_bf16 v[200:215], v[140:143], a[36:39], v[200:215]
  ds_read_b128 a[0:3], v75 offset:62464
  v_mfma_f32_32x32x16_bf16 v[200:215], v[144:147], a[40:43], v[200:215]
  ds_read_b128 a[4:7], v75 offset:63488
  s_waitcnt lgkmcnt(3)
  v_mfma_f32_32x32x16_bf16 v[216:231], v[132:135], a[44:47], v[216:231]
  ds_read_b128 a[8:11], v75 offset:64512
  v_mfma_f32_32x32x16_bf16 v[216:231], v[136:139], a[48:51], v[216:231]
  ds_read_b128 a[12:15], v75 offset:49152
  v_mfma_f32_32x32x16_bf16 v[216:231], v[140:143], a[52:55], v[216:231]
  ds_read_b128 a[16:19], v75 offset:50176
  s_xor_b32 s8, s6, 1
  s_lshl_b32 s8, s8, 13
  s_add_u32 s8, s8, s87
  s_nop 0
  v_cvt_pk_bf16_f32 v100, v200, v201
  v_cvt_pk_bf16_f32 v101, v202, v203
  v_cvt_pk_bf16_f32 v102, v204, v205
  v_cvt_pk_bf16_f32 v103, v206, v207
  buffer_store_dwordx4 v[100:103], v1, s[60:63], s8 offen sc1
  v_mfma_f32_32x32x16_bf16 v[216:231], v[144:147], a[56:59], v[216:231]
  ds_read_b128 a[20:23], v75 offset:51200
  v_cvt_pk_bf16_f32 v104, v208, v209
  v_cvt_pk_bf16_f32 v105, v210, v211
  v_cvt_pk_bf16_f32 v106, v212, v213
  v_cvt_pk_bf16_f32 v107, v214, v215
  buffer_store_dwordx4 v[104:107], v1, s[60:63], s8 offen offset:1024 sc1
  s_waitcnt lgkmcnt(3)
  v_mfma_f32_32x32x16_bf16 v[232:247], v[132:135], a[60:63], v[232:247]
  ds_read_b128 a[24:27], v75 offset:52224
  v_mfma_f32_32x32x16_bf16 v[232:247], v[136:139], a[0:3], v[232:247]
  v_mfma_f32_32x32x16_bf16 v[232:247], v[140:143], a[4:7], v[232:247]
  s_xor_b32 s8, s6, 2
  s_lshl_b32 s8, s8, 13
  s_add_u32 s8, s8, s87
  v_cvt_pk_bf16_f32 v108, v216, v217
  v_cvt_pk_bf16_f32 v109, v218, v219
  v_cvt_pk_bf16_f32 v110, v220, v221
  v_cvt_pk_bf16_f32 v111, v222, v223
  buffer_store_dwordx4 v[108:111], v1, s[60:63], s8 offen sc1
  v_mfma_f32_32x32x16_bf16 v[232:247], v[144:147], a[8:11], v[232:247]
  v_cvt_pk_bf16_f32 v112, v224, v225
  v_cvt_pk_bf16_f32 v113, v226, v227
  v_cvt_pk_bf16_f32 v114, v228, v229
  v_cvt_pk_bf16_f32 v115, v230, v231
  buffer_store_dwordx4 v[112:115], v1, s[60:63], s8 offen offset:1024 sc1
  s_waitcnt lgkmcnt(0)
  v_mfma_f32_32x32x16_bf16 v[184:199], v[132:135], a[12:15], v[184:199]
  v_mfma_f32_32x32x16_bf16 v[184:199], v[136:139], a[16:19], v[184:199]
  v_mfma_f32_32x32x16_bf16 v[184:199], v[140:143], a[20:23], v[184:199]
  s_xor_b32 s8, s6, 3
  s_lshl_b32 s8, s8, 13
  s_add_u32 s8, s8, s87
  v_cvt_pk_bf16_f32 v116, v232, v233
  v_cvt_pk_bf16_f32 v117, v234, v235
  v_cvt_pk_bf16_f32 v118, v236, v237
  v_cvt_pk_bf16_f32 v119, v238, v239
  buffer_store_dwordx4 v[116:119], v1, s[60:63], s8 offen sc1
  v_mfma_f32_32x32x16_bf16 v[184:199], v[144:147], a[24:27], v[184:199]
  v_cvt_pk_bf16_f32 v120, v240, v241
  v_cvt_pk_bf16_f32 v121, v242, v243
  v_cvt_pk_bf16_f32 v122, v244, v245
  v_cvt_pk_bf16_f32 v123, v246, v247
  buffer_store_dwordx4 v[120:123], v1, s[60:63], s8 offen offset:1024 sc1
  v_mfma_f32_32x32x16_bf16 v[184:199], a[64:67], a[224:227], v[184:199]
  v_mfma_f32_32x32x16_bf16 v[184:199], a[68:71], a[228:231], v[184:199]
  v_mfma_f32_32x32x16_bf16 v[184:199], a[72:75], a[232:235], v[184:199]
  v_mfma_f32_32x32x16_bf16 v[184:199], a[76:79], a[236:239], v[184:199]
  v_mfma_f32_32x32x16_bf16 v[184:199], a[80:83], a[240:243], v[184:199]
  v_mfma_f32_32x32x16_bf16 v[184:199], a[84:87], a[244:247], v[184:199]
  v_mfma_f32_32x32x16_bf16 v[184:199], a[88:91], a[248:251], v[184:199]
  v_mfma_f32_32x32x16_bf16 v[184:199], a[92:95], a[252:255], v[184:199]
  v_mfma_f32_32x32x16_bf16 v[184:199], a[96:99], a[192:195], v[184:199]
  v_mfma_f32_32x32x16_bf16 v[184:199], a[100:103], a[196:199], v[184:199]
  v_mfma_f32_32x32x16_bf16 v[184:199], a[104:107], a[200:203], v[184:199]
  v_mfma_f32_32x32x16_bf16 v[184:199], a[108:111], a[204:207], v[184:199]
  v_mfma_f32_32x32x16_bf16 v[184:199], a[112:115], a[208:211], v[184:199]
  v_mfma_f32_32x32x16_bf16 v[184:199], a[116:119], a[212:215], v[184:199]
  v_mfma_f32_32x32x16_bf16 v[184:199], a[120:123], a[216:219], v[184:199]
  v_mfma_f32_32x32x16_bf16 v[184:199], a[124:127], a[220:223], v[184:199]
  v_mfma_f32_32x32x16_bf16 v[184:199], a[160:163], a[176:179], v[184:199]
  v_mfma_f32_32x32x16_bf16 v[184:199], a[164:167], a[180:183], v[184:199]
  v_mfma_f32_32x32x16_bf16 v[184:199], a[168:171], a[184:187], v[184:199]
  v_mfma_f32_32x32x16_bf16 v[184:199], a[172:175], a[188:191], v[184:199]
  v_mfma_f32_32x32x16_bf16 v[184:199], v[148:151], v[164:167], v[184:199]
  v_mfma_f32_32x32x16_bf16 v[184:199], v[152:155], v[168:171], v[184:199]
  v_mfma_f32_32x32x16_bf16 v[184:199], v[156:159], v[172:175], v[184:199]
  v_mfma_f32_32x32x16_bf16 v[184:199], v[160:163], v[176:179], v[184:199]
  s_waitcnt vmcnt(14)
  s_barrier
  v_mfma_f32_32x32x16_bf16 v[184:199], v[84:87], v[52:55], v[184:199]
  ds_read_b64_tr_b16 a[28:29], v73
  ds_read_b64_tr_b16 a[30:31], v73 offset:1024
  ds_read_b128 a[32:35], v77
  v_mfma_f32_32x32x16_bf16 v[184:199], v[88:91], v[56:59], v[184:199]
  ds_read_b64_tr_b16 a[36:37], v73 offset:2048
  ds_read_b64_tr_b16 a[38:39], v73 offset:3072
  ds_read_b128 a[40:43], v77 offset:1024
  v_mfma_f32_32x32x16_bf16 v[184:199], v[92:95], v[248:251], v[184:199]
  ds_read_b64_tr_b16 a[44:45], v73 offset:4096
  ds_read_b64_tr_b16 a[46:47], v73 offset:5120
  ds_read_b128 a[48:51], v77 offset:2048
  v_mfma_f32_32x32x16_bf16 v[184:199], v[96:99], v[252:255], v[184:199]
  ds_read_b64_tr_b16 a[52:53], v73 offset:6144
  ds_read_b64_tr_b16 a[54:55], v73 offset:7168
  ds_read_b128 a[56:59], v77 offset:3072
  s_waitcnt lgkmcnt(6)
  v_mfma_f32_32x32x16_bf16 v[184:199], a[28:31], a[32:35], v[184:199]
  ds_read_b64_tr_b16 a[60:61], v73 offset:16384
  ds_read_b64_tr_b16 a[62:63], v73 offset:17408
  ds_read_b128 a[0:3], v77 offset:4096
  buffer_load_dwordx4 v[200:203], v1, s[60:63], s90 offen sc1
  buffer_load_dwordx4 v[204:207], v1, s[60:63], s90 offen offset:1024 sc1
  buffer_load_dwordx4 v[208:211], v1, s[60:63], s91 offen sc1
  buffer_load_dwordx4 v[212:215], v1, s[60:63], s91 offen offset:1024 sc1
  buffer_load_dwordx4 v[216:219], v1, s[60:63], s92 offen sc1
  buffer_load_dwordx4 v[220:223], v1, s[60:63], s92 offen offset:1024 sc1
  v_mfma_f32_32x32x16_bf16 v[184:199], a[36:39], a[40:43], v[184:199]
  ds_read_b64_tr_b16 a[4:5], v73 offset:18432
  ds_read_b64_tr_b16 a[6:7], v73 offset:19456
  ds_read_b128 a[8:11], v77 offset:5120
  ds_read_b64_tr_b16 a[12:13], v73 offset:20480
  ds_read_b64_tr_b16 a[14:15], v73 offset:21504
  ds_read_b128 a[16:19], v77 offset:6144
  ds_read_b64_tr_b16 a[20:21], v73 offset:22528
  ds_read_b64_tr_b16 a[22:23], v73 offset:23552
  ds_read_b128 a[24:27], v77 offset:7168
  s_waitcnt lgkmcnt(12)
  v_mfma_f32_32x32x16_bf16 v[184:199], a[44:47], a[48:51], v[184:199]
  v_mfma_f32_32x32x16_bf16 v[184:199], a[52:55], a[56:59], v[184:199]
  s_waitcnt vmcnt(12) lgkmcnt(0)
  s_barrier
  v_mfma_f32_32x32x16_bf16 v[184:199], a[60:63], a[0:3], v[184:199]
  ds_read_b64_tr_b16 a[28:29], v73 offset:32768
  ds_read_b64_tr_b16 a[30:31], v73 offset:33792
  ds_read_b128 a[32:35], v77 offset:8192
  v_mfma_f32_32x32x16_bf16 v[184:199], a[4:7], a[8:11], v[184:199]
  ds_read_b64_tr_b16 a[36:37], v73 offset:34816
  ds_read_b64_tr_b16 a[38:39], v73 offset:35840
  ds_read_b128 a[40:43], v77 offset:9216
  v_mfma_f32_32x32x16_bf16 v[184:199], a[12:15], a[16:19], v[184:199]
  ds_read_b64_tr_b16 a[44:45], v73 offset:36864
  ds_read_b64_tr_b16 a[46:47], v73 offset:37888
  ds_read_b128 a[48:51], v77 offset:10240
  v_mfma_f32_32x32x16_bf16 v[184:199], a[20:23], a[24:27], v[184:199]
  ds_read_b64_tr_b16 a[52:53], v73 offset:38912
  ds_read_b64_tr_b16 a[54:55], v73 offset:39936
  ds_read_b128 a[56:59], v77 offset:11264
  s_waitcnt lgkmcnt(6)
  v_mfma_f32_32x32x16_bf16 v[184:199], a[28:31], a[32:35], v[184:199]
  ds_read_b64_tr_b16 a[60:61], v73 offset:49152
  ds_read_b64_tr_b16 a[62:63], v73 offset:50176
  ds_read_b128 a[0:3], v77 offset:12288
  v_mfma_f32_32x32x16_bf16 v[184:199], a[36:39], a[40:43], v[184:199]
  ds_read_b64_tr_b16 a[4:5], v73 offset:51200
  ds_read_b64_tr_b16 a[6:7], v73 offset:52224
  ds_read_b128 a[8:11], v77 offset:13312
  s_waitcnt lgkmcnt(6)
  v_mfma_f32_32x32x16_bf16 v[184:199], a[44:47], a[48:51], v[184:199]
  ds_read_b64_tr_b16 a[12:13], v73 offset:53248
  ds_read_b64_tr_b16 a[14:15], v73 offset:54272
  ds_read_b128 a[16:19], v77 offset:14336
  v_mfma_f32_32x32x16_bf16 v[184:199], a[52:55], a[56:59], v[184:199]
  ds_read_b64_tr_b16 a[20:21], v73 offset:55296
  ds_read_b64_tr_b16 a[22:23], v73 offset:56320
  ds_read_b128 a[24:27], v77 offset:15360
  s_waitcnt lgkmcnt(6)
  v_mfma_f32_32x32x16_bf16 v[184:199], a[60:63], a[0:3], v[184:199]
  v_mfma_f32_32x32x16_bf16 v[184:199], a[4:7], a[8:11], v[184:199]
  s_waitcnt lgkmcnt(0)
  v_mfma_f32_32x32x16_bf16 v[184:199], a[12:15], a[16:19], v[184:199]
  v_mfma_f32_32x32x16_bf16 v[184:199], a[20:23], a[24:27], v[184:199]
  s_waitcnt vmcnt(5)
  v_max3_u32 v64, v200, v201, v202
  s_waitcnt vmcnt(4)
  v_max3_u32 v65, v203, v204, v205
  v_max3_u32 v64, v64, v206, v207
  s_waitcnt vmcnt(3)
  v_max3_u32 v65, v65, v208, v209
  v_max3_u32 v64, v64, v210, v211
  s_waitcnt vmcnt(2)
  v_max3_u32 v65, v65, v212, v213
  v_max3_u32 v64, v64, v214, v215
  s_waitcnt vmcnt(1)
  v_max3_u32 v65, v65, v216, v217
  v_max3_u32 v64, v64, v218, v219
  s_waitcnt vmcnt(0)
  v_max3_u32 v65, v65, v220, v221
  v_max3_u32 v64, v64, v222, v223
  v_max_u32 v64, v64, v65
  v_cmp_eq_u32 vcc, -1, v64
  s_nop 0
  s_cbranch_vccnz L2_slow_p
L2_res_p:
  v_dot2c_f32_bf16 v184, s94, v200
  v_dot2c_f32_bf16 v185, s99, v200
  v_dot2c_f32_bf16 v186, s94, v201
  v_dot2c_f32_bf16 v187, s99, v201
  v_dot2c_f32_bf16 v188, s94, v202
  v_dot2c_f32_bf16 v189, s99, v202
  v_dot2c_f32_bf16 v190, s94, v203
  v_dot2c_f32_bf16 v191, s99, v203
  v_dot2c_f32_bf16 v192, s94, v204
  v_dot2c_f32_bf16 v193, s99, v204
  v_dot2c_f32_bf16 v194, s94, v205
  v_dot2c_f32_bf16 v195, s99, v205
  v_dot2c_f32_bf16 v196, s94, v206
  v_dot2c_f32_bf16 v197, s99, v206
  v_dot2c_f32_bf16 v198, s94, v207
  v_dot2c_f32_bf16 v199, s99, v207
  v_dot2c_f32_bf16 v184, s94, v208
  v_dot2c_f32_bf16 v185, s99, v208
  v_dot2c_f32_bf16 v186, s94, v209
  v_dot2c_f32_bf16 v187, s99, v209
  v_dot2c_f32_bf16 v188, s94, v210
  v_dot2c_f32_bf16 v189, s99, v210
  v_dot2c_f32_bf16 v190, s94, v211
  v_dot2c_f32_bf16 v191, s99, v211
  v_dot2c_f32_bf16 v192, s94, v212
  v_dot2c_f32_bf16 v193, s99, v212
  v_dot2c_f32_bf16 v194, s94, v213
  v_dot2c_f32_bf16 v195, s99, v213
  v_dot2c_f32_bf16 v196, s94, v214
  v_dot2c_f32_bf16 v197, s99, v214
  v_dot2c_f32_bf16 v198, s94, v215
  v_dot2c_f32_bf16 v199, s99, v215
  v_dot2c_f32_bf16 v184, s94, v216
  v_dot2c_f32_bf16 v185, s99, v216
  v_dot2c_f32_bf16 v186, s94, v217
  v_dot2c_f32_bf16 v187, s99, v217
  v_dot2c_f32_bf16 v188, s94, v218
  v_dot2c_f32_bf16 v189, s99, v218
  v_dot2c_f32_bf16 v190, s94, v219
  v_dot2c_f32_bf16 v191, s99, v219
  v_dot2c_f32_bf16 v192, s94, v220
  v_dot2c_f32_bf16 v193, s99, v220
  v_dot2c_f32_bf16 v194, s94, v221
  v_dot2c_f32_bf16 v195, s99, v221
  v_dot2c_f32_bf16 v196, s94, v222
  v_dot2c_f32_bf16 v197, s99, v222
  v_dot2c_f32_bf16 v198, s94, v223
  v_dot2c_f32_bf16 v199, s99, v223
  v_cvt_pk_bf16_f32 v100, v184, v185
  v_cvt_pk_bf16_f32 v101, v186, v187
  v_cvt_pk_bf16_f32 v102, v188, v189
  v_cvt_pk_bf16_f32 v103, v190, v191
  s_nop 0
  v_permlane32_swap_b32 v100, v102
  v_permlane32_swap_b32 v101, v103
  buffer_store_dwordx4 v[100:103], v81, s[64:67], s93 offen
  v_cvt_pk_bf16_f32 v104, v192, v193
  v_cvt_pk_bf16_f32 v105, v194, v195
  v_cvt_pk_bf16_f32 v106, v196, v197
  v_cvt_pk_bf16_f32 v107, v198, v199
  s_nop 0
  v_permlane32_swap_b32 v104, v106
  v_permlane32_swap_b32 v105, v107
  buffer_store_dwordx4 v[104:107], v81, s[64:67], s93 offen offset:32
  s_endpgm
L2_slow_ka:
  s_mov_b32 s18, 20000
L2_slowl_ka:
  s_sleep 1
  buffer_load_dwordx2 v[36:37], v30, s[60:63], 0 offen sc1
  s_waitcnt vmcnt(0)
  v_cmp_eq_u64 vcc, v[36:37], v[34:35]
  s_nop 1
  s_cmp_eq_u64 vcc, -1
  s_cbranch_scc1 L2_res_ka
  s_sub_u32 s18, s18, 1
  s_cmp_lg_u32 s18, 0
  s_cbranch_scc1 L2_slowl_ka
  s_branch L2_res_ka
L2_slow_kh:
  s_mov_b32 s18, 20000
L2_slowl_kh:
  s_sleep 1
  buffer_load_dwordx2 v[36:37], v31, s[60:63], 0 offen sc1
  s_waitcnt vmcnt(0)
  v_cmp_eq_u64 vcc, v[36:37], v[34:35]
  s_nop 1
  s_cmp_eq_u64 vcc, -1
  s_cbranch_scc1 L2_res_kh
  s_sub_u32 s18, s18, 1
  s_cmp_lg_u32 s18, 0
  s_cbranch_scc1 L2_slowl_kh
  s_branch L2_res_kh
L2_slow_nonce:
  s_mov_b32 s18, 20000
L2_slowl_nonce:
  s_sleep 1
  v_mov_b32 v71, 0
  buffer_load_dwordx2 v[34:35], v71, s[68:71], 0 offen sc1
  s_waitcnt vmcnt(0)
  v_cmp_ne_u32 vcc, 0, v34
  s_nop 1
  s_cmp_eq_u64 vcc, -1
  s_cbranch_scc1 L2_res_nonce
  s_sub_u32 s18, s18, 1
  s_cmp_lg_u32 s18, 0
  s_cbranch_scc1 L2_slowl_nonce
  s_branch L2_res_nonce
L2_slow_p:
  s_mov_b32 s18, 20000
L2_slowl_p:
  buffer_load_dwordx4 v[200:203], v1, s[60:63], s90 offen sc1
  buffer_load_dwordx4 v[204:207], v1, s[60:63], s90 offen offset:1024 sc1
  buffer_load_dwordx4 v[208:211], v1, s[60:63], s91 offen sc1
  buffer_load_dwordx4 v[212:215], v1, s[60:63], s91 offen offset:1024 sc1
  buffer_load_dwordx4 v[216:219], v1, s[60:63], s92 offen sc1
  buffer_load_dwordx4 v[220:223], v1, s[60:63], s92 offen offset:1024 sc1
  s_waitcnt vmcnt(0)
  v_max3_u32 v64, v200, v201, v202
  v_max3_u32 v65, v203, v204, v205
  v_max3_u32 v64, v64, v206, v207
  v_max3_u32 v65, v65, v208, v209
  v_max3_u32 v64, v64, v210, v211
  v_max3_u32 v65, v65, v212, v213
  v_max3_u32 v64, v64, v214, v215
  v_max3_u32 v65, v65, v216, v217
  v_max3_u32 v64, v64, v218, v219
  v_max3_u32 v65, v65, v220, v221
  v_max3_u32 v64, v64, v222, v223
  v_max_u32 v64, v64, v65
  v_cmp_eq_u32 vcc, -1, v64
  s_nop 1
  s_cbranch_vccz L2_res_p
  s_sub_u32 s18, s18, 1
  s_cmp_lg_u32 s18, 0
  s_cbranch_scc1 L2_slowl_p
  s_branch L2_res_p
Lc_body3:
  s_waitcnt vmcnt(14)
  ds_read_b128 v[72:75], v14
  ds_read_b128 v[76:79], v15
  ds_read_b128 v[80:83], v16
  ds_read_b128 v[84:87], v17
  ds_read_b128 v[88:91], v14 offset:4096
  ds_read_b128 v[92:95], v15 offset:4096
  ds_read_b128 v[96:99], v16 offset:4096
  ds_read_b128 v[100:103], v17 offset:4096
  ds_read_b128 a[128:131], v14
  ds_read_b128 a[144:147], v14 offset:4096
  ds_read_b128 a[132:135], v15
  ds_read_b128 a[136:139], v16
  ds_read_b128 a[140:143], v17
  ds_read_b128 a[148:151], v15 offset:4096
  ds_read_b128 a[152:155], v16 offset:4096
  ds_read_b128 a[156:159], v17 offset:4096
  s_waitcnt vmcnt(12)
  s_barrier
  ds_read_b128 v[136:139], v18
  ds_read_b128 v[140:143], v18 offset:4096
  ds_read_b128 v[144:147], v18 offset:8192
  s_waitcnt lgkmcnt(3)
  s_add_u32 m0, s75, 0
  s_add_u32 s95, s94, 0x200
  s_and_b32 s95, s95, 0x3ff
  s_add_u32 s95, s95, s76
  buffer_load_dwordx4 v2, s[40:43], s95 offen lds
  buffer_load_dwordx4 v3, s[40:43], s95 offen offset:1024 lds
  buffer_load_dwordx4 v4, s[40:43], s95 offen offset:2048 lds
  buffer_load_dwordx4 v5, s[40:43], s95 offen offset:3072 lds
  s_add_u32 m0, s75, 0x1000
  s_add_u32 s95, s94, 0x280
  s_and_b32 s95, s95, 0x3ff
  v_dot2c_f32_bf16 v60, s99, v72
  v_dot2c_f32_bf16 v62, v72, v72
  v_dot2c_f32_bf16 v61, s99, v73
  v_dot2c_f32_bf16 v63, v73, v73
  v_dot2c_f32_bf16 v60, s99, v74
  v_dot2c_f32_bf16 v62, v74, v74
  v_dot2c_f32_bf16 v61, s99, v75
  v_dot2c_f32_bf16 v63, v75, v75
  v_dot2c_f32_bf16 v60, s99, v76
  v_dot2c_f32_bf16 v62, v76, v76
  v_dot2c_f32_bf16 v61, s99, v77
  v_dot2c_f32_bf16 v63, v77, v77
  v_dot2c_f32_bf16 v60, s99, v78
  v_dot2c_f32_bf16 v62, v78, v78
  v_dot2c_f32_bf16 v61, s99, v79
  v_dot2c_f32_bf16 v63, v79, v79
  v_dot2c_f32_bf16 v60, s99, v80
  v_dot2c_f32_bf16 v62, v80, v80
  v_dot2c_f32_bf16 v61, s99, v81
  v_dot2c_f32_bf16 v63, v81, v81
  v_dot2c_f32_bf16 v60, s99, v82
  v_dot2c_f32_bf16 v62, v82, v82
  v_dot2c_f32_bf16 v61, s99, v83
  v_dot2c_f32_bf16 v63, v83, v83
  v_dot2c_f32_bf16 v60, s99, v84
  v_dot2c_f32_bf16 v62, v84, v84
  v_dot2c_f32_bf16 v61, s99, v85
  v_dot2c_f32_bf16 v63, v85, v85
  v_dot2c_f32_bf16 v60, s99, v86
  v_dot2c_f32_bf16 v62, v86, v86
  v_dot2c_f32_bf16 v61, s99, v87
  v_dot2c_f32_bf16 v63, v87, v87
  v_dot2c_f32_bf16 v60, s99, v88
  v_dot2c_f32_bf16 v62, v88, v88
  v_dot2c_f32_bf16 v61, s99, v89
  v_dot2c_f32_bf16 v63, v89, v89
  v_dot2c_f32_bf16 v60, s99, v90
  v_dot2c_f32_bf16 v62, v90, v90
  v_dot2c_f32_bf16 v61, s99, v91
  v_dot2c_f32_bf16 v63, v91, v91
  v_dot2c_f32_bf16 v60, s99, v92
  v_dot2c_f32_bf16 v62, v92, v92
  v_dot2c_f32_bf16 v61, s99, v93
  v_dot2c_f32_bf16 v63, v93, v93
  v_dot2c_f32_bf16 v60, s99, v94
  v_dot2c_f32_bf16 v62, v94, v94
  v_dot2c_f32_bf16 v61, s99, v95
  v_dot2c_f32_bf16 v63, v95, v95
  v_dot2c_f32_bf16 v60, s99, v96
  v_dot2c_f32_bf16 v62, v96, v96
  v_dot2c_f32_bf16 v61, s99, v97
  v_dot2c_f32_bf16 v63, v97, v97
  v_dot2c_f32_bf16 v60, s99, v98
  v_dot2c_f32_bf16 v62, v98, v98
  v_dot2c_f32_bf16 v61, s99, v99
  v_dot2c_f32_bf16 v63, v99, v99
  v_dot2c_f32_bf16 v60, s99, v100
  v_dot2c_f32_bf16 v62, v100, v100
  v_dot2c_f32_bf16 v61, s99, v101
  v_dot2c_f32_bf16 v63, v101, v101
  v_dot2c_f32_bf16 v60, s99, v102
  v_dot2c_f32_bf16 v62, v102, v102
  v_dot2c_f32_bf16 v61, s99, v103
  v_dot2c_f32_bf16 v63, v103, v103
  s_waitcnt lgkmcnt(2)
  v_mfma_f32_32x32x16_bf16 v[184:199], a[128:131], v[136:139], 0
  ds_read_b128 v[148:151], v18 offset:12288
  s_add_u32 s95, s95, s76
  buffer_load_dwordx4 v2, s[40:43], s95 offen lds
  s_waitcnt lgkmcnt(2)
  v_mfma_f32_32x32x16_bf16 v[200:215], a[128:131], v[140:143], 0
  ds_read_b128 a[0:3], v19
  buffer_load_dwordx4 v3, s[40:43], s95 offen offset:1024 lds
  buffer_load_dwordx4 v4, s[40:43], s95 offen offset:2048 lds
  s_waitcnt lgkmcnt(2)
  v_mfma_f32_32x32x16_bf16 v[184:199], a[144:147], v[144:147], v[184:199]
  ds_read_b128 a[4:7], v19 offset:4096
  buffer_load_dwordx4 v5, s[40:43], s95 offen offset:3072 lds
  s_add_u32 m0, s73, 0x18000
  s_waitcnt lgkmcnt(2)
  v_mfma_f32_32x32x16_bf16 v[200:215], a[144:147], v[148:151], v[200:215]
  ds_read_b128 a[8:11], v20
  s_add_u32 s95, s94, 0x200
  s_and_b32 s95, s95, 0x3ff
  s_waitcnt lgkmcnt(2)
  v_mfma_f32_32x32x16_bf16 v[184:199], a[132:135], a[0:3], v[184:199]
  ds_read_b128 a[12:15], v20 offset:4096
  s_add_u32 s95, s95, s77
  buffer_load_dwordx4 v2, s[44:47], s95 offen lds
  s_waitcnt lgkmcnt(2)
  v_mfma_f32_32x32x16_bf16 v[200:215], a[132:135], a[4:7], v[200:215]
  ds_read_b128 a[16:19], v21
  buffer_load_dwordx4 v3, s[44:47], s95 offen offset:1024 lds
  s_add_u32 m0, s73, 0x1a000
  s_waitcnt lgkmcnt(2)
  v_mfma_f32_32x32x16_bf16 v[184:199], a[136:139], a[8:11], v[184:199]
  ds_read_b128 a[20:23], v21 offset:4096
  s_add_u32 s95, s94, 0x280
  s_and_b32 s95, s95, 0x3ff
  s_waitcnt lgkmcnt(2)
  v_mfma_f32_32x32x16_bf16 v[200:215], a[136:139], a[12:15], v[200:215]
  ds_read_b128 a[24:27], v19 offset:8192
  s_add_u32 s95, s95, s77
  buffer_load_dwordx4 v2, s[44:47], s95 offen lds
  s_waitcnt lgkmcnt(2)
  v_mfma_f32_32x32x16_bf16 v[184:199], a[140:143], a[16:19], v[184:199]
  ds_read_b128 a[28:31], v19 offset:12288
  buffer_load_dwordx4 v3, s[44:47], s95 offen offset:1024 lds
  s_waitcnt lgkmcnt(2)
  v_mfma_f32_32x32x16_bf16 v[200:215], a[140:143], a[20:23], v[200:215]
  ds_read_b128 a[32:35], v20 offset:8192
  s_waitcnt lgkmcnt(2)
  v_mfma_f32_32x32x16_bf16 v[184:199], a[148:151], a[24:27], v[184:199]
  ds_read_b128 a[36:39], v20 offset:12288
  s_waitcnt lgkmcnt(2)
  v_mfma_f32_32x32x16_bf16 v[200:215], a[148:151], a[28:31], v[200:215]
  ds_read_b128 a[40:43], v21 offset:8192
  s_waitcnt vmcnt(16)
  ds_read_b128 v[104:107], v14 offset:32768
  ds_read_b128 v[108:111], v15 offset:32768
  ds_read_b128 v[112:115], v16 offset:32768
  s_waitcnt lgkmcnt(5)
  v_mfma_f32_32x32x16_bf16 v[184:199], a[152:155], a[32:35], v[184:199]
  ds_read_b128 a[44:47], v21 offset:12288
  ds_read_b128 v[116:119], v17 offset:32768
  ds_read_b128 v[120:123], v14 offset:36864
  ds_read_b128 v[124:127], v15 offset:36864
  ds_read_b128 v[128:131], v16 offset:36864
  s_waitcnt lgkmcnt(9)
  v_mfma_f32_32x32x16_bf16 v[200:215], a[152:155], a[36:39], v[200:215]
  ds_read_b128 v[132:135], v17 offset:36864
  ds_read_b128 a[160:163], v14 offset:32768
  ds_read_b128 a[176:179], v14 offset:36864
  ds_read_b128 a[164:167], v15 offset:32768
  s_waitcnt lgkmcnt(12)
  v_mfma_f32_32x32x16_bf16 v[184:199], a[156:159], a[40:43], v[184:199]
  ds_read_b128 a[168:171], v16 offset:32768
  ds_read_b128 a[172:175], v17 offset:32768
  ds_read_b128 a[180:183], v15 offset:36864
  ds_read_b128 a[184:187], v16 offset:36864
  s_waitcnt lgkmcnt(12)
  v_mfma_f32_32x32x16_bf16 v[200:215], a[156:159], a[44:47], v[200:215]
  ds_read_b128 a[188:191], v17 offset:36864
  s_waitcnt vmcnt(12) lgkmcnt(0)
  s_barrier
  ds_read_b128 v[152:155], v18 offset:16384
  ds_read_b128 v[156:159], v18 offset:20480
  ds_read_b128 v[160:163], v18 offset:24576
  s_add_u32 m0, s75, 0x8000
  s_add_u32 s95, s94, 0x300
  s_and_b32 s95, s95, 0x3ff
  s_add_u32 s95, s95, s76
  buffer_load_dwordx4 v2, s[40:43], s95 offen lds
  buffer_load_dwordx4 v3, s[40:43], s95 offen offset:1024 lds
  buffer_load_dwordx4 v4, s[40:43], s95 offen offset:2048 lds
  buffer_load_dwordx4 v5, s[40:43], s95 offen offset:3072 lds
  s_add_u32 m0, s75, 0x9000
  s_add_u32 s95, s94, 0x380
  s_and_b32 s95, s95, 0x3ff
  v_dot2c_f32_bf16 v60, s99, v104
  v_dot2c_f32_bf16 v62, v104, v104
  v_dot2c_f32_bf16 v61, s99, v105
  v_dot2c_f32_bf16 v63, v105, v105
  v_dot2c_f32_bf16 v60, s99, v106
  v_dot2c_f32_bf16 v62, v106, v106
  v_dot2c_f32_bf16 v61, s99, v107
  v_dot2c_f32_bf16 v63, v107, v107
  v_dot2c_f32_bf16 v60, s99, v108
  v_dot2c_f32_bf16 v62, v108, v108
  v_dot2c_f32_bf16 v61, s99, v109
  v_dot2c_f32_bf16 v63, v109, v109
  v_dot2c_f32_bf16 v60, s99, v110
  v_dot2c_f32_bf16 v62, v110, v110
  v_dot2c_f32_bf16 v61, s99, v111
  v_dot2c_f32_bf16 v63, v111, v111
  v_dot2c_f32_bf16 v60, s99, v112
  v_dot2c_f32_bf16 v62, v112, v112
  v_dot2c_f32_bf16 v61, s99, v113
  v_dot2c_f32_bf16 v63, v113, v113
  v_dot2c_f32_bf16 v60, s99, v114
  v_dot2c_f32_bf16 v62, v114, v114
  v_dot2c_f32_bf16 v61, s99, v115
  v_dot2c_f32_bf16 v63, v115, v115
  v_dot2c_f32_bf16 v60, s99, v116
  v_dot2c_f32_bf16 v62, v116, v116
  v_dot2c_f32_bf16 v61, s99, v117
  v_dot2c_f32_bf16 v63, v117, v117
  v_dot2c_f32_bf16 v60, s99, v118
  v_dot2c_f32_bf16 v62, v118, v118
  v_dot2c_f32_bf16 v61, s99, v119
  v_dot2c_f32_bf16 v63, v119, v119
  v_dot2c_f32_bf16 v60, s99, v120
  v_dot2c_f32_bf16 v62, v120, v120
  v_dot2c_f32_bf16 v61, s99, v121
  v_dot2c_f32_bf16 v63, v121, v121
  v_dot2c_f32_bf16 v60, s99, v122
  v_dot2c_f32_bf16 v62, v122, v122
  v_dot2c_f32_bf16 v61, s99, v123
  v_dot2c_f32_bf16 v63, v123, v123
  v_dot2c_f32_bf16 v60, s99, v124
  v_dot2c_f32_bf16 v62, v124, v124
  v_dot2c_f32_bf16 v61, s99, v125
  v_dot2c_f32_bf16 v63, v125, v125
  v_dot2c_f32_bf16 v60, s99, v126
  v_dot2c_f32_bf16 v62, v126, v126
  v_dot2c_f32_bf16 v61, s99, v127
  v_dot2c_f32_bf16 v63, v127, v127
  v_dot2c_f32_bf16 v60, s99, v128
  v_dot2c_f32_bf16 v62, v128, v128
  v_dot2c_f32_bf16 v61, s99, v129
  v_dot2c_f32_bf16 v63, v129, v129
  v_dot2c_f32_bf16 v60, s99, v130
  v_dot2c_f32_bf16 v62, v130, v130
  v_dot2c_f32_bf16 v61, s99, v131
  v_dot2c_f32_bf16 v63, v131, v131
  v_dot2c_f32_bf16 v60, s99, v132
  v_dot2c_f32_bf16 v62, v132, v132
  v_dot2c_f32_bf16 v61, s99, v133
  v_dot2c_f32_bf16 v63, v133, v133
  v_dot2c_f32_bf16 v60, s99, v134
  v_dot2c_f32_bf16 v62, v134, v134
  v_dot2c_f32_bf16 v61, s99, v135
  v_dot2c_f32_bf16 v63, v135, v135
  v_dot2c_f32_bf16 v52, s99, v136
  v_dot2c_f32_bf16 v52, s99, v137
  v_dot2c_f32_bf16 v52, s99, v138
  v_dot2c_f32_bf16 v52, s99, v139
  v_dot2c_f32_bf16 v53, s99, v140
  v_dot2c_f32_bf16 v53, s99, v141
  v_dot2c_f32_bf16 v53, s99, v142
  v_dot2c_f32_bf16 v53, s99, v143
  v_dot2c_f32_bf16 v52, s99, v144
  v_dot2c_f32_bf16 v52, s99, v145
  v_dot2c_f32_bf16 v52, s99, v146
  v_dot2c_f32_bf16 v52, s99, v147
  v_dot2c_f32_bf16 v53, s99, v148
  v_dot2c_f32_bf16 v53, s99, v149
  v_dot2c_f32_bf16 v53, s99, v150
  v_dot2c_f32_bf16 v53, s99, v151
  s_waitcnt lgkmcnt(2)
  v_mfma_f32_32x32x16_bf16 v[184:199], a[160:163], v[152:155], v[184:199]
  ds_read_b128 v[164:167], v18 offset:28672
  s_add_u32 s95, s95, s76
  buffer_load_dwordx4 v2, s[40:43], s95 offen lds
  s_waitcnt lgkmcnt(2)
  v_mfma_f32_32x32x16_bf16 v[200:215], a[160:163], v[156:159], v[200:215]
  ds_read_b128 a[48:51], v19 offset:16384
  buffer_load_dwordx4 v3, s[40:43], s95 offen offset:1024 lds
  buffer_load_dwordx4 v4, s[40:43], s95 offen offset:2048 lds
  s_waitcnt lgkmcnt(2)
  v_mfma_f32_32x32x16_bf16 v[184:199], a[176:179], v[160:163], v[184:199]
  ds_read_b128 a[52:55], v19 offset:20480
  buffer_load_dwordx4 v5, s[40:43], s95 offen offset:3072 lds
  s_add_u32 m0, s73, 0x1c000
  s_waitcnt lgkmcnt(2)
  v_mfma_f32_32x32x16_bf16 v[200:215], a[176:179], v[164:167], v[200:215]
  ds_read_b128 a[56:59], v20 offset:16384
  s_add_u32 s95, s94, 0x300
  s_and_b32 s95, s95, 0x3ff
  s_waitcnt lgkmcnt(2)
  v_mfma_f32_32x32x16_bf16 v[184:199], a[164:167], a[48:51], v[184:199]
  ds_read_b128 a[60:63], v20 offset:20480
  s_add_u32 s95, s95, s77
  buffer_load_dwordx4 v2, s[44:47], s95 offen lds
  s_waitcnt lgkmcnt(2)
  v_mfma_f32_32x32x16_bf16 v[200:215], a[164:167], a[52:55], v[200:215]
  ds_read_b128 a[0:3], v21 offset:16384
  buffer_load_dwordx4 v3, s[44:47], s95 offen offset:1024 lds
  s_add_u32 m0, s73, 0x1e000
  s_waitcnt lgkmcnt(2)
  v_mfma_f32_32x32x16_bf16 v[184:199], a[168:171], a[56:59], v[184:199]
  ds_read_b128 a[4:7], v21 offset:20480
  s_add_u32 s95, s94, 0x380
  s_and_b32 s95, s95, 0x3ff
  s_waitcnt lgkmcnt(2)
  v_mfma_f32_32x32x16_bf16 v[200:215], a[168:171], a[60:63], v[200:215]
  ds_read_b128 a[8:11], v19 offset:24576
  s_add_u32 s95, s95, s77
  buffer_load_dwordx4 v2, s[44:47], s95 offen lds
  s_waitcnt lgkmcnt(2)
  v_mfma_f32_32x32x16_bf16 v[184:199], a[172:175], a[0:3], v[184:199]
  ds_read_b128 a[12:15], v19 offset:28672
  buffer_load_dwordx4 v3, s[44:47], s95 offen offset:1024 lds
  s_add_u32 m0, s83, 0x20000
  s_waitcnt lgkmcnt(2)
  v_mfma_f32_32x32x16_bf16 v[200:215], a[172:175], a[4:7], v[200:215]
  ds_read_b128 a[16:19], v20 offset:24576
  s_add_u32 s95, s19, 0
  s_and_b32 s95, s95, 7
  s_waitcnt lgkmcnt(2)
  v_mfma_f32_32x32x16_bf16 v[184:199], a[180:183], a[8:11], v[184:199]
  ds_read_b128 a[20:23], v20 offset:28672
  s_mul_i32 s95, s95, 0x38000
  s_add_u32 s95, s95, s78
  buffer_load_dwordx4 v7, s[48:51], s95 offen lds
  buffer_load_dwordx4 v8, s[48:51], s95 offen offset:1024 lds
  buffer_load_dwordx4 v9, s[48:51], s95 offen offset:2048 lds
  buffer_load_dwordx4 v10, s[48:51], s95 offen offset:3072 lds
  s_add_u32 m0, s83, 0x21000
  s_nop 0
  buffer_load_dwordx4 v11, s[48:51], s95 offen lds
  buffer_load_dwordx4 v12, s[48:51], s95 offen offset:1024 lds
  buffer_load_dwordx4 v13, s[48:51], s95 offen offset:2048 lds
  v_mov_b32 v71, 0
  buffer_load_dwordx2 v[34:35], v71, s[68:71], 0 offen sc1
  s_waitcnt lgkmcnt(2)
  v_mfma_f32_32x32x16_bf16 v[200:215], a[180:183], a[12:15], v[200:215]
  ds_read_b128 a[24:27], v21 offset:24576
  s_waitcnt vmcnt(24)
  ds_read_b128 v[72:75], v14
  ds_read_b128 v[76:79], v15
  ds_read_b128 v[80:83], v16
  s_waitcnt lgkmcnt(5)
  v_mfma_f32_32x32x16_bf16 v[184:199], a[184:187], a[16:19], v[184:199]
  ds_read_b128 a[28:31], v21 offset:28672
  ds_read_b128 v[84:87], v17
  ds_read_b128 v[88:91], v14 offset:4096
  ds_read_b128 v[92:95], v15 offset:4096
  ds_read_b128 v[96:99], v16 offset:4096
  s_waitcnt lgkmcnt(9)
  v_mfma_f32_32x32x16_bf16 v[200:215], a[184:187], a[20:23], v[200:215]
  ds_read_b128 v[100:103], v17 offset:4096
  ds_read_b128 a[192:195], v14
  ds_read_b128 a[208:211], v14 offset:4096
  ds_read_b128 a[196:199], v15
  s_waitcnt lgkmcnt(12)
  v_mfma_f32_32x32x16_bf16 v[184:199], a[188:191], a[24:27], v[184:199]
  ds_read_b128 a[200:203], v16
  ds_read_b128 a[204:207], v17
  ds_read_b128 a[212:215], v15 offset:4096
  ds_read_b128 a[216:219], v16 offset:4096
  s_waitcnt lgkmcnt(12)
  v_mfma_f32_32x32x16_bf16 v[200:215], a[188:191], a[28:31], v[200:215]
  ds_read_b128 a[220:223], v17 offset:4096
  s_waitcnt vmcnt(20) lgkmcnt(0)
  s_barrier
  ds_read_b128 v[136:139], v18 offset:32768
  ds_read_b128 v[140:143], v18 offset:36864
  ds_read_b128 v[144:147], v18 offset:40960
  v_dot2c_f32_bf16 v60, s99, v72
  v_dot2c_f32_bf16 v62, v72, v72
  v_dot2c_f32_bf16 v61, s99, v73
  v_dot2c_f32_bf16 v63, v73, v73
  v_dot2c_f32_bf16 v60, s99, v74
  v_dot2c_f32_bf16 v62, v74, v74
  v_dot2c_f32_bf16 v61, s99, v75
  v_dot2c_f32_bf16 v63, v75, v75
  v_dot2c_f32_bf16 v60, s99, v76
  v_dot2c_f32_bf16 v62, v76, v76
  v_dot2c_f32_bf16 v61, s99, v77
  v_dot2c_f32_bf16 v63, v77, v77
  v_dot2c_f32_bf16 v60, s99, v78
  v_dot2c_f32_bf16 v62, v78, v78
  v_dot2c_f32_bf16 v61, s99, v79
  v_dot2c_f32_bf16 v63, v79, v79
  v_dot2c_f32_bf16 v60, s99, v80
  v_dot2c_f32_bf16 v62, v80, v80
  v_dot2c_f32_bf16 v61, s99, v81
  v_dot2c_f32_bf16 v63, v81, v81
  v_dot2c_f32_bf16 v60, s99, v82
  v_dot2c_f32_bf16 v62, v82, v82
  v_dot2c_f32_bf16 v61, s99, v83
  v_dot2c_f32_bf16 v63, v83, v83
  v_dot2c_f32_bf16 v60, s99, v84
  v_dot2c_f32_bf16 v62, v84, v84
  v_dot2c_f32_bf16 v61, s99, v85
  v_dot2c_f32_bf16 v63, v85, v85
  v_dot2c_f32_bf16 v60, s99, v86
  v_dot2c_f32_bf16 v62, v86, v86
  v_dot2c_f32_bf16 v61, s99, v87
  v_dot2c_f32_bf16 v63, v87, v87
  v_dot2c_f32_bf16 v60, s99, v88
  v_dot2c_f32_bf16 v62, v88, v88
  v_dot2c_f32_bf16 v61, s99, v89
  v_dot2c_f32_bf16 v63, v89, v89
  v_dot2c_f32_bf16 v60, s99, v90
  v_dot2c_f32_bf16 v62, v90, v90
  v_dot2c_f32_bf16 v61, s99, v91
  v_dot2c_f32_bf16 v63, v91, v91
  v_dot2c_f32_bf16 v60, s99, v92
  v_dot2c_f32_bf16 v62, v92, v92
  v_dot2c_f32_bf16 v61, s99, v93
  v_dot2c_f32_bf16 v63, v93, v93
  v_dot2c_f32_bf16 v60, s99, v94
  v_dot2c_f32_bf16 v62, v94, v94
  v_dot2c_f32_bf16 v61, s99, v95
  v_dot2c_f32_bf16 v63, v95, v95
  v_dot2c_f32_bf16 v60, s99, v96
  v_dot2c_f32_bf16 v62, v96, v96
  v_dot2c_f32_bf16 v61, s99, v97
  v_dot2c_f32_bf16 v63, v97, v97
  v_dot2c_f32_bf16 v60, s99, v98
  v_dot2c_f32_bf16 v62, v98, v98
  v_dot2c_f32_bf16 v61, s99, v99
  v_dot2c_f32_bf16 v63, v99, v99
  v_dot2c_f32_bf16 v60, s99, v100
  v_dot2c_f32_bf16 v62, v100, v100
  v_dot2c_f32_bf16 v61, s99, v101
  v_dot2c_f32_bf16 v63, v101, v101
  v_dot2c_f32_bf16 v60, s99, v102
  v_dot2c_f32_bf16 v62, v102, v102
  v_dot2c_f32_bf16 v61, s99, v103
  v_dot2c_f32_bf16 v63, v103, v103
  v_dot2c_f32_bf16 v52, s99, v152
  v_dot2c_f32_bf16 v52, s99, v153
  v_dot2c_f32_bf16 v52, s99, v154
  v_dot2c_f32_bf16 v52, s99, v155
  v_dot2c_f32_bf16 v53, s99, v156
  v_dot2c_f32_bf16 v53, s99, v157
  v_dot2c_f32_bf16 v53, s99, v158
  v_dot2c_f32_bf16 v53, s99, v159
  v_dot2c_f32_bf16 v52, s99, v160
  v_dot2c_f32_bf16 v52, s99, v161
  v_dot2c_f32_bf16 v52, s99, v162
  v_dot2c_f32_bf16 v52, s99, v163
  v_dot2c_f32_bf16 v53, s99, v164
  v_dot2c_f32_bf16 v53, s99, v165
  v_dot2c_f32_bf16 v53, s99, v166
  v_dot2c_f32_bf16 v53, s99, v167
  s_waitcnt lgkmcnt(2)
  v_mfma_f32_32x32x16_bf16 v[184:199], a[192:195], v[136:139], v[184:199]
  ds_read_b128 v[148:151], v18 offset:45056
  s_waitcnt lgkmcnt(2)
  v_mfma_f32_32x32x16_bf16 v[200:215], a[192:195], v[140:143], v[200:215]
  ds_read_b128 a[32:35], v19 offset:32768
  s_waitcnt lgkmcnt(2)
  v_mfma_f32_32x32x16_bf16 v[184:199], a[208:211], v[144:147], v[184:199]
  ds_read_b128 a[36:39], v19 offset:36864
  s_waitcnt lgkmcnt(2)
  v_mfma_f32_32x32x16_bf16 v[200:215], a[208:211], v[148:151], v[200:215]
  ds_read_b128 a[40:43], v20 offset:32768
  s_waitcnt lgkmcnt(2)
  v_mfma_f32_32x32x16_bf16 v[184:199], a[196:199], a[32:35], v[184:199]
  ds_read_b128 a[44:47], v20 offset:36864
  s_waitcnt lgkmcnt(2)
  v_mfma_f32_32x32x16_bf16 v[200:215], a[196:199], a[36:39], v[200:215]
  ds_read_b128 a[48:51], v21 offset:32768
  s_waitcnt lgkmcnt(2)
  v_mfma_f32_32x32x16_bf16 v[184:199], a[200:203], a[40:43], v[184:199]
  ds_read_b128 a[52:55], v21 offset:36864
  s_waitcnt lgkmcnt(2)
  v_mfma_f32_32x32x16_bf16 v[200:215], a[200:203], a[44:47], v[200:215]
  ds_read_b128 a[56:59], v19 offset:40960
  s_waitcnt lgkmcnt(2)
  v_mfma_f32_32x32x16_bf16 v[184:199], a[204:207], a[48:51], v[184:199]
  ds_read_b128 a[60:63], v19 offset:45056
  s_waitcnt lgkmcnt(2)
  v_mfma_f32_32x32x16_bf16 v[200:215], a[204:207], a[52:55], v[200:215]
  ds_read_b128 a[0:3], v20 offset:40960
  s_waitcnt lgkmcnt(2)
  v_mfma_f32_32x32x16_bf16 v[184:199], a[212:215], a[56:59], v[184:199]
  ds_read_b128 a[4:7], v20 offset:45056
  s_waitcnt lgkmcnt(2)
  v_mfma_f32_32x32x16_bf16 v[200:215], a[212:215], a[60:63], v[200:215]
  ds_read_b128 a[8:11], v21 offset:40960
  s_waitcnt vmcnt(12)
  ds_read_b128 v[104:107], v14 offset:32768
  ds_read_b128 v[108:111], v15 offset:32768
  ds_read_b128 v[112:115], v16 offset:32768
  s_waitcnt lgkmcnt(5)
  v_mfma_f32_32x32x16_bf16 v[184:199], a[216:219], a[0:3], v[184:199]
  ds_read_b128 a[12:15], v21 offset:45056
  ds_read_b128 v[116:119], v17 offset:32768
  ds_read_b128 v[120:123], v14 offset:36864
  ds_read_b128 v[124:127], v15 offset:36864
  ds_read_b128 v[128:131], v16 offset:36864
  s_waitcnt lgkmcnt(9)
  v_mfma_f32_32x32x16_bf16 v[200:215], a[216:219], a[4:7], v[200:215]
  ds_read_b128 v[132:135], v17 offset:36864
  ds_read_b128 a[224:227], v14 offset:32768
  ds_read_b128 a[240:243], v14 offset:36864
  ds_read_b128 a[228:231], v15 offset:32768
  s_waitcnt lgkmcnt(12)
  v_mfma_f32_32x32x16_bf16 v[184:199], a[220:223], a[8:11], v[184:199]
  ds_read_b128 a[232:235], v16 offset:32768
  ds_read_b128 a[236:239], v17 offset:32768
  ds_read_b128 a[244:247], v15 offset:36864
  ds_read_b128 a[248:251], v16 offset:36864
  s_waitcnt lgkmcnt(12)
  v_mfma_f32_32x32x16_bf16 v[200:215], a[220:223], a[12:15], v[200:215]
  ds_read_b128 a[252:255], v17 offset:36864
  s_waitcnt vmcnt(8) lgkmcnt(0)
  s_barrier
  ds_read_b128 v[152:155], v18 offset:49152
  ds_read_b128 v[156:159], v18 offset:53248
  ds_read_b128 v[160:163], v18 offset:57344
  v_dot2c_f32_bf16 v60, s99, v104
  v_dot2c_f32_bf16 v62, v104, v104
  v_dot2c_f32_bf16 v61, s99, v105
  v_dot2c_f32_bf16 v63, v105, v105
  v_dot2c_f32_bf16 v60, s99, v106
  v_dot2c_f32_bf16 v62, v106, v106
  v_dot2c_f32_bf16 v61, s99, v107
  v_dot2c_f32_bf16 v63, v107, v107
  v_dot2c_f32_bf16 v60, s99, v108
  v_dot2c_f32_bf16 v62, v108, v108
  v_dot2c_f32_bf16 v61, s99, v109
  v_dot2c_f32_bf16 v63, v109, v109
  v_dot2c_f32_bf16 v60, s99, v110
  v_dot2c_f32_bf16 v62, v110, v110
  v_dot2c_f32_bf16 v61, s99, v111
  v_dot2c_f32_bf16 v63, v111, v111
  v_dot2c_f32_bf16 v60, s99, v112
  v_dot2c_f32_bf16 v62, v112, v112
  v_dot2c_f32_bf16 v61, s99, v113
  v_dot2c_f32_bf16 v63, v113, v113
  v_dot2c_f32_bf16 v60, s99, v114
  v_dot2c_f32_bf16 v62, v114, v114
  v_dot2c_f32_bf16 v61, s99, v115
  v_dot2c_f32_bf16 v63, v115, v115
  v_dot2c_f32_bf16 v60, s99, v116
  v_dot2c_f32_bf16 v62, v116, v116
  v_dot2c_f32_bf16 v61, s99, v117
  v_dot2c_f32_bf16 v63, v117, v117
  v_dot2c_f32_bf16 v60, s99, v118
  v_dot2c_f32_bf16 v62, v118, v118
  v_dot2c_f32_bf16 v61, s99, v119
  v_dot2c_f32_bf16 v63, v119, v119
  v_dot2c_f32_bf16 v60, s99, v120
  v_dot2c_f32_bf16 v62, v120, v120
  v_dot2c_f32_bf16 v61, s99, v121
  v_dot2c_f32_bf16 v63, v121, v121
  v_dot2c_f32_bf16 v60, s99, v122
  v_dot2c_f32_bf16 v62, v122, v122
  v_dot2c_f32_bf16 v61, s99, v123
  v_dot2c_f32_bf16 v63, v123, v123
  v_dot2c_f32_bf16 v60, s99, v124
  v_dot2c_f32_bf16 v62, v124, v124
  v_dot2c_f32_bf16 v61, s99, v125
  v_dot2c_f32_bf16 v63, v125, v125
  v_dot2c_f32_bf16 v60, s99, v126
  v_dot2c_f32_bf16 v62, v126, v126
  v_dot2c_f32_bf16 v61, s99, v127
  v_dot2c_f32_bf16 v63, v127, v127
  v_dot2c_f32_bf16 v60, s99, v128
  v_dot2c_f32_bf16 v62, v128, v128
  v_dot2c_f32_bf16 v61, s99, v129
  v_dot2c_f32_bf16 v63, v129, v129
  v_dot2c_f32_bf16 v60, s99, v130
  v_dot2c_f32_bf16 v62, v130, v130
  v_dot2c_f32_bf16 v61, s99, v131
  v_dot2c_f32_bf16 v63, v131, v131
  v_dot2c_f32_bf16 v60, s99, v132
  v_dot2c_f32_bf16 v62, v132, v132
  v_dot2c_f32_bf16 v61, s99, v133
  v_dot2c_f32_bf16 v63, v133, v133
  v_dot2c_f32_bf16 v60, s99, v134
  v_dot2c_f32_bf16 v62, v134, v134
  v_dot2c_f32_bf16 v61, s99, v135
  v_dot2c_f32_bf16 v63, v135, v135
  v_dot2c_f32_bf16 v52, s99, v136
  v_dot2c_f32_bf16 v52, s99, v137
  v_dot2c_f32_bf16 v52, s99, v138
  v_dot2c_f32_bf16 v52, s99, v139
  v_dot2c_f32_bf16 v53, s99, v140
  v_dot2c_f32_bf16 v53, s99, v141
  v_dot2c_f32_bf16 v53, s99, v142
  v_dot2c_f32_bf16 v53, s99, v143
  v_dot2c_f32_bf16 v52, s99, v144
  v_dot2c_f32_bf16 v52, s99, v145
  v_dot2c_f32_bf16 v52, s99, v146
  v_dot2c_f32_bf16 v52, s99, v147
  v_dot2c_f32_bf16 v53, s99, v148
  v_dot2c_f32_bf16 v53, s99, v149
  v_dot2c_f32_bf16 v53, s99, v150
  v_dot2c_f32_bf16 v53, s99, v151
  s_waitcnt lgkmcnt(2)
  v_mfma_f32_32x32x16_bf16 v[184:199], a[224:227], v[152:155], v[184:199]
  ds_read_b128 v[164:167], v18 offset:61440
  v_add_f32 v60, v60, v61
  v_add_f32 v62, v62, v63
  v_mov_b32 v61, v60
  v_mov_b32 v63, v62
  s_waitcnt lgkmcnt(2)
  v_mfma_f32_32x32x16_bf16 v[200:215], a[224:227], v[156:159], v[200:215]
  ds_read_b128 a[16:19], v19 offset:49152
  v_permlane32_swap_b32 v60, v61
  v_permlane32_swap_b32 v62, v63
  v_add_f32 v60, v60, v61
  v_add_f32 v62, v62, v63
  s_waitcnt lgkmcnt(2)
  v_mfma_f32_32x32x16_bf16 v[184:199], a[240:243], v[160:163], v[184:199]
  ds_read_b128 a[20:23], v19 offset:53248
  v_mul_f32 v60, 0x3b000000, v60
  v_mul_f32 v62, 0x3b000000, v62
  v_fma_f32 v62, -v60, v60, v62
  v_max_f32 v62, 0, v62
  s_waitcnt lgkmcnt(2)
  v_mfma_f32_32x32x16_bf16 v[200:215], a[240:243], v[164:167], v[200:215]
  ds_read_b128 a[24:27], v20 offset:49152
  v_cvt_pk_bf16_f32 v40, -v60, -v60
  v_cvt_pk_bf16_f32 v62, v62, v62
  v_lshlrev_b32 v62, 16, v62
  v_add_f32 v62, 0x3727c5ac, v62
  s_waitcnt lgkmcnt(2)
  v_mfma_f32_32x32x16_bf16 v[184:199], a[228:231], a[16:19], v[184:199]
  ds_read_b128 a[28:31], v20 offset:53248
  v_dot2c_f32_bf16 v52, s99, v152
  v_dot2c_f32_bf16 v52, s99, v153
  v_dot2c_f32_bf16 v52, s99, v154
  v_dot2c_f32_bf16 v52, s99, v155
  v_dot2c_f32_bf16 v53, s99, v156
  v_dot2c_f32_bf16 v53, s99, v157
  v_dot2c_f32_bf16 v53, s99, v158
  v_dot2c_f32_bf16 v53, s99, v159
  v_dot2c_f32_bf16 v52, s99, v160
  v_dot2c_f32_bf16 v52, s99, v161
  v_dot2c_f32_bf16 v52, s99, v162
  v_dot2c_f32_bf16 v52, s99, v163
  v_dot2c_f32_bf16 v53, s99, v164
  v_dot2c_f32_bf16 v53, s99, v165
  v_dot2c_f32_bf16 v53, s99, v166
  v_dot2c_f32_bf16 v53, s99, v167
  s_waitcnt lgkmcnt(2)
  v_mfma_f32_32x32x16_bf16 v[200:215], a[228:231], a[20:23], v[200:215]
  ds_read_b128 a[32:35], v21 offset:49152
  v_cvt_pk_bf16_f32 v62, v62, v62
  v_lshlrev_b32 v62, 16, v62
  v_sqrt_f32 v62, v62
  v_mov_b32 v41, v40
  s_waitcnt lgkmcnt(2)
  v_mfma_f32_32x32x16_bf16 v[184:199], a[232:235], a[24:27], v[184:199]
  ds_read_b128 a[36:39], v21 offset:53248
  v_mov_b32 v42, v40
  v_mov_b32 v43, v40
  v_cvt_pk_bf16_f32 v62, v62, v62
  v_lshlrev_b32 v62, 16, v62
  s_waitcnt lgkmcnt(2)
  v_mfma_f32_32x32x16_bf16 v[200:215], a[232:235], a[28:31], v[200:215]
  ds_read_b128 a[40:43], v19 offset:57344
  v_rcp_f32 v64, v62
  v_mul_f32 v46, v62, v62
  v_mul_f32 v44, 0xc0135761, v64
  v_mul_f32 v45, v64, v64
  s_waitcnt lgkmcnt(2)
  v_mfma_f32_32x32x16_bf16 v[184:199], a[236:239], a[32:35], v[184:199]
  ds_read_b128 a[44:47], v19 offset:61440
  v_mul_f32 v45, v45, v64
  v_mul_f32 v45, 0xbdd2d3e8, v45
  v_xor_b32 v64, s84, v64
  v_lshrrev_b32 v65, 2, v47
  s_waitcnt lgkmcnt(2)
  v_mfma_f32_32x32x16_bf16 v[200:215], a[236:239], a[36:39], v[200:215]
  ds_read_b128 a[48:51], v20 offset:57344
  s_lshl_b32 s15, s3, 7
  v_add_u32 v65, s15, v65
  ds_write_b32 v65, v64 offset:30848
  s_lshl_b32 s15, s3, 2
  s_waitcnt lgkmcnt(3)
  v_mfma_f32_32x32x16_bf16 v[184:199], a[244:247], a[40:43], v[184:199]
  ds_read_b128 a[52:55], v20 offset:61440
  v_add_u32 v66, s15, v48
  v_cvt_pk_bf16_f32 v67, v52, v52
  v_and_b32 v67, 0xffff0000, v67
  v_sub_f32 v67, v52, v67
  s_waitcnt lgkmcnt(3)
  v_mfma_f32_32x32x16_bf16 v[200:215], a[244:247], a[44:47], v[200:215]
  ds_read_b128 a[56:59], v21 offset:57344
  v_cvt_pk_bf16_f32 v67, v52, v67
  ds_write_b32 v66, v67 offset:28800
  v_mov_b32 v52, 0
  v_cvt_pk_bf16_f32 v68, v53, v53
  s_waitcnt lgkmcnt(4)
  v_mfma_f32_32x32x16_bf16 v[184:199], a[248:251], a[48:51], v[184:199]
  ds_read_b128 a[60:63], v21 offset:61440
  s_add_u32 m0, s83, 0
  s_add_u32 s95, s19, 1
  s_and_b32 s95, s95, 7
  s_mul_i32 s95, s95, 0x38000
  v_and_b32 v68, 0xffff0000, v68
  v_sub_f32 v68, v53, v68
  v_cvt_pk_bf16_f32 v68, v53, v68
  ds_write_b32 v66, v68 offset:29824
  s_waitcnt lgkmcnt(4)
  v_mfma_f32_32x32x16_bf16 v[200:215], a[248:251], a[52:55], v[200:215]
  s_add_u32 s95, s95, s78
  buffer_load_dwordx4 v7, s[48:51], s95 offen lds
  buffer_load_dwordx4 v8, s[48:51], s95 offen offset:1024 lds
  buffer_load_dwordx4 v9, s[48:51], s95 offen offset:2048 lds
  v_mov_b32 v53, 0
  s_waitcnt lgkmcnt(3)
  v_mfma_f32_32x32x16_bf16 v[184:199], a[252:255], a[56:59], v[184:199]
  buffer_load_dwordx4 v10, s[48:51], s95 offen offset:3072 lds
  s_add_u32 m0, s83, 0x1000
  s_nop 0
  buffer_load_dwordx4 v11, s[48:51], s95 offen lds
  buffer_load_dwordx4 v12, s[48:51], s95 offen offset:1024 lds
  s_waitcnt lgkmcnt(1)
  v_mfma_f32_32x32x16_bf16 v[200:215], a[252:255], a[60:63], v[200:215]
  buffer_load_dwordx4 v13, s[48:51], s95 offen offset:2048 lds
  s_add_u32 m0, s83, 0x8000
  s_add_u32 s95, s19, 2
  s_and_b32 s95, s95, 7
  s_mul_i32 s95, s95, 0x38000
  s_add_u32 s95, s95, s78
  buffer_load_dwordx4 v7, s[48:51], s95 offen lds
  buffer_load_dwordx4 v8, s[48:51], s95 offen offset:1024 lds
  buffer_load_dwordx4 v9, s[48:51], s95 offen offset:2048 lds
  buffer_load_dwordx4 v10, s[48:51], s95 offen offset:3072 lds
  s_add_u32 m0, s83, 0x9000
  s_nop 0
  buffer_load_dwordx4 v11, s[48:51], s95 offen lds
  buffer_load_dwordx4 v12, s[48:51], s95 offen offset:1024 lds
  buffer_load_dwordx4 v13, s[48:51], s95 offen offset:2048 lds
  s_waitcnt vmcnt(15)
  s_waitcnt lgkmcnt(0)
  s_barrier
  ds_read_b64_tr_b16 v[216:217], v26
  ds_read_b64_tr_b16 v[218:219], v26 offset:896
  ds_read_b64_tr_b16 v[220:221], v26 offset:32
  ds_read_b64_tr_b16 v[222:223], v26 offset:928
  ds_read_b64_tr_b16 v[224:225], v26 offset:64
  ds_read_b64_tr_b16 v[226:227], v26 offset:960
  ds_read_b64_tr_b16 v[228:229], v26 offset:96
  ds_read_b64_tr_b16 v[230:231], v26 offset:992
  s_waitcnt lgkmcnt(6)
  v_mfma_f32_32x32x16_bf16 v[72:87], v[216:219], a[128:131], 0
  ds_read_b64_tr_b16 v[232:233], v26 offset:128
  ds_read_b64_tr_b16 v[234:235], v26 offset:1024
  ds_read_b64_tr_b16 v[236:237], v26 offset:160
  ds_read_b64_tr_b16 v[238:239], v26 offset:1056
  v_lshrrev_b32 v68, 5, v0
  v_lshlrev_b32 v68, 4, v68
  s_waitcnt lgkmcnt(8)
  v_mfma_f32_32x32x16_bf16 v[88:103], v[220:223], a[128:131], 0
  ds_read_b128 a[0:3], v48 offset:28800
  ds_read_b64_tr_b16 v[240:241], v26 offset:192
  ds_read_b64_tr_b16 v[242:243], v26 offset:1088
  s_add_u32 m0, s83, 0x10000
  s_lshl_b32 s15, s3, 7
  v_add_u32 v68, s15, v68
  s_waitcnt lgkmcnt(9)
  v_mfma_f32_32x32x16_bf16 v[104:119], v[224:227], a[128:131], 0
  ds_read_b128 a[4:7], v48 offset:29824
  ds_read_b64_tr_b16 a[8:9], v27
  ds_read_b64_tr_b16 a[10:11], v27 offset:896
  s_add_u32 s95, s19, 3
  ds_read_b128 v[248:251], v68 offset:30848
  ds_read_b128 v[252:255], v68 offset:30880
  s_waitcnt lgkmcnt(12)
  v_mfma_f32_32x32x16_bf16 v[120:135], v[228:231], a[128:131], 0
  ds_read_b64_tr_b16 a[12:13], v27 offset:32
  ds_read_b64_tr_b16 a[14:15], v27 offset:928
  s_and_b32 s95, s95, 7
  s_waitcnt lgkmcnt(12)
  v_mfma_f32_32x32x16_bf16 v[136:151], v[232:235], a[128:131], 0
  ds_read_b64_tr_b16 a[16:17], v27 offset:64
  ds_read_b64_tr_b16 a[18:19], v27 offset:960
  s_mul_i32 s95, s95, 0x38000
  s_waitcnt lgkmcnt(11)
  v_mfma_f32_32x32x16_bf16 v[184:199], v[40:43], a[0:3], v[184:199]
  ds_read_b64_tr_b16 a[20:21], v27 offset:96
  ds_read_b64_tr_b16 a[22:23], v27 offset:992
  s_add_u32 s95, s95, s78
  s_waitcnt lgkmcnt(10)
  v_mfma_f32_32x32x16_bf16 v[200:215], v[40:43], a[4:7], v[200:215]
  ds_read_b64_tr_b16 a[24:25], v27 offset:128
  ds_read_b64_tr_b16 a[26:27], v27 offset:1024
  v_mfma_f32_32x32x16_bf16 v[152:167], v[236:239], a[128:131], 0
  ds_read_b64_tr_b16 a[28:29], v27 offset:160
  ds_read_b64_tr_b16 a[30:31], v27 offset:1056
  buffer_load_dwordx4 v7, s[48:51], s95 offen lds
  v_mfma_f32_32x32x16_bf16 v[168:183], v[240:243], a[128:131], 0
  ds_read_b64_tr_b16 a[32:33], v27 offset:192
  ds_read_b64_tr_b16 a[34:35], v27 offset:1088
  buffer_load_dwordx4 v8, s[48:51], s95 offen offset:1024 lds
  s_waitcnt lgkmcnt(6)
  v_mfma_f32_32x32x16_bf16 v[72:87], a[8:11], a[132:135], v[72:87]
  ds_read_b64_tr_b16 a[36:37], v28
  ds_read_b64_tr_b16 a[38:39], v28 offset:896
  v_dot2c_f32_bf16 v52, s99, v216
  v_dot2c_f32_bf16 v52, s99, v217
  v_dot2c_f32_bf16 v52, s99, v218
  v_dot2c_f32_bf16 v52, s99, v219
  v_dot2c_f32_bf16 v53, s99, v220
  v_dot2c_f32_bf16 v53, s99, v221
  v_dot2c_f32_bf16 v53, s99, v222
  v_dot2c_f32_bf16 v53, s99, v223
  v_dot2c_f32_bf16 v54, s99, v224
  v_dot2c_f32_bf16 v54, s99, v225
  v_dot2c_f32_bf16 v54, s99, v226
  v_dot2c_f32_bf16 v54, s99, v227
  v_dot2c_f32_bf16 v55, s99, v228
  v_dot2c_f32_bf16 v55, s99, v229
  v_dot2c_f32_bf16 v55, s99, v230
  v_dot2c_f32_bf16 v55, s99, v231
  v_dot2c_f32_bf16 v56, s99, v232
  v_dot2c_f32_bf16 v56, s99, v233
  v_dot2c_f32_bf16 v56, s99, v234
  v_dot2c_f32_bf16 v56, s99, v235
  v_dot2c_f32_bf16 v57, s99, v236
  v_dot2c_f32_bf16 v57, s99, v237
  v_dot2c_f32_bf16 v57, s99, v238
  v_dot2c_f32_bf16 v57, s99, v239
  v_dot2c_f32_bf16 v58, s99, v240
  v_dot2c_f32_bf16 v58, s99, v241
  v_dot2c_f32_bf16 v58, s99, v242
  v_dot2c_f32_bf16 v58, s99, v243
  buffer_load_dwordx4 v9, s[48:51], s95 offen offset:2048 lds
  v_lshrrev_b32 v69, 5, v0
  v_lshl_add_u32 v69, v69, 9, v47
  s_lshl_b32 s14, s3, 2
  v_add_u32 v69, s14, v69
  v_permlane32_swap_b32 v52, v53
  v_add_f32 v52, v52, v53
  ds_write_b32 v69, v52 offset:61568
  v_permlane32_swap_b32 v54, v55
  v_mfma_f32_32x32x16_bf16 v[88:103], a[12:15], a[132:135], v[88:103]
  ds_read_b64_tr_b16 a[40:41], v28 offset:32
  ds_read_b64_tr_b16 a[42:43], v28 offset:928
  buffer_load_dwordx4 v10, s[48:51], s95 offen offset:3072 lds
  v_add_f32 v54, v54, v55
  ds_write_b32 v69, v54 offset:62592
  v_permlane32_swap_b32 v56, v57
  v_add_f32 v56, v56, v57
  ds_write_b32 v69, v56 offset:63616
  v_mov_b32 v59, v58
  v_add_u32 v69, s14, v47
  s_nop 0
  v_permlane32_swap_b32 v58, v59
  v_mfma_f32_32x32x16_bf16 v[104:119], a[16:19], a[132:135], v[104:119]
  ds_read_b64_tr_b16 a[44:45], v28 offset:64
  ds_read_b64_tr_b16 a[46:47], v28 offset:960
  s_add_u32 m0, s83, 0x11000
  v_add_f32 v58, v58, v59
  ds_write_b32 v69, v58 offset:64640
  v_mfma_f32_32x32x16_bf16 v[120:135], a[20:23], a[132:135], v[120:135]
  ds_read_b64_tr_b16 a[48:49], v28 offset:96
  ds_read_b64_tr_b16 a[50:51], v28 offset:992
  buffer_load_dwordx4 v11, s[48:51], s95 offen lds
  s_waitcnt lgkmcnt(10)
  v_mfma_f32_32x32x16_bf16 v[136:151], a[24:27], a[132:135], v[136:151]
  ds_read_b64_tr_b16 a[52:53], v28 offset:128
  ds_read_b64_tr_b16 a[54:55], v28 offset:1024
  v_mul_f32 v184, v184, v248
  v_mul_f32 v185, v185, v249
  v_mul_f32 v186, v186, v250
  v_mul_f32 v187, v187, v251
  v_mul_f32 v188, v188, v252
  v_mul_f32 v189, v189, v253
  v_mul_f32 v190, v190, v254
  v_mul_f32 v191, v191, v255
  v_mfma_f32_32x32x16_bf16 v[152:167], a[28:31], a[132:135], v[152:167]
  ds_read_b64_tr_b16 a[56:57], v28 offset:160
  ds_read_b64_tr_b16 a[58:59], v28 offset:1056
  buffer_load_dwordx4 v12, s[48:51], s95 offen offset:1024 lds
  v_cvt_pk_bf16_f32 v60, v184, v185
  v_cvt_pk_bf16_f32 v61, v186, v187
  v_cvt_pk_bf16_f32 v62, v188, v189
  v_cvt_pk_bf16_f32 v63, v190, v191
  s_nop 0
  v_permlane32_swap_b32 v60, v62
  v_permlane32_swap_b32 v61, v63
  s_add_u32 s15, s85, 0
  buffer_store_dwordx4 v[60:63], v1, s[60:63], s15 offen sc1
  v_mfma_f32_32x32x16_bf16 v[168:183], a[32:35], a[132:135], v[168:183]
  ds_read_b64_tr_b16 a[60:61], v28 offset:192
  ds_read_b64_tr_b16 a[62:63], v28 offset:1088
  buffer_load_dwordx4 v13, s[48:51], s95 offen offset:2048 lds
  v_mul_f32 v200, v200, v248
  v_mul_f32 v201, v201, v249
  v_mul_f32 v202, v202, v250
  v_mul_f32 v203, v203, v251
  v_mul_f32 v204, v204, v252
  v_mul_f32 v205, v205, v253
  v_mul_f32 v206, v206, v254
  v_mul_f32 v207, v207, v255
  v_mfma_f32_32x32x16_bf16 v[72:87], a[36:39], a[136:139], v[72:87]
  ds_read_b64_tr_b16 a[0:1], v29
  ds_read_b64_tr_b16 a[2:3], v29 offset:896
  s_add_u32 m0, s83, 0x18000
  v_cvt_pk_bf16_f32 v64, v200, v201
  v_cvt_pk_bf16_f32 v65, v202, v203
  v_cvt_pk_bf16_f32 v66, v204, v205
  v_cvt_pk_bf16_f32 v67, v206, v207
  s_nop 0
  v_permlane32_swap_b32 v64, v66
  v_permlane32_swap_b32 v65, v67
  s_add_u32 s15, s85, 0x20000
  buffer_store_dwordx4 v[64:67], v1, s[60:63], s15 offen sc1
  s_waitcnt lgkmcnt(6)
  v_mfma_f32_32x32x16_bf16 v[88:103], a[40:43], a[136:139], v[88:103]
  ds_read_b64_tr_b16 a[4:5], v29 offset:32
  ds_read_b64_tr_b16 a[6:7], v29 offset:928
  s_add_u32 s95, s19, 4
  ds_read_b128 v[248:251], v68 offset:30912
  ds_read_b128 v[252:255], v68 offset:30944
  s_waitcnt lgkmcnt(1)
  v_mul_f32 v192, v192, v248
  v_mul_f32 v193, v193, v249
  v_mul_f32 v194, v194, v250
  v_mul_f32 v195, v195, v251
  s_waitcnt lgkmcnt(0)
  v_mul_f32 v196, v196, v252
  v_mul_f32 v197, v197, v253
  v_mfma_f32_32x32x16_bf16 v[104:119], a[44:47], a[136:139], v[104:119]
  ds_read_b64_tr_b16 a[8:9], v29 offset:64
  ds_read_b64_tr_b16 a[10:11], v29 offset:960
  s_and_b32 s95, s95, 7
  v_mul_f32 v198, v198, v254
  v_mul_f32 v199, v199, v255
  v_cvt_pk_bf16_f32 v60, v192, v193
  v_cvt_pk_bf16_f32 v61, v194, v195
  v_cvt_pk_bf16_f32 v62, v196, v197
  v_cvt_pk_bf16_f32 v63, v198, v199
  s_nop 0
  v_permlane32_swap_b32 v60, v62
  v_permlane32_swap_b32 v61, v63
  v_mfma_f32_32x32x16_bf16 v[120:135], a[48:51], a[136:139], v[120:135]
  ds_read_b64_tr_b16 a[12:13], v29 offset:96
  ds_read_b64_tr_b16 a[14:15], v29 offset:992
  s_mul_i32 s95, s95, 0x38000
  s_add_u32 s15, s85, 0
  buffer_store_dwordx4 v[60:63], v1, s[60:63], s15 offen offset:1024 sc1
  v_mul_f32 v208, v208, v248
  v_mul_f32 v209, v209, v249
  v_mul_f32 v210, v210, v250
  v_mul_f32 v211, v211, v251
  v_mul_f32 v212, v212, v252
  v_mul_f32 v213, v213, v253
  v_mfma_f32_32x32x16_bf16 v[136:151], a[52:55], a[136:139], v[136:151]
  ds_read_b64_tr_b16 a[16:17], v29 offset:128
  ds_read_b64_tr_b16 a[18:19], v29 offset:1024
  ds_read_b64_tr_b16 a[20:21], v29 offset:160
  ds_read_b64_tr_b16 a[22:23], v29 offset:1056
  ds_read_b64_tr_b16 a[24:25], v29 offset:192
  ds_read_b64_tr_b16 a[26:27], v29 offset:1088
  v_mul_f32 v214, v214, v254
  v_mul_f32 v215, v215, v255
  v_cvt_pk_bf16_f32 v64, v208, v209
  v_cvt_pk_bf16_f32 v65, v210, v211
  v_cvt_pk_bf16_f32 v66, v212, v213
  v_cvt_pk_bf16_f32 v67, v214, v215
  s_nop 0
  v_permlane32_swap_b32 v64, v66
  v_permlane32_swap_b32 v65, v67
  v_mfma_f32_32x32x16_bf16 v[152:167], a[56:59], a[136:139], v[152:167]
  s_add_u32 s95, s95, s78
  s_add_u32 s15, s85, 0x20000
  buffer_store_dwordx4 v[64:67], v1, s[60:63], s15 offen offset:1024 sc1
  v_mfma_f32_32x32x16_bf16 v[168:183], a[60:63], a[136:139], v[168:183]
  buffer_load_dwordx4 v7, s[48:51], s95 offen lds
  s_waitcnt vmcnt(19) lgkmcnt(0)
  s_barrier
  v_mfma_f32_32x32x16_bf16 v[72:87], a[0:3], a[140:143], v[72:87]
  v_subrev_u32 v26, 0x20000, v26
  ds_read_b64_tr_b16 a[28:29], v26
  ds_read_b64_tr_b16 a[30:31], v26 offset:896
  buffer_load_dwordx4 v8, s[48:51], s95 offen offset:1024 lds
  s_lshl_b32 s14, s3, 10
  v_add_u32 v69, s14, v1
  ds_read_b128 v[52:55], v69 offset:61568
  v_mfma_f32_32x32x16_bf16 v[88:103], a[4:7], a[140:143], v[88:103]
  ds_read_b64_tr_b16 a[32:33], v26 offset:32
  ds_read_b64_tr_b16 a[34:35], v26 offset:928
  buffer_load_dwordx4 v9, s[48:51], s95 offen offset:2048 lds
  v_mfma_f32_32x32x16_bf16 v[104:119], a[8:11], a[140:143], v[104:119]
  ds_read_b64_tr_b16 a[36:37], v26 offset:64
  ds_read_b64_tr_b16 a[38:39], v26 offset:960
  buffer_load_dwordx4 v10, s[48:51], s95 offen offset:3072 lds
  v_mfma_f32_32x32x16_bf16 v[120:135], a[12:15], a[140:143], v[120:135]
  ds_read_b64_tr_b16 a[40:41], v26 offset:96
  ds_read_b64_tr_b16 a[42:43], v26 offset:992
  s_add_u32 m0, s83, 0x19000
  v_lshrrev_b32 v69, 2, v69
  v_cmp_gt_u32 vcc, 0x380, v69
  s_nop 1
  v_cndmask_b32 v69, v33, v69, vcc
  s_lshl_b32 s14, s19, 10
  s_add_u32 s14, s14, s20
  s_waitcnt lgkmcnt(6)
  v_add_f32 v52, v52, v53
  v_add_f32 v54, v54, v55
  v_add_f32 v52, v52, v54
  v_cvt_pk_bf16_f32 v53, v52, v52
  v_mfma_f32_32x32x16_bf16 v[136:151], a[16:19], a[140:143], v[136:151]
  ds_read_b64_tr_b16 a[44:45], v26 offset:128
  ds_read_b64_tr_b16 a[46:47], v26 offset:1024
  v_and_b32 v53, 0xffff0000, v53
  v_sub_f32 v53, v52, v53
  v_cvt_pk_bf16_f32 v53, v52, v53
  buffer_store_dword v53, v69, s[60:63], s14 offen sc1
  v_mfma_f32_32x32x16_bf16 v[152:167], a[20:23], a[140:143], v[152:167]
  ds_read_b64_tr_b16 a[48:49], v26 offset:160
  ds_read_b64_tr_b16 a[50:51], v26 offset:1056
  buffer_load_dwordx4 v11, s[48:51], s95 offen lds
  v_mfma_f32_32x32x16_bf16 v[168:183], a[24:27], a[140:143], v[168:183]
  ds_read_b64_tr_b16 a[52:53], v26 offset:192
  ds_read_b64_tr_b16 a[54:55], v26 offset:1088
  buffer_load_dwordx4 v12, s[48:51], s95 offen offset:1024 lds
  s_waitcnt lgkmcnt(8)
  v_mfma_f32_32x32x16_bf16 v[72:87], a[28:31], a[144:147], v[72:87]
  v_subrev_u32 v27, 0x20000, v27
  ds_read_b64_tr_b16 a[56:57], v27
  ds_read_b64_tr_b16 a[58:59], v27 offset:896
  buffer_load_dwordx4 v13, s[48:51], s95 offen offset:2048 lds
  v_mfma_f32_32x32x16_bf16 v[88:103], a[32:35], a[144:147], v[88:103]
  ds_read_b64_tr_b16 a[60:61], v27 offset:32
  ds_read_b64_tr_b16 a[62:63], v27 offset:928
  s_add_u32 s95, s98, 0x200
  v_mfma_f32_32x32x16_bf16 v[104:119], a[36:39], a[144:147], v[104:119]
  ds_read_b64_tr_b16 a[0:1], v27 offset:64
  ds_read_b64_tr_b16 a[2:3], v27 offset:960
  s_and_b32 s95, s95, 0x7ff
  s_waitcnt lgkmcnt(6)
  v_mfma_f32_32x32x16_bf16 v[120:135], a[40:43], a[144:147], v[120:135]
  ds_read_b64_tr_b16 a[4:5], v27 offset:96
  ds_read_b64_tr_b16 a[6:7], v27 offset:992
  s_add_u32 s95, s95, s80
  v_mfma_f32_32x32x16_bf16 v[136:151], a[44:47], a[144:147], v[136:151]
  ds_read_b64_tr_b16 a[8:9], v27 offset:128
  ds_read_b64_tr_b16 a[10:11], v27 offset:1024
  v_mfma_f32_32x32x16_bf16 v[152:167], a[48:51], a[144:147], v[152:167]
  ds_read_b64_tr_b16 a[12:13], v27 offset:160
  ds_read_b64_tr_b16 a[14:15], v27 offset:1056
  buffer_load_dword v49, v51, s[52:55], s95 offen
  v_mfma_f32_32x32x16_bf16 v[168:183], a[52:55], a[144:147], v[168:183]
  ds_read_b64_tr_b16 a[16:17], v27 offset:192
  ds_read_b64_tr_b16 a[18:19], v27 offset:1088
  s_waitcnt lgkmcnt(6)
  v_mfma_f32_32x32x16_bf16 v[72:87], a[56:59], a[148:151], v[72:87]
  v_subrev_u32 v28, 0x20000, v28
  ds_read_b64_tr_b16 a[20:21], v28
  ds_read_b64_tr_b16 a[22:23], v28 offset:896
  s_waitcnt vmcnt(4)
  s_barrier
  v_cmp_ne_u32 vcc, 0, v34
  s_nop 0
  s_cmp_eq_u64 vcc, -1
  s_cbranch_scc0 L3_slow_nonce
L3_res_nonce:
  s_mov_b32 s94, 0
  buffer_store_dwordx2 v[34:35], v33, s[60:63], s94 offen sc1
  v_mfma_f32_32x32x16_bf16 v[88:103], a[60:63], a[148:151], v[88:103]
  ds_read_b64_tr_b16 a[24:25], v28 offset:32
  ds_read_b64_tr_b16 a[26:27], v28 offset:928
  v_mfma_f32_32x32x16_bf16 v[104:119], a[0:3], a[148:151], v[104:119]
  ds_read_b64_tr_b16 a[28:29], v28 offset:64
  ds_read_b64_tr_b16 a[30:31], v28 offset:960
  v_mfma_f32_32x32x16_bf16 v[120:135], a[4:7], a[148:151], v[120:135]
  ds_read_b64_tr_b16 a[32:33], v28 offset:96
  ds_read_b64_tr_b16 a[34:35], v28 offset:992
  s_waitcnt lgkmcnt(6)
  v_mfma_f32_32x32x16_bf16 v[136:151], a[8:11], a[148:151], v[136:151]
  ds_read_b64_tr_b16 a[36:37], v28 offset:128
  ds_read_b64_tr_b16 a[38:39], v28 offset:1024
  v_mfma_f32_32x32x16_bf16 v[152:167], a[12:15], a[148:151], v[152:167]
  ds_read_b64_tr_b16 a[40:41], v28 offset:160
  ds_read_b64_tr_b16 a[42:43], v28 offset:1056
  v_mfma_f32_32x32x16_bf16 v[168:183], a[16:19], a[148:151], v[168:183]
  ds_read_b64_tr_b16 a[44:45], v28 offset:192
  ds_read_b64_tr_b16 a[46:47], v28 offset:1088
  v_mfma_f32_32x32x16_bf16 v[72:87], a[20:23], a[152:155], v[72:87]
  v_subrev_u32 v29, 0x20000, v29
  ds_read_b64_tr_b16 a[48:49], v29
  ds_read_b64_tr_b16 a[50:51], v29 offset:896
  s_waitcnt lgkmcnt(6)
  v_mfma_f32_32x32x16_bf16 v[88:103], a[24:27], a[152:155], v[88:103]
  ds_read_b64_tr_b16 a[52:53], v29 offset:32
  ds_read_b64_tr_b16 a[54:55], v29 offset:928
  v_mfma_f32_32x32x16_bf16 v[104:119], a[28:31], a[152:155], v[104:119]
  ds_read_b64_tr_b16 a[56:57], v29 offset:64
  ds_read_b64_tr_b16 a[58:59], v29 offset:960
  v_mfma_f32_32x32x16_bf16 v[120:135], a[32:35], a[152:155], v[120:135]
  ds_read_b64_tr_b16 a[60:61], v29 offset:96
  ds_read_b64_tr_b16 a[62:63], v29 offset:992
  v_mfma_f32_32x32x16_bf16 v[136:151], a[36:39], a[152:155], v[136:151]
  ds_read_b64_tr_b16 a[0:1], v29 offset:128
  ds_read_b64_tr_b16 a[2:3], v29 offset:1024
  ds_read_b64_tr_b16 a[4:5], v29 offset:160
  ds_read_b64_tr_b16 a[6:7], v29 offset:1056
  ds_read_b64_tr_b16 a[8:9], v29 offset:192
  ds_read_b64_tr_b16 a[10:11], v29 offset:1088
  s_waitcnt lgkmcnt(10)
  v_mfma_f32_32x32x16_bf16 v[152:167], a[40:43], a[152:155], v[152:167]
  v_mfma_f32_32x32x16_bf16 v[168:183], a[44:47], a[152:155], v[168:183]
  s_waitcnt lgkmcnt(0)
  s_barrier
  v_mfma_f32_32x32x16_bf16 v[72:87], a[48:51], a[156:159], v[72:87]
  v_add_u32 v26, 0x8000, v26
  ds_read_b64_tr_b16 a[12:13], v26
  ds_read_b64_tr_b16 a[14:15], v26 offset:896
  v_mfma_f32_32x32x16_bf16 v[88:103], a[52:55], a[156:159], v[88:103]
  ds_read_b64_tr_b16 a[16:17], v26 offset:32
  ds_read_b64_tr_b16 a[18:19], v26 offset:928
  s_add_u32 m0, s83, 0x20000
  v_mfma_f32_32x32x16_bf16 v[104:119], a[56:59], a[156:159], v[104:119]
  ds_read_b64_tr_b16 a[20:21], v26 offset:64
  ds_read_b64_tr_b16 a[22:23], v26 offset:960
  s_add_u32 s95, s19, 5
  v_mfma_f32_32x32x16_bf16 v[120:135], a[60:63], a[156:159], v[120:135]
  ds_read_b64_tr_b16 a[24:25], v26 offset:96
  ds_read_b64_tr_b16 a[26:27], v26 offset:992
  s_and_b32 s95, s95, 7
  v_mfma_f32_32x32x16_bf16 v[136:151], a[0:3], a[156:159], v[136:151]
  ds_read_b64_tr_b16 a[28:29], v26 offset:128
  ds_read_b64_tr_b16 a[30:31], v26 offset:1024
  s_mul_i32 s95, s95, 0x38000
  v_mfma_f32_32x32x16_bf16 v[152:167], a[4:7], a[156:159], v[152:167]
  ds_read_b64_tr_b16 a[32:33], v26 offset:160
  ds_read_b64_tr_b16 a[34:35], v26 offset:1056
  s_add_u32 s95, s95, s78
  v_mfma_f32_32x32x16_bf16 v[168:183], a[8:11], a[156:159], v[168:183]
  ds_read_b64_tr_b16 a[36:37], v26 offset:192
  ds_read_b64_tr_b16 a[38:39], v26 offset:1088
  buffer_load_dwordx4 v7, s[48:51], s95 offen lds
  s_waitcnt lgkmcnt(8)
  v_mfma_f32_32x32x16_bf16 v[72:87], a[12:15], a[160:163], v[72:87]
  v_add_u32 v27, 0x8000, v27
  ds_read_b64_tr_b16 a[40:41], v27
  ds_read_b64_tr_b16 a[42:43], v27 offset:896
  buffer_load_dwordx4 v8, s[48:51], s95 offen offset:1024 lds
  v_mfma_f32_32x32x16_bf16 v[88:103], a[16:19], a[160:163], v[88:103]
  ds_read_b64_tr_b16 a[44:45], v27 offset:32
  ds_read_b64_tr_b16 a[46:47], v27 offset:928
  buffer_load_dwordx4 v9, s[48:51], s95 offen offset:2048 lds
  v_mfma_f32_32x32x16_bf16 v[104:119], a[20:23], a[160:163], v[104:119]
  ds_read_b64_tr_b16 a[48:49], v27 offset:64
  ds_read_b64_tr_b16 a[50:51], v27 offset:960
  buffer_load_dwordx4 v10, s[48:51], s95 offen offset:3072 lds
  s_waitcnt lgkmcnt(6)
  v_mfma_f32_32x32x16_bf16 v[120:135], a[24:27], a[160:163], v[120:135]
  ds_read_b64_tr_b16 a[52:53], v27 offset:96
  ds_read_b64_tr_b16 a[54:55], v27 offset:992
  s_add_u32 m0, s83, 0x21000
  v_mfma_f32_32x32x16_bf16 v[136:151], a[28:31], a[160:163], v[136:151]
  ds_read_b64_tr_b16 a[56:57], v27 offset:128
  ds_read_b64_tr_b16 a[58:59], v27 offset:1024
  buffer_load_dwordx4 v11, s[48:51], s95 offen lds
  v_mfma_f32_32x32x16_bf16 v[152:167], a[32:35], a[160:163], v[152:167]
  ds_read_b64_tr_b16 a[60:61], v27 offset:160
  ds_read_b64_tr_b16 a[62:63], v27 offset:1056
  buffer_load_dwordx4 v12, s[48:51], s95 offen offset:1024 lds
  v_mfma_f32_32x32x16_bf16 v[168:183], a[36:39], a[160:163], v[168:183]
  ds_read_b64_tr_b16 a[0:1], v27 offset:192
  ds_read_b64_tr_b16 a[2:3], v27 offset:1088
  buffer_load_dwordx4 v13, s[48:51], s95 offen offset:2048 lds
  s_waitcnt lgkmcnt(6)
  v_mfma_f32_32x32x16_bf16 v[72:87], a[40:43], a[164:167], v[72:87]
  v_add_u32 v28, 0x8000, v28
  ds_read_b64_tr_b16 a[4:5], v28
  ds_read_b64_tr_b16 a[6:7], v28 offset:896
  s_add_u32 m0, s83, 0
  v_mfma_f32_32x32x16_bf16 v[88:103], a[44:47], a[164:167], v[88:103]
  ds_read_b64_tr_b16 a[8:9], v28 offset:32
  ds_read_b64_tr_b16 a[10:11], v28 offset:928
  s_add_u32 s95, s19, 6
  v_mfma_f32_32x32x16_bf16 v[104:119], a[48:51], a[164:167], v[104:119]
  ds_read_b64_tr_b16 a[12:13], v28 offset:64
  ds_read_b64_tr_b16 a[14:15], v28 offset:960
  s_and_b32 s95, s95, 7
  v_mfma_f32_32x32x16_bf16 v[120:135], a[52:55], a[164:167], v[120:135]
  ds_read_b64_tr_b16 a[16:17], v28 offset:96
  ds_read_b64_tr_b16 a[18:19], v28 offset:992
  s_mul_i32 s95, s95, 0x38000
  s_waitcnt lgkmcnt(6)
  v_mfma_f32_32x32x16_bf16 v[136:151], a[56:59], a[164:167], v[136:151]
  ds_read_b64_tr_b16 a[20:21], v28 offset:128
  ds_read_b64_tr_b16 a[22:23], v28 offset:1024
  s_add_u32 s95, s95, s78
  v_mfma_f32_32x32x16_bf16 v[152:167], a[60:63], a[164:167], v[152:167]
  ds_read_b64_tr_b16 a[24:25], v28 offset:160
  ds_read_b64_tr_b16 a[26:27], v28 offset:1056
  buffer_load_dwordx4 v7, s[48:51], s95 offen lds
  v_mfma_f32_32x32x16_bf16 v[168:183], a[0:3], a[164:167], v[168:183]
  ds_read_b64_tr_b16 a[28:29], v28 offset:192
  ds_read_b64_tr_b16 a[30:31], v28 offset:1088
  buffer_load_dwordx4 v8, s[48:51], s95 offen offset:1024 lds
  v_mfma_f32_32x32x16_bf16 v[72:87], a[4:7], a[168:171], v[72:87]
  v_add_u32 v29, 0x8000, v29
  ds_read_b64_tr_b16 a[32:33], v29
  ds_read_b64_tr_b16 a[34:35], v29 offset:896
  buffer_load_dwordx4 v9, s[48:51], s95 offen offset:2048 lds
  s_waitcnt lgkmcnt(6)
  v_mfma_f32_32x32x16_bf16 v[88:103], a[8:11], a[168:171], v[88:103]
  ds_read_b64_tr_b16 a[36:37], v29 offset:32
  ds_read_b64_tr_b16 a[38:39], v29 offset:928
  buffer_load_dwordx4 v10, s[48:51], s95 offen offset:3072 lds
  v_mfma_f32_32x32x16_bf16 v[104:119], a[12:15], a[168:171], v[104:119]
  ds_read_b64_tr_b16 a[40:41], v29 offset:64
  ds_read_b64_tr_b16 a[42:43], v29 offset:960
  s_add_u32 m0, s83, 0x1000
  v_mfma_f32_32x32x16_bf16 v[120:135], a[16:19], a[168:171], v[120:135]
  ds_read_b64_tr_b16 a[44:45], v29 offset:96
  ds_read_b64_tr_b16 a[46:47], v29 offset:992
  buffer_load_dwordx4 v11, s[48:51], s95 offen lds
  v_mfma_f32_32x32x16_bf16 v[136:151], a[20:23], a[168:171], v[136:151]
  ds_read_b64_tr_b16 a[48:49], v29 offset:128
  ds_read_b64_tr_b16 a[50:51], v29 offset:1024
  ds_read_b64_tr_b16 a[52:53], v29 offset:160
  ds_read_b64_tr_b16 a[54:55], v29 offset:1056
  ds_read_b64_tr_b16 a[56:57], v29 offset:192
  ds_read_b64_tr_b16 a[58:59], v29 offset:1088
  buffer_load_dwordx4 v12, s[48:51], s95 offen offset:1024 lds
  s_waitcnt lgkmcnt(10)
  v_mfma_f32_32x32x16_bf16 v[152:167], a[24:27], a[168:171], v[152:167]
  v_mfma_f32_32x32x16_bf16 v[168:183], a[28:31], a[168:171], v[168:183]
  buffer_load_dwordx4 v13, s[48:51], s95 offen offset:2048 lds
  s_waitcnt lgkmcnt(0)
  s_barrier
  v_mfma_f32_32x32x16_bf16 v[72:87], a[32:35], a[172:175], v[72:87]
  v_add_u32 v26, 0x8000, v26
  ds_read_b64_tr_b16 a[60:61], v26
  ds_read_b64_tr_b16 a[62:63], v26 offset:896
  v_mfma_f32_32x32x16_bf16 v[88:103], a[36:39], a[172:175], v[88:103]
  ds_read_b64_tr_b16 a[0:1], v26 offset:32
  ds_read_b64_tr_b16 a[2:3], v26 offset:928
  s_add_u32 m0, s83, 0x8000
  v_mfma_f32_32x32x16_bf16 v[104:119], a[40:43], a[172:175], v[104:119]
  ds_read_b64_tr_b16 a[4:5], v26 offset:64
  ds_read_b64_tr_b16 a[6:7], v26 offset:960
  s_add_u32 s95, s19, 7
  v_mfma_f32_32x32x16_bf16 v[120:135], a[44:47], a[172:175], v[120:135]
  ds_read_b64_tr_b16 a[8:9], v26 offset:96
  ds_read_b64_tr_b16 a[10:11], v26 offset:992
  s_and_b32 s95, s95, 7
  v_mfma_f32_32x32x16_bf16 v[136:151], a[48:51], a[172:175], v[136:151]
  ds_read_b64_tr_b16 a[12:13], v26 offset:128
  ds_read_b64_tr_b16 a[14:15], v26 offset:1024
  s_mul_i32 s95, s95, 0x38000
  v_mfma_f32_32x32x16_bf16 v[152:167], a[52:55], a[172:175], v[152:167]
  ds_read_b64_tr_b16 a[16:17], v26 offset:160
  ds_read_b64_tr_b16 a[18:19], v26 offset:1056
  s_add_u32 s95, s95, s78
  v_mfma_f32_32x32x16_bf16 v[168:183], a[56:59], a[172:175], v[168:183]
  ds_read_b64_tr_b16 a[20:21], v26 offset:192
  ds_read_b64_tr_b16 a[22:23], v26 offset:1088
  buffer_load_dwordx4 v7, s[48:51], s95 offen lds
  s_waitcnt lgkmcnt(8)
  v_mfma_f32_32x32x16_bf16 v[72:87], a[60:63], a[176:179], v[72:87]
  v_add_u32 v27, 0x8000, v27
  ds_read_b64_tr_b16 a[24:25], v27
  ds_read_b64_tr_b16 a[26:27], v27 offset:896
  buffer_load_dwordx4 v8, s[48:51], s95 offen offset:1024 lds
  v_mfma_f32_32x32x16_bf16 v[88:103], a[0:3], a[176:179], v[88:103]
  ds_read_b64_tr_b16 a[28:29], v27 offset:32
  ds_read_b64_tr_b16 a[30:31], v27 offset:928
  buffer_load_dwordx4 v9, s[48:51], s95 offen offset:2048 lds
  v_mfma_f32_32x32x16_bf16 v[104:119], a[4:7], a[176:179], v[104:119]
  ds_read_b64_tr_b16 a[32:33], v27 offset:64
  ds_read_b64_tr_b16 a[34:35], v27 offset:960
  buffer_load_dwordx4 v10, s[48:51], s95 offen offset:3072 lds
  s_waitcnt lgkmcnt(6)
  v_mfma_f32_32x32x16_bf16 v[120:135], a[8:11], a[176:179], v[120:135]
  ds_read_b64_tr_b16 a[36:37], v27 offset:96
  ds_read_b64_tr_b16 a[38:39], v27 offset:992
  s_add_u32 m0, s83, 0x9000
  v_mfma_f32_32x32x16_bf16 v[136:151], a[12:15], a[176:179], v[136:151]
  ds_read_b64_tr_b16 a[40:41], v27 offset:128
  ds_read_b64_tr_b16 a[42:43], v27 offset:1024
  buffer_load_dwordx4 v11, s[48:51], s95 offen lds
  v_mfma_f32_32x32x16_bf16 v[152:167], a[16:19], a[176:179], v[152:167]
  ds_read_b64_tr_b16 a[44:45], v27 offset:160
  ds_read_b64_tr_b16 a[46:47], v27 offset:1056
  buffer_load_dwordx4 v12, s[48:51], s95 offen offset:1024 lds
  v_mfma_f32_32x32x16_bf16 v[168:183], a[20:23], a[176:179], v[168:183]
  ds_read_b64_tr_b16 a[48:49], v27 offset:192
  ds_read_b64_tr_b16 a[50:51], v27 offset:1088
  buffer_load_dwordx4 v13, s[48:51], s95 offen offset:2048 lds
  s_waitcnt lgkmcnt(6)
  v_mfma_f32_32x32x16_bf16 v[72:87], a[24:27], a[180:183], v[72:87]
  v_add_u32 v28, 0x8000, v28
  ds_read_b64_tr_b16 a[52:53], v28
  ds_read_b64_tr_b16 a[54:55], v28 offset:896
  v_mfma_f32_32x32x16_bf16 v[88:103], a[28:31], a[180:183], v[88:103]
  ds_read_b64_tr_b16 a[56:57], v28 offset:32
  ds_read_b64_tr_b16 a[58:59], v28 offset:928
  v_mfma_f32_32x32x16_bf16 v[104:119], a[32:35], a[180:183], v[104:119]
  ds_read_b64_tr_b16 a[60:61], v28 offset:64
  ds_read_b64_tr_b16 a[62:63], v28 offset:960
  buffer_load_dwordx2 v[36:37], v30, s[60:63], 0 offen sc1
  v_mfma_f32_32x32x16_bf16 v[120:135], a[36:39], a[180:183], v[120:135]
  ds_read_b64_tr_b16 a[0:1], v28 offset:96
  ds_read_b64_tr_b16 a[2:3], v28 offset:992
  s_waitcnt lgkmcnt(6)
  v_mfma_f32_32x32x16_bf16 v[136:151], a[40:43], a[180:183], v[136:151]
  ds_read_b64_tr_b16 a[4:5], v28 offset:128
  ds_read_b64_tr_b16 a[6:7], v28 offset:1024
  v_mfma_f32_32x32x16_bf16 v[152:167], a[44:47], a[180:183], v[152:167]
  ds_read_b64_tr_b16 a[8:9], v28 offset:160
  ds_read_b64_tr_b16 a[10:11], v28 offset:1056
  v_mfma_f32_32x32x16_bf16 v[168:183], a[48:51], a[180:183], v[168:183]
  ds_read_b64_tr_b16 a[12:13], v28 offset:192
  ds_read_b64_tr_b16 a[14:15], v28 offset:1088
  v_mfma_f32_32x32x16_bf16 v[72:87], a[52:55], a[184:187], v[72:87]
  v_add_u32 v29, 0x8000, v29
  ds_read_b64_tr_b16 a[16:17], v29
  ds_read_b64_tr_b16 a[18:19], v29 offset:896
  s_waitcnt lgkmcnt(6)
  v_mfma_f32_32x32x16_bf16 v[88:103], a[56:59], a[184:187], v[88:103]
  ds_read_b64_tr_b16 a[20:21], v29 offset:32
  ds_read_b64_tr_b16 a[22:23], v29 offset:928
  v_mfma_f32_32x32x16_bf16 v[104:119], a[60:63], a[184:187], v[104:119]
  ds_read_b64_tr_b16 a[24:25], v29 offset:64
  ds_read_b64_tr_b16 a[26:27], v29 offset:960
  v_mfma_f32_32x32x16_bf16 v[120:135], a[0:3], a[184:187], v[120:135]
  ds_read_b64_tr_b16 a[28:29], v29 offset:96
  ds_read_b64_tr_b16 a[30:31], v29 offset:992
  v_mfma_f32_32x32x16_bf16 v[136:151], a[4:7], a[184:187], v[136:151]
  ds_read_b64_tr_b16 a[32:33], v29 offset:128
  ds_read_b64_tr_b16 a[34:35], v29 offset:1024
  ds_read_b64_tr_b16 a[36:37], v29 offset:160
  ds_read_b64_tr_b16 a[38:39], v29 offset:1056
  ds_read_b64_tr_b16 a[40:41], v29 offset:192
  ds_read_b64_tr_b16 a[42:43], v29 offset:1088
  s_waitcnt lgkmcnt(10)
  v_mfma_f32_32x32x16_bf16 v[152:167], a[8:11], a[184:187], v[152:167]
  v_mfma_f32_32x32x16_bf16 v[168:183], a[12:15], a[184:187], v[168:183]
  s_waitcnt vmcnt(24) lgkmcnt(0)
  s_barrier
  v_mfma_f32_32x32x16_bf16 v[72:87], a[16:19], a[188:191], v[72:87]
  v_add_u32 v26, 0x8000, v26
  ds_read_b64_tr_b16 a[44:45], v26
  ds_read_b64_tr_b16 a[46:47], v26 offset:896
  v_mfma_f32_32x32x16_bf16 v[88:103], a[20:23], a[188:191], v[88:103]
  ds_read_b64_tr_b16 a[48:49], v26 offset:32
  ds_read_b64_tr_b16 a[50:51], v26 offset:928
  s_add_u32 s95, s98, 0
  v_mfma_f32_32x32x16_bf16 v[104:119], a[24:27], a[188:191], v[104:119]
  ds_read_b64_tr_b16 a[52:53], v26 offset:64
  ds_read_b64_tr_b16 a[54:55], v26 offset:960
  s_and_b32 s95, s95, 0x7ff
  v_mfma_f32_32x32x16_bf16 v[120:135], a[28:31], a[188:191], v[120:135]
  ds_read_b64_tr_b16 a[56:57], v26 offset:96
  ds_read_b64_tr_b16 a[58:59], v26 offset:992
  s_add_u32 s95, s95, s80
  v_mfma_f32_32x32x16_bf16 v[136:151], a[32:35], a[188:191], v[136:151]
  ds_read_b64_tr_b16 a[60:61], v26 offset:128
  ds_read_b64_tr_b16 a[62:63], v26 offset:1024
  v_mfma_f32_32x32x16_bf16 v[152:167], a[36:39], a[188:191], v[152:167]
  ds_read_b64_tr_b16 a[0:1], v26 offset:160
  ds_read_b64_tr_b16 a[2:3], v26 offset:1056
  s_add_u32 m0, s72, 0x10000
  v_mfma_f32_32x32x16_bf16 v[168:183], a[40:43], a[188:191], v[168:183]
  ds_read_b64_tr_b16 a[4:5], v26 offset:192
  ds_read_b64_tr_b16 a[6:7], v26 offset:1088
  buffer_load_dwordx4 v22, s[52:55], s95 offen lds
  s_waitcnt lgkmcnt(8)
  v_mfma_f32_32x32x16_bf16 v[72:87], a[44:47], a[192:195], v[72:87]
  v_add_u32 v27, 0x8000, v27
  ds_read_b64_tr_b16 a[8:9], v27
  ds_read_b64_tr_b16 a[10:11], v27 offset:896
  buffer_load_dwordx4 v23, s[52:55], s95 offen offset:1024 lds
  v_mfma_f32_32x32x16_bf16 v[88:103], a[48:51], a[192:195], v[88:103]
  ds_read_b64_tr_b16 a[12:13], v27 offset:32
  ds_read_b64_tr_b16 a[14:15], v27 offset:928
  v_mfma_f32_32x32x16_bf16 v[104:119], a[52:55], a[192:195], v[104:119]
  ds_read_b64_tr_b16 a[16:17], v27 offset:64
  ds_read_b64_tr_b16 a[18:19], v27 offset:960
  buffer_load_dwordx4 v24, s[52:55], s95 offen offset:2048 lds
  s_waitcnt lgkmcnt(6)
  v_mfma_f32_32x32x16_bf16 v[120:135], a[56:59], a[192:195], v[120:135]
  ds_read_b64_tr_b16 a[20:21], v27 offset:96
  ds_read_b64_tr_b16 a[22:23], v27 offset:992
  buffer_load_dwordx4 v25, s[52:55], s95 offen offset:3072 lds
  v_mfma_f32_32x32x16_bf16 v[136:151], a[60:63], a[192:195], v[136:151]
  ds_read_b64_tr_b16 a[24:25], v27 offset:128
  ds_read_b64_tr_b16 a[26:27], v27 offset:1024
  s_add_u32 m0, s72, 0x14000
  v_mfma_f32_32x32x16_bf16 v[152:167], a[0:3], a[192:195], v[152:167]
  ds_read_b64_tr_b16 a[28:29], v27 offset:160
  ds_read_b64_tr_b16 a[30:31], v27 offset:1056
  v_mfma_f32_32x32x16_bf16 v[168:183], a[4:7], a[192:195], v[168:183]
  ds_read_b64_tr_b16 a[32:33], v27 offset:192
  ds_read_b64_tr_b16 a[34:35], v27 offset:1088
  s_add_u32 s95, s95, 0x80
  s_waitcnt lgkmcnt(6)
  v_mfma_f32_32x32x16_bf16 v[72:87], a[8:11], a[196:199], v[72:87]
  v_add_u32 v28, 0x8000, v28
  ds_read_b64_tr_b16 a[36:37], v28
  ds_read_b64_tr_b16 a[38:39], v28 offset:896
  buffer_load_dwordx4 v22, s[52:55], s95 offen lds
  v_mfma_f32_32x32x16_bf16 v[88:103], a[12:15], a[196:199], v[88:103]
  ds_read_b64_tr_b16 a[40:41], v28 offset:32
  ds_read_b64_tr_b16 a[42:43], v28 offset:928
  buffer_load_dwordx4 v23, s[52:55], s95 offen offset:1024 lds
  v_mfma_f32_32x32x16_bf16 v[104:119], a[16:19], a[196:199], v[104:119]
  ds_read_b64_tr_b16 a[44:45], v28 offset:64
  ds_read_b64_tr_b16 a[46:47], v28 offset:960
  v_mfma_f32_32x32x16_bf16 v[120:135], a[20:23], a[196:199], v[120:135]
  ds_read_b64_tr_b16 a[48:49], v28 offset:96
  ds_read_b64_tr_b16 a[50:51], v28 offset:992
  buffer_load_dwordx4 v24, s[52:55], s95 offen offset:2048 lds
  s_waitcnt lgkmcnt(6)
  v_mfma_f32_32x32x16_bf16 v[136:151], a[24:27], a[196:199], v[136:151]
  ds_read_b64_tr_b16 a[52:53], v28 offset:128
  ds_read_b64_tr_b16 a[54:55], v28 offset:1024
  buffer_load_dwordx4 v25, s[52:55], s95 offen offset:3072 lds
  v_mfma_f32_32x32x16_bf16 v[152:167], a[28:31], a[196:199], v[152:167]
  ds_read_b64_tr_b16 a[56:57], v28 offset:160
  ds_read_b64_tr_b16 a[58:59], v28 offset:1056
  v_mfma_f32_32x32x16_bf16 v[168:183], a[32:35], a[196:199], v[168:183]
  ds_read_b64_tr_b16 a[60:61], v28 offset:192
  ds_read_b64_tr_b16 a[62:63], v28 offset:1088
  v_mfma_f32_32x32x16_bf16 v[72:87], a[36:39], a[200:203], v[72:87]
  v_add_u32 v29, 0x8000, v29
  ds_read_b64_tr_b16 a[0:1], v29
  ds_read_b64_tr_b16 a[2:3], v29 offset:896
  s_waitcnt lgkmcnt(6)
  v_mfma_f32_32x32x16_bf16 v[88:103], a[40:43], a[200:203], v[88:103]
  ds_read_b64_tr_b16 a[4:5], v29 offset:32
  ds_read_b64_tr_b16 a[6:7], v29 offset:928
  v_mfma_f32_32x32x16_bf16 v[104:119], a[44:47], a[200:203], v[104:119]
  ds_read_b64_tr_b16 a[8:9], v29 offset:64
  ds_read_b64_tr_b16 a[10:11], v29 offset:960
  s_waitcnt vmcnt(8)
  v_cmp_eq_u64 vcc, v[36:37], v[34:35]
  s_nop 0
  s_cmp_eq_u64 vcc, -1
  s_cbranch_scc0 L3_slow_ka
L3_res_ka:
  s_add_u32 s25, s100, 0
  s_and_b32 s25, s25, 0xffff
  s_add_u32 s25, s25, s79
  buffer_load_dwordx4 a[64:67], v1, s[60:63], s25 offen sc1
  buffer_load_dwordx4 a[68:71], v1, s[60:63], s25 offen offset:1024 sc1
  v_mfma_f32_32x32x16_bf16 v[120:135], a[48:51], a[200:203], v[120:135]
  ds_read_b64_tr_b16 a[12:13], v29 offset:96
  ds_read_b64_tr_b16 a[14:15], v29 offset:992
  buffer_load_dwordx4 a[72:75], v1, s[60:63], s25 offen offset:2048 sc1
  buffer_load_dwordx4 a[76:79], v1, s[60:63], s25 offen offset:3072 sc1
  s_add_u32 s25, s25, 0x1000
  buffer_load_dwordx4 a[80:83], v1, s[60:63], s25 offen sc1
  buffer_load_dwordx4 a[84:87], v1, s[60:63], s25 offen offset:1024 sc1
  buffer_load_dwordx4 a[88:91], v1, s[60:63], s25 offen offset:2048 sc1
  v_mfma_f32_32x32x16_bf16 v[136:151], a[52:55], a[200:203], v[136:151]
  ds_read_b64_tr_b16 a[16:17], v29 offset:128
  ds_read_b64_tr_b16 a[18:19], v29 offset:1024
  ds_read_b64_tr_b16 a[20:21], v29 offset:160
  ds_read_b64_tr_b16 a[22:23], v29 offset:1056
  ds_read_b64_tr_b16 a[24:25], v29 offset:192
  ds_read_b64_tr_b16 a[26:27], v29 offset:1088
  buffer_load_dwordx4 a[92:95], v1, s[60:63], s25 offen offset:3072 sc1
  v_mov_b32 v68, 0x7fff0000
  v_cmp_gt_u32 vcc, 0x380, v1
  s_nop 1
  v_cndmask_b32 v68, v68, v1, vcc
  s_add_u32 s14, s20, 0x1000
  buffer_load_dwordx4 v[216:219], v68, s[60:63], s20 offen sc1
  buffer_load_dwordx4 v[220:223], v68, s[60:63], s20 offen offset:1024 sc1
  s_waitcnt lgkmcnt(10)
  v_mfma_f32_32x32x16_bf16 v[152:167], a[56:59], a[200:203], v[152:167]
  buffer_load_dwordx4 v[224:227], v68, s[60:63], s20 offen offset:2048 sc1
  buffer_load_dwordx4 v[228:231], v68, s[60:63], s20 offen offset:3072 sc1
  buffer_load_dwordx4 v[232:235], v68, s[60:63], s14 offen sc1
  buffer_load_dwordx4 v[236:239], v68, s[60:63], s14 offen offset:1024 sc1
  buffer_load_dwordx4 v[240:243], v68, s[60:63], s14 offen offset:2048 sc1
  buffer_load_dwordx4 v[244:247], v68, s[60:63], s14 offen offset:3072 sc1
  v_mfma_f32_32x32x16_bf16 v[168:183], a[60:63], a[200:203], v[168:183]
  s_waitcnt lgkmcnt(0)
  s_barrier
  v_mfma_f32_32x32x16_bf16 v[72:87], a[0:3], a[204:207], v[72:87]
  v_add_u32 v26, 0x8000, v26
  ds_read_b64_tr_b16 a[28:29], v26
  ds_read_b64_tr_b16 a[30:31], v26 offset:896
  v_mfma_f32_32x32x16_bf16 v[88:103], a[4:7], a[204:207], v[88:103]
  ds_read_b64_tr_b16 a[32:33], v26 offset:32
  ds_read_b64_tr_b16 a[34:35], v26 offset:928
  s_add_u32 s95, s98, 0x700
  v_mfma_f32_32x32x16_bf16 v[104:119], a[8:11], a[204:207], v[104:119]
  ds_read_b64_tr_b16 a[36:37], v26 offset:64
  ds_read_b64_tr_b16 a[38:39], v26 offset:960
  s_and_b32 s95, s95, 0x7ff
  v_mfma_f32_32x32x16_bf16 v[120:135], a[12:15], a[204:207], v[120:135]
  ds_read_b64_tr_b16 a[40:41], v26 offset:96
  ds_read_b64_tr_b16 a[42:43], v26 offset:992
  s_add_u32 s95, s95, s80
  v_mfma_f32_32x32x16_bf16 v[136:151], a[16:19], a[204:207], v[136:151]
  ds_read_b64_tr_b16 a[44:45], v26 offset:128
  ds_read_b64_tr_b16 a[46:47], v26 offset:1024
  v_mfma_f32_32x32x16_bf16 v[152:167], a[20:23], a[204:207], v[152:167]
  ds_read_b64_tr_b16 a[48:49], v26 offset:160
  ds_read_b64_tr_b16 a[50:51], v26 offset:1056
  s_add_u32 m0, s72, 0x18000
  v_mfma_f32_32x32x16_bf16 v[168:183], a[24:27], a[204:207], v[168:183]
  ds_read_b64_tr_b16 a[52:53], v26 offset:192
  ds_read_b64_tr_b16 a[54:55], v26 offset:1088
  buffer_load_dwordx4 v22, s[52:55], s95 offen lds
  s_waitcnt lgkmcnt(8)
  v_mfma_f32_32x32x16_bf16 v[72:87], a[28:31], a[208:211], v[72:87]
  v_add_u32 v27, 0x8000, v27
  ds_read_b64_tr_b16 a[56:57], v27
  ds_read_b64_tr_b16 a[58:59], v27 offset:896
  buffer_load_dwordx4 v23, s[52:55], s95 offen offset:1024 lds
  v_mfma_f32_32x32x16_bf16 v[88:103], a[32:35], a[208:211], v[88:103]
  ds_read_b64_tr_b16 a[60:61], v27 offset:32
  ds_read_b64_tr_b16 a[62:63], v27 offset:928
  v_mfma_f32_32x32x16_bf16 v[104:119], a[36:39], a[208:211], v[104:119]
  ds_read_b64_tr_b16 a[0:1], v27 offset:64
  ds_read_b64_tr_b16 a[2:3], v27 offset:960
  buffer_load_dwordx4 v24, s[52:55], s95 offen offset:2048 lds
  s_waitcnt lgkmcnt(6)
  v_mfma_f32_32x32x16_bf16 v[120:135], a[40:43], a[208:211], v[120:135]
  ds_read_b64_tr_b16 a[4:5], v27 offset:96
  ds_read_b64_tr_b16 a[6:7], v27 offset:992
  buffer_load_dwordx4 v25, s[52:55], s95 offen offset:3072 lds
  v_mfma_f32_32x32x16_bf16 v[136:151], a[44:47], a[208:211], v[136:151]
  ds_read_b64_tr_b16 a[8:9], v27 offset:128
  ds_read_b64_tr_b16 a[10:11], v27 offset:1024
  s_add_u32 m0, s72, 0x1c000
  v_mfma_f32_32x32x16_bf16 v[152:167], a[48:51], a[208:211], v[152:167]
  ds_read_b64_tr_b16 a[12:13], v27 offset:160
  ds_read_b64_tr_b16 a[14:15], v27 offset:1056
  v_mfma_f32_32x32x16_bf16 v[168:183], a[52:55], a[208:211], v[168:183]
  ds_read_b64_tr_b16 a[16:17], v27 offset:192
  ds_read_b64_tr_b16 a[18:19], v27 offset:1088
  s_add_u32 s95, s95, 0x80
  s_waitcnt lgkmcnt(6)
  v_mfma_f32_32x32x16_bf16 v[72:87], a[56:59], a[212:215], v[72:87]
  v_add_u32 v28, 0x8000, v28
  ds_read_b64_tr_b16 a[20:21], v28
  ds_read_b64_tr_b16 a[22:23], v28 offset:896
  buffer_load_dwordx4 v22, s[52:55], s95 offen lds
  v_mfma_f32_32x32x16_bf16 v[88:103], a[60:63], a[212:215], v[88:103]
  ds_read_b64_tr_b16 a[24:25], v28 offset:32
  ds_read_b64_tr_b16 a[26:27], v28 offset:928
  buffer_load_dwordx4 v23, s[52:55], s95 offen offset:1024 lds
  v_mfma_f32_32x32x16_bf16 v[104:119], a[0:3], a[212:215], v[104:119]
  ds_read_b64_tr_b16 a[28:29], v28 offset:64
  ds_read_b64_tr_b16 a[30:31], v28 offset:960
  v_mfma_f32_32x32x16_bf16 v[120:135], a[4:7], a[212:215], v[120:135]
  ds_read_b64_tr_b16 a[32:33], v28 offset:96
  ds_read_b64_tr_b16 a[34:35], v28 offset:992
  buffer_load_dwordx4 v24, s[52:55], s95 offen offset:2048 lds
  s_waitcnt lgkmcnt(6)
  v_mfma_f32_32x32x16_bf16 v[136:151], a[8:11], a[212:215], v[136:151]
  ds_read_b64_tr_b16 a[36:37], v28 offset:128
  ds_read_b64_tr_b16 a[38:39], v28 offset:1024
  buffer_load_dwordx4 v25, s[52:55], s95 offen offset:3072 lds
  v_mfma_f32_32x32x16_bf16 v[152:167], a[12:15], a[212:215], v[152:167]
  ds_read_b64_tr_b16 a[40:41], v28 offset:160
  ds_read_b64_tr_b16 a[42:43], v28 offset:1056
  v_mfma_f32_32x32x16_bf16 v[168:183], a[16:19], a[212:215], v[168:183]
  ds_read_b64_tr_b16 a[44:45], v28 offset:192
  ds_read_b64_tr_b16 a[46:47], v28 offset:1088
  v_mfma_f32_32x32x16_bf16 v[72:87], a[20:23], a[216:219], v[72:87]
  v_add_u32 v29, 0x8000, v29
  ds_read_b64_tr_b16 a[48:49], v29
  ds_read_b64_tr_b16 a[50:51], v29 offset:896
  s_waitcnt lgkmcnt(6)
  v_mfma_f32_32x32x16_bf16 v[88:103], a[24:27], a[216:219], v[88:103]
  ds_read_b64_tr_b16 a[52:53], v29 offset:32
  ds_read_b64_tr_b16 a[54:55], v29 offset:928
  v_mfma_f32_32x32x16_bf16 v[104:119], a[28:31], a[216:219], v[104:119]
  ds_read_b64_tr_b16 a[56:57], v29 offset:64
  ds_read_b64_tr_b16 a[58:59], v29 offset:960
  v_mfma_f32_32x32x16_bf16 v[120:135], a[32:35], a[216:219], v[120:135]
  ds_read_b64_tr_b16 a[60:61], v29 offset:96
  ds_read_b64_tr_b16 a[62:63], v29 offset:992
  v_mfma_f32_32x32x16_bf16 v[136:151], a[36:39], a[216:219], v[136:151]
  ds_read_b64_tr_b16 a[0:1], v29 offset:128
  ds_read_b64_tr_b16 a[2:3], v29 offset:1024
  ds_read_b64_tr_b16 a[4:5], v29 offset:160
  ds_read_b64_tr_b16 a[6:7], v29 offset:1056
  ds_read_b64_tr_b16 a[8:9], v29 offset:192
  ds_read_b64_tr_b16 a[10:11], v29 offset:1088
  s_waitcnt lgkmcnt(10)
  v_mfma_f32_32x32x16_bf16 v[152:167], a[40:43], a[216:219], v[152:167]
  v_mfma_f32_32x32x16_bf16 v[168:183], a[44:47], a[216:219], v[168:183]
  s_waitcnt lgkmcnt(0)
  s_barrier
  v_mfma_f32_32x32x16_bf16 v[72:87], a[48:51], a[220:223], v[72:87]
  v_subrev_u32 v26, 0x20000, v26
  ds_read_b64_tr_b16 a[12:13], v26
  ds_read_b64_tr_b16 a[14:15], v26 offset:896
  v_mfma_f32_32x32x16_bf16 v[88:103], a[52:55], a[220:223], v[88:103]
  ds_read_b64_tr_b16 a[16:17], v26 offset:32
  ds_read_b64_tr_b16 a[18:19], v26 offset:928
  v_mfma_f32_32x32x16_bf16 v[104:119], a[56:59], a[220:223], v[104:119]
  ds_read_b64_tr_b16 a[20:21], v26 offset:64
  ds_read_b64_tr_b16 a[22:23], v26 offset:960
  v_mfma_f32_32x32x16_bf16 v[120:135], a[60:63], a[220:223], v[120:135]
  ds_read_b64_tr_b16 a[24:25], v26 offset:96
  ds_read_b64_tr_b16 a[26:27], v26 offset:992
  v_mfma_f32_32x32x16_bf16 v[136:151], a[0:3], a[220:223], v[136:151]
  ds_read_b64_tr_b16 a[28:29], v26 offset:128
  ds_read_b64_tr_b16 a[30:31], v26 offset:1024
  v_mfma_f32_32x32x16_bf16 v[152:167], a[4:7], a[220:223], v[152:167]
  ds_read_b64_tr_b16 a[32:33], v26 offset:160
  ds_read_b64_tr_b16 a[34:35], v26 offset:1056
  v_mfma_f32_32x32x16_bf16 v[168:183], a[8:11], a[220:223], v[168:183]
  ds_read_b64_tr_b16 a[36:37], v26 offset:192
  ds_read_b64_tr_b16 a[38:39], v26 offset:1088
  s_waitcnt lgkmcnt(8)
  v_mfma_f32_32x32x16_bf16 v[72:87], a[12:15], a[224:227], v[72:87]
  v_subrev_u32 v27, 0x20000, v27
  ds_read_b64_tr_b16 a[40:41], v27
  ds_read_b64_tr_b16 a[42:43], v27 offset:896
  v_lshlrev_b32 v69, 3, v47
  v_lshrrev_b32 v71, 5, v0
  v_mfma_f32_32x32x16_bf16 v[88:103], a[16:19], a[224:227], v[88:103]
  ds_read_b64_tr_b16 a[44:45], v27 offset:32
  ds_read_b64_tr_b16 a[46:47], v27 offset:928
  v_bfe_u32 v70, v0, 1, 3
  v_xor_b32 v70, v70, v71
  v_mfma_f32_32x32x16_bf16 v[104:119], a[20:23], a[224:227], v[104:119]
  ds_read_b64_tr_b16 a[48:49], v27 offset:64
  ds_read_b64_tr_b16 a[50:51], v27 offset:960
  v_xor_b32 v71, 0, v70
  v_lshl_add_u32 v7, v71, 4, v69
  s_waitcnt lgkmcnt(6)
  v_mfma_f32_32x32x16_bf16 v[120:135], a[24:27], a[224:227], v[120:135]
  ds_read_b64_tr_b16 a[52:53], v27 offset:96
  ds_read_b64_tr_b16 a[54:55], v27 offset:992
  v_add_u32 v11, 0x10000, v7
  v_add_u32 v15, 0x20000, v7
  v_mfma_f32_32x32x16_bf16 v[136:151], a[28:31], a[224:227], v[136:151]
  ds_read_b64_tr_b16 a[56:57], v27 offset:128
  ds_read_b64_tr_b16 a[58:59], v27 offset:1024
  v_xor_b32 v71, 2, v70
  v_lshl_add_u32 v8, v71, 4, v69
  v_mfma_f32_32x32x16_bf16 v[152:167], a[32:35], a[224:227], v[152:167]
  ds_read_b64_tr_b16 a[60:61], v27 offset:160
  ds_read_b64_tr_b16 a[62:63], v27 offset:1056
  v_add_u32 v12, 0x10000, v8
  v_add_u32 v16, 0x20000, v8
  v_mfma_f32_32x32x16_bf16 v[168:183], a[36:39], a[224:227], v[168:183]
  ds_read_b64_tr_b16 a[0:1], v27 offset:192
  ds_read_b64_tr_b16 a[2:3], v27 offset:1088
  v_xor_b32 v71, 4, v70
  v_lshl_add_u32 v9, v71, 4, v69
  s_waitcnt lgkmcnt(6)
  v_mfma_f32_32x32x16_bf16 v[72:87], a[40:43], a[228:231], v[72:87]
  v_subrev_u32 v28, 0x20000, v28
  ds_read_b64_tr_b16 a[4:5], v28
  ds_read_b64_tr_b16 a[6:7], v28 offset:896
  v_add_u32 v13, 0x10000, v9
  v_add_u32 v17, 0x20000, v9
  v_mfma_f32_32x32x16_bf16 v[88:103], a[44:47], a[228:231], v[88:103]
  ds_read_b64_tr_b16 a[8:9], v28 offset:32
  ds_read_b64_tr_b16 a[10:11], v28 offset:928
  v_xor_b32 v71, 6, v70
  v_lshl_add_u32 v10, v71, 4, v69
  v_mfma_f32_32x32x16_bf16 v[104:119], a[48:51], a[228:231], v[104:119]
  ds_read_b64_tr_b16 a[12:13], v28 offset:64
  ds_read_b64_tr_b16 a[14:15], v28 offset:960
  v_add_u32 v14, 0x10000, v10
  v_add_u32 v18, 0x20000, v10
  v_mfma_f32_32x32x16_bf16 v[120:135], a[52:55], a[228:231], v[120:135]
  ds_read_b64_tr_b16 a[16:17], v28 offset:96
  ds_read_b64_tr_b16 a[18:19], v28 offset:992
  s_waitcnt lgkmcnt(6)
  v_mfma_f32_32x32x16_bf16 v[136:151], a[56:59], a[228:231], v[136:151]
  ds_read_b64_tr_b16 a[20:21], v28 offset:128
  ds_read_b64_tr_b16 a[22:23], v28 offset:1024
  v_mfma_f32_32x32x16_bf16 v[152:167], a[60:63], a[228:231], v[152:167]
  ds_read_b64_tr_b16 a[24:25], v28 offset:160
  ds_read_b64_tr_b16 a[26:27], v28 offset:1056
  v_mfma_f32_32x32x16_bf16 v[168:183], a[0:3], a[228:231], v[168:183]
  ds_read_b64_tr_b16 a[28:29], v28 offset:192
  ds_read_b64_tr_b16 a[30:31], v28 offset:1088
  v_mfma_f32_32x32x16_bf16 v[72:87], a[4:7], a[232:235], v[72:87]
  v_subrev_u32 v29, 0x20000, v29
  ds_read_b64_tr_b16 a[32:33], v29
  ds_read_b64_tr_b16 a[34:35], v29 offset:896
  s_add_u32 s95, s98, 0x100
  s_and_b32 s95, s95, 0x7ff
  s_waitcnt lgkmcnt(6)
  v_mfma_f32_32x32x16_bf16 v[88:103], a[8:11], a[232:235], v[88:103]
  ds_read_b64_tr_b16 a[36:37], v29 offset:32
  ds_read_b64_tr_b16 a[38:39], v29 offset:928
  s_add_u32 s95, s95, s80
  s_add_u32 m0, s72, 0x20000
  s_nop 0
  buffer_load_dwordx4 v22, s[52:55], s95 offen lds
  v_mfma_f32_32x32x16_bf16 v[104:119], a[12:15], a[232:235], v[104:119]
  ds_read_b64_tr_b16 a[40:41], v29 offset:64
  ds_read_b64_tr_b16 a[42:43], v29 offset:960
  buffer_load_dwordx4 v23, s[52:55], s95 offen offset:1024 lds
  buffer_load_dwordx4 v24, s[52:55], s95 offen offset:2048 lds
  buffer_load_dwordx4 v25, s[52:55], s95 offen offset:3072 lds
  v_mfma_f32_32x32x16_bf16 v[120:135], a[16:19], a[232:235], v[120:135]
  ds_read_b64_tr_b16 a[44:45], v29 offset:96
  ds_read_b64_tr_b16 a[46:47], v29 offset:992
  s_add_u32 m0, s72, 0x24000
  s_add_u32 s95, s95, 0x80
  buffer_load_dwordx4 v22, s[52:55], s95 offen lds
  v_mfma_f32_32x32x16_bf16 v[136:151], a[20:23], a[232:235], v[136:151]
  ds_read_b64_tr_b16 a[48:49], v29 offset:128
  ds_read_b64_tr_b16 a[50:51], v29 offset:1024
  ds_read_b64_tr_b16 a[52:53], v29 offset:160
  ds_read_b64_tr_b16 a[54:55], v29 offset:1056
  ds_read_b64_tr_b16 a[56:57], v29 offset:192
  ds_read_b64_tr_b16 a[58:59], v29 offset:1088
  buffer_load_dwordx4 v23, s[52:55], s95 offen offset:1024 lds
  buffer_load_dwordx4 v24, s[52:55], s95 offen offset:2048 lds
  buffer_load_dwordx4 v25, s[52:55], s95 offen offset:3072 lds
  s_waitcnt lgkmcnt(10)
  v_mfma_f32_32x32x16_bf16 v[152:167], a[24:27], a[232:235], v[152:167]
  s_add_u32 s25, s100, 0x2000
  s_and_b32 s25, s25, 0xffff
  s_add_u32 s25, s25, s79
  v_mfma_f32_32x32x16_bf16 v[168:183], a[28:31], a[232:235], v[168:183]
  buffer_load_dwordx4 a[96:99], v1, s[60:63], s25 offen sc1
  buffer_load_dwordx4 a[100:103], v1, s[60:63], s25 offen offset:1024 sc1
  buffer_load_dwordx4 a[104:107], v1, s[60:63], s25 offen offset:2048 sc1
  s_waitcnt lgkmcnt(0)
  s_barrier
  v_mfma_f32_32x32x16_bf16 v[72:87], a[32:35], a[236:239], v[72:87]
  v_add_u32 v26, 0x8000, v26
  ds_read_b64_tr_b16 a[60:61], v26
  ds_read_b64_tr_b16 a[62:63], v26 offset:896
  buffer_load_dwordx4 a[108:111], v1, s[60:63], s25 offen offset:3072 sc1
  s_add_u32 s25, s25, 0x1000
  buffer_load_dwordx4 a[112:115], v1, s[60:63], s25 offen sc1
  v_mfma_f32_32x32x16_bf16 v[88:103], a[36:39], a[236:239], v[88:103]
  ds_read_b64_tr_b16 a[0:1], v26 offset:32
  ds_read_b64_tr_b16 a[2:3], v26 offset:928
  buffer_load_dwordx4 a[116:119], v1, s[60:63], s25 offen offset:1024 sc1
  buffer_load_dwordx4 a[120:123], v1, s[60:63], s25 offen offset:2048 sc1
  v_mfma_f32_32x32x16_bf16 v[104:119], a[40:43], a[236:239], v[104:119]
  ds_read_b64_tr_b16 a[4:5], v26 offset:64
  ds_read_b64_tr_b16 a[6:7], v26 offset:960
  buffer_load_dwordx4 a[124:127], v1, s[60:63], s25 offen offset:3072 sc1
  v_mfma_f32_32x32x16_bf16 v[120:135], a[44:47], a[236:239], v[120:135]
  ds_read_b64_tr_b16 a[8:9], v26 offset:96
  ds_read_b64_tr_b16 a[10:11], v26 offset:992
  v_mov_b32 v60, 0
  v_mov_b32 v61, 0
  v_mov_b32 v62, 0
  v_mov_b32 v63, 0
  s_waitcnt vmcnt(31)
  v_dot2c_f32_bf16 v60, 0x3f803f80, v216
  v_dot2c_f32_bf16 v61, 0x3f803f80, v217
  v_dot2c_f32_bf16 v62, 0x3f803f80, v218
  v_mfma_f32_32x32x16_bf16 v[136:151], a[48:51], a[236:239], v[136:151]
  ds_read_b64_tr_b16 a[12:13], v26 offset:128
  ds_read_b64_tr_b16 a[14:15], v26 offset:1024
  v_dot2c_f32_bf16 v63, 0x3f803f80, v219
  s_waitcnt vmcnt(30)
  v_dot2c_f32_bf16 v60, 0x3f803f80, v220
  v_dot2c_f32_bf16 v61, 0x3f803f80, v221
  v_dot2c_f32_bf16 v62, 0x3f803f80, v222
  v_dot2c_f32_bf16 v63, 0x3f803f80, v223
  s_waitcnt vmcnt(29)
  v_dot2c_f32_bf16 v60, 0x3f803f80, v224
  v_dot2c_f32_bf16 v61, 0x3f803f80, v225
  v_mfma_f32_32x32x16_bf16 v[152:167], a[52:55], a[236:239], v[152:167]
  ds_read_b64_tr_b16 a[16:17], v26 offset:160
  ds_read_b64_tr_b16 a[18:19], v26 offset:1056
  v_dot2c_f32_bf16 v62, 0x3f803f80, v226
  v_dot2c_f32_bf16 v63, 0x3f803f80, v227
  s_waitcnt vmcnt(28)
  v_dot2c_f32_bf16 v60, 0x3f803f80, v228
  v_dot2c_f32_bf16 v61, 0x3f803f80, v229
  v_dot2c_f32_bf16 v62, 0x3f803f80, v230
  v_dot2c_f32_bf16 v63, 0x3f803f80, v231
  s_waitcnt vmcnt(27)
  v_dot2c_f32_bf16 v60, 0x3f803f80, v232
  v_dot2c_f32_bf16 v61, 0x3f803f80, v233
  v_mfma_f32_32x32x16_bf16 v[168:183], a[56:59], a[236:239], v[168:183]
  ds_read_b64_tr_b16 a[20:21], v26 offset:192
  ds_read_b64_tr_b16 a[22:23], v26 offset:1088
  v_dot2c_f32_bf16 v62, 0x3f803f80, v234
  v_dot2c_f32_bf16 v63, 0x3f803f80, v235
  s_waitcnt vmcnt(26)
  v_dot2c_f32_bf16 v60, 0x3f803f80, v236
  v_dot2c_f32_bf16 v61, 0x3f803f80, v237
  v_dot2c_f32_bf16 v62, 0x3f803f80, v238
  v_dot2c_f32_bf16 v63, 0x3f803f80, v239
  s_waitcnt vmcnt(25)
  v_dot2c_f32_bf16 v60, 0x3f803f80, v240
  s_waitcnt lgkmcnt(8)
  v_mfma_f32_32x32x16_bf16 v[72:87], a[60:63], a[240:243], v[72:87]
  v_add_u32 v27, 0x8000, v27
  ds_read_b64_tr_b16 a[24:25], v27
  ds_read_b64_tr_b16 a[26:27], v27 offset:896
  v_dot2c_f32_bf16 v61, 0x3f803f80, v241
  v_dot2c_f32_bf16 v62, 0x3f803f80, v242
  v_dot2c_f32_bf16 v63, 0x3f803f80, v243
  s_waitcnt vmcnt(24)
  v_dot2c_f32_bf16 v60, 0x3f803f80, v244
  v_dot2c_f32_bf16 v61, 0x3f803f80, v245
  v_dot2c_f32_bf16 v62, 0x3f803f80, v246
  v_dot2c_f32_bf16 v63, 0x3f803f80, v247
  v_cvt_pk_bf16_f32 v64, v60, v60
  v_mfma_f32_32x32x16_bf16 v[88:103], a[0:3], a[240:243], v[88:103]
  ds_read_b64_tr_b16 a[28:29], v27 offset:32
  ds_read_b64_tr_b16 a[30:31], v27 offset:928
  v_and_b32 v64, 0xffff0000, v64
  v_sub_f32 v64, v60, v64
  v_cvt_pk_bf16_f32 v64, v60, v64
  v_cvt_pk_bf16_f32 v65, v61, v61
  v_and_b32 v65, 0xffff0000, v65
  v_sub_f32 v65, v61, v65
  v_cvt_pk_bf16_f32 v65, v61, v65
  v_mfma_f32_32x32x16_bf16 v[104:119], a[4:7], a[240:243], v[104:119]
  ds_read_b64_tr_b16 a[32:33], v27 offset:64
  ds_read_b64_tr_b16 a[34:35], v27 offset:960
  v_cvt_pk_bf16_f32 v66, v62, v62
  v_and_b32 v66, 0xffff0000, v66
  v_sub_f32 v66, v62, v66
  v_cvt_pk_bf16_f32 v66, v62, v66
  v_cvt_pk_bf16_f32 v67, v63, v63
  v_and_b32 v67, 0xffff0000, v67
  v_sub_f32 v67, v63, v67
  v_cvt_pk_bf16_f32 v67, v63, v67
  s_waitcnt lgkmcnt(6)
  v_mfma_f32_32x32x16_bf16 v[120:135], a[8:11], a[240:243], v[120:135]
  ds_read_b64_tr_b16 a[36:37], v27 offset:96
  ds_read_b64_tr_b16 a[38:39], v27 offset:992
  v_add_u32 v68, 0xf080, v1
  ds_write_b128 v68, v[64:67]
  v_lshrrev_b32 v68, 2, v47
  v_add_u32 v68, 0xf080, v68
  ds_read_b32 v216, v68
  ds_read_b32 v220, v68 offset:128
  ds_read_b32 v224, v68 offset:256
  v_mfma_f32_32x32x16_bf16 v[136:151], a[12:15], a[240:243], v[136:151]
  ds_read_b64_tr_b16 a[40:41], v27 offset:128
  ds_read_b64_tr_b16 a[42:43], v27 offset:1024
  ds_read_b32 v228, v68 offset:384
  ds_read_b32 v232, v68 offset:512
  ds_read_b32 v236, v68 offset:640
  ds_read_b32 v240, v68 offset:768
  v_mov_b32 v41, 0
  v_mov_b32 v42, 0
  v_mov_b32 v43, 0
  v_cmp_gt_u32 vcc, 32, v0
  s_nop 1
  v_cndmask_b32 v40, 0, v40, vcc
  v_mfma_f32_32x32x16_bf16 v[152:167], a[16:19], a[240:243], v[152:167]
  ds_read_b64_tr_b16 a[44:45], v27 offset:160
  ds_read_b64_tr_b16 a[46:47], v27 offset:1056
  v_mfma_f32_32x32x16_bf16 v[168:183], a[20:23], a[240:243], v[168:183]
  ds_read_b64_tr_b16 a[48:49], v27 offset:192
  ds_read_b64_tr_b16 a[50:51], v27 offset:1088
  s_add_u32 s25, s100, 0x4000
  s_and_b32 s25, s25, 0xffff
  s_waitcnt lgkmcnt(14)
  v_mfma_f32_32x32x16_bf16 v[72:87], a[24:27], a[244:247], v[72:87]
  v_add_u32 v28, 0x8000, v28
  ds_read_b64_tr_b16 a[52:53], v28
  ds_read_b64_tr_b16 a[54:55], v28 offset:896
  s_add_u32 s25, s25, s79
  buffer_load_dwordx4 a[128:131], v1, s[60:63], s25 offen sc1
  v_mfma_f32_32x32x16_bf16 v[88:103], a[28:31], a[244:247], v[88:103]
  ds_read_b64_tr_b16 a[56:57], v28 offset:32
  ds_read_b64_tr_b16 a[58:59], v28 offset:928
  buffer_load_dwordx4 a[132:135], v1, s[60:63], s25 offen offset:1024 sc1
  buffer_load_dwordx4 a[136:139], v1, s[60:63], s25 offen offset:2048 sc1
  v_mfma_f32_32x32x16_bf16 v[104:119], a[32:35], a[244:247], v[104:119]
  ds_read_b64_tr_b16 a[60:61], v28 offset:64
  ds_read_b64_tr_b16 a[62:63], v28 offset:960
  buffer_load_dwordx4 a[140:143], v1, s[60:63], s25 offen offset:3072 sc1
  s_add_u32 s25, s25, 0x1000
  buffer_load_dwordx4 a[144:147], v1, s[60:63], s25 offen sc1
  v_mfma_f32_32x32x16_bf16 v[120:135], a[36:39], a[244:247], v[120:135]
  ds_read_b64_tr_b16 a[0:1], v28 offset:96
  ds_read_b64_tr_b16 a[2:3], v28 offset:992
  buffer_load_dwordx4 a[148:151], v1, s[60:63], s25 offen offset:1024 sc1
  buffer_load_dwordx4 a[152:155], v1, s[60:63], s25 offen offset:2048 sc1
  s_waitcnt lgkmcnt(6)
  v_mfma_f32_32x32x16_bf16 v[136:151], a[40:43], a[244:247], v[136:151]
  ds_read_b64_tr_b16 a[4:5], v28 offset:128
  ds_read_b64_tr_b16 a[6:7], v28 offset:1024
  buffer_load_dwordx4 a[156:159], v1, s[60:63], s25 offen offset:3072 sc1
  s_add_u32 s95, s98, 0x200
  v_mfma_f32_32x32x16_bf16 v[152:167], a[44:47], a[244:247], v[152:167]
  ds_read_b64_tr_b16 a[8:9], v28 offset:160
  ds_read_b64_tr_b16 a[10:11], v28 offset:1056
  s_and_b32 s95, s95, 0x7ff
  s_add_u32 s95, s95, s80
  v_mfma_f32_32x32x16_bf16 v[168:183], a[48:51], a[244:247], v[168:183]
  ds_read_b64_tr_b16 a[12:13], v28 offset:192
  ds_read_b64_tr_b16 a[14:15], v28 offset:1088
  s_add_u32 m0, s72, 0
  s_nop 0
  buffer_load_dwordx4 v22, s[52:55], s95 offen lds
  buffer_load_dwordx4 v23, s[52:55], s95 offen offset:1024 lds
  v_mfma_f32_32x32x16_bf16 v[72:87], a[52:55], a[248:251], v[72:87]
  v_add_u32 v29, 0x8000, v29
  ds_read_b64_tr_b16 a[16:17], v29
  ds_read_b64_tr_b16 a[18:19], v29 offset:896
  buffer_load_dwordx4 v24, s[52:55], s95 offen offset:2048 lds
  buffer_load_dwordx4 v25, s[52:55], s95 offen offset:3072 lds
  s_waitcnt lgkmcnt(6)
  v_mfma_f32_32x32x16_bf16 v[88:103], a[56:59], a[248:251], v[88:103]
  ds_read_b64_tr_b16 a[20:21], v29 offset:32
  ds_read_b64_tr_b16 a[22:23], v29 offset:928
  s_add_u32 m0, s72, 0x4000
  s_add_u32 s95, s95, 0x80
  v_mfma_f32_32x32x16_bf16 v[104:119], a[60:63], a[248:251], v[104:119]
  ds_read_b64_tr_b16 a[24:25], v29 offset:64
  ds_read_b64_tr_b16 a[26:27], v29 offset:960
  buffer_load_dwordx4 v22, s[52:55], s95 offen lds
  buffer_load_dwordx4 v23, s[52:55], s95 offen offset:1024 lds
  buffer_load_dwordx4 v24, s[52:55], s95 offen offset:2048 lds
  v_mfma_f32_32x32x16_bf16 v[120:135], a[0:3], a[248:251], v[120:135]
  ds_read_b64_tr_b16 a[28:29], v29 offset:96
  ds_read_b64_tr_b16 a[30:31], v29 offset:992
  buffer_load_dwordx4 v25, s[52:55], s95 offen offset:3072 lds
  v_lshrrev_b32 v5, 3, v0
  v_mfma_f32_32x32x16_bf16 v[136:151], a[4:7], a[248:251], v[136:151]
  ds_read_b64_tr_b16 a[32:33], v29 offset:128
  ds_read_b64_tr_b16 a[34:35], v29 offset:1024
  v_lshlrev_b32 v5, 10, v5
  v_bfe_u32 v3, v0, 4, 1
  s_waitcnt lgkmcnt(6)
  v_mfma_f32_32x32x16_bf16 v[152:167], a[8:11], a[248:251], v[152:167]
  ds_read_b64_tr_b16 a[36:37], v29 offset:160
  ds_read_b64_tr_b16 a[38:39], v29 offset:1056
  v_lshlrev_b32 v3, 2, v3
  v_and_b32 v4, 7, v0
  v_mfma_f32_32x32x16_bf16 v[168:183], a[12:15], a[248:251], v[168:183]
  ds_read_b64_tr_b16 a[40:41], v29 offset:192
  ds_read_b64_tr_b16 a[42:43], v29 offset:1088
  v_xor_b32 v3, v3, v4
  v_lshl_add_u32 v2, v3, 4, v5
  v_add_u32 v3, 0x1c00, v2
  v_mfma_f32_32x32x16_bf16 v[72:87], a[16:19], a[252:255], v[72:87]
  v_add_u32 v4, 0x3800, v2
  v_add_u32 v5, 0x5400, v2
  v_mfma_f32_32x32x16_bf16 v[88:103], a[20:23], a[252:255], v[88:103]
  s_add_u32 s25, s100, 0x6000
  s_and_b32 s25, s25, 0xffff
  s_waitcnt lgkmcnt(2)
  v_mfma_f32_32x32x16_bf16 v[104:119], a[24:27], a[252:255], v[104:119]
  s_add_u32 s25, s25, s79
  buffer_load_dwordx4 a[160:163], v1, s[60:63], s25 offen sc1
  buffer_load_dwordx4 a[164:167], v1, s[60:63], s25 offen offset:1024 sc1
  v_mfma_f32_32x32x16_bf16 v[120:135], a[28:31], a[252:255], v[120:135]
  buffer_load_dwordx4 a[168:171], v1, s[60:63], s25 offen offset:2048 sc1
  buffer_load_dwordx4 a[172:175], v1, s[60:63], s25 offen offset:3072 sc1
  v_mfma_f32_32x32x16_bf16 v[136:151], a[32:35], a[252:255], v[136:151]
  s_add_u32 s25, s25, 0x1000
  buffer_load_dwordx4 a[176:179], v1, s[60:63], s25 offen sc1
  v_mfma_f32_32x32x16_bf16 v[152:167], a[36:39], a[252:255], v[152:167]
  buffer_load_dwordx4 a[180:183], v1, s[60:63], s25 offen offset:1024 sc1
  buffer_load_dwordx4 a[184:187], v1, s[60:63], s25 offen offset:2048 sc1
  s_waitcnt lgkmcnt(0)
  v_mfma_f32_32x32x16_bf16 v[168:183], a[40:43], a[252:255], v[168:183]
  buffer_load_dwordx4 a[188:191], v1, s[60:63], s25 offen offset:3072 sc1
  s_barrier
  v_mfma_f32_32x32x16_bf16 v[72:87], v[216:219], v[40:43], v[72:87]
  ds_read_b128 a[44:47], v11
  s_add_u32 s95, s98, 0x300
  v_mfma_f32_32x32x16_bf16 v[88:103], v[220:223], v[40:43], v[88:103]
  ds_read_b128 a[48:51], v11 offset:4096
  s_and_b32 s95, s95, 0x7ff
  v_mfma_f32_32x32x16_bf16 v[104:119], v[224:227], v[40:43], v[104:119]
  ds_read_b128 a[52:55], v11 offset:8192
  s_add_u32 s95, s95, s80
  v_mfma_f32_32x32x16_bf16 v[120:135], v[228:231], v[40:43], v[120:135]
  ds_read_b128 a[56:59], v11 offset:12288
  s_add_u32 m0, s72, 0x8000
  v_mfma_f32_32x32x16_bf16 v[136:151], v[232:235], v[40:43], v[136:151]
  ds_read_b128 a[60:63], v12
  buffer_load_dwordx4 v22, s[52:55], s95 offen lds
  v_mfma_f32_32x32x16_bf16 v[152:167], v[236:239], v[40:43], v[152:167]
  ds_read_b128 a[0:3], v12 offset:4096
  buffer_load_dwordx4 v23, s[52:55], s95 offen offset:1024 lds
  v_mfma_f32_32x32x16_bf16 v[168:183], v[240:243], v[40:43], v[168:183]
  ds_read_b128 a[4:7], v12 offset:8192
  buffer_load_dwordx4 v24, s[52:55], s95 offen offset:2048 lds
  s_waitcnt lgkmcnt(3)
  v_mfma_f32_32x32x16_bf16 v[184:199], a[64:67], a[44:47], 0
  ds_read_b128 a[8:11], v12 offset:12288
  buffer_load_dwordx4 v25, s[52:55], s95 offen offset:3072 lds
  v_mfma_f32_32x32x16_bf16 v[200:215], a[64:67], a[48:51], 0
  ds_read_b128 a[12:15], v13
  s_add_u32 m0, s72, 0xc000
  v_mfma_f32_32x32x16_bf16 v[216:231], a[64:67], a[52:55], 0
  ds_read_b128 a[16:19], v13 offset:4096
  s_add_u32 s95, s95, 0x80
  v_mul_f32 v64, v72, v72
  v_mul_f32 v65, v73, v73
  v_fma_f32 v64, v64, v45, v44
  v_fma_f32 v65, v65, v45, v44
  v_mfma_f32_32x32x16_bf16 v[232:247], a[64:67], a[56:59], 0
  ds_read_b128 a[20:23], v13 offset:8192
  buffer_load_dwordx4 v22, s[52:55], s95 offen lds
  v_mul_f32 v64, v64, v72
  v_mul_f32 v65, v65, v73
  v_exp_f32 v64, v64
  v_mul_f32 v80, v72, v80
  s_waitcnt lgkmcnt(3)
  v_mfma_f32_32x32x16_bf16 v[184:199], a[68:71], a[60:63], v[184:199]
  ds_read_b128 a[24:27], v13 offset:12288
  buffer_load_dwordx4 v23, s[52:55], s95 offen offset:1024 lds
  v_exp_f32 v65, v65
  v_mul_f32 v81, v73, v81
  v_fma_f32 v64, v64, v46, v46
  v_fma_f32 v65, v65, v46, v46
  v_mfma_f32_32x32x16_bf16 v[200:215], a[68:71], a[0:3], v[200:215]
  ds_read_b128 a[28:31], v14
  buffer_load_dwordx4 v24, s[52:55], s95 offen offset:2048 lds
  v_rcp_f32 v64, v64
  v_rcp_f32 v65, v65
  v_mul_f32 v80, v80, v64
  v_mul_f32 v81, v81, v65
  v_mfma_f32_32x32x16_bf16 v[216:231], a[68:71], a[4:7], v[216:231]
  ds_read_b128 a[32:35], v14 offset:4096
  buffer_load_dwordx4 v25, s[52:55], s95 offen offset:3072 lds
  v_cvt_pk_bf16_f32 v72, v80, v81
  v_mul_f32 v64, v74, v74
  v_mul_f32 v65, v75, v75
  v_fma_f32 v64, v64, v45, v44
  v_mfma_f32_32x32x16_bf16 v[232:247], a[68:71], a[8:11], v[232:247]
  ds_read_b128 a[36:39], v14 offset:8192
  s_add_u32 s25, s100, 0xe000
  v_fma_f32 v65, v65, v45, v44
  v_mul_f32 v64, v64, v74
  v_mul_f32 v65, v65, v75
  v_exp_f32 v64, v64
  s_waitcnt lgkmcnt(3)
  v_mfma_f32_32x32x16_bf16 v[184:199], a[72:75], a[12:15], v[184:199]
  ds_read_b128 a[40:43], v14 offset:12288
  s_and_b32 s25, s25, 0xffff
  v_mul_f32 v82, v74, v82
  v_exp_f32 v65, v65
  v_mul_f32 v83, v75, v83
  v_fma_f32 v64, v64, v46, v46
  v_mfma_f32_32x32x16_bf16 v[200:215], a[72:75], a[16:19], v[200:215]
  ds_read_b128 a[44:47], v11 offset:16384
  s_add_u32 s25, s25, s79
  v_fma_f32 v65, v65, v46, v46
  v_rcp_f32 v64, v64
  v_rcp_f32 v65, v65
  v_mul_f32 v82, v82, v64
  v_mfma_f32_32x32x16_bf16 v[216:231], a[72:75], a[20:23], v[216:231]
  ds_read_b128 a[48:51], v11 offset:20480
  buffer_load_dwordx4 a[192:195], v1, s[60:63], s25 offen sc1
  v_mul_f32 v83, v83, v65
  v_cvt_pk_bf16_f32 v73, v82, v83
  v_mul_f32 v64, v76, v76
  v_mul_f32 v65, v77, v77
  v_mfma_f32_32x32x16_bf16 v[232:247], a[72:75], a[24:27], v[232:247]
  ds_read_b128 a[52:55], v11 offset:24576
  buffer_load_dwordx4 a[196:199], v1, s[60:63], s25 offen offset:1024 sc1
  v_fma_f32 v64, v64, v45, v44
  v_fma_f32 v65, v65, v45, v44
  v_mul_f32 v64, v64, v76
  v_mul_f32 v65, v65, v77
  s_waitcnt lgkmcnt(3)
  v_mfma_f32_32x32x16_bf16 v[184:199], a[76:79], a[28:31], v[184:199]
  ds_read_b128 a[56:59], v11 offset:28672
  buffer_load_dwordx4 a[200:203], v1, s[60:63], s25 offen offset:2048 sc1
  v_exp_f32 v64, v64
  v_mul_f32 v84, v76, v84
  v_exp_f32 v65, v65
  v_mul_f32 v85, v77, v85
  v_mfma_f32_32x32x16_bf16 v[200:215], a[76:79], a[32:35], v[200:215]
  ds_read_b128 a[60:63], v12 offset:16384
  buffer_load_dwordx4 a[204:207], v1, s[60:63], s25 offen offset:3072 sc1
  v_fma_f32 v64, v64, v46, v46
  v_fma_f32 v65, v65, v46, v46
  v_rcp_f32 v64, v64
  v_rcp_f32 v65, v65
  v_mfma_f32_32x32x16_bf16 v[216:231], a[76:79], a[36:39], v[216:231]
  ds_read_b128 a[0:3], v12 offset:20480
  s_add_u32 s25, s25, 0x1000
  v_mul_f32 v84, v84, v64
  v_mul_f32 v85, v85, v65
  v_cvt_pk_bf16_f32 v74, v84, v85
  v_mul_f32 v64, v78, v78
  v_mfma_f32_32x32x16_bf16 v[232:247], a[76:79], a[40:43], v[232:247]
  ds_read_b128 a[4:7], v12 offset:24576
  buffer_load_dwordx4 a[208:211], v1, s[60:63], s25 offen sc1
  v_mul_f32 v65, v79, v79
  v_fma_f32 v64, v64, v45, v44
  v_fma_f32 v65, v65, v45, v44
  v_mul_f32 v64, v64, v78
  s_waitcnt lgkmcnt(3)
  v_mfma_f32_32x32x16_bf16 v[184:199], a[80:83], a[44:47], v[184:199]
  ds_read_b128 a[8:11], v12 offset:28672
  buffer_load_dwordx4 a[212:215], v1, s[60:63], s25 offen offset:1024 sc1
  v_mul_f32 v65, v65, v79
  v_exp_f32 v64, v64
  v_mul_f32 v86, v78, v86
  v_exp_f32 v65, v65
  v_mfma_f32_32x32x16_bf16 v[200:215], a[80:83], a[48:51], v[200:215]
  ds_read_b128 a[12:15], v13 offset:16384
  buffer_load_dwordx4 a[216:219], v1, s[60:63], s25 offen offset:2048 sc1
  v_mul_f32 v87, v79, v87
  v_fma_f32 v64, v64, v46, v46
  v_fma_f32 v65, v65, v46, v46
  v_rcp_f32 v64, v64
  v_mfma_f32_32x32x16_bf16 v[216:231], a[80:83], a[52:55], v[216:231]
  ds_read_b128 a[16:19], v13 offset:20480
  buffer_load_dwordx4 a[220:223], v1, s[60:63], s25 offen offset:3072 sc1
  v_rcp_f32 v65, v65
  v_mul_f32 v86, v86, v64
  v_mul_f32 v87, v87, v65
  v_cvt_pk_bf16_f32 v75, v86, v87
  v_mfma_f32_32x32x16_bf16 v[232:247], a[80:83], a[56:59], v[232:247]
  ds_read_b128 a[20:23], v13 offset:24576
  v_mov_b32 v248, -1
  v_mul_f32 v64, v88, v88
  v_mul_f32 v65, v89, v89
  v_fma_f32 v64, v64, v45, v44
  v_fma_f32 v65, v65, v45, v44
  s_waitcnt lgkmcnt(3)
  v_mfma_f32_32x32x16_bf16 v[184:199], a[84:87], a[60:63], v[184:199]
  ds_read_b128 a[24:27], v13 offset:28672
  v_mov_b32 v249, -1
  v_mul_f32 v64, v64, v88
  v_mul_f32 v65, v65, v89
  v_exp_f32 v64, v64
  v_mul_f32 v96, v88, v96
  v_mfma_f32_32x32x16_bf16 v[200:215], a[84:87], a[0:3], v[200:215]
  ds_read_b128 a[28:31], v14 offset:16384
  v_mov_b32 v250, -1
  v_exp_f32 v65, v65
  v_mul_f32 v97, v89, v97
  v_fma_f32 v64, v64, v46, v46
  v_fma_f32 v65, v65, v46, v46
  v_mfma_f32_32x32x16_bf16 v[216:231], a[84:87], a[4:7], v[216:231]
  ds_read_b128 a[32:35], v14 offset:20480
  ds_read_b128 a[36:39], v14 offset:24576
  ds_read_b128 a[40:43], v14 offset:28672
  v_mov_b32 v251, -1
  v_rcp_f32 v64, v64
  v_rcp_f32 v65, v65
  v_mul_f32 v96, v96, v64
  v_mul_f32 v97, v97, v65
  v_mfma_f32_32x32x16_bf16 v[232:247], a[84:87], a[8:11], v[232:247]
  buffer_store_dwordx4 v[248:251], v1, s[60:63], s90 offen sc1
  v_cvt_pk_bf16_f32 v88, v96, v97
  v_mul_f32 v64, v90, v90
  v_mul_f32 v65, v91, v91
  v_fma_f32 v64, v64, v45, v44
  s_waitcnt lgkmcnt(4)
  v_mfma_f32_32x32x16_bf16 v[184:199], a[88:91], a[12:15], v[184:199]
  buffer_store_dwordx4 v[248:251], v1, s[60:63], s90 offen offset:1024 sc1
  v_fma_f32 v65, v65, v45, v44
  v_mul_f32 v64, v64, v90
  v_mul_f32 v65, v65, v91
  v_exp_f32 v64, v64
  s_waitcnt vmcnt(50) lgkmcnt(0)
  s_barrier
  v_mfma_f32_32x32x16_bf16 v[200:215], a[88:91], a[16:19], v[200:215]
  ds_read_b128 a[44:47], v15
  s_add_u32 s95, s98, 0x400
  v_mul_f32 v98, v90, v98
  v_exp_f32 v65, v65
  v_mul_f32 v99, v91, v99
  v_fma_f32 v64, v64, v46, v46
  v_mfma_f32_32x32x16_bf16 v[216:231], a[88:91], a[20:23], v[216:231]
  ds_read_b128 a[48:51], v15 offset:4096
  s_and_b32 s95, s95, 0x7ff
  v_fma_f32 v65, v65, v46, v46
  v_rcp_f32 v64, v64
  v_rcp_f32 v65, v65
  v_mul_f32 v98, v98, v64
  v_mfma_f32_32x32x16_bf16 v[232:247], a[88:91], a[24:27], v[232:247]
  ds_read_b128 a[52:55], v15 offset:8192
  s_add_u32 s95, s95, s80
  v_mul_f32 v99, v99, v65
  v_cvt_pk_bf16_f32 v89, v98, v99
  v_mul_f32 v64, v92, v92
  v_mul_f32 v65, v93, v93
  v_mfma_f32_32x32x16_bf16 v[184:199], a[92:95], a[28:31], v[184:199]
  ds_read_b128 a[56:59], v15 offset:12288
  s_add_u32 m0, s72, 0x10000
  s_nop 0
  buffer_load_dwordx4 v22, s[52:55], s95 offen lds
  v_fma_f32 v64, v64, v45, v44
  v_fma_f32 v65, v65, v45, v44
  v_mul_f32 v64, v64, v92
  v_mul_f32 v65, v65, v93
  v_mfma_f32_32x32x16_bf16 v[200:215], a[92:95], a[32:35], v[200:215]
  ds_read_b128 a[60:63], v16
  buffer_load_dwordx4 v23, s[52:55], s95 offen offset:1024 lds
  v_exp_f32 v64, v64
  v_mul_f32 v100, v92, v100
  v_exp_f32 v65, v65
  v_mul_f32 v101, v93, v101
  v_mfma_f32_32x32x16_bf16 v[216:231], a[92:95], a[36:39], v[216:231]
  ds_read_b128 a[0:3], v16 offset:4096
  buffer_load_dwordx4 v24, s[52:55], s95 offen offset:2048 lds
  v_fma_f32 v64, v64, v46, v46
  v_fma_f32 v65, v65, v46, v46
  v_rcp_f32 v64, v64
  v_rcp_f32 v65, v65
  v_mfma_f32_32x32x16_bf16 v[232:247], a[92:95], a[40:43], v[232:247]
  ds_read_b128 a[4:7], v16 offset:8192
  buffer_load_dwordx4 v25, s[52:55], s95 offen offset:3072 lds
  v_mul_f32 v100, v100, v64
  v_mul_f32 v101, v101, v65
  v_cvt_pk_bf16_f32 v90, v100, v101
  v_mul_f32 v64, v94, v94
  s_waitcnt lgkmcnt(3)
  s_waitcnt vmcnt(53)
  v_mfma_f32_32x32x16_bf16 v[184:199], a[96:99], a[44:47], v[184:199]
  ds_read_b128 a[8:11], v16 offset:12288
  s_add_u32 m0, s72, 0x14000
  s_add_u32 s95, s95, 0x80
  v_mul_f32 v65, v95, v95
  v_fma_f32 v64, v64, v45, v44
  v_fma_f32 v65, v65, v45, v44
  v_mul_f32 v64, v64, v94
  v_mfma_f32_32x32x16_bf16 v[200:215], a[96:99], a[48:51], v[200:215]
  ds_read_b128 a[12:15], v17
  buffer_load_dwordx4 v22, s[52:55], s95 offen lds
  v_mul_f32 v65, v65, v95
  v_exp_f32 v64, v64
  v_mul_f32 v102, v94, v102
  v_exp_f32 v65, v65
  v_mfma_f32_32x32x16_bf16 v[216:231], a[96:99], a[52:55], v[216:231]
  ds_read_b128 a[16:19], v17 offset:4096
  buffer_load_dwordx4 v23, s[52:55], s95 offen offset:1024 lds
  v_mul_f32 v103, v95, v103
  v_fma_f32 v64, v64, v46, v46
  v_fma_f32 v65, v65, v46, v46
  v_rcp_f32 v64, v64
  v_mfma_f32_32x32x16_bf16 v[232:247], a[96:99], a[56:59], v[232:247]
  ds_read_b128 a[20:23], v17 offset:8192
  buffer_load_dwordx4 v24, s[52:55], s95 offen offset:2048 lds
  v_rcp_f32 v65, v65
  v_mul_f32 v102, v102, v64
  v_mul_f32 v103, v103, v65
  v_cvt_pk_bf16_f32 v91, v102, v103
  s_waitcnt lgkmcnt(3)
  s_waitcnt vmcnt(55)
  v_mfma_f32_32x32x16_bf16 v[184:199], a[100:103], a[60:63], v[184:199]
  ds_read_b128 a[24:27], v17 offset:12288
  buffer_load_dwordx4 v25, s[52:55], s95 offen offset:3072 lds
  s_add_u32 s25, s100, 0x8000
  v_mul_f32 v64, v104, v104
  v_mul_f32 v65, v105, v105
  v_fma_f32 v64, v64, v45, v44
  v_fma_f32 v65, v65, v45, v44
  v_mfma_f32_32x32x16_bf16 v[200:215], a[100:103], a[0:3], v[200:215]
  ds_read_b128 a[28:31], v18
  s_and_b32 s25, s25, 0xffff
  v_mul_f32 v64, v64, v104
  v_mul_f32 v65, v65, v105
  v_exp_f32 v64, v64
  v_mul_f32 v112, v104, v112
  v_mfma_f32_32x32x16_bf16 v[216:231], a[100:103], a[4:7], v[216:231]
  ds_read_b128 a[32:35], v18 offset:4096
  s_add_u32 s25, s25, s79
  v_exp_f32 v65, v65
  v_mul_f32 v113, v105, v113
  v_fma_f32 v64, v64, v46, v46
  v_fma_f32 v65, v65, v46, v46
  v_mfma_f32_32x32x16_bf16 v[232:247], a[100:103], a[8:11], v[232:247]
  ds_read_b128 a[36:39], v18 offset:8192
  buffer_load_dwordx4 a[224:227], v1, s[60:63], s25 offen sc1
  buffer_load_dwordx4 a[228:231], v1, s[60:63], s25 offen offset:1024 sc1
  v_rcp_f32 v64, v64
  v_rcp_f32 v65, v65
  v_mul_f32 v112, v112, v64
  v_mul_f32 v113, v113, v65
  s_waitcnt lgkmcnt(3)
  s_waitcnt vmcnt(57)
  v_mfma_f32_32x32x16_bf16 v[184:199], a[104:107], a[12:15], v[184:199]
  ds_read_b128 a[40:43], v18 offset:12288
  buffer_load_dwordx4 a[232:235], v1, s[60:63], s25 offen offset:2048 sc1
  v_cvt_pk_bf16_f32 v104, v112, v113
  v_mul_f32 v64, v106, v106
  v_mul_f32 v65, v107, v107
  v_fma_f32 v64, v64, v45, v44
  v_mfma_f32_32x32x16_bf16 v[200:215], a[104:107], a[16:19], v[200:215]
  ds_read_b128 a[44:47], v15 offset:16384
  buffer_load_dwordx4 a[236:239], v1, s[60:63], s25 offen offset:3072 sc1
  v_fma_f32 v65, v65, v45, v44
  v_mul_f32 v64, v64, v106
  v_mul_f32 v65, v65, v107
  v_exp_f32 v64, v64
  v_mfma_f32_32x32x16_bf16 v[216:231], a[104:107], a[20:23], v[216:231]
  ds_read_b128 a[48:51], v15 offset:20480
  s_add_u32 s25, s25, 0x1000
  v_mul_f32 v114, v106, v114
  v_exp_f32 v65, v65
  v_mul_f32 v115, v107, v115
  v_fma_f32 v64, v64, v46, v46
  v_mfma_f32_32x32x16_bf16 v[232:247], a[104:107], a[24:27], v[232:247]
  ds_read_b128 a[52:55], v15 offset:24576
  buffer_load_dwordx4 a[240:243], v1, s[60:63], s25 offen sc1
  buffer_load_dwordx4 a[244:247], v1, s[60:63], s25 offen offset:1024 sc1
  v_fma_f32 v65, v65, v46, v46
  v_rcp_f32 v64, v64
  v_rcp_f32 v65, v65
  v_mul_f32 v114, v114, v64
  s_waitcnt lgkmcnt(3)
  s_waitcnt vmcnt(60)
  v_mfma_f32_32x32x16_bf16 v[184:199], a[108:111], a[28:31], v[184:199]
  ds_read_b128 a[56:59], v15 offset:28672
  buffer_load_dwordx4 a[248:251], v1, s[60:63], s25 offen offset:2048 sc1
  v_mul_f32 v115, v115, v65
  v_cvt_pk_bf16_f32 v105, v114, v115
  v_mul_f32 v64, v108, v108
  v_mul_f32 v65, v109, v109
  v_mfma_f32_32x32x16_bf16 v[200:215], a[108:111], a[32:35], v[200:215]
  ds_read_b128 a[60:63], v16 offset:16384
  buffer_load_dwordx4 a[252:255], v1, s[60:63], s25 offen offset:3072 sc1
  v_fma_f32 v64, v64, v45, v44
  v_fma_f32 v65, v65, v45, v44
  v_mul_f32 v64, v64, v108
  v_mul_f32 v65, v65, v109
  v_mfma_f32_32x32x16_bf16 v[216:231], a[108:111], a[36:39], v[216:231]
  ds_read_b128 a[0:3], v16 offset:20480
  buffer_store_dwordx4 v[248:251], v1, s[60:63], s91 offen sc1
  v_exp_f32 v64, v64
  v_mul_f32 v116, v108, v116
  v_exp_f32 v65, v65
  v_mul_f32 v117, v109, v117
  v_mfma_f32_32x32x16_bf16 v[232:247], a[108:111], a[40:43], v[232:247]
  ds_read_b128 a[4:7], v16 offset:24576
  buffer_store_dwordx4 v[248:251], v1, s[60:63], s91 offen offset:1024 sc1
  v_fma_f32 v64, v64, v46, v46
  v_fma_f32 v65, v65, v46, v46
  v_rcp_f32 v64, v64
  v_rcp_f32 v65, v65
  s_waitcnt lgkmcnt(3)
  s_waitcnt vmcnt(63)
  v_mfma_f32_32x32x16_bf16 v[184:199], a[112:115], a[44:47], v[184:199]
  ds_read_b128 a[8:11], v16 offset:28672
  s_add_u32 s25, s100, 0xa000
  v_mul_f32 v116, v116, v64
  v_mul_f32 v117, v117, v65
  v_cvt_pk_bf16_f32 v106, v116, v117
  v_mul_f32 v64, v110, v110
  v_mfma_f32_32x32x16_bf16 v[200:215], a[112:115], a[48:51], v[200:215]
  ds_read_b128 a[12:15], v17 offset:16384
  s_and_b32 s25, s25, 0xffff
  s_add_u32 s25, s25, s79
  v_mul_f32 v65, v111, v111
  v_fma_f32 v64, v64, v45, v44
  v_fma_f32 v65, v65, v45, v44
  v_mul_f32 v64, v64, v110
  v_mfma_f32_32x32x16_bf16 v[216:231], a[112:115], a[52:55], v[216:231]
  ds_read_b128 a[16:19], v17 offset:20480
  buffer_load_dwordx4 a[64:67], v1, s[60:63], s25 offen sc1
  v_mul_f32 v65, v65, v111
  v_exp_f32 v64, v64
  v_mul_f32 v118, v110, v118
  v_exp_f32 v65, v65
  v_mfma_f32_32x32x16_bf16 v[232:247], a[112:115], a[56:59], v[232:247]
  ds_read_b128 a[20:23], v17 offset:24576
  buffer_load_dwordx4 a[68:71], v1, s[60:63], s25 offen offset:1024 sc1
  buffer_load_dwordx4 a[72:75], v1, s[60:63], s25 offen offset:2048 sc1
  v_mul_f32 v119, v111, v119
  v_fma_f32 v64, v64, v46, v46
  v_fma_f32 v65, v65, v46, v46
  v_rcp_f32 v64, v64
  s_waitcnt lgkmcnt(3)
  s_waitcnt vmcnt(63)
  v_mfma_f32_32x32x16_bf16 v[184:199], a[116:119], a[60:63], v[184:199]
  ds_read_b128 a[24:27], v17 offset:28672
  buffer_load_dwordx4 a[76:79], v1, s[60:63], s25 offen offset:3072 sc1
  v_rcp_f32 v65, v65
  v_mul_f32 v118, v118, v64
  v_mul_f32 v119, v119, v65
  v_cvt_pk_bf16_f32 v107, v118, v119
  v_mfma_f32_32x32x16_bf16 v[200:215], a[116:119], a[0:3], v[200:215]
  ds_read_b128 a[28:31], v18 offset:16384
  s_add_u32 s25, s25, 0x1000
  buffer_load_dwordx4 a[80:83], v1, s[60:63], s25 offen sc1
  v_mul_f32 v64, v120, v120
  v_mul_f32 v65, v121, v121
  v_fma_f32 v64, v64, v45, v44
  v_fma_f32 v65, v65, v45, v44
  v_mfma_f32_32x32x16_bf16 v[216:231], a[116:119], a[4:7], v[216:231]
  ds_read_b128 a[32:35], v18 offset:20480
  ds_read_b128 a[36:39], v18 offset:24576
  ds_read_b128 a[40:43], v18 offset:28672
  buffer_load_dwordx4 a[84:87], v1, s[60:63], s25 offen offset:1024 sc1
  v_mul_f32 v64, v64, v120
  v_mul_f32 v65, v65, v121
  v_exp_f32 v64, v64
  v_mul_f32 v128, v120, v128
  v_mfma_f32_32x32x16_bf16 v[232:247], a[116:119], a[8:11], v[232:247]
  buffer_load_dwordx4 a[88:91], v1, s[60:63], s25 offen offset:2048 sc1
  buffer_load_dwordx4 a[92:95], v1, s[60:63], s25 offen offset:3072 sc1
  v_exp_f32 v65, v65
  v_mul_f32 v129, v121, v129
  v_fma_f32 v64, v64, v46, v46
  v_fma_f32 v65, v65, v46, v46
  s_waitcnt lgkmcnt(4)
  v_mfma_f32_32x32x16_bf16 v[184:199], a[120:123], a[12:15], v[184:199]
  v_rcp_f32 v64, v64
  v_rcp_f32 v65, v65
  v_mul_f32 v128, v128, v64
  v_mul_f32 v129, v129, v65
  s_waitcnt vmcnt(52) lgkmcnt(0)
  s_barrier
  v_mfma_f32_32x32x16_bf16 v[200:215], a[120:123], a[16:19], v[200:215]
  ds_read_b128 a[44:47], v7
  s_add_u32 s95, s98, 0x500
  v_cvt_pk_bf16_f32 v120, v128, v129
  v_mul_f32 v64, v122, v122
  v_mul_f32 v65, v123, v123
  v_fma_f32 v64, v64, v45, v44
  v_mfma_f32_32x32x16_bf16 v[216:231], a[120:123], a[20:23], v[216:231]
  ds_read_b128 a[48:51], v7 offset:4096
  s_and_b32 s95, s95, 0x7ff
  v_fma_f32 v65, v65, v45, v44
  v_mul_f32 v64, v64, v122
  v_mul_f32 v65, v65, v123
  v_exp_f32 v64, v64
  v_mfma_f32_32x32x16_bf16 v[232:247], a[120:123], a[24:27], v[232:247]
  ds_read_b128 a[52:55], v7 offset:8192
  s_add_u32 s95, s95, s80
  v_mul_f32 v130, v122, v130
  v_exp_f32 v65, v65
  v_mul_f32 v131, v123, v131
  v_fma_f32 v64, v64, v46, v46
  v_mfma_f32_32x32x16_bf16 v[184:199], a[124:127], a[28:31], v[184:199]
  ds_read_b128 a[56:59], v7 offset:12288
  s_add_u32 m0, s72, 0x20000
  v_fma_f32 v65, v65, v46, v46
  v_rcp_f32 v64, v64
  v_rcp_f32 v65, v65
  v_mul_f32 v130, v130, v64
  v_mfma_f32_32x32x16_bf16 v[200:215], a[124:127], a[32:35], v[200:215]
  ds_read_b128 a[60:63], v8
  buffer_load_dwordx4 v22, s[52:55], s95 offen lds
  v_mul_f32 v131, v131, v65
  v_cvt_pk_bf16_f32 v121, v130, v131
  v_mul_f32 v64, v124, v124
  v_mul_f32 v65, v125, v125
  v_mfma_f32_32x32x16_bf16 v[216:231], a[124:127], a[36:39], v[216:231]
  ds_read_b128 a[0:3], v8 offset:4096
  buffer_load_dwordx4 v23, s[52:55], s95 offen offset:1024 lds
  v_fma_f32 v64, v64, v45, v44
  v_fma_f32 v65, v65, v45, v44
  v_mul_f32 v64, v64, v124
  v_mul_f32 v65, v65, v125
  v_mfma_f32_32x32x16_bf16 v[232:247], a[124:127], a[40:43], v[232:247]
  ds_read_b128 a[4:7], v8 offset:8192
  buffer_load_dwordx4 v24, s[52:55], s95 offen offset:2048 lds
  v_exp_f32 v64, v64
  v_mul_f32 v132, v124, v132
  v_exp_f32 v65, v65
  v_mul_f32 v133, v125, v133
  s_waitcnt lgkmcnt(3)
  v_mfma_f32_32x32x16_bf16 v[184:199], a[128:131], a[44:47], v[184:199]
  ds_read_b128 a[8:11], v8 offset:12288
  buffer_load_dwordx4 v25, s[52:55], s95 offen offset:3072 lds
  s_add_u32 m0, s72, 0x24000
  v_fma_f32 v64, v64, v46, v46
  v_fma_f32 v65, v65, v46, v46
  v_rcp_f32 v64, v64
  v_rcp_f32 v65, v65
  v_mfma_f32_32x32x16_bf16 v[200:215], a[128:131], a[48:51], v[200:215]
  ds_read_b128 a[12:15], v9
  s_add_u32 s95, s95, 0x80
  v_mul_f32 v132, v132, v64
  v_mul_f32 v133, v133, v65
  v_cvt_pk_bf16_f32 v122, v132, v133
  v_mul_f32 v64, v126, v126
  v_mfma_f32_32x32x16_bf16 v[216:231], a[128:131], a[52:55], v[216:231]
  ds_read_b128 a[16:19], v9 offset:4096
  buffer_load_dwordx4 v22, s[52:55], s95 offen lds
  v_mul_f32 v65, v127, v127
  v_fma_f32 v64, v64, v45, v44
  v_fma_f32 v65, v65, v45, v44
  v_mul_f32 v64, v64, v126
  v_mfma_f32_32x32x16_bf16 v[232:247], a[128:131], a[56:59], v[232:247]
  ds_read_b128 a[20:23], v9 offset:8192
  buffer_load_dwordx4 v23, s[52:55], s95 offen offset:1024 lds
  v_mul_f32 v65, v65, v127
  v_exp_f32 v64, v64
  v_mul_f32 v134, v126, v134
  v_exp_f32 v65, v65
  s_waitcnt lgkmcnt(3)
  v_mfma_f32_32x32x16_bf16 v[184:199], a[132:135], a[60:63], v[184:199]
  ds_read_b128 a[24:27], v9 offset:12288
  buffer_load_dwordx4 v24, s[52:55], s95 offen offset:2048 lds
  v_mul_f32 v135, v127, v135
  v_fma_f32 v64, v64, v46, v46
  v_fma_f32 v65, v65, v46, v46
  v_rcp_f32 v64, v64
  v_mfma_f32_32x32x16_bf16 v[200:215], a[132:135], a[0:3], v[200:215]
  ds_read_b128 a[28:31], v10
  buffer_load_dwordx4 v25, s[52:55], s95 offen offset:3072 lds
  v_rcp_f32 v65, v65
  v_mul_f32 v134, v134, v64
  v_mul_f32 v135, v135, v65
  v_cvt_pk_bf16_f32 v123, v134, v135
  v_mfma_f32_32x32x16_bf16 v[216:231], a[132:135], a[4:7], v[216:231]
  ds_read_b128 a[32:35], v10 offset:4096
  buffer_store_dwordx4 v[248:251], v1, s[60:63], s92 offen sc1
  v_mul_f32 v64, v136, v136
  v_mul_f32 v65, v137, v137
  v_fma_f32 v64, v64, v45, v44
  v_fma_f32 v65, v65, v45, v44
  v_mfma_f32_32x32x16_bf16 v[232:247], a[132:135], a[8:11], v[232:247]
  ds_read_b128 a[36:39], v10 offset:8192
  buffer_store_dwordx4 v[248:251], v1, s[60:63], s92 offen offset:1024 sc1
  v_mul_f32 v64, v64, v136
  v_mul_f32 v65, v65, v137
  v_exp_f32 v64, v64
  v_mul_f32 v144, v136, v144
  s_waitcnt lgkmcnt(3)
  v_mfma_f32_32x32x16_bf16 v[184:199], a[136:139], a[12:15], v[184:199]
  ds_read_b128 a[40:43], v10 offset:12288
  v_exp_f32 v65, v65
  v_mul_f32 v145, v137, v145
  v_fma_f32 v64, v64, v46, v46
  v_fma_f32 v65, v65, v46, v46
  v_mfma_f32_32x32x16_bf16 v[200:215], a[136:139], a[16:19], v[200:215]
  ds_read_b128 a[44:47], v7 offset:16384
  s_add_u32 s25, s100, 0xc000
  v_rcp_f32 v64, v64
  v_rcp_f32 v65, v65
  v_mul_f32 v144, v144, v64
  v_mul_f32 v145, v145, v65
  v_mfma_f32_32x32x16_bf16 v[216:231], a[136:139], a[20:23], v[216:231]
  ds_read_b128 a[48:51], v7 offset:20480
  s_and_b32 s25, s25, 0xffff
  v_cvt_pk_bf16_f32 v136, v144, v145
  v_mul_f32 v64, v138, v138
  v_mul_f32 v65, v139, v139
  v_fma_f32 v64, v64, v45, v44
  v_mfma_f32_32x32x16_bf16 v[232:247], a[136:139], a[24:27], v[232:247]
  ds_read_b128 a[52:55], v7 offset:24576
  s_add_u32 s25, s25, s79
  v_fma_f32 v65, v65, v45, v44
  v_mul_f32 v64, v64, v138
  v_mul_f32 v65, v65, v139
  v_exp_f32 v64, v64
  s_waitcnt lgkmcnt(3)
  v_mfma_f32_32x32x16_bf16 v[184:199], a[140:143], a[28:31], v[184:199]
  ds_read_b128 a[56:59], v7 offset:28672
  v_mul_f32 v146, v138, v146
  v_exp_f32 v65, v65
  v_mul_f32 v147, v139, v147
  v_fma_f32 v64, v64, v46, v46
  v_mfma_f32_32x32x16_bf16 v[200:215], a[140:143], a[32:35], v[200:215]
  ds_read_b128 a[60:63], v8 offset:16384
  buffer_load_dwordx4 a[96:99], v1, s[60:63], s25 offen sc1
  v_fma_f32 v65, v65, v46, v46
  v_rcp_f32 v64, v64
  v_rcp_f32 v65, v65
  v_mul_f32 v146, v146, v64
  v_mfma_f32_32x32x16_bf16 v[216:231], a[140:143], a[36:39], v[216:231]
  ds_read_b128 a[0:3], v8 offset:20480
  buffer_load_dwordx4 a[100:103], v1, s[60:63], s25 offen offset:1024 sc1
  v_mul_f32 v147, v147, v65
  v_cvt_pk_bf16_f32 v137, v146, v147
  v_mul_f32 v64, v140, v140
  v_mul_f32 v65, v141, v141
  v_mfma_f32_32x32x16_bf16 v[232:247], a[140:143], a[40:43], v[232:247]
  ds_read_b128 a[4:7], v8 offset:24576
  buffer_load_dwordx4 a[104:107], v1, s[60:63], s25 offen offset:2048 sc1
  v_fma_f32 v64, v64, v45, v44
  v_fma_f32 v65, v65, v45, v44
  v_mul_f32 v64, v64, v140
  v_mul_f32 v65, v65, v141
  s_waitcnt lgkmcnt(3)
  v_mfma_f32_32x32x16_bf16 v[184:199], a[144:147], a[44:47], v[184:199]
  ds_read_b128 a[8:11], v8 offset:28672
  v_exp_f32 v64, v64
  v_mul_f32 v148, v140, v148
  v_exp_f32 v65, v65
  v_mul_f32 v149, v141, v149
  v_mfma_f32_32x32x16_bf16 v[200:215], a[144:147], a[48:51], v[200:215]
  ds_read_b128 a[12:15], v9 offset:16384
  buffer_load_dwordx4 a[108:111], v1, s[60:63], s25 offen offset:3072 sc1
  v_fma_f32 v64, v64, v46, v46
  v_fma_f32 v65, v65, v46, v46
  v_rcp_f32 v64, v64
  v_rcp_f32 v65, v65
  v_mfma_f32_32x32x16_bf16 v[216:231], a[144:147], a[52:55], v[216:231]
  ds_read_b128 a[16:19], v9 offset:20480
  s_add_u32 s25, s25, 0x1000
  v_mul_f32 v148, v148, v64
  v_mul_f32 v149, v149, v65
  v_cvt_pk_bf16_f32 v138, v148, v149
  v_mul_f32 v64, v142, v142
  v_mfma_f32_32x32x16_bf16 v[232:247], a[144:147], a[56:59], v[232:247]
  ds_read_b128 a[20:23], v9 offset:24576
  buffer_load_dwordx4 a[112:115], v1, s[60:63], s25 offen sc1
  v_mul_f32 v65, v143, v143
  v_fma_f32 v64, v64, v45, v44
  v_fma_f32 v65, v65, v45, v44
  v_mul_f32 v64, v64, v142
  s_waitcnt lgkmcnt(3)
  v_mfma_f32_32x32x16_bf16 v[184:199], a[148:151], a[60:63], v[184:199]
  ds_read_b128 a[24:27], v9 offset:28672
  v_mul_f32 v65, v65, v143
  v_exp_f32 v64, v64
  v_mul_f32 v150, v142, v150
  v_exp_f32 v65, v65
  v_mfma_f32_32x32x16_bf16 v[200:215], a[148:151], a[0:3], v[200:215]
  ds_read_b128 a[28:31], v10 offset:16384
  buffer_load_dwordx4 a[116:119], v1, s[60:63], s25 offen offset:1024 sc1
  v_mul_f32 v151, v143, v151
  v_fma_f32 v64, v64, v46, v46
  v_fma_f32 v65, v65, v46, v46
  v_rcp_f32 v64, v64
  v_mfma_f32_32x32x16_bf16 v[216:231], a[148:151], a[4:7], v[216:231]
  ds_read_b128 a[32:35], v10 offset:20480
  ds_read_b128 a[36:39], v10 offset:24576
  ds_read_b128 a[40:43], v10 offset:28672
  buffer_load_dwordx4 a[120:123], v1, s[60:63], s25 offen offset:2048 sc1
  v_rcp_f32 v65, v65
  v_mul_f32 v150, v150, v64
  v_mul_f32 v151, v151, v65
  v_cvt_pk_bf16_f32 v139, v150, v151
  v_mfma_f32_32x32x16_bf16 v[232:247], a[148:151], a[8:11], v[232:247]
  buffer_load_dwordx4 a[124:127], v1, s[60:63], s25 offen offset:3072 sc1
  v_mul_f32 v64, v152, v152
  v_mul_f32 v65, v153, v153
  v_fma_f32 v64, v64, v45, v44
  v_fma_f32 v65, v65, v45, v44
  s_waitcnt lgkmcnt(4)
  v_mfma_f32_32x32x16_bf16 v[184:199], a[152:155], a[12:15], v[184:199]
  v_mul_f32 v64, v64, v152
  v_mul_f32 v65, v65, v153
  v_exp_f32 v64, v64
  v_mul_f32 v160, v152, v160
  s_waitcnt vmcnt(54) lgkmcnt(0)
  s_barrier
  v_mfma_f32_32x32x16_bf16 v[200:215], a[152:155], a[16:19], v[200:215]
  ds_read_b128 a[44:47], v7 offset:32768
  v_exp_f32 v65, v65
  v_mul_f32 v161, v153, v161
  v_fma_f32 v64, v64, v46, v46
  v_fma_f32 v65, v65, v46, v46
  v_mfma_f32_32x32x16_bf16 v[216:231], a[152:155], a[20:23], v[216:231]
  ds_read_b128 a[48:51], v7 offset:36864
  s_add_u32 s95, s98, 0x600
  v_rcp_f32 v64, v64
  v_rcp_f32 v65, v65
  v_mul_f32 v160, v160, v64
  v_mul_f32 v161, v161, v65
  v_mfma_f32_32x32x16_bf16 v[232:247], a[152:155], a[24:27], v[232:247]
  ds_read_b128 a[52:55], v7 offset:40960
  s_and_b32 s95, s95, 0x7ff
  v_cvt_pk_bf16_f32 v152, v160, v161
  v_mul_f32 v64, v154, v154
  v_mul_f32 v65, v155, v155
  v_fma_f32 v64, v64, v45, v44
  v_mfma_f32_32x32x16_bf16 v[184:199], a[156:159], a[28:31], v[184:199]
  ds_read_b128 a[56:59], v7 offset:45056
  s_add_u32 s95, s95, s80
  v_fma_f32 v65, v65, v45, v44
  v_mul_f32 v64, v64, v154
  v_mul_f32 v65, v65, v155
  v_exp_f32 v64, v64
  v_mfma_f32_32x32x16_bf16 v[200:215], a[156:159], a[32:35], v[200:215]
  ds_read_b128 a[60:63], v8 offset:32768
  v_mul_f32 v162, v154, v162
  v_exp_f32 v65, v65
  v_mul_f32 v163, v155, v163
  v_fma_f32 v64, v64, v46, v46
  v_mfma_f32_32x32x16_bf16 v[216:231], a[156:159], a[36:39], v[216:231]
  ds_read_b128 a[0:3], v8 offset:36864
  s_add_u32 m0, s72, 0
  v_fma_f32 v65, v65, v46, v46
  v_rcp_f32 v64, v64
  v_rcp_f32 v65, v65
  v_mul_f32 v162, v162, v64
  v_mfma_f32_32x32x16_bf16 v[232:247], a[156:159], a[40:43], v[232:247]
  ds_read_b128 a[4:7], v8 offset:40960
  buffer_load_dwordx4 v22, s[52:55], s95 offen lds
  v_mul_f32 v163, v163, v65
  v_cvt_pk_bf16_f32 v153, v162, v163
  v_mul_f32 v64, v156, v156
  v_mul_f32 v65, v157, v157
  s_waitcnt lgkmcnt(3)
  v_mfma_f32_32x32x16_bf16 v[184:199], a[160:163], a[44:47], v[184:199]
  ds_read_b128 a[8:11], v8 offset:45056
  buffer_load_dwordx4 v23, s[52:55], s95 offen offset:1024 lds
  v_fma_f32 v64, v64, v45, v44
  v_fma_f32 v65, v65, v45, v44
  v_mul_f32 v64, v64, v156
  v_mul_f32 v65, v65, v157
  v_mfma_f32_32x32x16_bf16 v[200:215], a[160:163], a[48:51], v[200:215]
  ds_read_b128 a[12:15], v9 offset:32768
  v_exp_f32 v64, v64
  v_mul_f32 v164, v156, v164
  v_exp_f32 v65, v65
  v_mul_f32 v165, v157, v165
  v_mfma_f32_32x32x16_bf16 v[216:231], a[160:163], a[52:55], v[216:231]
  ds_read_b128 a[16:19], v9 offset:36864
  buffer_load_dwordx4 v24, s[52:55], s95 offen offset:2048 lds
  v_fma_f32 v64, v64, v46, v46
  v_fma_f32 v65, v65, v46, v46
  v_rcp_f32 v64, v64
  v_rcp_f32 v65, v65
  v_mfma_f32_32x32x16_bf16 v[232:247], a[160:163], a[56:59], v[232:247]
  ds_read_b128 a[20:23], v9 offset:40960
  buffer_load_dwordx4 v25, s[52:55], s95 offen offset:3072 lds
  v_mul_f32 v164, v164, v64
  v_mul_f32 v165, v165, v65
  v_cvt_pk_bf16_f32 v154, v164, v165
  v_mul_f32 v64, v158, v158
  s_waitcnt lgkmcnt(3)
  v_mfma_f32_32x32x16_bf16 v[184:199], a[164:167], a[60:63], v[184:199]
  ds_read_b128 a[24:27], v9 offset:45056
  s_add_u32 m0, s72, 0x4000
  v_mul_f32 v65, v159, v159
  v_fma_f32 v64, v64, v45, v44
  v_fma_f32 v65, v65, v45, v44
  v_mul_f32 v64, v64, v158
  v_mfma_f32_32x32x16_bf16 v[200:215], a[164:167], a[0:3], v[200:215]
  ds_read_b128 a[28:31], v10 offset:32768
  v_mul_f32 v65, v65, v159
  v_exp_f32 v64, v64
  v_mul_f32 v166, v158, v166
  v_exp_f32 v65, v65
  v_mfma_f32_32x32x16_bf16 v[216:231], a[164:167], a[4:7], v[216:231]
  ds_read_b128 a[32:35], v10 offset:36864
  s_add_u32 s95, s95, 0x80
  v_mul_f32 v167, v159, v167
  v_fma_f32 v64, v64, v46, v46
  v_fma_f32 v65, v65, v46, v46
  v_rcp_f32 v64, v64
  v_mfma_f32_32x32x16_bf16 v[232:247], a[164:167], a[8:11], v[232:247]
  ds_read_b128 a[36:39], v10 offset:40960
  buffer_load_dwordx4 v22, s[52:55], s95 offen lds
  v_rcp_f32 v65, v65
  v_mul_f32 v166, v166, v64
  v_mul_f32 v167, v167, v65
  v_cvt_pk_bf16_f32 v155, v166, v167
  s_waitcnt lgkmcnt(3)
  v_mfma_f32_32x32x16_bf16 v[184:199], a[168:171], a[12:15], v[184:199]
  ds_read_b128 a[40:43], v10 offset:45056
  buffer_load_dwordx4 v23, s[52:55], s95 offen offset:1024 lds
  v_mul_f32 v64, v168, v168
  v_mul_f32 v65, v169, v169
  v_fma_f32 v64, v64, v45, v44
  v_fma_f32 v65, v65, v45, v44
  v_mfma_f32_32x32x16_bf16 v[200:215], a[168:171], a[16:19], v[200:215]
  ds_read_b128 a[44:47], v7 offset:49152
  v_mul_f32 v64, v64, v168
  v_mul_f32 v65, v65, v169
  v_exp_f32 v64, v64
  v_mul_f32 v176, v168, v176
  v_mfma_f32_32x32x16_bf16 v[216:231], a[168:171], a[20:23], v[216:231]
  ds_read_b128 a[48:51], v7 offset:53248
  buffer_load_dwordx4 v24, s[52:55], s95 offen offset:2048 lds
  v_exp_f32 v65, v65
  v_mul_f32 v177, v169, v177
  v_fma_f32 v64, v64, v46, v46
  v_fma_f32 v65, v65, v46, v46
  v_mfma_f32_32x32x16_bf16 v[232:247], a[168:171], a[24:27], v[232:247]
  ds_read_b128 a[52:55], v7 offset:57344
  buffer_load_dwordx4 v25, s[52:55], s95 offen offset:3072 lds
  v_rcp_f32 v64, v64
  v_rcp_f32 v65, v65
  v_mul_f32 v176, v176, v64
  v_mul_f32 v177, v177, v65
  s_waitcnt lgkmcnt(3)
  v_mfma_f32_32x32x16_bf16 v[184:199], a[172:175], a[28:31], v[184:199]
  ds_read_b128 a[56:59], v7 offset:61440
  v_cvt_pk_bf16_f32 v168, v176, v177
  v_mul_f32 v64, v170, v170
  v_mul_f32 v65, v171, v171
  v_fma_f32 v64, v64, v45, v44
  v_mfma_f32_32x32x16_bf16 v[200:215], a[172:175], a[32:35], v[200:215]
  ds_read_b128 a[60:63], v8 offset:49152
  v_fma_f32 v65, v65, v45, v44
  v_mul_f32 v64, v64, v170
  v_mul_f32 v65, v65, v171
  v_exp_f32 v64, v64
  v_mfma_f32_32x32x16_bf16 v[216:231], a[172:175], a[36:39], v[216:231]
  ds_read_b128 a[0:3], v8 offset:53248
  v_mul_f32 v178, v170, v178
  v_exp_f32 v65, v65
  v_mul_f32 v179, v171, v179
  v_fma_f32 v64, v64, v46, v46
  v_mfma_f32_32x32x16_bf16 v[232:247], a[172:175], a[40:43], v[232:247]
  ds_read_b128 a[4:7], v8 offset:57344
  v_fma_f32 v65, v65, v46, v46
  v_rcp_f32 v64, v64
  v_rcp_f32 v65, v65
  v_mul_f32 v178, v178, v64
  s_waitcnt lgkmcnt(3)
  v_mfma_f32_32x32x16_bf16 v[184:199], a[176:179], a[44:47], v[184:199]
  ds_read_b128 a[8:11], v8 offset:61440
  v_mul_f32 v179, v179, v65
  v_cvt_pk_bf16_f32 v169, v178, v179
  v_mul_f32 v64, v172, v172
  v_mul_f32 v65, v173, v173
  v_mfma_f32_32x32x16_bf16 v[200:215], a[176:179], a[48:51], v[200:215]
  ds_read_b128 a[12:15], v9 offset:49152
  v_fma_f32 v64, v64, v45, v44
  v_fma_f32 v65, v65, v45, v44
  v_mul_f32 v64, v64, v172
  v_mul_f32 v65, v65, v173
  v_mfma_f32_32x32x16_bf16 v[216:231], a[176:179], a[52:55], v[216:231]
  ds_read_b128 a[16:19], v9 offset:53248
  v_exp_f32 v64, v64
  v_mul_f32 v180, v172, v180
  v_exp_f32 v65, v65
  v_mul_f32 v181, v173, v181
  v_mfma_f32_32x32x16_bf16 v[232:247], a[176:179], a[56:59], v[232:247]
  ds_read_b128 a[20:23], v9 offset:57344
  v_fma_f32 v64, v64, v46, v46
  v_fma_f32 v65, v65, v46, v46
  v_rcp_f32 v64, v64
  v_rcp_f32 v65, v65
  s_waitcnt lgkmcnt(3)
  v_mfma_f32_32x32x16_bf16 v[184:199], a[180:183], a[60:63], v[184:199]
  ds_read_b128 a[24:27], v9 offset:61440
  v_mul_f32 v180, v180, v64
  v_mul_f32 v181, v181, v65
  v_cvt_pk_bf16_f32 v170, v180, v181
  v_mul_f32 v64, v174, v174
  v_mfma_f32_32x32x16_bf16 v[200:215], a[180:183], a[0:3], v[200:215]
  ds_read_b128 a[28:31], v10 offset:49152
  v_mul_f32 v65, v175, v175
  v_fma_f32 v64, v64, v45, v44
  v_fma_f32 v65, v65, v45, v44
  v_mul_f32 v64, v64, v174
  v_mfma_f32_32x32x16_bf16 v[216:231], a[180:183], a[4:7], v[216:231]
  ds_read_b128 a[32:35], v10 offset:53248
  ds_read_b128 a[36:39], v10 offset:57344
  ds_read_b128 a[40:43], v10 offset:61440
  v_mul_f32 v65, v65, v175
  v_exp_f32 v64, v64
  v_mul_f32 v182, v174, v182
  v_exp_f32 v65, v65
  v_mfma_f32_32x32x16_bf16 v[232:247], a[180:183], a[8:11], v[232:247]
  v_mul_f32 v183, v175, v183
  v_fma_f32 v64, v64, v46, v46
  v_fma_f32 v65, v65, v46, v46
  v_rcp_f32 v64, v64
  s_waitcnt lgkmcnt(4)
  v_mfma_f32_32x32x16_bf16 v[184:199], a[184:187], a[12:15], v[184:199]
  v_rcp_f32 v65, v65
  v_mul_f32 v182, v182, v64
  v_mul_f32 v183, v183, v65
  v_cvt_pk_bf16_f32 v171, v182, v183
  s_waitcnt lgkmcnt(0)
  s_barrier
  v_mfma_f32_32x32x16_bf16 v[200:215], a[184:187], a[16:19], v[200:215]
  ds_read_b128 a[44:47], v11 offset:32768
  buffer_store_dwordx4 v[72:75], v1, s[60:63], s86 offen sc1
  buffer_store_dwordx4 v[88:91], v1, s[60:63], s86 offen offset:1024 sc1
  buffer_store_dwordx4 v[104:107], v1, s[60:63], s86 offen offset:2048 sc1
  buffer_store_dwordx4 v[120:123], v1, s[60:63], s86 offen offset:3072 sc1
  v_mfma_f32_32x32x16_bf16 v[216:231], a[184:187], a[20:23], v[216:231]
  ds_read_b128 a[48:51], v11 offset:36864
  s_add_u32 s86, s86, 0x1000
  buffer_store_dwordx4 v[136:139], v1, s[60:63], s86 offen sc1
  buffer_store_dwordx4 v[152:155], v1, s[60:63], s86 offen offset:1024 sc1
  buffer_store_dwordx4 v[168:171], v1, s[60:63], s86 offen offset:2048 sc1
  v_mfma_f32_32x32x16_bf16 v[232:247], a[184:187], a[24:27], v[232:247]
  ds_read_b128 a[52:55], v11 offset:40960
  v_mfma_f32_32x32x16_bf16 v[184:199], a[188:191], a[28:31], v[184:199]
  ds_read_b128 a[56:59], v11 offset:45056
  v_lshrrev_b32 v82, 5, v0
  v_bfe_u32 v65, v0, 2, 2
  v_mfma_f32_32x32x16_bf16 v[200:215], a[188:191], a[32:35], v[200:215]
  ds_read_b128 a[60:63], v12 offset:32768
  v_lshl_add_u32 v64, v82, 2, v65
  v_lshlrev_b32 v64, 7, v64
  v_mfma_f32_32x32x16_bf16 v[216:231], a[188:191], a[36:39], v[216:231]
  ds_read_b128 a[0:3], v12 offset:36864
  v_bfe_u32 v65, v0, 4, 1
  v_lshlrev_b32 v65, 1, v65
  v_mfma_f32_32x32x16_bf16 v[232:247], a[188:191], a[40:43], v[232:247]
  ds_read_b128 a[4:7], v12 offset:40960
  v_bfe_u32 v66, v0, 1, 1
  v_add_u32 v65, v65, v66
  s_waitcnt lgkmcnt(3)
  s_waitcnt vmcnt(63)
  v_mfma_f32_32x32x16_bf16 v[184:199], a[192:195], a[44:47], v[184:199]
  ds_read_b128 a[8:11], v12 offset:45056
  s_and_b32 s8, s3, 1
  s_lshl_b32 s8, s8, 2
  v_mfma_f32_32x32x16_bf16 v[200:215], a[192:195], a[48:51], v[200:215]
  ds_read_b128 a[12:15], v13 offset:32768
  v_add_u32 v65, s8, v65
  v_bfe_u32 v66, v0, 3, 1
  v_mfma_f32_32x32x16_bf16 v[216:231], a[192:195], a[52:55], v[216:231]
  ds_read_b128 a[16:19], v13 offset:36864
  v_lshlrev_b32 v66, 2, v66
  v_xor_b32 v65, v65, v66
  v_mfma_f32_32x32x16_bf16 v[232:247], a[192:195], a[56:59], v[232:247]
  ds_read_b128 a[20:23], v13 offset:40960
  v_lshl_add_u32 v64, v65, 4, v64
  s_lshr_b32 s9, s3, 1
  s_waitcnt lgkmcnt(3)
  v_mfma_f32_32x32x16_bf16 v[184:199], a[196:199], a[60:63], v[184:199]
  ds_read_b128 a[24:27], v13 offset:45056
  s_lshl_b32 s9, s9, 13
  v_add_u32 v64, s9, v64
  v_mfma_f32_32x32x16_bf16 v[200:215], a[196:199], a[0:3], v[200:215]
  ds_read_b128 a[28:31], v14 offset:32768
  v_and_b32 v66, 1, v0
  v_lshl_add_u32 v72, v66, 3, v64
  v_mfma_f32_32x32x16_bf16 v[216:231], a[196:199], a[4:7], v[216:231]
  ds_read_b128 a[32:35], v14 offset:36864
  v_add_u32 v73, 0x10000, v72
  v_add_u32 v74, 0x20000, v72
  v_mfma_f32_32x32x16_bf16 v[232:247], a[196:199], a[8:11], v[232:247]
  ds_read_b128 a[36:39], v14 offset:40960
  v_mov_b32 v75, v1
  v_add_u32 v76, 0x10000, v1
  s_waitcnt lgkmcnt(3)
  v_mfma_f32_32x32x16_bf16 v[184:199], a[200:203], a[12:15], v[184:199]
  ds_read_b128 a[40:43], v14 offset:45056
  v_add_u32 v77, 0x20000, v1
  v_lshlrev_b32 v81, 6, v47
  v_mfma_f32_32x32x16_bf16 v[200:215], a[200:203], a[16:19], v[200:215]
  ds_read_b128 a[44:47], v11 offset:49152
  v_lshl_add_u32 v81, v82, 3, v81
  buffer_load_dwordx2 v[124:125], v81, s[40:43], s93 offen
  v_mfma_f32_32x32x16_bf16 v[216:231], a[200:203], a[20:23], v[216:231]
  ds_read_b128 a[48:51], v11 offset:53248
  buffer_load_dwordx2 v[126:127], v81, s[40:43], s93 offen offset:16
  buffer_load_dwordx2 v[128:129], v81, s[40:43], s93 offen offset:32
  v_mfma_f32_32x32x16_bf16 v[232:247], a[200:203], a[24:27], v[232:247]
  ds_read_b128 a[52:55], v11 offset:57344
  buffer_load_dwordx2 v[130:131], v81, s[40:43], s93 offen offset:48
  s_waitcnt lgkmcnt(3)
  v_mfma_f32_32x32x16_bf16 v[184:199], a[204:207], a[28:31], v[184:199]
  ds_read_b128 a[56:59], v11 offset:61440
  v_mfma_f32_32x32x16_bf16 v[200:215], a[204:207], a[32:35], v[200:215]
  ds_read_b128 a[60:63], v12 offset:49152
  v_mfma_f32_32x32x16_bf16 v[216:231], a[204:207], a[36:39], v[216:231]
  ds_read_b128 a[0:3], v12 offset:53248
  v_mfma_f32_32x32x16_bf16 v[232:247], a[204:207], a[40:43], v[232:247]
  ds_read_b128 a[4:7], v12 offset:57344
  s_waitcnt lgkmcnt(3)
  v_mfma_f32_32x32x16_bf16 v[184:199], a[208:211], a[44:47], v[184:199]
  ds_read_b128 a[8:11], v12 offset:61440
  s_waitcnt vmcnt(4)
  s_barrier
  s_mov_b32 s94, 0x8000
  buffer_store_dwordx2 v[34:35], v33, s[60:63], s94 offen sc1
  v_mfma_f32_32x32x16_bf16 v[200:215], a[208:211], a[48:51], v[200:215]
  ds_read_b128 a[12:15], v13 offset:49152
  v_mfma_f32_32x32x16_bf16 v[216:231], a[208:211], a[52:55], v[216:231]
  ds_read_b128 a[16:19], v13 offset:53248
  v_mfma_f32_32x32x16_bf16 v[232:247], a[208:211], a[56:59], v[232:247]
  ds_read_b128 a[20:23], v13 offset:57344
  buffer_load_dword v49, v6, s[56:59], 0 offen
  s_waitcnt lgkmcnt(3)
  v_mfma_f32_32x32x16_bf16 v[184:199], a[212:215], a[60:63], v[184:199]
  ds_read_b128 a[24:27], v13 offset:61440
  v_mfma_f32_32x32x16_bf16 v[200:215], a[212:215], a[0:3], v[200:215]
  ds_read_b128 a[28:31], v14 offset:49152
  v_mfma_f32_32x32x16_bf16 v[216:231], a[212:215], a[4:7], v[216:231]
  ds_read_b128 a[32:35], v14 offset:53248
  ds_read_b128 a[36:39], v14 offset:57344
  ds_read_b128 a[40:43], v14 offset:61440
  v_mfma_f32_32x32x16_bf16 v[232:247], a[212:215], a[8:11], v[232:247]
  s_waitcnt lgkmcnt(4)
  v_mfma_f32_32x32x16_bf16 v[184:199], a[216:219], a[12:15], v[184:199]
  s_waitcnt lgkmcnt(0)
  s_barrier
  v_mfma_f32_32x32x16_bf16 v[200:215], a[216:219], a[16:19], v[200:215]
  ds_read_b128 a[44:47], v11
  v_mfma_f32_32x32x16_bf16 v[216:231], a[216:219], a[20:23], v[216:231]
  ds_read_b128 a[48:51], v11 offset:4096
  s_add_u32 m0, s72, 0x8000
  v_mfma_f32_32x32x16_bf16 v[232:247], a[216:219], a[24:27], v[232:247]
  ds_read_b128 a[52:55], v11 offset:8192
  s_add_u32 s95, s101, 0
  v_mfma_f32_32x32x16_bf16 v[184:199], a[220:223], a[28:31], v[184:199]
  ds_read_b128 a[56:59], v11 offset:12288
  s_sub_u32 s12, s95, 6
  v_mfma_f32_32x32x16_bf16 v[200:215], a[220:223], a[32:35], v[200:215]
  ds_read_b128 a[60:63], v12
  v_mfma_f32_32x32x16_bf16 v[216:231], a[220:223], a[36:39], v[216:231]
  ds_read_b128 a[0:3], v12 offset:4096
  s_min_u32 s95, s95, s12
  v_mfma_f32_32x32x16_bf16 v[232:247], a[220:223], a[40:43], v[232:247]
  ds_read_b128 a[4:7], v12 offset:8192
  s_mul_i32 s95, s95, 0x10000
  s_waitcnt lgkmcnt(3)
  v_mfma_f32_32x32x16_bf16 v[184:199], a[224:227], a[44:47], v[184:199]
  ds_read_b128 a[8:11], v12 offset:12288
  s_add_u32 s95, s95, s81
  v_mfma_f32_32x32x16_bf16 v[200:215], a[224:227], a[48:51], v[200:215]
  ds_read_b128 a[12:15], v13
  v_mfma_f32_32x32x16_bf16 v[216:231], a[224:227], a[52:55], v[216:231]
  ds_read_b128 a[16:19], v13 offset:4096
  buffer_load_dwordx4 v2, s[56:59], s95 offen lds
  v_mfma_f32_32x32x16_bf16 v[232:247], a[224:227], a[56:59], v[232:247]
  ds_read_b128 a[20:23], v13 offset:8192
  buffer_load_dwordx4 v3, s[56:59], s95 offen offset:1024 lds
  s_waitcnt lgkmcnt(3)
  v_mfma_f32_32x32x16_bf16 v[184:199], a[228:231], a[60:63], v[184:199]
  ds_read_b128 a[24:27], v13 offset:12288
  buffer_load_dwordx4 v4, s[56:59], s95 offen offset:2048 lds
  v_mfma_f32_32x32x16_bf16 v[200:215], a[228:231], a[0:3], v[200:215]
  ds_read_b128 a[28:31], v14
  v_mfma_f32_32x32x16_bf16 v[216:231], a[228:231], a[4:7], v[216:231]
  ds_read_b128 a[32:35], v14 offset:4096
  buffer_load_dwordx4 v5, s[56:59], s95 offen offset:3072 lds
  v_mfma_f32_32x32x16_bf16 v[232:247], a[228:231], a[8:11], v[232:247]
  ds_read_b128 a[36:39], v14 offset:8192
  s_waitcnt lgkmcnt(3)
  v_mfma_f32_32x32x16_bf16 v[184:199], a[232:235], a[12:15], v[184:199]
  ds_read_b128 a[40:43], v14 offset:12288
  v_mfma_f32_32x32x16_bf16 v[200:215], a[232:235], a[16:19], v[200:215]
  ds_read_b128 a[44:47], v11 offset:16384
  v_mfma_f32_32x32x16_bf16 v[216:231], a[232:235], a[20:23], v[216:231]
  ds_read_b128 a[48:51], v11 offset:20480
  v_mfma_f32_32x32x16_bf16 v[232:247], a[232:235], a[24:27], v[232:247]
  ds_read_b128 a[52:55], v11 offset:24576
  s_waitcnt lgkmcnt(3)
  v_mfma_f32_32x32x16_bf16 v[184:199], a[236:239], a[28:31], v[184:199]
  ds_read_b128 a[56:59], v11 offset:28672
  v_mfma_f32_32x32x16_bf16 v[200:215], a[236:239], a[32:35], v[200:215]
  ds_read_b128 a[60:63], v12 offset:16384
  s_add_u32 m0, s72, 0x18000
  v_mfma_f32_32x32x16_bf16 v[216:231], a[236:239], a[36:39], v[216:231]
  ds_read_b128 a[0:3], v12 offset:20480
  s_add_u32 s95, s101, 1
  v_mfma_f32_32x32x16_bf16 v[232:247], a[236:239], a[40:43], v[232:247]
  ds_read_b128 a[4:7], v12 offset:24576
  s_sub_u32 s12, s95, 6
  s_waitcnt lgkmcnt(3)
  v_mfma_f32_32x32x16_bf16 v[184:199], a[240:243], a[44:47], v[184:199]
  ds_read_b128 a[8:11], v12 offset:28672
  s_min_u32 s95, s95, s12
  v_mfma_f32_32x32x16_bf16 v[200:215], a[240:243], a[48:51], v[200:215]
  ds_read_b128 a[12:15], v13 offset:16384
  s_mul_i32 s95, s95, 0x10000
  v_mfma_f32_32x32x16_bf16 v[216:231], a[240:243], a[52:55], v[216:231]
  ds_read_b128 a[16:19], v13 offset:20480
  v_mfma_f32_32x32x16_bf16 v[232:247], a[240:243], a[56:59], v[232:247]
  ds_read_b128 a[20:23], v13 offset:24576
  s_add_u32 s95, s95, s81
  s_waitcnt lgkmcnt(3)
  v_mfma_f32_32x32x16_bf16 v[184:199], a[244:247], a[60:63], v[184:199]
  ds_read_b128 a[24:27], v13 offset:28672
  buffer_load_dwordx4 v2, s[56:59], s95 offen lds
  v_mfma_f32_32x32x16_bf16 v[200:215], a[244:247], a[0:3], v[200:215]
  ds_read_b128 a[28:31], v14 offset:16384
  buffer_load_dwordx4 v3, s[56:59], s95 offen offset:1024 lds
  v_mfma_f32_32x32x16_bf16 v[216:231], a[244:247], a[4:7], v[216:231]
  ds_read_b128 a[32:35], v14 offset:20480
  ds_read_b128 a[36:39], v14 offset:24576
  ds_read_b128 a[40:43], v14 offset:28672
  buffer_load_dwordx4 v4, s[56:59], s95 offen offset:2048 lds
  v_mfma_f32_32x32x16_bf16 v[232:247], a[244:247], a[8:11], v[232:247]
  buffer_load_dwordx4 v5, s[56:59], s95 offen offset:3072 lds
  s_waitcnt lgkmcnt(4)
  v_mfma_f32_32x32x16_bf16 v[184:199], a[248:251], a[12:15], v[184:199]
  s_waitcnt lgkmcnt(0)
  s_barrier
  v_mfma_f32_32x32x16_bf16 v[200:215], a[248:251], a[16:19], v[200:215]
  ds_read_b128 a[44:47], v15 offset:4096
  v_mfma_f32_32x32x16_bf16 v[216:231], a[248:251], a[20:23], v[216:231]
  ds_read_b128 a[48:51], v15 offset:8192
  s_add_u32 m0, s72, 0x10000
  v_mfma_f32_32x32x16_bf16 v[232:247], a[248:251], a[24:27], v[232:247]
  ds_read_b128 a[52:55], v15 offset:12288
  ds_read_b128 a[224:227], v15
  s_add_u32 s95, s101, 2
  v_mfma_f32_32x32x16_bf16 v[184:199], a[252:255], a[28:31], v[184:199]
  ds_read_b128 a[56:59], v16 offset:4096
  s_sub_u32 s12, s95, 6
  v_mfma_f32_32x32x16_bf16 v[200:215], a[252:255], a[32:35], v[200:215]
  ds_read_b128 a[60:63], v16 offset:8192
  s_min_u32 s95, s95, s12
  v_mfma_f32_32x32x16_bf16 v[216:231], a[252:255], a[36:39], v[216:231]
  ds_read_b128 a[0:3], v16 offset:12288
  ds_read_b128 a[228:231], v16
  s_mul_i32 s95, s95, 0x10000
  v_mfma_f32_32x32x16_bf16 v[232:247], a[252:255], a[40:43], v[232:247]
  ds_read_b128 a[4:7], v17 offset:4096
  s_waitcnt lgkmcnt(4)
  v_mfma_f32_32x32x16_bf16 v[200:215], a[64:67], a[44:47], v[200:215]
  ds_read_b128 a[8:11], v17 offset:8192
  s_add_u32 s95, s95, s81
  v_mfma_f32_32x32x16_bf16 v[216:231], a[64:67], a[48:51], v[216:231]
  ds_read_b128 a[12:15], v17 offset:12288
  ds_read_b128 a[232:235], v17
  buffer_load_dwordx4 v2, s[56:59], s95 offen lds
  v_mfma_f32_32x32x16_bf16 v[232:247], a[64:67], a[52:55], v[232:247]
  ds_read_b128 a[16:19], v18 offset:4096
  buffer_load_dwordx4 v3, s[56:59], s95 offen offset:1024 lds
  v_mfma_f32_32x32x16_bf16 v[200:215], a[68:71], a[56:59], v[200:215]
  ds_read_b128 a[20:23], v18 offset:8192
  buffer_load_dwordx4 v4, s[56:59], s95 offen offset:2048 lds
  s_waitcnt lgkmcnt(4)
  v_mfma_f32_32x32x16_bf16 v[216:231], a[68:71], a[60:63], v[216:231]
  ds_read_b128 a[24:27], v18 offset:12288
  ds_read_b128 a[236:239], v18
  buffer_load_dwordx4 v5, s[56:59], s95 offen offset:3072 lds
  v_mfma_f32_32x32x16_bf16 v[232:247], a[68:71], a[0:3], v[232:247]
  ds_read_b128 a[28:31], v15 offset:20480
  v_mfma_f32_32x32x16_bf16 v[200:215], a[72:75], a[4:7], v[200:215]
  ds_read_b128 a[32:35], v15 offset:24576
  v_mfma_f32_32x32x16_bf16 v[216:231], a[72:75], a[8:11], v[216:231]
  ds_read_b128 a[36:39], v15 offset:28672
  ds_read_b128 a[240:243], v15 offset:16384
  buffer_load_dwordx2 v[36:37], v31, s[60:63], 0 offen sc1
  s_waitcnt lgkmcnt(4)
  v_mfma_f32_32x32x16_bf16 v[232:247], a[72:75], a[12:15], v[232:247]
  ds_read_b128 a[40:43], v16 offset:20480
  s_mov_b32 s94, 0x3f80
  s_mov_b32 s99, 0x3f800000
  v_mfma_f32_32x32x16_bf16 v[200:215], a[76:79], a[16:19], v[200:215]
  ds_read_b128 a[44:47], v16 offset:24576
  s_waitcnt vmcnt(18)
  v_dot2c_f32_bf16 v184, s94, v124
  v_dot2c_f32_bf16 v185, s99, v124
  v_mfma_f32_32x32x16_bf16 v[216:231], a[76:79], a[20:23], v[216:231]
  ds_read_b128 a[48:51], v16 offset:28672
  ds_read_b128 a[244:247], v16 offset:16384
  v_dot2c_f32_bf16 v186, s94, v125
  v_dot2c_f32_bf16 v187, s99, v125
  v_mfma_f32_32x32x16_bf16 v[232:247], a[76:79], a[24:27], v[232:247]
  ds_read_b128 a[52:55], v17 offset:20480
  s_waitcnt vmcnt(17)
  v_dot2c_f32_bf16 v188, s94, v126
  v_dot2c_f32_bf16 v189, s99, v126
  s_waitcnt lgkmcnt(4)
  v_mfma_f32_32x32x16_bf16 v[200:215], a[80:83], a[28:31], v[200:215]
  ds_read_b128 a[56:59], v17 offset:24576
  v_dot2c_f32_bf16 v190, s94, v127
  v_dot2c_f32_bf16 v191, s99, v127
  v_mfma_f32_32x32x16_bf16 v[216:231], a[80:83], a[32:35], v[216:231]
  ds_read_b128 a[60:63], v17 offset:28672
  ds_read_b128 a[248:251], v17 offset:16384
  s_waitcnt vmcnt(16)
  v_dot2c_f32_bf16 v192, s94, v128
  v_dot2c_f32_bf16 v193, s99, v128
  v_mfma_f32_32x32x16_bf16 v[232:247], a[80:83], a[36:39], v[232:247]
  ds_read_b128 a[0:3], v18 offset:20480
  ds_read_b128 a[4:7], v18 offset:24576
  ds_read_b128 a[8:11], v18 offset:28672
  ds_read_b128 a[252:255], v18 offset:16384
  v_dot2c_f32_bf16 v194, s94, v129
  v_dot2c_f32_bf16 v195, s99, v129
  v_mfma_f32_32x32x16_bf16 v[200:215], a[84:87], a[40:43], v[200:215]
  s_waitcnt vmcnt(15)
  v_dot2c_f32_bf16 v196, s94, v130
  v_dot2c_f32_bf16 v197, s99, v130
  s_waitcnt lgkmcnt(6)
  v_mfma_f32_32x32x16_bf16 v[216:231], a[84:87], a[44:47], v[216:231]
  v_dot2c_f32_bf16 v198, s94, v131
  v_dot2c_f32_bf16 v199, s99, v131
  s_waitcnt lgkmcnt(0)
  s_barrier
  v_mfma_f32_32x32x16_bf16 v[232:247], a[84:87], a[48:51], v[232:247]
  ds_read_b128 a[12:15], v7 offset:4096
  s_waitcnt vmcnt(0)
  v_cmp_eq_u64 vcc, v[36:37], v[34:35]
  s_nop 0
  s_cmp_eq_u64 vcc, -1
  s_cbranch_scc0 L3_slow_kh
L3_res_kh:
  s_add_u32 m0, s72, 0xc000
  s_add_u32 s95, s101, 0
  s_sub_u32 s12, s95, 6
  v_lshl_add_u32 v81, v82, 3, v81
  v_mfma_f32_32x32x16_bf16 v[200:215], a[88:91], a[52:55], v[200:215]
  ds_read_b128 a[16:19], v7 offset:8192
  s_min_u32 s95, s95, s12
  s_mul_i32 s95, s95, 0x1000
  s_add_u32 s95, s95, s82
  buffer_load_dwordx4 v1, s[60:63], s95 offen sc1 lds
  v_mfma_f32_32x32x16_bf16 v[216:231], a[88:91], a[56:59], v[216:231]
  ds_read_b128 a[20:23], v7 offset:12288
  ds_read_b128 a[192:195], v7
  buffer_load_dwordx4 v1, s[60:63], s95 offen offset:1024 sc1 lds
  buffer_load_dwordx4 v1, s[60:63], s95 offen offset:2048 sc1 lds
  buffer_load_dwordx4 v1, s[60:63], s95 offen offset:3072 sc1 lds
  s_add_u32 m0, s72, 0x1c000
  v_mfma_f32_32x32x16_bf16 v[232:247], a[88:91], a[60:63], v[232:247]
  ds_read_b128 a[24:27], v8 offset:4096
  s_add_u32 s95, s101, 1
  s_sub_u32 s12, s95, 6
  s_min_u32 s95, s95, s12
  s_mul_i32 s95, s95, 0x1000
  v_mfma_f32_32x32x16_bf16 v[200:215], a[92:95], a[0:3], v[200:215]
  ds_read_b128 a[28:31], v8 offset:8192
  s_add_u32 s95, s95, s82
  buffer_load_dwordx4 v1, s[60:63], s95 offen sc1 lds
  buffer_load_dwordx4 v1, s[60:63], s95 offen offset:1024 sc1 lds
  buffer_load_dwordx4 v1, s[60:63], s95 offen offset:2048 sc1 lds
  v_mfma_f32_32x32x16_bf16 v[216:231], a[92:95], a[4:7], v[216:231]
  ds_read_b128 a[32:35], v8 offset:12288
  ds_read_b128 a[196:199], v8
  buffer_load_dwordx4 v1, s[60:63], s95 offen offset:3072 sc1 lds
  v_mfma_f32_32x32x16_bf16 v[232:247], a[92:95], a[8:11], v[232:247]
  ds_read_b128 a[36:39], v9 offset:4096
  s_waitcnt lgkmcnt(4)
  v_mfma_f32_32x32x16_bf16 v[200:215], a[96:99], a[12:15], v[200:215]
  ds_read_b128 a[40:43], v9 offset:8192
  v_mfma_f32_32x32x16_bf16 v[216:231], a[96:99], a[16:19], v[216:231]
  ds_read_b128 a[44:47], v9 offset:12288
  ds_read_b128 a[200:203], v9
  v_mfma_f32_32x32x16_bf16 v[232:247], a[96:99], a[20:23], v[232:247]
  ds_read_b128 a[48:51], v10 offset:4096
  v_mfma_f32_32x32x16_bf16 v[200:215], a[100:103], a[24:27], v[200:215]
  ds_read_b128 a[52:55], v10 offset:8192
  s_waitcnt lgkmcnt(4)
  v_mfma_f32_32x32x16_bf16 v[216:231], a[100:103], a[28:31], v[216:231]
  ds_read_b128 a[56:59], v10 offset:12288
  ds_read_b128 a[204:207], v10
  v_mfma_f32_32x32x16_bf16 v[232:247], a[100:103], a[32:35], v[232:247]
  ds_read_b128 a[60:63], v7 offset:20480
  v_mfma_f32_32x32x16_bf16 v[200:215], a[104:107], a[36:39], v[200:215]
  ds_read_b128 a[0:3], v7 offset:24576
  s_add_u32 m0, s72, 0x14000
  s_add_u32 s95, s101, 2
  s_sub_u32 s12, s95, 6
  v_mfma_f32_32x32x16_bf16 v[216:231], a[104:107], a[40:43], v[216:231]
  ds_read_b128 a[4:7], v7 offset:28672
  ds_read_b128 a[208:211], v7 offset:16384
  s_min_u32 s95, s95, s12
  s_mul_i32 s95, s95, 0x1000
  s_add_u32 s95, s95, s82
  s_waitcnt lgkmcnt(4)
  v_mfma_f32_32x32x16_bf16 v[232:247], a[104:107], a[44:47], v[232:247]
  ds_read_b128 a[8:11], v8 offset:20480
  buffer_load_dwordx4 v1, s[60:63], s95 offen sc1 lds
  buffer_load_dwordx4 v1, s[60:63], s95 offen offset:1024 sc1 lds
  buffer_load_dwordx4 v1, s[60:63], s95 offen offset:2048 sc1 lds
  v_mfma_f32_32x32x16_bf16 v[200:215], a[108:111], a[48:51], v[200:215]
  ds_read_b128 a[12:15], v8 offset:24576
  buffer_load_dwordx4 v1, s[60:63], s95 offen offset:3072 sc1 lds
  s_add_u32 m0, s72, 0x20000
  s_add_u32 s95, s101, 3
  v_mfma_f32_32x32x16_bf16 v[216:231], a[108:111], a[52:55], v[216:231]
  ds_read_b128 a[16:19], v8 offset:28672
  ds_read_b128 a[212:215], v8 offset:16384
  s_sub_u32 s12, s95, 6
  s_min_u32 s95, s95, s12
  s_mul_i32 s95, s95, 0x10000
  v_mfma_f32_32x32x16_bf16 v[232:247], a[108:111], a[56:59], v[232:247]
  ds_read_b128 a[20:23], v9 offset:20480
  s_add_u32 s95, s95, s81
  buffer_load_dwordx4 v2, s[56:59], s95 offen lds
  buffer_load_dwordx4 v3, s[56:59], s95 offen offset:1024 lds
  s_waitcnt lgkmcnt(4)
  v_mfma_f32_32x32x16_bf16 v[200:215], a[112:115], a[60:63], v[200:215]
  ds_read_b128 a[24:27], v9 offset:24576
  buffer_load_dwordx4 v4, s[56:59], s95 offen offset:2048 lds
  buffer_load_dwordx4 v5, s[56:59], s95 offen offset:3072 lds
  s_add_u32 m0, s72, 0x24000
  v_mfma_f32_32x32x16_bf16 v[216:231], a[112:115], a[0:3], v[216:231]
  ds_read_b128 a[28:31], v9 offset:28672
  ds_read_b128 a[216:219], v9 offset:16384
  s_add_u32 s95, s101, 3
  s_sub_u32 s12, s95, 6
  s_min_u32 s95, s95, s12
  v_mfma_f32_32x32x16_bf16 v[232:247], a[112:115], a[4:7], v[232:247]
  ds_read_b128 a[32:35], v10 offset:20480
  ds_read_b128 a[36:39], v10 offset:24576
  ds_read_b128 a[40:43], v10 offset:28672
  ds_read_b128 a[220:223], v10 offset:16384
  s_mul_i32 s95, s95, 0x1000
  s_add_u32 s95, s95, s82
  buffer_load_dwordx4 v1, s[60:63], s95 offen sc1 lds
  v_mfma_f32_32x32x16_bf16 v[200:215], a[116:119], a[8:11], v[200:215]
  buffer_load_dwordx4 v1, s[60:63], s95 offen offset:1024 sc1 lds
  buffer_load_dwordx4 v1, s[60:63], s95 offen offset:2048 sc1 lds
  buffer_load_dwordx4 v1, s[60:63], s95 offen offset:3072 sc1 lds
  s_waitcnt lgkmcnt(6)
  v_mfma_f32_32x32x16_bf16 v[216:231], a[116:119], a[12:15], v[216:231]
  s_waitcnt vmcnt(16) lgkmcnt(0)
  s_barrier
  v_mfma_f32_32x32x16_bf16 v[232:247], a[116:119], a[16:19], v[232:247]
  ds_read_b64_tr_b16 a[44:45], v72 offset:32768
  ds_read_b64_tr_b16 a[46:47], v72 offset:33792
  ds_read_b128 a[48:51], v75 offset:49152
  s_add_u32 m0, s72, 0
  v_mfma_f32_32x32x16_bf16 v[200:215], a[120:123], a[20:23], v[200:215]
  ds_read_b128 a[52:55], v75 offset:53248
  s_add_u32 s95, s101, 4
  v_mfma_f32_32x32x16_bf16 v[216:231], a[120:123], a[24:27], v[216:231]
  ds_read_b128 a[56:59], v75 offset:57344
  s_sub_u32 s12, s95, 6
  v_mfma_f32_32x32x16_bf16 v[232:247], a[120:123], a[28:31], v[232:247]
  ds_read_b128 a[60:63], v75 offset:61440
  s_min_u32 s95, s95, s12
  s_mul_i32 s95, s95, 0x10000
  v_mfma_f32_32x32x16_bf16 v[200:215], a[124:127], a[32:35], v[200:215]
  ds_read_b64_tr_b16 a[0:1], v72 offset:34816
  ds_read_b64_tr_b16 a[2:3], v72 offset:35840
  ds_read_b128 a[4:7], v75 offset:50176
  s_add_u32 s95, s95, s81
  v_mfma_f32_32x32x16_bf16 v[216:231], a[124:127], a[36:39], v[216:231]
  ds_read_b128 a[8:11], v75 offset:54272
  buffer_load_dwordx4 v2, s[56:59], s95 offen lds
  v_mfma_f32_32x32x16_bf16 v[232:247], a[124:127], a[40:43], v[232:247]
  ds_read_b128 a[12:15], v75 offset:58368
  buffer_load_dwordx4 v3, s[56:59], s95 offen offset:1024 lds
  buffer_load_dwordx4 v4, s[56:59], s95 offen offset:2048 lds
  s_waitcnt lgkmcnt(5)
  v_mfma_f32_32x32x16_bf16 v[184:199], a[44:47], a[48:51], v[184:199]
  ds_read_b128 a[16:19], v75 offset:62464
  buffer_load_dwordx4 v5, s[56:59], s95 offen offset:3072 lds
  v_mfma_f32_32x32x16_bf16 v[200:215], a[44:47], a[52:55], v[200:215]
  ds_read_b64_tr_b16 a[20:21], v72 offset:36864
  ds_read_b64_tr_b16 a[22:23], v72 offset:37888
  ds_read_b128 a[24:27], v75 offset:51200
  s_add_u32 m0, s72, 0x4000
  v_mfma_f32_32x32x16_bf16 v[216:231], a[44:47], a[56:59], v[216:231]
  ds_read_b128 a[28:31], v75 offset:55296
  s_add_u32 s95, s101, 4
  s_sub_u32 s12, s95, 6
  v_mfma_f32_32x32x16_bf16 v[232:247], a[44:47], a[60:63], v[232:247]
  ds_read_b128 a[32:35], v75 offset:59392
  s_min_u32 s95, s95, s12
  s_waitcnt lgkmcnt(5)
  v_mfma_f32_32x32x16_bf16 v[184:199], a[0:3], a[4:7], v[184:199]
  ds_read_b128 a[36:39], v75 offset:63488
  s_mul_i32 s95, s95, 0x1000
  v_mfma_f32_32x32x16_bf16 v[200:215], a[0:3], a[8:11], v[200:215]
  ds_read_b64_tr_b16 a[40:41], v72 offset:38912
  ds_read_b64_tr_b16 a[42:43], v72 offset:39936
  ds_read_b128 a[44:47], v75 offset:52224
  s_add_u32 s95, s95, s82
  buffer_load_dwordx4 v1, s[60:63], s95 offen sc1 lds
  v_mfma_f32_32x32x16_bf16 v[216:231], a[0:3], a[12:15], v[216:231]
  ds_read_b128 a[48:51], v75 offset:56320
  ds_read_b128 a[52:55], v75 offset:60416
  ds_read_b128 a[56:59], v75 offset:64512
  buffer_load_dwordx4 v1, s[60:63], s95 offen offset:1024 sc1 lds
  v_mfma_f32_32x32x16_bf16 v[232:247], a[0:3], a[16:19], v[232:247]
  buffer_load_dwordx4 v1, s[60:63], s95 offen offset:2048 sc1 lds
  s_waitcnt lgkmcnt(6)
  v_mfma_f32_32x32x16_bf16 v[184:199], a[20:23], a[24:27], v[184:199]
  buffer_load_dwordx4 v1, s[60:63], s95 offen offset:3072 sc1 lds
  s_waitcnt vmcnt(20) lgkmcnt(0)
  s_barrier
  v_mfma_f32_32x32x16_bf16 v[200:215], a[20:23], a[28:31], v[200:215]
  ds_read_b64_tr_b16 a[60:61], v73 offset:32768
  ds_read_b64_tr_b16 a[62:63], v73 offset:33792
  ds_read_b128 a[0:3], v76 offset:49152
  s_add_u32 m0, s72, 0x8000
  v_mfma_f32_32x32x16_bf16 v[216:231], a[20:23], a[32:35], v[216:231]
  ds_read_b128 a[4:7], v76 offset:53248
  s_add_u32 s95, s101, 5
  v_mfma_f32_32x32x16_bf16 v[232:247], a[20:23], a[36:39], v[232:247]
  ds_read_b128 a[8:11], v76 offset:57344
  s_sub_u32 s12, s95, 6
  v_mfma_f32_32x32x16_bf16 v[184:199], a[40:43], a[44:47], v[184:199]
  ds_read_b128 a[12:15], v76 offset:61440
  s_min_u32 s95, s95, s12
  s_mul_i32 s95, s95, 0x10000
  v_mfma_f32_32x32x16_bf16 v[200:215], a[40:43], a[48:51], v[200:215]
  ds_read_b64_tr_b16 a[16:17], v73 offset:34816
  ds_read_b64_tr_b16 a[18:19], v73 offset:35840
  ds_read_b128 a[20:23], v76 offset:50176
  s_add_u32 s95, s95, s81
  v_mfma_f32_32x32x16_bf16 v[216:231], a[40:43], a[52:55], v[216:231]
  ds_read_b128 a[24:27], v76 offset:54272
  buffer_load_dwordx4 v2, s[56:59], s95 offen lds
  v_mfma_f32_32x32x16_bf16 v[232:247], a[40:43], a[56:59], v[232:247]
  ds_read_b128 a[28:31], v76 offset:58368
  buffer_load_dwordx4 v3, s[56:59], s95 offen offset:1024 lds
  buffer_load_dwordx4 v4, s[56:59], s95 offen offset:2048 lds
  s_waitcnt lgkmcnt(5)
  v_mfma_f32_32x32x16_bf16 v[184:199], a[60:63], a[0:3], v[184:199]
  ds_read_b128 a[32:35], v76 offset:62464
  buffer_load_dwordx4 v5, s[56:59], s95 offen offset:3072 lds
  v_mfma_f32_32x32x16_bf16 v[200:215], a[60:63], a[4:7], v[200:215]
  ds_read_b64_tr_b16 a[36:37], v73 offset:36864
  ds_read_b64_tr_b16 a[38:39], v73 offset:37888
  ds_read_b128 a[40:43], v76 offset:51200
  s_add_u32 m0, s72, 0xc000
  v_mfma_f32_32x32x16_bf16 v[216:231], a[60:63], a[8:11], v[216:231]
  ds_read_b128 a[44:47], v76 offset:55296
  s_add_u32 s95, s101, 5
  s_sub_u32 s12, s95, 6
  v_mfma_f32_32x32x16_bf16 v[232:247], a[60:63], a[12:15], v[232:247]
  ds_read_b128 a[48:51], v76 offset:59392
  s_min_u32 s95, s95, s12
  s_waitcnt lgkmcnt(5)
  v_mfma_f32_32x32x16_bf16 v[184:199], a[16:19], a[20:23], v[184:199]
  ds_read_b128 a[52:55], v76 offset:63488
  s_mul_i32 s95, s95, 0x1000
  v_mfma_f32_32x32x16_bf16 v[200:215], a[16:19], a[24:27], v[200:215]
  ds_read_b64_tr_b16 a[56:57], v73 offset:38912
  ds_read_b64_tr_b16 a[58:59], v73 offset:39936
  ds_read_b128 a[60:63], v76 offset:52224
  s_add_u32 s95, s95, s82
  buffer_load_dwordx4 v1, s[60:63], s95 offen sc1 lds
  v_mfma_f32_32x32x16_bf16 v[216:231], a[16:19], a[28:31], v[216:231]
  ds_read_b128 a[0:3], v76 offset:56320
  ds_read_b128 a[4:7], v76 offset:60416
  ds_read_b128 a[8:11], v76 offset:64512
  buffer_load_dwordx4 v1, s[60:63], s95 offen offset:1024 sc1 lds
  v_mfma_f32_32x32x16_bf16 v[232:247], a[16:19], a[32:35], v[232:247]
  buffer_load_dwordx4 v1, s[60:63], s95 offen offset:2048 sc1 lds
  s_waitcnt lgkmcnt(6)
  v_mfma_f32_32x32x16_bf16 v[184:199], a[36:39], a[40:43], v[184:199]
  buffer_load_dwordx4 v1, s[60:63], s95 offen offset:3072 sc1 lds
  s_waitcnt vmcnt(24) lgkmcnt(0)
  s_barrier
  v_mfma_f32_32x32x16_bf16 v[200:215], a[36:39], a[44:47], v[200:215]
  ds_read_b64_tr_b16 a[160:161], v73
  ds_read_b64_tr_b16 a[162:163], v73 offset:1024
  ds_read_b128 a[12:15], v76 offset:20480
  v_mfma_f32_32x32x16_bf16 v[216:231], a[36:39], a[48:51], v[216:231]
  ds_read_b128 a[16:19], v76 offset:24576
  s_mul_i32 s12, s3, 0x1000
  v_mfma_f32_32x32x16_bf16 v[232:247], a[36:39], a[52:55], v[232:247]
  ds_read_b128 a[20:23], v76 offset:28672
  ds_read_b128 a[176:179], v76 offset:16384
  s_add_u32 m0, s12, 0x18000
  v_mfma_f32_32x32x16_bf16 v[184:199], a[56:59], a[60:63], v[184:199]
  ds_read_b64_tr_b16 a[164:165], v73 offset:2048
  ds_read_b64_tr_b16 a[166:167], v73 offset:3072
  ds_read_b128 a[24:27], v76 offset:21504
  s_add_u32 s95, s17, 0
  v_mfma_f32_32x32x16_bf16 v[200:215], a[56:59], a[0:3], v[200:215]
  ds_read_b128 a[28:31], v76 offset:25600
  v_mfma_f32_32x32x16_bf16 v[216:231], a[56:59], a[4:7], v[216:231]
  ds_read_b128 a[32:35], v76 offset:29696
  ds_read_b128 a[180:183], v76 offset:17408
  buffer_load_dwordx4 v1, s[60:63], s95 offen sc1 lds
  v_mfma_f32_32x32x16_bf16 v[232:247], a[56:59], a[8:11], v[232:247]
  ds_read_b64_tr_b16 a[168:169], v73 offset:4096
  ds_read_b64_tr_b16 a[170:171], v73 offset:5120
  ds_read_b128 a[36:39], v76 offset:22528
  buffer_load_dwordx4 v1, s[60:63], s95 offen offset:1024 sc1 lds
  s_waitcnt lgkmcnt(6)
  v_mfma_f32_32x32x16_bf16 v[200:215], a[160:163], a[12:15], v[200:215]
  ds_read_b128 a[40:43], v76 offset:26624
  buffer_load_dwordx4 v1, s[60:63], s95 offen offset:2048 sc1 lds
  v_mfma_f32_32x32x16_bf16 v[216:231], a[160:163], a[16:19], v[216:231]
  ds_read_b128 a[44:47], v76 offset:30720
  ds_read_b128 a[184:187], v76 offset:18432
  v_mfma_f32_32x32x16_bf16 v[232:247], a[160:163], a[20:23], v[232:247]
  ds_read_b64_tr_b16 a[172:173], v73 offset:6144
  ds_read_b64_tr_b16 a[174:175], v73 offset:7168
  ds_read_b128 a[48:51], v76 offset:23552
  ds_read_b128 a[52:55], v76 offset:27648
  ds_read_b128 a[56:59], v76 offset:31744
  ds_read_b128 a[188:191], v76 offset:19456
  buffer_load_dwordx4 v1, s[60:63], s95 offen offset:3072 sc1 lds
  v_mfma_f32_32x32x16_bf16 v[200:215], a[164:167], a[24:27], v[200:215]
  s_waitcnt lgkmcnt(8)
  v_mfma_f32_32x32x16_bf16 v[216:231], a[164:167], a[28:31], v[216:231]
  s_waitcnt vmcnt(20) lgkmcnt(0)
  s_barrier
  v_mfma_f32_32x32x16_bf16 v[232:247], a[164:167], a[32:35], v[232:247]
  ds_read_b64_tr_b16 v[148:149], v74
  ds_read_b64_tr_b16 v[150:151], v74 offset:1024
  ds_read_b128 a[60:63], v77 offset:20480
  s_add_u32 m0, s72, 0x10000
  v_mfma_f32_32x32x16_bf16 v[200:215], a[168:171], a[36:39], v[200:215]
  ds_read_b128 a[0:3], v77 offset:24576
  s_add_u32 s95, s16, 0
  v_mfma_f32_32x32x16_bf16 v[216:231], a[168:171], a[40:43], v[216:231]
  ds_read_b128 a[4:7], v77 offset:28672
  ds_read_b128 v[164:167], v77 offset:16384
  buffer_load_dwordx4 v2, s[56:59], s95 offen lds
  v_mfma_f32_32x32x16_bf16 v[232:247], a[168:171], a[44:47], v[232:247]
  ds_read_b64_tr_b16 v[152:153], v74 offset:2048
  ds_read_b64_tr_b16 v[154:155], v74 offset:3072
  ds_read_b128 a[8:11], v77 offset:21504
  buffer_load_dwordx4 v3, s[56:59], s95 offen offset:1024 lds
  v_mfma_f32_32x32x16_bf16 v[200:215], a[172:175], a[48:51], v[200:215]
  ds_read_b128 a[12:15], v77 offset:25600
  buffer_load_dwordx4 v4, s[56:59], s95 offen offset:2048 lds
  v_mfma_f32_32x32x16_bf16 v[216:231], a[172:175], a[52:55], v[216:231]
  ds_read_b128 a[16:19], v77 offset:29696
  ds_read_b128 v[168:171], v77 offset:17408
  buffer_load_dwordx4 v5, s[56:59], s95 offen offset:3072 lds
  v_mfma_f32_32x32x16_bf16 v[232:247], a[172:175], a[56:59], v[232:247]
  ds_read_b64_tr_b16 v[156:157], v74 offset:4096
  ds_read_b64_tr_b16 v[158:159], v74 offset:5120
  ds_read_b128 a[20:23], v77 offset:22528
  s_add_u32 m0, s72, 0x14000
  s_waitcnt lgkmcnt(6)
  v_mfma_f32_32x32x16_bf16 v[200:215], v[148:151], a[60:63], v[200:215]
  ds_read_b128 a[24:27], v77 offset:26624
  s_add_u32 s95, s16, 0x10000
  v_mfma_f32_32x32x16_bf16 v[216:231], v[148:151], a[0:3], v[216:231]
  ds_read_b128 a[28:31], v77 offset:30720
  ds_read_b128 v[172:175], v77 offset:18432
  buffer_load_dwordx4 v2, s[56:59], s95 offen lds
  v_mfma_f32_32x32x16_bf16 v[232:247], v[148:151], a[4:7], v[232:247]
  ds_read_b64_tr_b16 v[160:161], v74 offset:6144
  ds_read_b64_tr_b16 v[162:163], v74 offset:7168
  ds_read_b128 a[32:35], v77 offset:23552
  ds_read_b128 a[36:39], v77 offset:27648
  ds_read_b128 a[40:43], v77 offset:31744
  ds_read_b128 v[176:179], v77 offset:19456
  buffer_load_dwordx4 v3, s[56:59], s95 offen offset:1024 lds
  v_mfma_f32_32x32x16_bf16 v[200:215], v[152:155], a[8:11], v[200:215]
  buffer_load_dwordx4 v4, s[56:59], s95 offen offset:2048 lds
  s_waitcnt lgkmcnt(8)
  v_mfma_f32_32x32x16_bf16 v[216:231], v[152:155], a[12:15], v[216:231]
  buffer_load_dwordx4 v5, s[56:59], s95 offen offset:3072 lds
  s_waitcnt vmcnt(20) lgkmcnt(0)
  s_barrier
  v_mfma_f32_32x32x16_bf16 v[232:247], v[152:155], a[16:19], v[232:247]
  ds_read_b64_tr_b16 v[84:85], v72
  ds_read_b64_tr_b16 v[86:87], v72 offset:1024
  ds_read_b128 a[44:47], v75 offset:20480
  v_mfma_f32_32x32x16_bf16 v[200:215], v[156:159], a[20:23], v[200:215]
  ds_read_b128 a[48:51], v75 offset:24576
  s_add_u32 m0, s72, 0x20000
  v_mfma_f32_32x32x16_bf16 v[216:231], v[156:159], a[24:27], v[216:231]
  ds_read_b128 a[52:55], v75 offset:28672
  ds_read_b128 v[52:55], v75 offset:16384
  s_add_u32 s95, s16, 0x20000
  v_mfma_f32_32x32x16_bf16 v[232:247], v[156:159], a[28:31], v[232:247]
  ds_read_b64_tr_b16 v[88:89], v72 offset:2048
  ds_read_b64_tr_b16 v[90:91], v72 offset:3072
  ds_read_b128 a[56:59], v75 offset:21504
  buffer_load_dwordx4 v2, s[56:59], s95 offen lds
  v_mfma_f32_32x32x16_bf16 v[200:215], v[160:163], a[32:35], v[200:215]
  ds_read_b128 a[60:63], v75 offset:25600
  v_mfma_f32_32x32x16_bf16 v[216:231], v[160:163], a[36:39], v[216:231]
  ds_read_b128 a[0:3], v75 offset:29696
  ds_read_b128 v[56:59], v75 offset:17408
  buffer_load_dwordx4 v3, s[56:59], s95 offen offset:1024 lds
  v_mfma_f32_32x32x16_bf16 v[232:247], v[160:163], a[40:43], v[232:247]
  ds_read_b64_tr_b16 v[92:93], v72 offset:4096
  ds_read_b64_tr_b16 v[94:95], v72 offset:5120
  ds_read_b128 a[4:7], v75 offset:22528
  buffer_load_dwordx4 v4, s[56:59], s95 offen offset:2048 lds
  s_waitcnt lgkmcnt(6)
  v_mfma_f32_32x32x16_bf16 v[200:215], v[84:87], a[44:47], v[200:215]
  ds_read_b128 a[8:11], v75 offset:26624
  buffer_load_dwordx4 v5, s[56:59], s95 offen offset:3072 lds
  v_mfma_f32_32x32x16_bf16 v[216:231], v[84:87], a[48:51], v[216:231]
  ds_read_b128 a[12:15], v75 offset:30720
  ds_read_b128 v[248:251], v75 offset:18432
  v_mfma_f32_32x32x16_bf16 v[232:247], v[84:87], a[52:55], v[232:247]
  ds_read_b64_tr_b16 v[96:97], v72 offset:6144
  ds_read_b64_tr_b16 v[98:99], v72 offset:7168
  ds_read_b128 a[16:19], v75 offset:23552
  ds_read_b128 a[20:23], v75 offset:27648
  ds_read_b128 a[24:27], v75 offset:31744
  ds_read_b128 v[252:255], v75 offset:19456
  s_add_u32 m0, s72, 0x24000
  v_mfma_f32_32x32x16_bf16 v[200:215], v[88:91], a[56:59], v[200:215]
  s_add_u32 s95, s16, 0x30000
  s_waitcnt lgkmcnt(8)
  v_mfma_f32_32x32x16_bf16 v[216:231], v[88:91], a[60:63], v[216:231]
  buffer_load_dwordx4 v2, s[56:59], s95 offen lds
  s_waitcnt vmcnt(17) lgkmcnt(0)
  s_barrier
  v_mfma_f32_32x32x16_bf16 v[232:247], v[88:91], a[0:3], v[232:247]
  ds_read_b64_tr_b16 v[132:133], v72 offset:32768
  ds_read_b64_tr_b16 v[134:135], v72 offset:33792
  ds_read_b128 a[28:31], v75 offset:53248
  v_mfma_f32_32x32x16_bf16 v[200:215], v[92:95], a[4:7], v[200:215]
  ds_read_b64_tr_b16 v[136:137], v72 offset:34816
  ds_read_b64_tr_b16 v[138:139], v72 offset:35840
  ds_read_b128 a[32:35], v75 offset:54272
  buffer_load_dwordx4 v3, s[56:59], s95 offen offset:1024 lds
  v_mfma_f32_32x32x16_bf16 v[216:231], v[92:95], a[8:11], v[216:231]
  ds_read_b64_tr_b16 v[140:141], v72 offset:36864
  ds_read_b64_tr_b16 v[142:143], v72 offset:37888
  ds_read_b128 a[36:39], v75 offset:55296
  buffer_load_dwordx4 v4, s[56:59], s95 offen offset:2048 lds
  v_mfma_f32_32x32x16_bf16 v[232:247], v[92:95], a[12:15], v[232:247]
  ds_read_b64_tr_b16 v[144:145], v72 offset:38912
  ds_read_b64_tr_b16 v[146:147], v72 offset:39936
  ds_read_b128 a[40:43], v75 offset:56320
  buffer_load_dwordx4 v5, s[56:59], s95 offen offset:3072 lds
  v_mfma_f32_32x32x16_bf16 v[200:215], v[96:99], a[16:19], v[200:215]
  ds_read_b128 a[44:47], v75 offset:57344
  v_mfma_f32_32x32x16_bf16 v[216:231], v[96:99], a[20:23], v[216:231]
  ds_read_b128 a[48:51], v75 offset:58368
  v_mfma_f32_32x32x16_bf16 v[232:247], v[96:99], a[24:27], v[232:247]
  ds_read_b128 a[52:55], v75 offset:59392
  s_waitcnt lgkmcnt(3)
  v_mfma_f32_32x32x16_bf16 v[200:215], v[132:135], a[28:31], v[200:215]
  ds_read_b128 a[56:59], v75 offset:60416
  v_mfma_f32_32x32x16_bf16 v[200:215], v[136:139], a[32:35], v[200:215]
  ds_read_b128 a[60:63], v75 offset:61440
  v_mfma_f32_32x32x16_bf16 v[200:215], v[140:143], a[36:39], v[200:215]
  ds_read_b128 a[0:3], v75 offset:62464
  v_mfma_f32_32x32x16_bf16 v[200:215], v[144:147], a[40:43], v[200:215]
  ds_read_b128 a[4:7], v75 offset:63488
  s_waitcnt lgkmcnt(3)
  v_mfma_f32_32x32x16_bf16 v[216:231], v[132:135], a[44:47], v[216:231]
  ds_read_b128 a[8:11], v75 offset:64512
  v_mfma_f32_32x32x16_bf16 v[216:231], v[136:139], a[48:51], v[216:231]
  ds_read_b128 a[12:15], v75 offset:49152
  v_mfma_f32_32x32x16_bf16 v[216:231], v[140:143], a[52:55], v[216:231]
  ds_read_b128 a[16:19], v75 offset:50176
  s_xor_b32 s8, s6, 1
  s_lshl_b32 s8, s8, 13
  s_add_u32 s8, s8, s87
  s_nop 0
  v_cvt_pk_bf16_f32 v100, v200, v201
  v_cvt_pk_bf16_f32 v101, v202, v203
  v_cvt_pk_bf16_f32 v102, v204, v205
  v_cvt_pk_bf16_f32 v103, v206, v207
  buffer_store_dwordx4 v[100:103], v1, s[60:63], s8 offen sc1
  v_mfma_f32_32x32x16_bf16 v[216:231], v[144:147], a[56:59], v[216:231]
  ds_read_b128 a[20:23], v75 offset:51200
  v_cvt_pk_bf16_f32 v104, v208, v209
  v_cvt_pk_bf16_f32 v105, v210, v211
  v_cvt_pk_bf16_f32 v106, v212, v213
  v_cvt_pk_bf16_f32 v107, v214, v215
  buffer_store_dwordx4 v[104:107], v1, s[60:63], s8 offen offset:1024 sc1
  s_waitcnt lgkmcnt(3)
  v_mfma_f32_32x32x16_bf16 v[232:247], v[132:135], a[60:63], v[232:247]
  ds_read_b128 a[24:27], v75 offset:52224
  v_mfma_f32_32x32x16_bf16 v[232:247], v[136:139], a[0:3], v[232:247]
  v_mfma_f32_32x32x16_bf16 v[232:247], v[140:143], a[4:7], v[232:247]
  s_xor_b32 s8, s6, 2
  s_lshl_b32 s8, s8, 13
  s_add_u32 s8, s8, s87
  v_cvt_pk_bf16_f32 v108, v216, v217
  v_cvt_pk_bf16_f32 v109, v218, v219
  v_cvt_pk_bf16_f32 v110, v220, v221
  v_cvt_pk_bf16_f32 v111, v222, v223
  buffer_store_dwordx4 v[108:111], v1, s[60:63], s8 offen sc1
  v_mfma_f32_32x32x16_bf16 v[232:247], v[144:147], a[8:11], v[232:247]
  v_cvt_pk_bf16_f32 v112, v224, v225
  v_cvt_pk_bf16_f32 v113, v226, v227
  v_cvt_pk_bf16_f32 v114, v228, v229
  v_cvt_pk_bf16_f32 v115, v230, v231
  buffer_store_dwordx4 v[112:115], v1, s[60:63], s8 offen offset:1024 sc1
  s_waitcnt lgkmcnt(0)
  v_mfma_f32_32x32x16_bf16 v[184:199], v[132:135], a[12:15], v[184:199]
  v_mfma_f32_32x32x16_bf16 v[184:199], v[136:139], a[16:19], v[184:199]
  v_mfma_f32_32x32x16_bf16 v[184:199], v[140:143], a[20:23], v[184:199]
  s_xor_b32 s8, s6, 3
  s_lshl_b32 s8, s8, 13
  s_add_u32 s8, s8, s87
  v_cvt_pk_bf16_f32 v116, v232, v233
  v_cvt_pk_bf16_f32 v117, v234, v235
  v_cvt_pk_bf16_f32 v118, v236, v237
  v_cvt_pk_bf16_f32 v119, v238, v239
  buffer_store_dwordx4 v[116:119], v1, s[60:63], s8 offen sc1
  v_mfma_f32_32x32x16_bf16 v[184:199], v[144:147], a[24:27], v[184:199]
  v_cvt_pk_bf16_f32 v120, v240, v241
  v_cvt_pk_bf16_f32 v121, v242, v243
  v_cvt_pk_bf16_f32 v122, v244, v245
  v_cvt_pk_bf16_f32 v123, v246, v247
  buffer_store_dwordx4 v[120:123], v1, s[60:63], s8 offen offset:1024 sc1
  v_mfma_f32_32x32x16_bf16 v[184:199], a[64:67], a[224:227], v[184:199]
  v_mfma_f32_32x32x16_bf16 v[184:199], a[68:71], a[228:231], v[184:199]
  v_mfma_f32_32x32x16_bf16 v[184:199], a[72:75], a[232:235], v[184:199]
  v_mfma_f32_32x32x16_bf16 v[184:199], a[76:79], a[236:239], v[184:199]
  v_mfma_f32_32x32x16_bf16 v[184:199], a[80:83], a[240:243], v[184:199]
  v_mfma_f32_32x32x16_bf16 v[184:199], a[84:87], a[244:247], v[184:199]
  v_mfma_f32_32x32x16_bf16 v[184:199], a[88:91], a[248:251], v[184:199]
  v_mfma_f32_32x32x16_bf16 v[184:199], a[92:95], a[252:255], v[184:199]
  v_mfma_f32_32x32x16_bf16 v[184:199], a[96:99], a[192:195], v[184:199]
  v_mfma_f32_32x32x16_bf16 v[184:199], a[100:103], a[196:199], v[184:199]
  v_mfma_f32_32x32x16_bf16 v[184:199], a[104:107], a[200:203], v[184:199]
  v_mfma_f32_32x32x16_bf16 v[184:199], a[108:111], a[204:207], v[184:199]
  v_mfma_f32_32x32x16_bf16 v[184:199], a[112:115], a[208:211], v[184:199]
  v_mfma_f32_32x32x16_bf16 v[184:199], a[116:119], a[212:215], v[184:199]
  v_mfma_f32_32x32x16_bf16 v[184:199], a[120:123], a[216:219], v[184:199]
  v_mfma_f32_32x32x16_bf16 v[184:199], a[124:127], a[220:223], v[184:199]
  v_mfma_f32_32x32x16_bf16 v[184:199], a[160:163], a[176:179], v[184:199]
  v_mfma_f32_32x32x16_bf16 v[184:199], a[164:167], a[180:183], v[184:199]
  v_mfma_f32_32x32x16_bf16 v[184:199], a[168:171], a[184:187], v[184:199]
  v_mfma_f32_32x32x16_bf16 v[184:199], a[172:175], a[188:191], v[184:199]
  v_mfma_f32_32x32x16_bf16 v[184:199], v[148:151], v[164:167], v[184:199]
  v_mfma_f32_32x32x16_bf16 v[184:199], v[152:155], v[168:171], v[184:199]
  v_mfma_f32_32x32x16_bf16 v[184:199], v[156:159], v[172:175], v[184:199]
  v_mfma_f32_32x32x16_bf16 v[184:199], v[160:163], v[176:179], v[184:199]
  s_waitcnt vmcnt(14)
  s_barrier
  v_mfma_f32_32x32x16_bf16 v[184:199], v[84:87], v[52:55], v[184:199]
  ds_read_b64_tr_b16 a[28:29], v73
  ds_read_b64_tr_b16 a[30:31], v73 offset:1024
  ds_read_b128 a[32:35], v76 offset:32768
  v_mfma_f32_32x32x16_bf16 v[184:199], v[88:91], v[56:59], v[184:199]
  ds_read_b64_tr_b16 a[36:37], v73 offset:2048
  ds_read_b64_tr_b16 a[38:39], v73 offset:3072
  ds_read_b128 a[40:43], v76 offset:33792
  v_mfma_f32_32x32x16_bf16 v[184:199], v[92:95], v[248:251], v[184:199]
  ds_read_b64_tr_b16 a[44:45], v73 offset:4096
  ds_read_b64_tr_b16 a[46:47], v73 offset:5120
  ds_read_b128 a[48:51], v76 offset:34816
  v_mfma_f32_32x32x16_bf16 v[184:199], v[96:99], v[252:255], v[184:199]
  ds_read_b64_tr_b16 a[52:53], v73 offset:6144
  ds_read_b64_tr_b16 a[54:55], v73 offset:7168
  ds_read_b128 a[56:59], v76 offset:35840
  s_waitcnt lgkmcnt(6)
  v_mfma_f32_32x32x16_bf16 v[184:199], a[28:31], a[32:35], v[184:199]
  ds_read_b64_tr_b16 a[60:61], v73 offset:16384
  ds_read_b64_tr_b16 a[62:63], v73 offset:17408
  ds_read_b128 a[0:3], v76 offset:36864
  buffer_load_dwordx4 v[200:203], v1, s[60:63], s90 offen sc1
  buffer_load_dwordx4 v[204:207], v1, s[60:63], s90 offen offset:1024 sc1
  buffer_load_dwordx4 v[208:211], v1, s[60:63], s91 offen sc1
  buffer_load_dwordx4 v[212:215], v1, s[60:63], s91 offen offset:1024 sc1
  buffer_load_dwordx4 v[216:219], v1, s[60:63], s92 offen sc1
  buffer_load_dwordx4 v[220:223], v1, s[60:63], s92 offen offset:1024 sc1
  v_mfma_f32_32x32x16_bf16 v[184:199], a[36:39], a[40:43], v[184:199]
  ds_read_b64_tr_b16 a[4:5], v73 offset:18432
  ds_read_b64_tr_b16 a[6:7], v73 offset:19456
  ds_read_b128 a[8:11], v76 offset:37888
  ds_read_b64_tr_b16 a[12:13], v73 offset:20480
  ds_read_b64_tr_b16 a[14:15], v73 offset:21504
  ds_read_b128 a[16:19], v76 offset:38912
  ds_read_b64_tr_b16 a[20:21], v73 offset:22528
  ds_read_b64_tr_b16 a[22:23], v73 offset:23552
  ds_read_b128 a[24:27], v76 offset:39936
  s_waitcnt lgkmcnt(12)
  v_mfma_f32_32x32x16_bf16 v[184:199], a[44:47], a[48:51], v[184:199]
  v_mfma_f32_32x32x16_bf16 v[184:199], a[52:55], a[56:59], v[184:199]
  s_waitcnt vmcnt(12) lgkmcnt(0)
  s_barrier
  v_mfma_f32_32x32x16_bf16 v[184:199], a[60:63], a[0:3], v[184:199]
  ds_read_b64_tr_b16 a[28:29], v74
  ds_read_b64_tr_b16 a[30:31], v74 offset:1024
  ds_read_b128 a[32:35], v76 offset:40960
  v_mfma_f32_32x32x16_bf16 v[184:199], a[4:7], a[8:11], v[184:199]
  ds_read_b64_tr_b16 a[36:37], v74 offset:2048
  ds_read_b64_tr_b16 a[38:39], v74 offset:3072
  ds_read_b128 a[40:43], v76 offset:41984
  v_mfma_f32_32x32x16_bf16 v[184:199], a[12:15], a[16:19], v[184:199]
  ds_read_b64_tr_b16 a[44:45], v74 offset:4096
  ds_read_b64_tr_b16 a[46:47], v74 offset:5120
  ds_read_b128 a[48:51], v76 offset:43008
  v_mfma_f32_32x32x16_bf16 v[184:199], a[20:23], a[24:27], v[184:199]
  ds_read_b64_tr_b16 a[52:53], v74 offset:6144
  ds_read_b64_tr_b16 a[54:55], v74 offset:7168
  ds_read_b128 a[56:59], v76 offset:44032
  s_waitcnt lgkmcnt(6)
  v_mfma_f32_32x32x16_bf16 v[184:199], a[28:31], a[32:35], v[184:199]
  ds_read_b64_tr_b16 a[60:61], v74 offset:16384
  ds_read_b64_tr_b16 a[62:63], v74 offset:17408
  ds_read_b128 a[0:3], v76 offset:45056
  v_mfma_f32_32x32x16_bf16 v[184:199], a[36:39], a[40:43], v[184:199]
  ds_read_b64_tr_b16 a[4:5], v74 offset:18432
  ds_read_b64_tr_b16 a[6:7], v74 offset:19456
  ds_read_b128 a[8:11], v76 offset:46080
  s_waitcnt lgkmcnt(6)
  v_mfma_f32_32x32x16_bf16 v[184:199], a[44:47], a[48:51], v[184:199]
  ds_read_b64_tr_b16 a[12:13], v74 offset:20480
  ds_read_b64_tr_b16 a[14:15], v74 offset:21504
  ds_read_b128 a[16:19], v76 offset:47104
  v_mfma_f32_32x32x16_bf16 v[184:199], a[52:55], a[56:59], v[184:199]
  ds_read_b64_tr_b16 a[20:21], v74 offset:22528
  ds_read_b64_tr_b16 a[22:23], v74 offset:23552
  ds_read_b128 a[24:27], v76 offset:48128
  s_waitcnt lgkmcnt(6)
  v_mfma_f32_32x32x16_bf16 v[184:199], a[60:63], a[0:3], v[184:199]
  v_mfma_f32_32x32x16_bf16 v[184:199], a[4:7], a[8:11], v[184:199]
  s_waitcnt lgkmcnt(0)
  v_mfma_f32_32x32x16_bf16 v[184:199], a[12:15], a[16:19], v[184:199]
  v_mfma_f32_32x32x16_bf16 v[184:199], a[20:23], a[24:27], v[184:199]
  s_waitcnt vmcnt(5)
  v_max3_u32 v64, v200, v201, v202
  s_waitcnt vmcnt(4)
  v_max3_u32 v65, v203, v204, v205
  v_max3_u32 v64, v64, v206, v207
  s_waitcnt vmcnt(3)
  v_max3_u32 v65, v65, v208, v209
  v_max3_u32 v64, v64, v210, v211
  s_waitcnt vmcnt(2)
  v_max3_u32 v65, v65, v212, v213
  v_max3_u32 v64, v64, v214, v215
  s_waitcnt vmcnt(1)
  v_max3_u32 v65, v65, v216, v217
  v_max3_u32 v64, v64, v218, v219
  s_waitcnt vmcnt(0)
  v_max3_u32 v65, v65, v220, v221
  v_max3_u32 v64, v64, v222, v223
  v_max_u32 v64, v64, v65
  v_cmp_eq_u32 vcc, -1, v64
  s_nop 0
  s_cbranch_vccnz L3_slow_p
L3_res_p:
  v_dot2c_f32_bf16 v184, s94, v200
  v_dot2c_f32_bf16 v185, s99, v200
  v_dot2c_f32_bf16 v186, s94, v201
  v_dot2c_f32_bf16 v187, s99, v201
  v_dot2c_f32_bf16 v188, s94, v202
  v_dot2c_f32_bf16 v189, s99, v202
  v_dot2c_f32_bf16 v190, s94, v203
  v_dot2c_f32_bf16 v191, s99, v203
  v_dot2c_f32_bf16 v192, s94, v204
  v_dot2c_f32_bf16 v193, s99, v204
  v_dot2c_f32_bf16 v194, s94, v205
  v_dot2c_f32_bf16 v195, s99, v205
  v_dot2c_f32_bf16 v196, s94, v206
  v_dot2c_f32_bf16 v197, s99, v206
  v_dot2c_f32_bf16 v198, s94, v207
  v_dot2c_f32_bf16 v199, s99, v207
  v_dot2c_f32_bf16 v184, s94, v208
  v_dot2c_f32_bf16 v185, s99, v208
  v_dot2c_f32_bf16 v186, s94, v209
  v_dot2c_f32_bf16 v187, s99, v209
  v_dot2c_f32_bf16 v188, s94, v210
  v_dot2c_f32_bf16 v189, s99, v210
  v_dot2c_f32_bf16 v190, s94, v211
  v_dot2c_f32_bf16 v191, s99, v211
  v_dot2c_f32_bf16 v192, s94, v212
  v_dot2c_f32_bf16 v193, s99, v212
  v_dot2c_f32_bf16 v194, s94, v213
  v_dot2c_f32_bf16 v195, s99, v213
  v_dot2c_f32_bf16 v196, s94, v214
  v_dot2c_f32_bf16 v197, s99, v214
  v_dot2c_f32_bf16 v198, s94, v215
  v_dot2c_f32_bf16 v199, s99, v215
  v_dot2c_f32_bf16 v184, s94, v216
  v_dot2c_f32_bf16 v185, s99, v216
  v_dot2c_f32_bf16 v186, s94, v217
  v_dot2c_f32_bf16 v187, s99, v217
  v_dot2c_f32_bf16 v188, s94, v218
  v_dot2c_f32_bf16 v189, s99, v218
  v_dot2c_f32_bf16 v190, s94, v219
  v_dot2c_f32_bf16 v191, s99, v219
  v_dot2c_f32_bf16 v192, s94, v220
  v_dot2c_f32_bf16 v193, s99, v220
  v_dot2c_f32_bf16 v194, s94, v221
  v_dot2c_f32_bf16 v195, s99, v221
  v_dot2c_f32_bf16 v196, s94, v222
  v_dot2c_f32_bf16 v197, s99, v222
  v_dot2c_f32_bf16 v198, s94, v223
  v_dot2c_f32_bf16 v199, s99, v223
  v_cvt_pk_bf16_f32 v100, v184, v185
  v_cvt_pk_bf16_f32 v101, v186, v187
  v_cvt_pk_bf16_f32 v102, v188, v189
  v_cvt_pk_bf16_f32 v103, v190, v191
  s_nop 0
  v_permlane32_swap_b32 v100, v102
  v_permlane32_swap_b32 v101, v103
  buffer_store_dwordx4 v[100:103], v81, s[64:67], s93 offen
  v_cvt_pk_bf16_f32 v104, v192, v193
  v_cvt_pk_bf16_f32 v105, v194, v195
  v_cvt_pk_bf16_f32 v106, v196, v197
  v_cvt_pk_bf16_f32 v107, v198, v199
  s_nop 0
  v_permlane32_swap_b32 v104, v106
  v_permlane32_swap_b32 v105, v107
  buffer_store_dwordx4 v[104:107], v81, s[64:67], s93 offen offset:32
  s_endpgm
L3_slow_ka:
  s_mov_b32 s18, 20000
L3_slowl_ka:
  s_sleep 1
  buffer_load_dwordx2 v[36:37], v30, s[60:63], 0 offen sc1
  s_waitcnt vmcnt(0)
  v_cmp_eq_u64 vcc, v[36:37], v[34:35]
  s_nop 1
  s_cmp_eq_u64 vcc, -1
  s_cbranch_scc1 L3_res_ka
  s_sub_u32 s18, s18, 1
  s_cmp_lg_u32 s18, 0
  s_cbranch_scc1 L3_slowl_ka
  s_branch L3_res_ka
L3_slow_kh:
  s_mov_b32 s18, 20000
L3_slowl_kh:
  s_sleep 1
  buffer_load_dwordx2 v[36:37], v31, s[60:63], 0 offen sc1
  s_waitcnt vmcnt(0)
  v_cmp_eq_u64 vcc, v[36:37], v[34:35]
  s_nop 1
  s_cmp_eq_u64 vcc, -1
  s_cbranch_scc1 L3_res_kh
  s_sub_u32 s18, s18, 1
  s_cmp_lg_u32 s18, 0
  s_cbranch_scc1 L3_slowl_kh
  s_branch L3_res_kh
L3_slow_nonce:
  s_mov_b32 s18, 20000
L3_slowl_nonce:
  s_sleep 1
  v_mov_b32 v71, 0
  buffer_load_dwordx2 v[34:35], v71, s[68:71], 0 offen sc1
  s_waitcnt vmcnt(0)
  v_cmp_ne_u32 vcc, 0, v34
  s_nop 1
  s_cmp_eq_u64 vcc, -1
  s_cbranch_scc1 L3_res_nonce
  s_sub_u32 s18, s18, 1
  s_cmp_lg_u32 s18, 0
  s_cbranch_scc1 L3_slowl_nonce
  s_branch L3_res_nonce
L3_slow_p:
  s_mov_b32 s18, 20000
L3_slowl_p:
  buffer_load_dwordx4 v[200:203], v1, s[60:63], s90 offen sc1
  buffer_load_dwordx4 v[204:207], v1, s[60:63], s90 offen offset:1024 sc1
  buffer_load_dwordx4 v[208:211], v1, s[60:63], s91 offen sc1
  buffer_load_dwordx4 v[212:215], v1, s[60:63], s91 offen offset:1024 sc1
  buffer_load_dwordx4 v[216:219], v1, s[60:63], s92 offen sc1
  buffer_load_dwordx4 v[220:223], v1, s[60:63], s92 offen offset:1024 sc1
  s_waitcnt vmcnt(0)
  v_max3_u32 v64, v200, v201, v202
  v_max3_u32 v65, v203, v204, v205
  v_max3_u32 v64, v64, v206, v207
  v_max3_u32 v65, v65, v208, v209
  v_max3_u32 v64, v64, v210, v211
  v_max3_u32 v65, v65, v212, v213
  v_max3_u32 v64, v64, v214, v215
  v_max3_u32 v65, v65, v216, v217
  v_max3_u32 v64, v64, v218, v219
  v_max3_u32 v65, v65, v220, v221
  v_max3_u32 v64, v64, v222, v223
  v_max_u32 v64, v64, v65
  v_cmp_eq_u32 vcc, -1, v64
  s_nop 1
  s_cbranch_vccz L3_res_p
  s_sub_u32 s18, s18, 1
  s_cmp_lg_u32 s18, 0
  s_cbranch_scc1 L3_slowl_p
  s_branch L3_res_p
Lc_code_end:
.section .rodata,"a"
.p2align 6
.amdhsa_kernel parallel_sum__spectral_fnet__geglu_ffn__prompt_kernel
  .amdhsa_next_free_vgpr 512
  .amdhsa_next_free_sgpr 102
  .amdhsa_accum_offset 256
  .amdhsa_group_segment_fixed_size 0
  .amdhsa_kernarg_size 96
  .amdhsa_user_sgpr_count 2
  .amdhsa_user_sgpr_kernarg_segment_ptr 1
  .amdhsa_system_sgpr_workgroup_id_x 1
.end_amdhsa_kernel
```
